```python
import torch

def _softmax(x, axis=-1):
    return torch.softmax(x, dim=axis)
def _gelu(x):
    return torch.nn.functional.gelu(x, approximate="tanh")
def _silu(x):
    return torch.nn.functional.silu(x)
def _sigmoid(x):
    return torch.sigmoid(x)
def _layernorm(x, axis=-1, eps=1e-5):
    m = x.mean(dim=axis, keepdim=True)
    v = x.var(dim=axis, keepdim=True, unbiased=False)
    return (x - m) / torch.sqrt(v + eps)
def _scatter_add(tgt, idx, src, axis=0):
    return tgt.clone().index_add_(axis, idx, src)
def _segment_sum(src, seg, n):
    out = torch.zeros((n,) + src.shape[1:], dtype=src.dtype)
    return out.index_add_(0, seg, src)
def _pad(x, pw):
    flat = tuple(v for pair in reversed(pw) for v in pair)
    return torch.nn.functional.pad(x, flat)

kernel_name = 'parallel_sum__softmax_full_mha__dense_activation_silu__prompt'

def setup_inputs():

    _w = (lambda a: (lambda t: t.to(torch.bfloat16) if t.is_floating_point() else t)(torch.as_tensor(a)))
    def _A_setup():
        B, S, D = 1, 2048, 1024
        return {
            "x": _w((lambda *s: torch.randn(*s, dtype=torch.bfloat16) * 0.05)(B, S, D)),
            "wqkv": _w((lambda *s: torch.randn(*s, dtype=torch.bfloat16) * 0.05)(D, 3 * D)),
            "wo": _w((lambda *s: torch.randn(*s, dtype=torch.bfloat16) * 0.05)(D, D)),
        }
    _A_in = _A_setup()

    def _B_setup():
        B, S, D, F = 1, 2048, 1024, 3584
        return {
            "x": _w((lambda *s: torch.randn(*s, dtype=torch.bfloat16) * 0.05)(B, S, D)),
            "w1": _w((lambda *s: torch.randn(*s, dtype=torch.bfloat16) * 3.2)(D, F) * (D ** -0.5)),
            "w2": _w((lambda *s: torch.randn(*s, dtype=torch.bfloat16) * 0.4)(F, D) * (F ** -0.5)),
        }
    _B_in = _B_setup()

    return {
        "A_x": _A_in["x"],
        "A_wqkv": _A_in["wqkv"],
        "A_wo": _A_in["wo"],
        "B_x": _B_in["x"],
        "B_w1": _B_in["w1"],
        "B_w2": _B_in["w2"],
    }

def reference(A_x, A_wqkv, A_wo, B_x, B_w1, B_w2):
    def _A_ref(x, wqkv, wo):
        B, S, D = x.shape
        H = 32; Dh = D // H
        qkv = (lambda x, *d: x.permute(*d))((x @ wqkv).reshape(B, S, 3, H, Dh), 2, 0, 3, 1, 4)
        q, k, v = qkv[0], qkv[1], qkv[2]
        scale = Dh ** -0.5
        scores = torch.einsum("bhqd,bhkd->bhqk", q, k) * scale
        p = _softmax(scores, axis=-1)
        o = torch.einsum("bhqk,bhkd->bhqd", p, v)
        return (lambda x, *d: x.permute(*d))(o, 0, 2, 1, 3).reshape(B, S, D) @ wo

    def _B_ref(x, w1, w2):
        h = torch.einsum("bsd,df->bsf", x, w1)
        h = _silu(h)
        out = torch.einsum("bsf,fd->bsd", h, w2)
        return out

    x = A_x
    xn = _layernorm(x, axis=-1)
    return x + _A_ref(xn, A_wqkv, A_wo) + _B_ref(xn, B_w1, B_w2)
```

```asm
; @launch grid=(256,1,1) block=(256,1,1) lds=163840
.amdgcn_target "amdgcn-amd-amdhsa--gfx950"
.text
.globl parallel_sum__softmax_full_mha__dense_activation_silu__prompt_kernel
.p2align 8
.type parallel_sum__softmax_full_mha__dense_activation_silu__prompt_kernel,@function
parallel_sum__softmax_full_mha__dense_activation_silu__prompt_kernel:
    s_cmp_ge_u32 s2, 256
    s_cbranch_scc1 parallel_sum__softmax_full_mha__dense_activation_silu__prompt_kernel_end
    s_getpc_b64 s[44:45]
parallel_sum__softmax_full_mha__dense_activation_silu__prompt_kernel_pc:
    s_sub_u32 s44, s44, parallel_sum__softmax_full_mha__dense_activation_silu__prompt_kernel_pc - parallel_sum__softmax_full_mha__dense_activation_silu__prompt_kernel
    s_subb_u32 s45, s45, 0
    s_lshr_b32 s3, s2, 3
    s_lshl_b32 s3, s3, 12
    v_lshl_add_u32 v12, v0, 4, s3
    v_min_u32 v12, parallel_sum__softmax_full_mha__dense_activation_silu__prompt_kernel_codeend - parallel_sum__softmax_full_mha__dense_activation_silu__prompt_kernel - 16, v12
    v_mov_b32 v13, s45
    v_add_co_u32 v12, vcc, s44, v12
    s_nop 1
    v_addc_co_u32 v13, vcc, 0, v13, vcc
    global_load_dwordx4 v[48:51], v[12:13], off
    s_load_dwordx2 s[40:41], s[0:1], 0
    s_load_dwordx2 s[4:5], s[0:1], 8
    s_load_dwordx2 s[6:7], s[0:1], 32
    s_load_dwordx2 s[28:29], s[0:1], 64
    s_load_dwordx2 s[42:43], s[0:1], 56
    v_lshrrev_b32 v1, 6, v0
    v_and_b32 v0, 63, v0
    s_nop 0
    v_readfirstlane_b32 s24, v1
    v_and_b32 v2, 3, v0
    s_lshl_b32 s3, s2, 3
    s_lshl_b32 s30, s24, 2
    s_add_u32 s3, s3, s30
    v_add_u32 v2, s3, v2
    v_lshlrev_b32 v2, 11, v2
    v_lshrrev_b32 v3, 4, v0
    v_lshl_add_u32 v2, v3, 6, v2
    v_bfe_u32 v3, v0, 2, 2
    v_lshl_add_u32 v2, v3, 3, v2
    s_waitcnt lgkmcnt(0)
    s_add_u32 s36, s28, 46301184
    s_addc_u32 s37, s29, 0
    s_load_dword s94, s[36:37], 0
    s_cmp_ge_u32 s24, 2
    s_cbranch_scc1 parallel_sum__softmax_full_mha__dense_activation_silu__prompt_kernel_nox
    s_mov_b32 s44, s40
    s_mov_b32 s45, s41
    s_mov_b32 s46, 4194304
    s_mov_b32 s47, 0x00020000
    buffer_load_dwordx2 v[16:17], v2, s[44:47], 0 offen offset:0
    buffer_load_dwordx2 v[18:19], v2, s[44:47], 0 offen offset:32
    buffer_load_dwordx2 v[20:21], v2, s[44:47], 0 offen offset:256
    buffer_load_dwordx2 v[22:23], v2, s[44:47], 0 offen offset:288
    buffer_load_dwordx2 v[24:25], v2, s[44:47], 0 offen offset:512
    buffer_load_dwordx2 v[26:27], v2, s[44:47], 0 offen offset:544
    buffer_load_dwordx2 v[28:29], v2, s[44:47], 0 offen offset:768
    buffer_load_dwordx2 v[30:31], v2, s[44:47], 0 offen offset:800
    buffer_load_dwordx2 v[32:33], v2, s[44:47], 0 offen offset:1024
    buffer_load_dwordx2 v[34:35], v2, s[44:47], 0 offen offset:1056
    buffer_load_dwordx2 v[36:37], v2, s[44:47], 0 offen offset:1280
    buffer_load_dwordx2 v[38:39], v2, s[44:47], 0 offen offset:1312
    buffer_load_dwordx2 v[40:41], v2, s[44:47], 0 offen offset:1536
    buffer_load_dwordx2 v[42:43], v2, s[44:47], 0 offen offset:1568
    buffer_load_dwordx2 v[44:45], v2, s[44:47], 0 offen offset:1792
    buffer_load_dwordx2 v[46:47], v2, s[44:47], 0 offen offset:1824
parallel_sum__softmax_full_mha__dense_activation_silu__prompt_kernel_nox:
    s_and_b32 s26, s2, 7
    s_lshr_b32 s25, s2, 3
    s_and_b32 s3, s25, 3
    s_lshr_b32 s25, s25, 2
    s_lshl_b32 s26, s26, 1
    s_and_b32 s30, s3, 1
    s_add_u32 s26, s26, s30
    s_lshr_b32 s3, s3, 1
    s_lshl_b32 s3, s3, 4
    s_add_u32 s26, s26, s3
    s_lshl_b32 s3, s25, 2
    s_add_u32 s3, s3, s24
    s_lshl_b32 s3, s3, 17
    v_lshlrev_b32 v1, 4, v0
    v_add_u32 v1, s3, v1
    s_and_b32 s31, s26, 1
    s_lshl_b32 s31, s31, 1
    s_mul_i32 s32, s26, 224
    s_lshl_b32 s33, s26, 6
    s_lshl_b32 s3, s24, 4
    s_add_u32 s3, s3, 384
    v_and_b32 v11, 15, v0
    v_add_u32 v11, s3, v11
    v_mul_u32_u24 v12, 4682, v11
    v_lshrrev_b32 v12, 16, v12
    v_mul_u32_u24 v13, 14, v12
    v_sub_u32 v13, v11, v13
    v_add_u32 v13, s31, v13
    v_subrev_u32 v14, 14, v13
    v_cmp_le_u32 vcc, 14, v13
    s_nop 1
    v_cndmask_b32 v13, v13, v14, vcc
    v_mul_u32_u24 v12, 7168, v12
    v_lshl_add_u32 v12, v13, 4, v12
    v_add_u32 v5, s32, v12
    s_cmp_lt_u32 s24, 2
    s_cbranch_scc0 parallel_sum__softmax_full_mha__dense_activation_silu__prompt_kernel_fsetup
    s_mul_i32 s3, s24, 192
    v_add_u32 v11, s3, v0
    v_mul_u32_u24 v12, 5462, v11
    v_lshrrev_b32 v12, 16, v12
    v_mul_u32_u24 v13, 12, v12
    v_sub_u32 v13, v11, v13
    v_lshrrev_b32 v14, 1, v13
    v_bfe_u32 v15, v12, 2, 1
    v_xor_b32 v14, v14, v15
    v_and_b32 v13, 1, v13
    v_lshlrev_b32 v13, 4, v13
    v_and_b32 v15, 1, v14
    v_lshl_add_u32 v13, v15, 5, v13
    v_lshrrev_b32 v14, 1, v14
    v_lshl_add_u32 v13, v14, 11, v13
    v_mul_u32_u24 v12, 6144, v12
    v_add_u32 v12, v12, v13
    v_add_u32 v2, s33, v12
    v_add_u32 v11, s3, v0
    v_add_u32 v11, 64, v11
    v_mul_u32_u24 v12, 5462, v11
    v_lshrrev_b32 v12, 16, v12
    v_mul_u32_u24 v13, 12, v12
    v_sub_u32 v13, v11, v13
    v_lshrrev_b32 v14, 1, v13
    v_bfe_u32 v15, v12, 2, 1
    v_xor_b32 v14, v14, v15
    v_and_b32 v13, 1, v13
    v_lshlrev_b32 v13, 4, v13
    v_and_b32 v15, 1, v14
    v_lshl_add_u32 v13, v15, 5, v13
    v_lshrrev_b32 v14, 1, v14
    v_lshl_add_u32 v13, v14, 11, v13
    v_mul_u32_u24 v12, 6144, v12
    v_add_u32 v12, v12, v13
    v_add_u32 v3, s33, v12
    v_add_u32 v11, s3, v0
    v_add_u32 v11, 128, v11
    v_mul_u32_u24 v12, 5462, v11
    v_lshrrev_b32 v12, 16, v12
    v_mul_u32_u24 v13, 12, v12
    v_sub_u32 v13, v11, v13
    v_lshrrev_b32 v14, 1, v13
    v_bfe_u32 v15, v12, 2, 1
    v_xor_b32 v14, v14, v15
    v_and_b32 v13, 1, v13
    v_lshlrev_b32 v13, 4, v13
    v_and_b32 v15, 1, v14
    v_lshl_add_u32 v13, v15, 5, v13
    v_lshrrev_b32 v14, 1, v14
    v_lshl_add_u32 v13, v14, 11, v13
    v_mul_u32_u24 v12, 6144, v12
    v_add_u32 v12, v12, v13
    v_add_u32 v4, s33, v12
    s_mul_i32 s27, s24, 3072
    s_mov_b32 s23, 196608
    s_branch parallel_sum__softmax_full_mha__dense_activation_silu__prompt_kernel_setup2
parallel_sum__softmax_full_mha__dense_activation_silu__prompt_kernel_fsetup:
    s_sub_u32 s3, s24, 2
    s_mul_i32 s3, s3, 192
    v_add_u32 v11, s3, v0
    v_mul_u32_u24 v12, 4682, v11
    v_lshrrev_b32 v12, 16, v12
    v_mul_u32_u24 v13, 14, v12
    v_sub_u32 v13, v11, v13
    v_add_u32 v13, s31, v13
    v_subrev_u32 v14, 14, v13
    v_cmp_le_u32 vcc, 14, v13
    s_nop 1
    v_cndmask_b32 v13, v13, v14, vcc
    v_mul_u32_u24 v12, 7168, v12
    v_lshl_add_u32 v12, v13, 4, v12
    v_add_u32 v2, s32, v12
    v_add_u32 v11, s3, v0
    v_add_u32 v11, 64, v11
    v_mul_u32_u24 v12, 4682, v11
    v_lshrrev_b32 v12, 16, v12
    v_mul_u32_u24 v13, 14, v12
    v_sub_u32 v13, v11, v13
    v_add_u32 v13, s31, v13
    v_subrev_u32 v14, 14, v13
    v_cmp_le_u32 vcc, 14, v13
    s_nop 1
    v_cndmask_b32 v13, v13, v14, vcc
    v_mul_u32_u24 v12, 7168, v12
    v_lshl_add_u32 v12, v13, 4, v12
    v_add_u32 v3, s32, v12
    v_add_u32 v11, s3, v0
    v_add_u32 v11, 128, v11
    v_mul_u32_u24 v12, 4682, v11
    v_lshrrev_b32 v12, 16, v12
    v_mul_u32_u24 v13, 14, v12
    v_sub_u32 v13, v11, v13
    v_add_u32 v13, s31, v13
    v_subrev_u32 v14, 14, v13
    v_cmp_le_u32 vcc, 14, v13
    s_nop 1
    v_cndmask_b32 v13, v13, v14, vcc
    v_mul_u32_u24 v12, 7168, v12
    v_lshl_add_u32 v12, v13, 4, v12
    v_add_u32 v4, s32, v12
    s_sub_u32 s27, s24, 2
    s_mul_i32 s27, s27, 3072
    s_add_u32 s27, s27, 6144
    s_mov_b32 s23, 229376
parallel_sum__softmax_full_mha__dense_activation_silu__prompt_kernel_setup2:
    s_lshl_b32 s30, s24, 8
    s_add_u32 s30, s30, 12288
    v_lshrrev_b32 v11, 2, v0
    v_and_b32 v12, 3, v0
    v_lshlrev_b32 v12, 3, v12
    v_bfe_u32 v13, v0, 4, 1
    v_lshlrev_b32 v13, 5, v13
    v_mul_u32_u24 v14, 192, v11
    v_add_u32 v14, v14, v12
    v_add_u32 v6, v14, v13
    v_sub_u32 v7, v14, v13
    v_mul_u32_u24 v14, 224, v11
    v_add_u32 v8, v14, v12
    v_add_u32 v9, 53248, v6
    v_add_u32 v10, 53248, v7
    v_add_u32 v11, 53248, v8
    s_waitcnt lgkmcnt(0)
    s_mov_b32 s8, s28
    s_mov_b32 s9, s29
    s_mov_b32 s10, 4194304
    s_mov_b32 s11, 0x00020000
    s_mov_b32 s16, s6
    s_mov_b32 s17, s7
    s_mov_b32 s18, 7340032
    s_mov_b32 s19, 0x00020000
    s_cmp_lt_u32 s24, 2
    s_cselect_b32 s12, s4, s6
    s_cselect_b32 s13, s5, s7
    s_mov_b32 s3, 6291456
    s_cselect_b32 s14, s3, 7340032
    s_mov_b32 s15, 0x00020000
    s_mov_b32 s20, 0
    s_mov_b32 s21, 0
    s_mov_b32 s22, 0
    s_add_u32 m0, s27, 0
    s_nop 0
    buffer_load_dwordx4 v2, s[12:15], s21 offen lds
    s_add_u32 m0, s27, 1024
    s_nop 0
    buffer_load_dwordx4 v3, s[12:15], s21 offen lds
    s_add_u32 m0, s27, 2048
    s_nop 0
    buffer_load_dwordx4 v4, s[12:15], s21 offen lds
    s_add_u32 s21, s21, s23
    s_add_u32 m0, s30, 0
    s_mov_b64 exec, 0xffff
    buffer_load_dwordx4 v5, s[16:19], s22 offen lds
    s_mov_b64 exec, -1
    s_add_u32 s22, s22, 229376
    s_add_u32 m0, s27, 13312
    s_nop 0
    buffer_load_dwordx4 v2, s[12:15], s21 offen lds
    s_add_u32 m0, s27, 14336
    s_nop 0
    buffer_load_dwordx4 v3, s[12:15], s21 offen lds
    s_add_u32 m0, s27, 15360
    s_nop 0
    buffer_load_dwordx4 v4, s[12:15], s21 offen lds
    s_add_u32 s21, s21, s23
    s_add_u32 m0, s30, 13312
    s_mov_b64 exec, 0xffff
    buffer_load_dwordx4 v5, s[16:19], s22 offen lds
    s_mov_b64 exec, -1
    s_add_u32 s22, s22, 229376
    s_cmp_ge_u32 s24, 2
    s_cbranch_scc1 parallel_sum__softmax_full_mha__dense_activation_silu__prompt_kernel_pf
    s_add_u32 s32, s28, 46137344
    s_addc_u32 s33, s29, 0
    s_mov_b32 s34, 196608
    s_mov_b32 s35, 0x00020000
    s_mov_b32 s36, 0xffff0000
    s_waitcnt vmcnt(8)
    v_lshlrev_b32 v48, 16, v16
    v_and_b32 v49, s36, v16
    v_lshlrev_b32 v50, 16, v17
    v_and_b32 v51, s36, v17
    v_lshlrev_b32 v52, 16, v18
    v_and_b32 v53, s36, v18
    v_lshlrev_b32 v54, 16, v19
    v_and_b32 v55, s36, v19
    v_lshlrev_b32 v56, 16, v20
    v_and_b32 v57, s36, v20
    v_lshlrev_b32 v58, 16, v21
    v_and_b32 v59, s36, v21
    v_lshlrev_b32 v60, 16, v22
    v_and_b32 v61, s36, v22
    v_lshlrev_b32 v62, 16, v23
    v_and_b32 v63, s36, v23
    v_lshlrev_b32 v64, 16, v24
    v_and_b32 v65, s36, v24
    v_lshlrev_b32 v66, 16, v25
    v_and_b32 v67, s36, v25
    v_lshlrev_b32 v68, 16, v26
    v_and_b32 v69, s36, v26
    v_lshlrev_b32 v70, 16, v27
    v_and_b32 v71, s36, v27
    v_lshlrev_b32 v72, 16, v28
    v_and_b32 v73, s36, v28
    v_lshlrev_b32 v74, 16, v29
    v_and_b32 v75, s36, v29
    v_lshlrev_b32 v76, 16, v30
    v_and_b32 v77, s36, v30
    v_lshlrev_b32 v78, 16, v31
    v_and_b32 v79, s36, v31
    v_lshlrev_b32 v80, 16, v32
    v_and_b32 v81, s36, v32
    v_lshlrev_b32 v82, 16, v33
    v_and_b32 v83, s36, v33
    v_lshlrev_b32 v84, 16, v34
    v_and_b32 v85, s36, v34
    v_lshlrev_b32 v86, 16, v35
    v_and_b32 v87, s36, v35
    v_lshlrev_b32 v88, 16, v36
    v_and_b32 v89, s36, v36
    v_lshlrev_b32 v90, 16, v37
    v_and_b32 v91, s36, v37
    v_lshlrev_b32 v92, 16, v38
    v_and_b32 v93, s36, v38
    v_lshlrev_b32 v94, 16, v39
    v_and_b32 v95, s36, v39
    v_lshlrev_b32 v96, 16, v40
    v_and_b32 v97, s36, v40
    v_lshlrev_b32 v98, 16, v41
    v_and_b32 v99, s36, v41
    v_lshlrev_b32 v100, 16, v42
    v_and_b32 v101, s36, v42
    v_lshlrev_b32 v102, 16, v43
    v_and_b32 v103, s36, v43
    v_lshlrev_b32 v104, 16, v44
    v_and_b32 v105, s36, v44
    v_lshlrev_b32 v106, 16, v45
    v_and_b32 v107, s36, v45
    v_lshlrev_b32 v108, 16, v46
    v_and_b32 v109, s36, v46
    v_lshlrev_b32 v110, 16, v47
    v_and_b32 v111, s36, v47
    v_pk_add_f32 v[112:113], v[48:49], v[50:51]
    v_pk_add_f32 v[114:115], v[52:53], v[54:55]
    v_pk_add_f32 v[112:113], v[112:113], v[56:57]
    v_pk_add_f32 v[114:115], v[114:115], v[58:59]
    v_pk_add_f32 v[112:113], v[112:113], v[60:61]
    v_pk_add_f32 v[114:115], v[114:115], v[62:63]
    v_pk_add_f32 v[112:113], v[112:113], v[64:65]
    v_pk_add_f32 v[114:115], v[114:115], v[66:67]
    v_pk_add_f32 v[112:113], v[112:113], v[68:69]
    v_pk_add_f32 v[114:115], v[114:115], v[70:71]
    v_pk_add_f32 v[112:113], v[112:113], v[72:73]
    v_pk_add_f32 v[114:115], v[114:115], v[74:75]
    v_pk_add_f32 v[112:113], v[112:113], v[76:77]
    v_pk_add_f32 v[114:115], v[114:115], v[78:79]
    v_pk_add_f32 v[112:113], v[112:113], v[80:81]
    v_pk_add_f32 v[114:115], v[114:115], v[82:83]
    v_pk_add_f32 v[112:113], v[112:113], v[84:85]
    v_pk_add_f32 v[114:115], v[114:115], v[86:87]
    v_pk_add_f32 v[112:113], v[112:113], v[88:89]
    v_pk_add_f32 v[114:115], v[114:115], v[90:91]
    v_pk_add_f32 v[112:113], v[112:113], v[92:93]
    v_pk_add_f32 v[114:115], v[114:115], v[94:95]
    v_pk_add_f32 v[112:113], v[112:113], v[96:97]
    v_pk_add_f32 v[114:115], v[114:115], v[98:99]
    v_pk_add_f32 v[112:113], v[112:113], v[100:101]
    v_pk_add_f32 v[114:115], v[114:115], v[102:103]
    v_pk_add_f32 v[112:113], v[112:113], v[104:105]
    v_pk_add_f32 v[114:115], v[114:115], v[106:107]
    v_pk_add_f32 v[112:113], v[112:113], v[108:109]
    v_pk_add_f32 v[114:115], v[114:115], v[110:111]
    v_pk_add_f32 v[112:113], v[112:113], v[114:115]
    v_add_f32 v14, v112, v113
    s_nop 1
    v_add_f32_dpp v14, v14, v14 row_ror:4 row_mask:0xf bank_mask:0xf
    s_nop 1
    v_add_f32_dpp v14, v14, v14 row_ror:8 row_mask:0xf bank_mask:0xf
    v_mov_b32 v13, v14
    s_nop 1
    v_permlane16_swap_b32 v14, v13
    s_nop 1
    v_add_f32 v14, v14, v13
    v_mov_b32 v13, v14
    s_nop 1
    v_permlane32_swap_b32 v14, v13
    s_nop 1
    v_add_f32 v14, v14, v13
    v_mul_f32 v116, 0x3a800000, v14
    v_mov_b32 v117, v116
    v_pk_add_f32 v[118:119], v[48:49], v[116:117] neg_lo:[0,1] neg_hi:[0,1]
    v_pk_mul_f32 v[112:113], v[118:119], v[118:119]
    v_pk_add_f32 v[120:121], v[50:51], v[116:117] neg_lo:[0,1] neg_hi:[0,1]
    v_pk_mul_f32 v[114:115], v[120:121], v[120:121]
    v_pk_add_f32 v[118:119], v[52:53], v[116:117] neg_lo:[0,1] neg_hi:[0,1]
    v_pk_fma_f32 v[112:113], v[118:119], v[118:119], v[112:113]
    v_pk_add_f32 v[120:121], v[54:55], v[116:117] neg_lo:[0,1] neg_hi:[0,1]
    v_pk_fma_f32 v[114:115], v[120:121], v[120:121], v[114:115]
    v_pk_add_f32 v[118:119], v[56:57], v[116:117] neg_lo:[0,1] neg_hi:[0,1]
    v_pk_fma_f32 v[112:113], v[118:119], v[118:119], v[112:113]
    v_pk_add_f32 v[120:121], v[58:59], v[116:117] neg_lo:[0,1] neg_hi:[0,1]
    v_pk_fma_f32 v[114:115], v[120:121], v[120:121], v[114:115]
    v_pk_add_f32 v[118:119], v[60:61], v[116:117] neg_lo:[0,1] neg_hi:[0,1]
    v_pk_fma_f32 v[112:113], v[118:119], v[118:119], v[112:113]
    v_pk_add_f32 v[120:121], v[62:63], v[116:117] neg_lo:[0,1] neg_hi:[0,1]
    v_pk_fma_f32 v[114:115], v[120:121], v[120:121], v[114:115]
    v_pk_add_f32 v[118:119], v[64:65], v[116:117] neg_lo:[0,1] neg_hi:[0,1]
    v_pk_fma_f32 v[112:113], v[118:119], v[118:119], v[112:113]
    v_pk_add_f32 v[120:121], v[66:67], v[116:117] neg_lo:[0,1] neg_hi:[0,1]
    v_pk_fma_f32 v[114:115], v[120:121], v[120:121], v[114:115]
    v_pk_add_f32 v[118:119], v[68:69], v[116:117] neg_lo:[0,1] neg_hi:[0,1]
    v_pk_fma_f32 v[112:113], v[118:119], v[118:119], v[112:113]
    v_pk_add_f32 v[120:121], v[70:71], v[116:117] neg_lo:[0,1] neg_hi:[0,1]
    v_pk_fma_f32 v[114:115], v[120:121], v[120:121], v[114:115]
    v_pk_add_f32 v[118:119], v[72:73], v[116:117] neg_lo:[0,1] neg_hi:[0,1]
    v_pk_fma_f32 v[112:113], v[118:119], v[118:119], v[112:113]
    v_pk_add_f32 v[120:121], v[74:75], v[116:117] neg_lo:[0,1] neg_hi:[0,1]
    v_pk_fma_f32 v[114:115], v[120:121], v[120:121], v[114:115]
    v_pk_add_f32 v[118:119], v[76:77], v[116:117] neg_lo:[0,1] neg_hi:[0,1]
    v_pk_fma_f32 v[112:113], v[118:119], v[118:119], v[112:113]
    v_pk_add_f32 v[120:121], v[78:79], v[116:117] neg_lo:[0,1] neg_hi:[0,1]
    v_pk_fma_f32 v[114:115], v[120:121], v[120:121], v[114:115]
    v_pk_add_f32 v[118:119], v[80:81], v[116:117] neg_lo:[0,1] neg_hi:[0,1]
    v_pk_fma_f32 v[112:113], v[118:119], v[118:119], v[112:113]
    v_pk_add_f32 v[120:121], v[82:83], v[116:117] neg_lo:[0,1] neg_hi:[0,1]
    v_pk_fma_f32 v[114:115], v[120:121], v[120:121], v[114:115]
    v_pk_add_f32 v[118:119], v[84:85], v[116:117] neg_lo:[0,1] neg_hi:[0,1]
    v_pk_fma_f32 v[112:113], v[118:119], v[118:119], v[112:113]
    v_pk_add_f32 v[120:121], v[86:87], v[116:117] neg_lo:[0,1] neg_hi:[0,1]
    v_pk_fma_f32 v[114:115], v[120:121], v[120:121], v[114:115]
    v_pk_add_f32 v[118:119], v[88:89], v[116:117] neg_lo:[0,1] neg_hi:[0,1]
    v_pk_fma_f32 v[112:113], v[118:119], v[118:119], v[112:113]
    v_pk_add_f32 v[120:121], v[90:91], v[116:117] neg_lo:[0,1] neg_hi:[0,1]
    v_pk_fma_f32 v[114:115], v[120:121], v[120:121], v[114:115]
    v_pk_add_f32 v[118:119], v[92:93], v[116:117] neg_lo:[0,1] neg_hi:[0,1]
    v_pk_fma_f32 v[112:113], v[118:119], v[118:119], v[112:113]
    v_pk_add_f32 v[120:121], v[94:95], v[116:117] neg_lo:[0,1] neg_hi:[0,1]
    v_pk_fma_f32 v[114:115], v[120:121], v[120:121], v[114:115]
    v_pk_add_f32 v[118:119], v[96:97], v[116:117] neg_lo:[0,1] neg_hi:[0,1]
    v_pk_fma_f32 v[112:113], v[118:119], v[118:119], v[112:113]
    v_pk_add_f32 v[120:121], v[98:99], v[116:117] neg_lo:[0,1] neg_hi:[0,1]
    v_pk_fma_f32 v[114:115], v[120:121], v[120:121], v[114:115]
    v_pk_add_f32 v[118:119], v[100:101], v[116:117] neg_lo:[0,1] neg_hi:[0,1]
    v_pk_fma_f32 v[112:113], v[118:119], v[118:119], v[112:113]
    v_pk_add_f32 v[120:121], v[102:103], v[116:117] neg_lo:[0,1] neg_hi:[0,1]
    v_pk_fma_f32 v[114:115], v[120:121], v[120:121], v[114:115]
    v_pk_add_f32 v[118:119], v[104:105], v[116:117] neg_lo:[0,1] neg_hi:[0,1]
    v_pk_fma_f32 v[112:113], v[118:119], v[118:119], v[112:113]
    v_pk_add_f32 v[120:121], v[106:107], v[116:117] neg_lo:[0,1] neg_hi:[0,1]
    v_pk_fma_f32 v[114:115], v[120:121], v[120:121], v[114:115]
    v_pk_add_f32 v[118:119], v[108:109], v[116:117] neg_lo:[0,1] neg_hi:[0,1]
    v_pk_fma_f32 v[112:113], v[118:119], v[118:119], v[112:113]
    v_pk_add_f32 v[120:121], v[110:111], v[116:117] neg_lo:[0,1] neg_hi:[0,1]
    v_pk_fma_f32 v[114:115], v[120:121], v[120:121], v[114:115]
    v_pk_add_f32 v[112:113], v[112:113], v[114:115]
    v_add_f32 v14, v112, v113
    s_nop 1
    v_add_f32_dpp v14, v14, v14 row_ror:4 row_mask:0xf bank_mask:0xf
    s_nop 1
    v_add_f32_dpp v14, v14, v14 row_ror:8 row_mask:0xf bank_mask:0xf
    v_mov_b32 v13, v14
    s_nop 1
    v_permlane16_swap_b32 v14, v13
    s_nop 1
    v_add_f32 v14, v14, v13
    v_mov_b32 v13, v14
    s_nop 1
    v_permlane32_swap_b32 v14, v13
    s_nop 1
    v_add_f32 v14, v14, v13
    v_mul_f32 v15, 0x3a800000, v14
    v_cvt_pk_bf16_f32 v13, v116, v15
    s_nop 0
    v_lshlrev_b32 v116, 16, v13
    v_mov_b32 v117, v116
    v_and_b32 v15, s36, v13
    v_add_f32 v15, 0x3727c5ac, v15
    v_cvt_pk_bf16_f32 v15, v15, v15
    s_nop 0
    v_and_b32 v15, s36, v15
    v_sqrt_f32 v15, v15
    s_nop 0
    v_cvt_pk_bf16_f32 v15, v15, v15
    s_nop 0
    v_and_b32 v15, s36, v15
    v_rcp_f32 v14, v15
    s_nop 0
    v_fma_f32 v13, -v15, v14, 1.0
    v_fma_f32 v14, v13, v14, v14
    v_mov_b32 v122, v14
    v_mov_b32 v123, v14
    v_pk_add_f32 v[118:119], v[48:49], v[116:117] neg_lo:[0,1] neg_hi:[0,1]
    v_cvt_pk_bf16_f32 v13, v118, v119
    s_nop 0
    v_lshlrev_b32 v118, 16, v13
    v_and_b32 v119, s36, v13
    v_pk_mul_f32 v[118:119], v[118:119], v[122:123]
    v_cvt_pk_bf16_f32 v16, v118, v119
    v_pk_add_f32 v[120:121], v[50:51], v[116:117] neg_lo:[0,1] neg_hi:[0,1]
    v_cvt_pk_bf16_f32 v13, v120, v121
    s_nop 0
    v_lshlrev_b32 v120, 16, v13
    v_and_b32 v121, s36, v13
    v_pk_mul_f32 v[120:121], v[120:121], v[122:123]
    v_cvt_pk_bf16_f32 v17, v120, v121
    v_pk_add_f32 v[118:119], v[52:53], v[116:117] neg_lo:[0,1] neg_hi:[0,1]
    v_cvt_pk_bf16_f32 v13, v118, v119
    s_nop 0
    v_lshlrev_b32 v118, 16, v13
    v_and_b32 v119, s36, v13
    v_pk_mul_f32 v[118:119], v[118:119], v[122:123]
    v_cvt_pk_bf16_f32 v18, v118, v119
    v_pk_add_f32 v[120:121], v[54:55], v[116:117] neg_lo:[0,1] neg_hi:[0,1]
    v_cvt_pk_bf16_f32 v13, v120, v121
    s_nop 0
    v_lshlrev_b32 v120, 16, v13
    v_and_b32 v121, s36, v13
    v_pk_mul_f32 v[120:121], v[120:121], v[122:123]
    v_cvt_pk_bf16_f32 v19, v120, v121
    v_pk_add_f32 v[118:119], v[56:57], v[116:117] neg_lo:[0,1] neg_hi:[0,1]
    v_cvt_pk_bf16_f32 v13, v118, v119
    s_nop 0
    v_lshlrev_b32 v118, 16, v13
    v_and_b32 v119, s36, v13
    v_pk_mul_f32 v[118:119], v[118:119], v[122:123]
    v_cvt_pk_bf16_f32 v20, v118, v119
    v_pk_add_f32 v[120:121], v[58:59], v[116:117] neg_lo:[0,1] neg_hi:[0,1]
    v_cvt_pk_bf16_f32 v13, v120, v121
    s_nop 0
    v_lshlrev_b32 v120, 16, v13
    v_and_b32 v121, s36, v13
    v_pk_mul_f32 v[120:121], v[120:121], v[122:123]
    v_cvt_pk_bf16_f32 v21, v120, v121
    v_pk_add_f32 v[118:119], v[60:61], v[116:117] neg_lo:[0,1] neg_hi:[0,1]
    v_cvt_pk_bf16_f32 v13, v118, v119
    s_nop 0
    v_lshlrev_b32 v118, 16, v13
    v_and_b32 v119, s36, v13
    v_pk_mul_f32 v[118:119], v[118:119], v[122:123]
    v_cvt_pk_bf16_f32 v22, v118, v119
    v_pk_add_f32 v[120:121], v[62:63], v[116:117] neg_lo:[0,1] neg_hi:[0,1]
    v_cvt_pk_bf16_f32 v13, v120, v121
    s_nop 0
    v_lshlrev_b32 v120, 16, v13
    v_and_b32 v121, s36, v13
    v_pk_mul_f32 v[120:121], v[120:121], v[122:123]
    v_cvt_pk_bf16_f32 v23, v120, v121
    v_pk_add_f32 v[118:119], v[64:65], v[116:117] neg_lo:[0,1] neg_hi:[0,1]
    v_cvt_pk_bf16_f32 v13, v118, v119
    s_nop 0
    v_lshlrev_b32 v118, 16, v13
    v_and_b32 v119, s36, v13
    v_pk_mul_f32 v[118:119], v[118:119], v[122:123]
    v_cvt_pk_bf16_f32 v24, v118, v119
    v_pk_add_f32 v[120:121], v[66:67], v[116:117] neg_lo:[0,1] neg_hi:[0,1]
    v_cvt_pk_bf16_f32 v13, v120, v121
    s_nop 0
    v_lshlrev_b32 v120, 16, v13
    v_and_b32 v121, s36, v13
    v_pk_mul_f32 v[120:121], v[120:121], v[122:123]
    v_cvt_pk_bf16_f32 v25, v120, v121
    v_pk_add_f32 v[118:119], v[68:69], v[116:117] neg_lo:[0,1] neg_hi:[0,1]
    v_cvt_pk_bf16_f32 v13, v118, v119
    s_nop 0
    v_lshlrev_b32 v118, 16, v13
    v_and_b32 v119, s36, v13
    v_pk_mul_f32 v[118:119], v[118:119], v[122:123]
    v_cvt_pk_bf16_f32 v26, v118, v119
    v_pk_add_f32 v[120:121], v[70:71], v[116:117] neg_lo:[0,1] neg_hi:[0,1]
    v_cvt_pk_bf16_f32 v13, v120, v121
    s_nop 0
    v_lshlrev_b32 v120, 16, v13
    v_and_b32 v121, s36, v13
    v_pk_mul_f32 v[120:121], v[120:121], v[122:123]
    v_cvt_pk_bf16_f32 v27, v120, v121
    v_pk_add_f32 v[118:119], v[72:73], v[116:117] neg_lo:[0,1] neg_hi:[0,1]
    v_cvt_pk_bf16_f32 v13, v118, v119
    s_nop 0
    v_lshlrev_b32 v118, 16, v13
    v_and_b32 v119, s36, v13
    v_pk_mul_f32 v[118:119], v[118:119], v[122:123]
    v_cvt_pk_bf16_f32 v28, v118, v119
    v_pk_add_f32 v[120:121], v[74:75], v[116:117] neg_lo:[0,1] neg_hi:[0,1]
    v_cvt_pk_bf16_f32 v13, v120, v121
    s_nop 0
    v_lshlrev_b32 v120, 16, v13
    v_and_b32 v121, s36, v13
    v_pk_mul_f32 v[120:121], v[120:121], v[122:123]
    v_cvt_pk_bf16_f32 v29, v120, v121
    v_pk_add_f32 v[118:119], v[76:77], v[116:117] neg_lo:[0,1] neg_hi:[0,1]
    v_cvt_pk_bf16_f32 v13, v118, v119
    s_nop 0
    v_lshlrev_b32 v118, 16, v13
    v_and_b32 v119, s36, v13
    v_pk_mul_f32 v[118:119], v[118:119], v[122:123]
    v_cvt_pk_bf16_f32 v30, v118, v119
    v_pk_add_f32 v[120:121], v[78:79], v[116:117] neg_lo:[0,1] neg_hi:[0,1]
    v_cvt_pk_bf16_f32 v13, v120, v121
    s_nop 0
    v_lshlrev_b32 v120, 16, v13
    v_and_b32 v121, s36, v13
    v_pk_mul_f32 v[120:121], v[120:121], v[122:123]
    v_cvt_pk_bf16_f32 v31, v120, v121
    v_pk_add_f32 v[118:119], v[80:81], v[116:117] neg_lo:[0,1] neg_hi:[0,1]
    v_cvt_pk_bf16_f32 v13, v118, v119
    s_nop 0
    v_lshlrev_b32 v118, 16, v13
    v_and_b32 v119, s36, v13
    v_pk_mul_f32 v[118:119], v[118:119], v[122:123]
    v_cvt_pk_bf16_f32 v32, v118, v119
    v_pk_add_f32 v[120:121], v[82:83], v[116:117] neg_lo:[0,1] neg_hi:[0,1]
    v_cvt_pk_bf16_f32 v13, v120, v121
    s_nop 0
    v_lshlrev_b32 v120, 16, v13
    v_and_b32 v121, s36, v13
    v_pk_mul_f32 v[120:121], v[120:121], v[122:123]
    v_cvt_pk_bf16_f32 v33, v120, v121
    v_pk_add_f32 v[118:119], v[84:85], v[116:117] neg_lo:[0,1] neg_hi:[0,1]
    v_cvt_pk_bf16_f32 v13, v118, v119
    s_nop 0
    v_lshlrev_b32 v118, 16, v13
    v_and_b32 v119, s36, v13
    v_pk_mul_f32 v[118:119], v[118:119], v[122:123]
    v_cvt_pk_bf16_f32 v34, v118, v119
    v_pk_add_f32 v[120:121], v[86:87], v[116:117] neg_lo:[0,1] neg_hi:[0,1]
    v_cvt_pk_bf16_f32 v13, v120, v121
    s_nop 0
    v_lshlrev_b32 v120, 16, v13
    v_and_b32 v121, s36, v13
    v_pk_mul_f32 v[120:121], v[120:121], v[122:123]
    v_cvt_pk_bf16_f32 v35, v120, v121
    v_pk_add_f32 v[118:119], v[88:89], v[116:117] neg_lo:[0,1] neg_hi:[0,1]
    v_cvt_pk_bf16_f32 v13, v118, v119
    s_nop 0
    v_lshlrev_b32 v118, 16, v13
    v_and_b32 v119, s36, v13
    v_pk_mul_f32 v[118:119], v[118:119], v[122:123]
    v_cvt_pk_bf16_f32 v36, v118, v119
    v_pk_add_f32 v[120:121], v[90:91], v[116:117] neg_lo:[0,1] neg_hi:[0,1]
    v_cvt_pk_bf16_f32 v13, v120, v121
    s_nop 0
    v_lshlrev_b32 v120, 16, v13
    v_and_b32 v121, s36, v13
    v_pk_mul_f32 v[120:121], v[120:121], v[122:123]
    v_cvt_pk_bf16_f32 v37, v120, v121
    v_pk_add_f32 v[118:119], v[92:93], v[116:117] neg_lo:[0,1] neg_hi:[0,1]
    v_cvt_pk_bf16_f32 v13, v118, v119
    s_nop 0
    v_lshlrev_b32 v118, 16, v13
    v_and_b32 v119, s36, v13
    v_pk_mul_f32 v[118:119], v[118:119], v[122:123]
    v_cvt_pk_bf16_f32 v38, v118, v119
    v_pk_add_f32 v[120:121], v[94:95], v[116:117] neg_lo:[0,1] neg_hi:[0,1]
    v_cvt_pk_bf16_f32 v13, v120, v121
    s_nop 0
    v_lshlrev_b32 v120, 16, v13
    v_and_b32 v121, s36, v13
    v_pk_mul_f32 v[120:121], v[120:121], v[122:123]
    v_cvt_pk_bf16_f32 v39, v120, v121
    v_pk_add_f32 v[118:119], v[96:97], v[116:117] neg_lo:[0,1] neg_hi:[0,1]
    v_cvt_pk_bf16_f32 v13, v118, v119
    s_nop 0
    v_lshlrev_b32 v118, 16, v13
    v_and_b32 v119, s36, v13
    v_pk_mul_f32 v[118:119], v[118:119], v[122:123]
    v_cvt_pk_bf16_f32 v40, v118, v119
    v_pk_add_f32 v[120:121], v[98:99], v[116:117] neg_lo:[0,1] neg_hi:[0,1]
    v_cvt_pk_bf16_f32 v13, v120, v121
    s_nop 0
    v_lshlrev_b32 v120, 16, v13
    v_and_b32 v121, s36, v13
    v_pk_mul_f32 v[120:121], v[120:121], v[122:123]
    v_cvt_pk_bf16_f32 v41, v120, v121
    v_pk_add_f32 v[118:119], v[100:101], v[116:117] neg_lo:[0,1] neg_hi:[0,1]
    v_cvt_pk_bf16_f32 v13, v118, v119
    s_nop 0
    v_lshlrev_b32 v118, 16, v13
    v_and_b32 v119, s36, v13
    v_pk_mul_f32 v[118:119], v[118:119], v[122:123]
    v_cvt_pk_bf16_f32 v42, v118, v119
    v_pk_add_f32 v[120:121], v[102:103], v[116:117] neg_lo:[0,1] neg_hi:[0,1]
    v_cvt_pk_bf16_f32 v13, v120, v121
    s_nop 0
    v_lshlrev_b32 v120, 16, v13
    v_and_b32 v121, s36, v13
    v_pk_mul_f32 v[120:121], v[120:121], v[122:123]
    v_cvt_pk_bf16_f32 v43, v120, v121
    v_pk_add_f32 v[118:119], v[104:105], v[116:117] neg_lo:[0,1] neg_hi:[0,1]
    v_cvt_pk_bf16_f32 v13, v118, v119
    s_nop 0
    v_lshlrev_b32 v118, 16, v13
    v_and_b32 v119, s36, v13
    v_pk_mul_f32 v[118:119], v[118:119], v[122:123]
    v_cvt_pk_bf16_f32 v44, v118, v119
    v_pk_add_f32 v[120:121], v[106:107], v[116:117] neg_lo:[0,1] neg_hi:[0,1]
    v_cvt_pk_bf16_f32 v13, v120, v121
    s_nop 0
    v_lshlrev_b32 v120, 16, v13
    v_and_b32 v121, s36, v13
    v_pk_mul_f32 v[120:121], v[120:121], v[122:123]
    v_cvt_pk_bf16_f32 v45, v120, v121
    v_pk_add_f32 v[118:119], v[108:109], v[116:117] neg_lo:[0,1] neg_hi:[0,1]
    v_cvt_pk_bf16_f32 v13, v118, v119
    s_nop 0
    v_lshlrev_b32 v118, 16, v13
    v_and_b32 v119, s36, v13
    v_pk_mul_f32 v[118:119], v[118:119], v[122:123]
    v_cvt_pk_bf16_f32 v46, v118, v119
    v_pk_add_f32 v[120:121], v[110:111], v[116:117] neg_lo:[0,1] neg_hi:[0,1]
    v_cvt_pk_bf16_f32 v13, v120, v121
    s_nop 0
    v_lshlrev_b32 v120, 16, v13
    v_and_b32 v121, s36, v13
    v_pk_mul_f32 v[120:121], v[120:121], v[122:123]
    v_cvt_pk_bf16_f32 v47, v120, v121
    s_mov_b32 s44, s28
    s_mov_b32 s45, s29
    s_mov_b32 s46, 4194304
    s_mov_b32 s47, 0x00020000
    s_lshr_b32 s3, s2, 3
    s_lshl_b32 s3, s3, 17
    s_lshr_b32 s36, s2, 1
    s_and_b32 s36, s36, 3
    s_lshl_b32 s36, s36, 10
    s_add_u32 s3, s3, s36
    s_and_b32 s36, s2, 1
    s_lshl_b32 s36, s36, 1
    s_add_u32 s36, s36, s24
    s_lshl_b32 s36, s36, 6
    s_add_u32 s3, s3, s36
    v_and_b32 v12, 3, v0
    v_lshlrev_b32 v12, 4, v12
    v_bfe_u32 v13, v0, 2, 2
    v_lshl_add_u32 v12, v13, 8, v12
    v_lshrrev_b32 v13, 4, v0
    v_lshl_add_u32 v12, v13, 12, v12
    v_add_u32 v12, s3, v12
    s_mov_b32 s48, s42
    s_mov_b32 s49, s43
    s_mov_b32 s50, 256
    s_mov_b32 s51, 0x00020000
    v_mov_b32 v14, 0
    buffer_load_dword v15, v14, s[48:51], 0 offen sc0 sc1
    s_mov_b32 s3, 0
    buffer_store_dwordx4 v[16:19], v12, s[44:47], s3 offen sc0 sc1
    s_add_u32 s3, s3, 16384
    buffer_store_dwordx4 v[20:23], v12, s[44:47], s3 offen sc0 sc1
    s_add_u32 s3, s3, 16384
    buffer_store_dwordx4 v[24:27], v12, s[44:47], s3 offen sc0 sc1
    s_add_u32 s3, s3, 16384
    buffer_store_dwordx4 v[28:31], v12, s[44:47], s3 offen sc0 sc1
    s_add_u32 s3, s3, 16384
    buffer_store_dwordx4 v[32:35], v12, s[44:47], s3 offen sc0 sc1
    s_add_u32 s3, s3, 16384
    buffer_store_dwordx4 v[36:39], v12, s[44:47], s3 offen sc0 sc1
    s_add_u32 s3, s3, 16384
    buffer_store_dwordx4 v[40:43], v12, s[44:47], s3 offen sc0 sc1
    s_add_u32 s3, s3, 16384
    buffer_store_dwordx4 v[44:47], v12, s[44:47], s3 offen sc0 sc1
    s_waitcnt vmcnt(0)
    s_barrier
    s_cmp_lg_u32 s24, 0
    s_cbranch_scc1 parallel_sum__softmax_full_mha__dense_activation_silu__prompt_kernel_rdo
    s_mov_b32 s100, 0x40000
parallel_sum__softmax_full_mha__dense_activation_silu__prompt_kernel_tag:
    v_cmp_eq_u32 vcc, 0, v15
    s_nop 1
    s_cbranch_vccz parallel_sum__softmax_full_mha__dense_activation_silu__prompt_kernel_tagok
    buffer_load_dword v15, v14, s[48:51], 0 offen sc0 sc1
    s_sub_u32 s100, s100, 1
    s_cmp_eq_u32 s100, 0
    s_cbranch_scc1 parallel_sum__softmax_full_mha__dense_activation_silu__prompt_kernel_tagok
    s_waitcnt vmcnt(0)
    s_branch parallel_sum__softmax_full_mha__dense_activation_silu__prompt_kernel_tag
parallel_sum__softmax_full_mha__dense_activation_silu__prompt_kernel_tagok:
    v_readfirstlane_b32 s94, v15
    v_mov_b32 v12, 163832
    ds_write_b32 v12, v15
    s_lshl_b32 s3, s2, 7
    s_add_u32 s3, s3, 131072
    s_mov_b64 exec, 1
    buffer_store_dword v15, v14, s[32:35], s3 offen sc0 sc1
    s_mov_b64 exec, -1
    ds_read_b64_tr_b16 a[0:1], v6 offset:0
    ds_read_b64_tr_b16 a[2:3], v6 offset:3072
    ds_read_b64_tr_b16 a[52:53], v6 offset:13312
    ds_read_b64_tr_b16 a[54:55], v6 offset:16384
    ds_read_b64_tr_b16 a[4:5], v7 offset:32
    ds_read_b64_tr_b16 a[6:7], v7 offset:3104
    ds_read_b64_tr_b16 a[56:57], v7 offset:13344
    ds_read_b64_tr_b16 a[58:59], v7 offset:16416
    ds_read_b64_tr_b16 a[8:9], v6 offset:64
    ds_read_b64_tr_b16 a[10:11], v6 offset:3136
    ds_read_b64_tr_b16 a[60:61], v6 offset:13376
    ds_read_b64_tr_b16 a[62:63], v6 offset:16448
    s_waitcnt lgkmcnt(4)
    ds_read_b64_tr_b16 a[12:13], v7 offset:96
    ds_read_b64_tr_b16 a[14:15], v7 offset:3168
    ds_read_b64_tr_b16 a[64:65], v7 offset:13408
    ds_read_b64_tr_b16 a[66:67], v7 offset:16480
    ds_read_b64_tr_b16 a[16:17], v6 offset:128
    ds_read_b64_tr_b16 a[18:19], v6 offset:3200
    ds_read_b64_tr_b16 a[68:69], v6 offset:13440
    ds_read_b64_tr_b16 a[70:71], v6 offset:16512
    ds_read_b64_tr_b16 a[20:21], v7 offset:160
    ds_read_b64_tr_b16 a[22:23], v7 offset:3232
    ds_read_b64_tr_b16 a[72:73], v7 offset:13472
    ds_read_b64_tr_b16 a[74:75], v7 offset:16544
    s_waitcnt lgkmcnt(4)
    ds_read_b64_tr_b16 a[24:25], v8 offset:6144
    ds_read_b64_tr_b16 a[26:27], v8 offset:9728
    ds_read_b64_tr_b16 a[76:77], v8 offset:19456
    ds_read_b64_tr_b16 a[78:79], v8 offset:23040
    ds_read_b64_tr_b16 a[28:29], v8 offset:6176
    ds_read_b64_tr_b16 a[30:31], v8 offset:9760
    ds_read_b64_tr_b16 a[80:81], v8 offset:19488
    ds_read_b64_tr_b16 a[82:83], v8 offset:23072
    ds_read_b64_tr_b16 a[32:33], v8 offset:6208
    ds_read_b64_tr_b16 a[34:35], v8 offset:9792
    ds_read_b64_tr_b16 a[84:85], v8 offset:19520
    ds_read_b64_tr_b16 a[86:87], v8 offset:23104
    s_waitcnt lgkmcnt(4)
    ds_read_b64_tr_b16 a[36:37], v8 offset:6240
    ds_read_b64_tr_b16 a[38:39], v8 offset:9824
    ds_read_b64_tr_b16 a[88:89], v8 offset:19552
    ds_read_b64_tr_b16 a[90:91], v8 offset:23136
    ds_read_b64_tr_b16 a[40:41], v8 offset:6272
    ds_read_b64_tr_b16 a[42:43], v8 offset:9856
    ds_read_b64_tr_b16 a[92:93], v8 offset:19584
    ds_read_b64_tr_b16 a[94:95], v8 offset:23168
    ds_read_b64_tr_b16 a[44:45], v8 offset:6304
    ds_read_b64_tr_b16 a[46:47], v8 offset:9888
    ds_read_b64_tr_b16 a[96:97], v8 offset:19616
    ds_read_b64_tr_b16 a[98:99], v8 offset:23200
    s_waitcnt lgkmcnt(4)
    ds_read_b64_tr_b16 a[48:49], v8 offset:6336
    ds_read_b64_tr_b16 a[50:51], v8 offset:9920
    ds_read_b64_tr_b16 a[100:101], v8 offset:19648
    ds_read_b64_tr_b16 a[102:103], v8 offset:23232
    v_and_b32 v12, 31, v0
    s_lshl_b32 s3, s25, 5
    v_add_u32 v12, s3, v12
    v_lshlrev_b32 v12, 7, v12
    s_mov_b32 s3, 131072
    s_mov_b32 s100, 0x40000
parallel_sum__softmax_full_mha__dense_activation_silu__prompt_kernel_poll_ln:
    buffer_load_dword v13, v12, s[32:35], s3 offen sc0 sc1
    s_sub_u32 s100, s100, 1
    s_cmp_eq_u32 s100, 0
    s_cbranch_scc1 parallel_sum__softmax_full_mha__dense_activation_silu__prompt_kernel_pollx_ln
    s_waitcnt vmcnt(0)
    v_cmp_ne_u32 vcc, s94, v13
    s_nop 1
    s_cbranch_vccnz parallel_sum__softmax_full_mha__dense_activation_silu__prompt_kernel_poll_ln
parallel_sum__softmax_full_mha__dense_activation_silu__prompt_kernel_pollx_ln:
    s_waitcnt lgkmcnt(0)
    s_branch parallel_sum__softmax_full_mha__dense_activation_silu__prompt_kernel_bar2
parallel_sum__softmax_full_mha__dense_activation_silu__prompt_kernel_pf:
    s_lshl_b32 s3, s2, 2
    s_add_u32 s3, s3, s24
    s_cmp_lg_u32 s3, 2
    s_cbranch_scc1 parallel_sum__softmax_full_mha__dense_activation_silu__prompt_kernel_notag
    s_waitcnt lgkmcnt(0)
    s_or_b32 s94, s94, 1
    s_add_u32 s94, s94, 0x9e3779b8
    s_mov_b32 s48, s42
    s_mov_b32 s49, s43
    s_mov_b32 s50, 256
    s_mov_b32 s51, 0x00020000
    s_add_u32 s32, s28, 46137344
    s_addc_u32 s33, s29, 0
    s_mov_b32 s34, 196608
    s_mov_b32 s35, 0x00020000
    v_mov_b32 v12, s94
    v_mov_b32 v13, 0
    s_mov_b32 s3, 163840
    s_mov_b64 exec, 1
    buffer_store_dword v12, v13, s[48:51], 0 offen sc0 sc1
    buffer_store_dword v12, v13, s[32:35], s3 offen sc0 sc1
    s_mov_b64 exec, -1
parallel_sum__softmax_full_mha__dense_activation_silu__prompt_kernel_notag:
    v_lshlrev_b32 v12, 4, v0
    s_sub_u32 s3, s24, 2
    s_lshl_b32 s3, s3, 11
    s_lshl_b32 s36, s2, 12
    s_add_u32 s36, s36, s3
    s_mov_b32 s44, s4
    s_mov_b32 s45, s5
    s_mov_b32 s46, 6291456
    s_mov_b32 s47, 0x00020000
    buffer_load_dwordx4 v[16:19], v12, s[44:47], s36 offen offset:0
    buffer_load_dwordx4 v[20:23], v12, s[44:47], s36 offen offset:1024
    buffer_load_dwordx4 v[24:27], v12, s[16:19], s36 offen offset:0
    buffer_load_dwordx4 v[28:31], v12, s[16:19], s36 offen offset:1024
    s_add_u32 s36, s36, 1048576
    buffer_load_dwordx4 v[32:35], v12, s[44:47], s36 offen offset:0
    buffer_load_dwordx4 v[36:39], v12, s[44:47], s36 offen offset:1024
    buffer_load_dwordx4 v[40:43], v12, s[16:19], s36 offen offset:0
    buffer_load_dwordx4 v[44:47], v12, s[16:19], s36 offen offset:1024
    s_add_u32 s36, s36, 1048576
    buffer_load_dwordx4 v[16:19], v12, s[44:47], s36 offen offset:0
    buffer_load_dwordx4 v[20:23], v12, s[44:47], s36 offen offset:1024
    buffer_load_dwordx4 v[24:27], v12, s[16:19], s36 offen offset:0
    buffer_load_dwordx4 v[28:31], v12, s[16:19], s36 offen offset:1024
    s_waitcnt vmcnt(12)
    s_barrier
parallel_sum__softmax_full_mha__dense_activation_silu__prompt_kernel_rdo:
    ds_read_b64_tr_b16 a[0:1], v6 offset:0
    ds_read_b64_tr_b16 a[2:3], v6 offset:3072
    ds_read_b64_tr_b16 a[52:53], v6 offset:13312
    ds_read_b64_tr_b16 a[54:55], v6 offset:16384
    ds_read_b64_tr_b16 a[4:5], v7 offset:32
    ds_read_b64_tr_b16 a[6:7], v7 offset:3104
    ds_read_b64_tr_b16 a[56:57], v7 offset:13344
    ds_read_b64_tr_b16 a[58:59], v7 offset:16416
    ds_read_b64_tr_b16 a[8:9], v6 offset:64
    ds_read_b64_tr_b16 a[10:11], v6 offset:3136
    ds_read_b64_tr_b16 a[60:61], v6 offset:13376
    ds_read_b64_tr_b16 a[62:63], v6 offset:16448
    s_waitcnt lgkmcnt(4)
    ds_read_b64_tr_b16 a[12:13], v7 offset:96
    ds_read_b64_tr_b16 a[14:15], v7 offset:3168
    ds_read_b64_tr_b16 a[64:65], v7 offset:13408
    ds_read_b64_tr_b16 a[66:67], v7 offset:16480
    ds_read_b64_tr_b16 a[16:17], v6 offset:128
    ds_read_b64_tr_b16 a[18:19], v6 offset:3200
    ds_read_b64_tr_b16 a[68:69], v6 offset:13440
    ds_read_b64_tr_b16 a[70:71], v6 offset:16512
    ds_read_b64_tr_b16 a[20:21], v7 offset:160
    ds_read_b64_tr_b16 a[22:23], v7 offset:3232
    ds_read_b64_tr_b16 a[72:73], v7 offset:13472
    ds_read_b64_tr_b16 a[74:75], v7 offset:16544
    s_waitcnt lgkmcnt(4)
    ds_read_b64_tr_b16 a[24:25], v8 offset:6144
    ds_read_b64_tr_b16 a[26:27], v8 offset:9728
    ds_read_b64_tr_b16 a[76:77], v8 offset:19456
    ds_read_b64_tr_b16 a[78:79], v8 offset:23040
    ds_read_b64_tr_b16 a[28:29], v8 offset:6176
    ds_read_b64_tr_b16 a[30:31], v8 offset:9760
    ds_read_b64_tr_b16 a[80:81], v8 offset:19488
    ds_read_b64_tr_b16 a[82:83], v8 offset:23072
    ds_read_b64_tr_b16 a[32:33], v8 offset:6208
    ds_read_b64_tr_b16 a[34:35], v8 offset:9792
    ds_read_b64_tr_b16 a[84:85], v8 offset:19520
    ds_read_b64_tr_b16 a[86:87], v8 offset:23104
    s_waitcnt lgkmcnt(4)
    ds_read_b64_tr_b16 a[36:37], v8 offset:6240
    ds_read_b64_tr_b16 a[38:39], v8 offset:9824
    ds_read_b64_tr_b16 a[88:89], v8 offset:19552
    ds_read_b64_tr_b16 a[90:91], v8 offset:23136
    ds_read_b64_tr_b16 a[40:41], v8 offset:6272
    ds_read_b64_tr_b16 a[42:43], v8 offset:9856
    ds_read_b64_tr_b16 a[92:93], v8 offset:19584
    ds_read_b64_tr_b16 a[94:95], v8 offset:23168
    ds_read_b64_tr_b16 a[44:45], v8 offset:6304
    ds_read_b64_tr_b16 a[46:47], v8 offset:9888
    ds_read_b64_tr_b16 a[96:97], v8 offset:19616
    ds_read_b64_tr_b16 a[98:99], v8 offset:23200
    s_waitcnt lgkmcnt(4)
    ds_read_b64_tr_b16 a[48:49], v8 offset:6336
    ds_read_b64_tr_b16 a[50:51], v8 offset:9920
    ds_read_b64_tr_b16 a[100:101], v8 offset:19648
    ds_read_b64_tr_b16 a[102:103], v8 offset:23232
parallel_sum__softmax_full_mha__dense_activation_silu__prompt_kernel_bar2:
    s_barrier
    v_mov_b32 v12, 163832
    ds_read_b32 v12, v12
    s_waitcnt lgkmcnt(0)
    v_readfirstlane_b32 s94, v12
    buffer_load_dwordx4 a[104:107], v1, s[8:11], s20 offen offset:0 sc1
    buffer_load_dwordx4 a[108:111], v1, s[8:11], s20 offen offset:1024 sc1
    buffer_load_dwordx4 a[112:115], v1, s[8:11], s20 offen offset:2048 sc1
    buffer_load_dwordx4 a[116:119], v1, s[8:11], s20 offen offset:3072 sc1
    s_add_u32 s20, s20, 4096
    buffer_load_dwordx4 a[120:123], v1, s[8:11], s20 offen offset:0 sc1
    buffer_load_dwordx4 a[124:127], v1, s[8:11], s20 offen offset:1024 sc1
    buffer_load_dwordx4 a[128:131], v1, s[8:11], s20 offen offset:2048 sc1
    buffer_load_dwordx4 a[132:135], v1, s[8:11], s20 offen offset:3072 sc1
    s_add_u32 s20, s20, 4096
    s_add_u32 m0, s27, 26624
    s_nop 0
    buffer_load_dwordx4 v2, s[12:15], s21 offen lds
    s_add_u32 m0, s27, 27648
    s_nop 0
    buffer_load_dwordx4 v3, s[12:15], s21 offen lds
    s_add_u32 m0, s27, 28672
    s_nop 0
    buffer_load_dwordx4 v4, s[12:15], s21 offen lds
    s_add_u32 s21, s21, s23
    s_add_u32 m0, s30, 26624
    s_mov_b64 exec, 0xffff
    buffer_load_dwordx4 v5, s[16:19], s22 offen lds
    s_mov_b64 exec, -1
    s_add_u32 s22, s22, 229376
    s_add_u32 m0, s27, 39936
    s_nop 0
    buffer_load_dwordx4 v2, s[12:15], s21 offen lds
    s_add_u32 m0, s27, 40960
    s_nop 0
    buffer_load_dwordx4 v3, s[12:15], s21 offen lds
    s_add_u32 m0, s27, 41984
    s_nop 0
    buffer_load_dwordx4 v4, s[12:15], s21 offen lds
    s_add_u32 s21, s21, s23
    s_add_u32 m0, s30, 39936
    s_mov_b64 exec, 0xffff
    buffer_load_dwordx4 v5, s[16:19], s22 offen lds
    s_mov_b64 exec, -1
    s_add_u32 s22, s22, 229376
    s_mov_b32 s44, s4
    s_mov_b32 s45, s5
    s_mov_b32 s46, 6291456
    s_mov_b32 s47, 0x00020000
    v_lshlrev_b32 v15, 4, v0
    s_lshl_b32 s48, s2, 2
    s_add_u32 s48, s48, s24
    s_lshl_b32 s48, s48, 10
    s_add_u32 s48, s48, 3145728
    s_mov_b32 s49, s48
    s_waitcnt lgkmcnt(0)
    s_waitcnt vmcnt(0)
    s_barrier
    s_waitcnt lgkmcnt(8)
    v_mfma_f32_16x16x32_bf16 v[48:51], a[0:3], a[104:107], 0
    v_mfma_f32_16x16x32_bf16 v[48:51], a[52:55], a[120:123], v[48:51]
    v_mfma_f32_16x16x32_bf16 v[52:55], a[0:3], a[108:111], 0
    v_mfma_f32_16x16x32_bf16 v[52:55], a[52:55], a[124:127], v[52:55]
    buffer_load_dwordx4 a[136:139], v1, s[8:11], s20 offen offset:0 sc1
    v_mfma_f32_16x16x32_bf16 v[56:59], a[0:3], a[112:115], 0
    buffer_load_dwordx4 a[140:143], v1, s[8:11], s20 offen offset:1024 sc1
    v_mfma_f32_16x16x32_bf16 v[56:59], a[52:55], a[128:131], v[56:59]
    v_mfma_f32_16x16x32_bf16 v[60:63], a[0:3], a[116:119], 0
    buffer_load_dwordx4 a[144:147], v1, s[8:11], s20 offen offset:2048 sc1
    v_mfma_f32_16x16x32_bf16 v[60:63], a[52:55], a[132:135], v[60:63]
    ds_read_b64_tr_b16 a[0:1], v6 offset:26624
    buffer_load_dwordx4 a[148:151], v1, s[8:11], s20 offen offset:3072 sc1
    v_mfma_f32_16x16x32_bf16 v[64:67], a[4:7], a[104:107], 0
    ds_read_b64_tr_b16 a[2:3], v6 offset:29696
    v_mfma_f32_16x16x32_bf16 v[64:67], a[56:59], a[120:123], v[64:67]
    ds_read_b64_tr_b16 a[52:53], v6 offset:39936
    s_add_u32 s20, s20, 4096
    v_mfma_f32_16x16x32_bf16 v[68:71], a[4:7], a[108:111], 0
    ds_read_b64_tr_b16 a[54:55], v6 offset:43008
    v_mfma_f32_16x16x32_bf16 v[68:71], a[56:59], a[124:127], v[68:71]
    s_add_u32 m0, s27, 53248
    v_mfma_f32_16x16x32_bf16 v[72:75], a[4:7], a[112:115], 0
    buffer_load_dwordx4 v2, s[12:15], s21 offen lds
    v_mfma_f32_16x16x32_bf16 v[72:75], a[56:59], a[128:131], v[72:75]
    v_mfma_f32_16x16x32_bf16 v[76:79], a[4:7], a[116:119], 0
    s_add_u32 m0, s27, 54272
    v_mfma_f32_16x16x32_bf16 v[76:79], a[56:59], a[132:135], v[76:79]
    ds_read_b64_tr_b16 a[4:5], v7 offset:26656
    v_mfma_f32_16x16x32_bf16 v[80:83], a[8:11], a[104:107], 0
    ds_read_b64_tr_b16 a[6:7], v7 offset:29728
    buffer_load_dwordx4 v3, s[12:15], s21 offen lds
    v_mfma_f32_16x16x32_bf16 v[80:83], a[60:63], a[120:123], v[80:83]
    ds_read_b64_tr_b16 a[56:57], v7 offset:39968
    s_add_u32 m0, s27, 55296
    v_mfma_f32_16x16x32_bf16 v[84:87], a[8:11], a[108:111], 0
    ds_read_b64_tr_b16 a[58:59], v7 offset:43040
    v_mfma_f32_16x16x32_bf16 v[84:87], a[60:63], a[124:127], v[84:87]
    buffer_load_dwordx4 v4, s[12:15], s21 offen lds
    v_mfma_f32_16x16x32_bf16 v[88:91], a[8:11], a[112:115], 0
    s_add_u32 s21, s21, s23
    v_mfma_f32_16x16x32_bf16 v[88:91], a[60:63], a[128:131], v[88:91]
    v_mfma_f32_16x16x32_bf16 v[92:95], a[8:11], a[116:119], 0
    s_add_u32 m0, s30, 53248
    v_mfma_f32_16x16x32_bf16 v[92:95], a[60:63], a[132:135], v[92:95]
    ds_read_b64_tr_b16 a[8:9], v6 offset:26688
    v_mfma_f32_16x16x32_bf16 v[96:99], a[12:15], a[104:107], 0
    ds_read_b64_tr_b16 a[10:11], v6 offset:29760
    s_mov_b64 exec, 0xffff
    buffer_load_dwordx4 v5, s[16:19], s22 offen lds
    s_mov_b64 exec, -1
    v_mfma_f32_16x16x32_bf16 v[96:99], a[64:67], a[120:123], v[96:99]
    ds_read_b64_tr_b16 a[60:61], v6 offset:40000
    s_add_u32 s22, s22, 229376
    v_mfma_f32_16x16x32_bf16 v[100:103], a[12:15], a[108:111], 0
    ds_read_b64_tr_b16 a[62:63], v6 offset:43072
    v_mfma_f32_16x16x32_bf16 v[100:103], a[64:67], a[124:127], v[100:103]
    buffer_load_dwordx4 a[152:155], v1, s[8:11], s20 offen offset:0 sc1
    v_mfma_f32_16x16x32_bf16 v[104:107], a[12:15], a[112:115], 0
    v_mfma_f32_16x16x32_bf16 v[104:107], a[64:67], a[128:131], v[104:107]
    buffer_load_dwordx4 a[156:159], v1, s[8:11], s20 offen offset:1024 sc1
    v_mfma_f32_16x16x32_bf16 v[108:111], a[12:15], a[116:119], 0
    buffer_load_dwordx4 a[160:163], v1, s[8:11], s20 offen offset:2048 sc1
    v_mfma_f32_16x16x32_bf16 v[108:111], a[64:67], a[132:135], v[108:111]
    ds_read_b64_tr_b16 a[12:13], v7 offset:26720
    v_mfma_f32_16x16x32_bf16 v[112:115], a[104:107], a[16:19], 0
    ds_read_b64_tr_b16 a[14:15], v7 offset:29792
    buffer_load_dwordx4 a[164:167], v1, s[8:11], s20 offen offset:3072 sc1
    v_mfma_f32_16x16x32_bf16 v[112:115], a[120:123], a[68:71], v[112:115]
    ds_read_b64_tr_b16 a[64:65], v7 offset:40032
    s_add_u32 s20, s20, 4096
    v_mfma_f32_16x16x32_bf16 v[116:119], a[108:111], a[16:19], 0
    ds_read_b64_tr_b16 a[66:67], v7 offset:43104
    v_mfma_f32_16x16x32_bf16 v[116:119], a[124:127], a[68:71], v[116:119]
    s_add_u32 m0, s27, 66560
    v_mfma_f32_16x16x32_bf16 v[120:123], a[112:115], a[16:19], 0
    v_mfma_f32_16x16x32_bf16 v[120:123], a[128:131], a[68:71], v[120:123]
    buffer_load_dwordx4 v2, s[12:15], s21 offen lds
    v_mfma_f32_16x16x32_bf16 v[124:127], a[116:119], a[16:19], 0
    s_add_u32 m0, s27, 67584
    v_mfma_f32_16x16x32_bf16 v[124:127], a[132:135], a[68:71], v[124:127]
    ds_read_b64_tr_b16 a[16:17], v6 offset:26752
    v_mfma_f32_16x16x32_bf16 v[128:131], a[104:107], a[20:23], 0
    ds_read_b64_tr_b16 a[18:19], v6 offset:29824
    buffer_load_dwordx4 v3, s[12:15], s21 offen lds
    v_mfma_f32_16x16x32_bf16 v[128:131], a[120:123], a[72:75], v[128:131]
    ds_read_b64_tr_b16 a[68:69], v6 offset:40064
    v_mfma_f32_16x16x32_bf16 v[132:135], a[108:111], a[20:23], 0
    ds_read_b64_tr_b16 a[70:71], v6 offset:43136
    s_add_u32 m0, s27, 68608
    v_mfma_f32_16x16x32_bf16 v[132:135], a[124:127], a[72:75], v[132:135]
    buffer_load_dwordx4 v4, s[12:15], s21 offen lds
    v_mfma_f32_16x16x32_bf16 v[136:139], a[112:115], a[20:23], 0
    v_mfma_f32_16x16x32_bf16 v[136:139], a[128:131], a[72:75], v[136:139]
    s_add_u32 s21, s21, s23
    v_mfma_f32_16x16x32_bf16 v[140:143], a[116:119], a[20:23], 0
    s_add_u32 m0, s30, 66560
    v_mfma_f32_16x16x32_bf16 v[140:143], a[132:135], a[72:75], v[140:143]
    ds_read_b64_tr_b16 a[20:21], v7 offset:26784
    v_mfma_f32_16x16x32_bf16 v[144:147], a[24:27], a[104:107], 0
    ds_read_b64_tr_b16 a[22:23], v7 offset:29856
    s_mov_b64 exec, 0xffff
    buffer_load_dwordx4 v5, s[16:19], s22 offen lds
    s_mov_b64 exec, -1
    v_mfma_f32_16x16x32_bf16 v[144:147], a[76:79], a[120:123], v[144:147]
    ds_read_b64_tr_b16 a[72:73], v7 offset:40096
    v_mfma_f32_16x16x32_bf16 v[148:151], a[24:27], a[108:111], 0
    ds_read_b64_tr_b16 a[74:75], v7 offset:43168
    s_add_u32 s22, s22, 229376
    v_mfma_f32_16x16x32_bf16 v[148:151], a[76:79], a[124:127], v[148:151]
    buffer_load_dwordx4 a[168:171], v1, s[8:11], s20 offen offset:0 sc1
    v_mfma_f32_16x16x32_bf16 v[152:155], a[24:27], a[112:115], 0
    v_mfma_f32_16x16x32_bf16 v[152:155], a[76:79], a[128:131], v[152:155]
    buffer_load_dwordx4 a[172:175], v1, s[8:11], s20 offen offset:1024 sc1
    v_mfma_f32_16x16x32_bf16 v[156:159], a[24:27], a[116:119], 0
    v_mfma_f32_16x16x32_bf16 v[156:159], a[76:79], a[132:135], v[156:159]
    ds_read_b64_tr_b16 a[24:25], v8 offset:32768
    buffer_load_dwordx4 a[176:179], v1, s[8:11], s20 offen offset:2048 sc1
    v_mfma_f32_16x16x32_bf16 v[160:163], a[28:31], a[104:107], 0
    ds_read_b64_tr_b16 a[26:27], v8 offset:36352
    buffer_load_dwordx4 a[180:183], v1, s[8:11], s20 offen offset:3072 sc1
    v_mfma_f32_16x16x32_bf16 v[160:163], a[80:83], a[120:123], v[160:163]
    ds_read_b64_tr_b16 a[76:77], v8 offset:46080
    v_mfma_f32_16x16x32_bf16 v[164:167], a[28:31], a[108:111], 0
    ds_read_b64_tr_b16 a[78:79], v8 offset:49664
    s_add_u32 s20, s20, 4096
    v_mfma_f32_16x16x32_bf16 v[164:167], a[80:83], a[124:127], v[164:167]
    v_mfma_f32_16x16x32_bf16 v[168:171], a[28:31], a[112:115], 0
    s_add_u32 m0, s27, 79872
    v_mfma_f32_16x16x32_bf16 v[168:171], a[80:83], a[128:131], v[168:171]
    buffer_load_dwordx4 v2, s[12:15], s21 offen lds
    v_mfma_f32_16x16x32_bf16 v[172:175], a[28:31], a[116:119], 0
    v_mfma_f32_16x16x32_bf16 v[172:175], a[80:83], a[132:135], v[172:175]
    ds_read_b64_tr_b16 a[28:29], v8 offset:32800
    s_add_u32 m0, s27, 80896
    s_waitcnt lgkmcnt(8)
    v_mfma_f32_16x16x32_bf16 v[176:179], a[32:35], a[104:107], 0
    ds_read_b64_tr_b16 a[30:31], v8 offset:36384
    buffer_load_dwordx4 v3, s[12:15], s21 offen lds
    v_mfma_f32_16x16x32_bf16 v[176:179], a[84:87], a[120:123], v[176:179]
    ds_read_b64_tr_b16 a[80:81], v8 offset:46112
    v_mfma_f32_16x16x32_bf16 v[180:183], a[32:35], a[108:111], 0
    ds_read_b64_tr_b16 a[82:83], v8 offset:49696
    s_add_u32 m0, s27, 81920
    v_mfma_f32_16x16x32_bf16 v[180:183], a[84:87], a[124:127], v[180:183]
    v_mfma_f32_16x16x32_bf16 v[184:187], a[32:35], a[112:115], 0
    buffer_load_dwordx4 v4, s[12:15], s21 offen lds
    v_mfma_f32_16x16x32_bf16 v[184:187], a[84:87], a[128:131], v[184:187]
    s_add_u32 s21, s21, s23
    v_mfma_f32_16x16x32_bf16 v[188:191], a[32:35], a[116:119], 0
    v_mfma_f32_16x16x32_bf16 v[188:191], a[84:87], a[132:135], v[188:191]
    ds_read_b64_tr_b16 a[32:33], v8 offset:32832
    s_add_u32 m0, s30, 79872
    v_mfma_f32_16x16x32_bf16 v[192:195], a[36:39], a[104:107], 0
    ds_read_b64_tr_b16 a[34:35], v8 offset:36416
    v_mfma_f32_16x16x32_bf16 v[192:195], a[88:91], a[120:123], v[192:195]
    ds_read_b64_tr_b16 a[84:85], v8 offset:46144
    s_mov_b64 exec, 0xffff
    buffer_load_dwordx4 v5, s[16:19], s22 offen lds
    s_mov_b64 exec, -1
    v_mfma_f32_16x16x32_bf16 v[196:199], a[36:39], a[108:111], 0
    ds_read_b64_tr_b16 a[86:87], v8 offset:49728
    s_add_u32 s22, s22, 229376
    v_mfma_f32_16x16x32_bf16 v[196:199], a[88:91], a[124:127], v[196:199]
    v_mfma_f32_16x16x32_bf16 v[200:203], a[36:39], a[112:115], 0
    buffer_load_dwordx4 a[184:187], v1, s[8:11], s20 offen offset:0 sc1
    v_mfma_f32_16x16x32_bf16 v[200:203], a[88:91], a[128:131], v[200:203]
    buffer_load_dwordx4 a[188:191], v1, s[8:11], s20 offen offset:1024 sc1
    v_mfma_f32_16x16x32_bf16 v[204:207], a[36:39], a[116:119], 0
    v_mfma_f32_16x16x32_bf16 v[204:207], a[88:91], a[132:135], v[204:207]
    ds_read_b64_tr_b16 a[36:37], v8 offset:32864
    buffer_load_dwordx4 a[192:195], v1, s[8:11], s20 offen offset:2048 sc1
    v_mfma_f32_16x16x32_bf16 v[208:211], a[40:43], a[104:107], 0
    ds_read_b64_tr_b16 a[38:39], v8 offset:36448
    v_mfma_f32_16x16x32_bf16 v[208:211], a[92:95], a[120:123], v[208:211]
    ds_read_b64_tr_b16 a[88:89], v8 offset:46176
    buffer_load_dwordx4 a[196:199], v1, s[8:11], s20 offen offset:3072 sc1
    v_mfma_f32_16x16x32_bf16 v[212:215], a[40:43], a[108:111], 0
    ds_read_b64_tr_b16 a[90:91], v8 offset:49760
    s_add_u32 s20, s20, 4096
    v_mfma_f32_16x16x32_bf16 v[212:215], a[92:95], a[124:127], v[212:215]
    v_mfma_f32_16x16x32_bf16 v[216:219], a[40:43], a[112:115], 0
    s_add_u32 m0, s27, 93184
    v_mfma_f32_16x16x32_bf16 v[216:219], a[92:95], a[128:131], v[216:219]
    v_mfma_f32_16x16x32_bf16 v[220:223], a[40:43], a[116:119], 0
    buffer_load_dwordx4 v2, s[12:15], s21 offen lds
    v_mfma_f32_16x16x32_bf16 v[220:223], a[92:95], a[132:135], v[220:223]
    ds_read_b64_tr_b16 a[40:41], v8 offset:32896
    s_add_u32 m0, s27, 94208
    v_mfma_f32_16x16x32_bf16 v[224:227], a[44:47], a[104:107], 0
    ds_read_b64_tr_b16 a[42:43], v8 offset:36480
    v_mfma_f32_16x16x32_bf16 v[224:227], a[96:99], a[120:123], v[224:227]
    ds_read_b64_tr_b16 a[92:93], v8 offset:46208
    buffer_load_dwordx4 v3, s[12:15], s21 offen lds
    v_mfma_f32_16x16x32_bf16 v[228:231], a[44:47], a[108:111], 0
    ds_read_b64_tr_b16 a[94:95], v8 offset:49792
    s_add_u32 m0, s27, 95232
    v_mfma_f32_16x16x32_bf16 v[228:231], a[96:99], a[124:127], v[228:231]
    v_mfma_f32_16x16x32_bf16 v[232:235], a[44:47], a[112:115], 0
    buffer_load_dwordx4 v4, s[12:15], s21 offen lds
    v_mfma_f32_16x16x32_bf16 v[232:235], a[96:99], a[128:131], v[232:235]
    v_mfma_f32_16x16x32_bf16 v[236:239], a[44:47], a[116:119], 0
    s_add_u32 s21, s21, s23
    v_mfma_f32_16x16x32_bf16 v[236:239], a[96:99], a[132:135], v[236:239]
    ds_read_b64_tr_b16 a[44:45], v8 offset:32928
    s_add_u32 m0, s30, 93184
    v_mfma_f32_16x16x32_bf16 v[240:243], a[48:51], a[104:107], 0
    ds_read_b64_tr_b16 a[46:47], v8 offset:36512
    v_mfma_f32_16x16x32_bf16 v[240:243], a[100:103], a[120:123], v[240:243]
    ds_read_b64_tr_b16 a[96:97], v8 offset:46240
    s_mov_b64 exec, 0xffff
    buffer_load_dwordx4 v5, s[16:19], s22 offen lds
    s_mov_b64 exec, -1
    v_mfma_f32_16x16x32_bf16 v[244:247], a[48:51], a[108:111], 0
    ds_read_b64_tr_b16 a[98:99], v8 offset:49824
    v_mfma_f32_16x16x32_bf16 v[244:247], a[100:103], a[124:127], v[244:247]
    s_add_u32 s22, s22, 229376
    v_mfma_f32_16x16x32_bf16 v[248:251], a[48:51], a[112:115], 0
    buffer_load_dwordx4 v[16:19], v15, s[16:19], s49 offen
    v_mfma_f32_16x16x32_bf16 v[248:251], a[100:103], a[128:131], v[248:251]
    v_mfma_f32_16x16x32_bf16 v[252:255], a[48:51], a[116:119], 0
    s_add_u32 s49, s49, 1048576
    v_mfma_f32_16x16x32_bf16 v[252:255], a[100:103], a[132:135], v[252:255]
    ds_read_b64_tr_b16 a[48:49], v8 offset:32960
    ds_read_b64_tr_b16 a[50:51], v8 offset:36544
    ds_read_b64_tr_b16 a[100:101], v8 offset:46272
    ds_read_b64_tr_b16 a[102:103], v8 offset:49856
    s_waitcnt vmcnt(17)
    s_barrier
    s_waitcnt lgkmcnt(8)
    v_mfma_f32_16x16x32_bf16 v[48:51], a[0:3], a[136:139], v[48:51]
    v_mfma_f32_16x16x32_bf16 v[48:51], a[52:55], a[152:155], v[48:51]
    v_mfma_f32_16x16x32_bf16 v[52:55], a[0:3], a[140:143], v[52:55]
    v_mfma_f32_16x16x32_bf16 v[52:55], a[52:55], a[156:159], v[52:55]
    buffer_load_dwordx4 a[200:203], v1, s[8:11], s20 offen offset:0 sc1
    v_mfma_f32_16x16x32_bf16 v[56:59], a[0:3], a[144:147], v[56:59]
    buffer_load_dwordx4 a[204:207], v1, s[8:11], s20 offen offset:1024 sc1
    v_mfma_f32_16x16x32_bf16 v[56:59], a[52:55], a[160:163], v[56:59]
    v_mfma_f32_16x16x32_bf16 v[60:63], a[0:3], a[148:151], v[60:63]
    buffer_load_dwordx4 a[208:211], v1, s[8:11], s20 offen offset:2048 sc1
    v_mfma_f32_16x16x32_bf16 v[60:63], a[52:55], a[164:167], v[60:63]
    ds_read_b64_tr_b16 a[0:1], v9 offset:0
    v_mfma_f32_16x16x32_bf16 v[64:67], a[4:7], a[136:139], v[64:67]
    ds_read_b64_tr_b16 a[2:3], v9 offset:3072
    v_mfma_f32_16x16x32_bf16 v[64:67], a[56:59], a[152:155], v[64:67]
    ds_read_b64_tr_b16 a[52:53], v9 offset:13312
    v_mfma_f32_16x16x32_bf16 v[68:71], a[4:7], a[140:143], v[68:71]
    ds_read_b64_tr_b16 a[54:55], v9 offset:16384
    v_mfma_f32_16x16x32_bf16 v[68:71], a[56:59], a[156:159], v[68:71]
    buffer_load_dwordx4 a[212:215], v1, s[8:11], s20 offen offset:3072 sc1
    v_mfma_f32_16x16x32_bf16 v[72:75], a[4:7], a[144:147], v[72:75]
    v_mfma_f32_16x16x32_bf16 v[72:75], a[56:59], a[160:163], v[72:75]
    s_add_u32 s20, s20, 4096
    v_mfma_f32_16x16x32_bf16 v[76:79], a[4:7], a[148:151], v[76:79]
    v_mfma_f32_16x16x32_bf16 v[76:79], a[56:59], a[164:167], v[76:79]
    ds_read_b64_tr_b16 a[4:5], v10 offset:32
    v_mfma_f32_16x16x32_bf16 v[80:83], a[8:11], a[136:139], v[80:83]
    ds_read_b64_tr_b16 a[6:7], v10 offset:3104
    v_mfma_f32_16x16x32_bf16 v[80:83], a[60:63], a[152:155], v[80:83]
    ds_read_b64_tr_b16 a[56:57], v10 offset:13344
    v_mfma_f32_16x16x32_bf16 v[84:87], a[8:11], a[140:143], v[84:87]
    ds_read_b64_tr_b16 a[58:59], v10 offset:16416
    v_mfma_f32_16x16x32_bf16 v[84:87], a[60:63], a[156:159], v[84:87]
    s_add_u32 m0, s27, 0
    v_mfma_f32_16x16x32_bf16 v[88:91], a[8:11], a[144:147], v[88:91]
    buffer_load_dwordx4 v2, s[12:15], s21 offen lds
    v_mfma_f32_16x16x32_bf16 v[88:91], a[60:63], a[160:163], v[88:91]
    v_mfma_f32_16x16x32_bf16 v[92:95], a[8:11], a[148:151], v[92:95]
    s_add_u32 m0, s27, 1024
    v_mfma_f32_16x16x32_bf16 v[92:95], a[60:63], a[164:167], v[92:95]
    ds_read_b64_tr_b16 a[8:9], v9 offset:64
    v_mfma_f32_16x16x32_bf16 v[96:99], a[12:15], a[136:139], v[96:99]
    ds_read_b64_tr_b16 a[10:11], v9 offset:3136
    v_mfma_f32_16x16x32_bf16 v[96:99], a[64:67], a[152:155], v[96:99]
    ds_read_b64_tr_b16 a[60:61], v9 offset:13376
    v_mfma_f32_16x16x32_bf16 v[100:103], a[12:15], a[140:143], v[100:103]
    ds_read_b64_tr_b16 a[62:63], v9 offset:16448
    v_mfma_f32_16x16x32_bf16 v[100:103], a[64:67], a[156:159], v[100:103]
    v_mfma_f32_16x16x32_bf16 v[104:107], a[12:15], a[144:147], v[104:107]
    buffer_load_dwordx4 v3, s[12:15], s21 offen lds
    v_mfma_f32_16x16x32_bf16 v[104:107], a[64:67], a[160:163], v[104:107]
    s_add_u32 m0, s27, 2048
    v_mfma_f32_16x16x32_bf16 v[108:111], a[12:15], a[148:151], v[108:111]
    v_mfma_f32_16x16x32_bf16 v[108:111], a[64:67], a[164:167], v[108:111]
    ds_read_b64_tr_b16 a[12:13], v10 offset:96
    v_mfma_f32_16x16x32_bf16 v[112:115], a[136:139], a[16:19], v[112:115]
    ds_read_b64_tr_b16 a[14:15], v10 offset:3168
    v_mfma_f32_16x16x32_bf16 v[112:115], a[152:155], a[68:71], v[112:115]
    ds_read_b64_tr_b16 a[64:65], v10 offset:13408
    v_mfma_f32_16x16x32_bf16 v[116:119], a[140:143], a[16:19], v[116:119]
    ds_read_b64_tr_b16 a[66:67], v10 offset:16480
    v_mfma_f32_16x16x32_bf16 v[116:119], a[156:159], a[68:71], v[116:119]
    buffer_load_dwordx4 v4, s[12:15], s21 offen lds
    v_mfma_f32_16x16x32_bf16 v[120:123], a[144:147], a[16:19], v[120:123]
    s_add_u32 s21, s21, s23
    v_mfma_f32_16x16x32_bf16 v[120:123], a[160:163], a[68:71], v[120:123]
    v_mfma_f32_16x16x32_bf16 v[124:127], a[148:151], a[16:19], v[124:127]
    s_add_u32 m0, s30, 0
    v_mfma_f32_16x16x32_bf16 v[124:127], a[164:167], a[68:71], v[124:127]
    ds_read_b64_tr_b16 a[16:17], v9 offset:128
    v_mfma_f32_16x16x32_bf16 v[128:131], a[136:139], a[20:23], v[128:131]
    ds_read_b64_tr_b16 a[18:19], v9 offset:3200
    v_mfma_f32_16x16x32_bf16 v[128:131], a[152:155], a[72:75], v[128:131]
    ds_read_b64_tr_b16 a[68:69], v9 offset:13440
    v_mfma_f32_16x16x32_bf16 v[132:135], a[140:143], a[20:23], v[132:135]
    ds_read_b64_tr_b16 a[70:71], v9 offset:16512
    v_mfma_f32_16x16x32_bf16 v[132:135], a[156:159], a[72:75], v[132:135]
    v_mfma_f32_16x16x32_bf16 v[136:139], a[144:147], a[20:23], v[136:139]
    s_mov_b64 exec, 0xffff
    buffer_load_dwordx4 v5, s[16:19], s22 offen lds
    s_mov_b64 exec, -1
    v_mfma_f32_16x16x32_bf16 v[136:139], a[160:163], a[72:75], v[136:139]
    s_add_u32 s22, s22, 229376
    v_mfma_f32_16x16x32_bf16 v[140:143], a[148:151], a[20:23], v[140:143]
    v_mfma_f32_16x16x32_bf16 v[140:143], a[164:167], a[72:75], v[140:143]
    ds_read_b64_tr_b16 a[20:21], v10 offset:160
    v_mfma_f32_16x16x32_bf16 v[144:147], a[24:27], a[136:139], v[144:147]
    ds_read_b64_tr_b16 a[22:23], v10 offset:3232
    v_mfma_f32_16x16x32_bf16 v[144:147], a[76:79], a[152:155], v[144:147]
    ds_read_b64_tr_b16 a[72:73], v10 offset:13472
    v_mfma_f32_16x16x32_bf16 v[148:151], a[24:27], a[140:143], v[148:151]
    ds_read_b64_tr_b16 a[74:75], v10 offset:16544
    v_mfma_f32_16x16x32_bf16 v[148:151], a[76:79], a[156:159], v[148:151]
    buffer_load_dwordx4 a[216:219], v1, s[8:11], s20 offen offset:0 sc1
    v_mfma_f32_16x16x32_bf16 v[152:155], a[24:27], a[144:147], v[152:155]
    v_mfma_f32_16x16x32_bf16 v[152:155], a[76:79], a[160:163], v[152:155]
    buffer_load_dwordx4 a[220:223], v1, s[8:11], s20 offen offset:1024 sc1
    v_mfma_f32_16x16x32_bf16 v[156:159], a[24:27], a[148:151], v[156:159]
    buffer_load_dwordx4 a[224:227], v1, s[8:11], s20 offen offset:2048 sc1
    v_mfma_f32_16x16x32_bf16 v[156:159], a[76:79], a[164:167], v[156:159]
    ds_read_b64_tr_b16 a[24:25], v11 offset:6144
    v_mfma_f32_16x16x32_bf16 v[160:163], a[28:31], a[136:139], v[160:163]
    ds_read_b64_tr_b16 a[26:27], v11 offset:9728
    v_mfma_f32_16x16x32_bf16 v[160:163], a[80:83], a[152:155], v[160:163]
    ds_read_b64_tr_b16 a[76:77], v11 offset:19456
    v_mfma_f32_16x16x32_bf16 v[164:167], a[28:31], a[140:143], v[164:167]
    ds_read_b64_tr_b16 a[78:79], v11 offset:23040
    v_mfma_f32_16x16x32_bf16 v[164:167], a[80:83], a[156:159], v[164:167]
    v_mfma_f32_16x16x32_bf16 v[168:171], a[28:31], a[144:147], v[168:171]
    buffer_load_dwordx4 a[228:231], v1, s[8:11], s20 offen offset:3072 sc1
    v_mfma_f32_16x16x32_bf16 v[168:171], a[80:83], a[160:163], v[168:171]
    s_add_u32 s20, s20, 4096
    v_mfma_f32_16x16x32_bf16 v[172:175], a[28:31], a[148:151], v[172:175]
    v_mfma_f32_16x16x32_bf16 v[172:175], a[80:83], a[164:167], v[172:175]
    ds_read_b64_tr_b16 a[28:29], v11 offset:6176
    s_waitcnt lgkmcnt(8)
    v_mfma_f32_16x16x32_bf16 v[176:179], a[32:35], a[136:139], v[176:179]
    ds_read_b64_tr_b16 a[30:31], v11 offset:9760
    v_mfma_f32_16x16x32_bf16 v[176:179], a[84:87], a[152:155], v[176:179]
    ds_read_b64_tr_b16 a[80:81], v11 offset:19488
    v_mfma_f32_16x16x32_bf16 v[180:183], a[32:35], a[140:143], v[180:183]
    ds_read_b64_tr_b16 a[82:83], v11 offset:23072
    v_mfma_f32_16x16x32_bf16 v[180:183], a[84:87], a[156:159], v[180:183]
    s_add_u32 m0, s27, 13312
    v_mfma_f32_16x16x32_bf16 v[184:187], a[32:35], a[144:147], v[184:187]
    v_mfma_f32_16x16x32_bf16 v[184:187], a[84:87], a[160:163], v[184:187]
    buffer_load_dwordx4 v2, s[12:15], s21 offen lds
    v_mfma_f32_16x16x32_bf16 v[188:191], a[32:35], a[148:151], v[188:191]
    s_add_u32 m0, s27, 14336
    v_mfma_f32_16x16x32_bf16 v[188:191], a[84:87], a[164:167], v[188:191]
    ds_read_b64_tr_b16 a[32:33], v11 offset:6208
    v_mfma_f32_16x16x32_bf16 v[192:195], a[36:39], a[136:139], v[192:195]
    ds_read_b64_tr_b16 a[34:35], v11 offset:9792
    v_mfma_f32_16x16x32_bf16 v[192:195], a[88:91], a[152:155], v[192:195]
    ds_read_b64_tr_b16 a[84:85], v11 offset:19520
    v_mfma_f32_16x16x32_bf16 v[196:199], a[36:39], a[140:143], v[196:199]
    ds_read_b64_tr_b16 a[86:87], v11 offset:23104
    v_mfma_f32_16x16x32_bf16 v[196:199], a[88:91], a[156:159], v[196:199]
    v_mfma_f32_16x16x32_bf16 v[200:203], a[36:39], a[144:147], v[200:203]
    buffer_load_dwordx4 v3, s[12:15], s21 offen lds
    v_mfma_f32_16x16x32_bf16 v[200:203], a[88:91], a[160:163], v[200:203]
    v_mfma_f32_16x16x32_bf16 v[204:207], a[36:39], a[148:151], v[204:207]
    s_add_u32 m0, s27, 15360
    v_mfma_f32_16x16x32_bf16 v[204:207], a[88:91], a[164:167], v[204:207]
    ds_read_b64_tr_b16 a[36:37], v11 offset:6240
    v_mfma_f32_16x16x32_bf16 v[208:211], a[40:43], a[136:139], v[208:211]
    ds_read_b64_tr_b16 a[38:39], v11 offset:9824
    v_mfma_f32_16x16x32_bf16 v[208:211], a[92:95], a[152:155], v[208:211]
    ds_read_b64_tr_b16 a[88:89], v11 offset:19552
    v_mfma_f32_16x16x32_bf16 v[212:215], a[40:43], a[140:143], v[212:215]
    ds_read_b64_tr_b16 a[90:91], v11 offset:23136
    v_mfma_f32_16x16x32_bf16 v[212:215], a[92:95], a[156:159], v[212:215]
    buffer_load_dwordx4 v4, s[12:15], s21 offen lds
    v_mfma_f32_16x16x32_bf16 v[216:219], a[40:43], a[144:147], v[216:219]
    v_mfma_f32_16x16x32_bf16 v[216:219], a[92:95], a[160:163], v[216:219]
    s_add_u32 s21, s21, s23
    v_mfma_f32_16x16x32_bf16 v[220:223], a[40:43], a[148:151], v[220:223]
    s_add_u32 m0, s30, 13312
    v_mfma_f32_16x16x32_bf16 v[220:223], a[92:95], a[164:167], v[220:223]
    ds_read_b64_tr_b16 a[40:41], v11 offset:6272
    v_mfma_f32_16x16x32_bf16 v[224:227], a[44:47], a[136:139], v[224:227]
    ds_read_b64_tr_b16 a[42:43], v11 offset:9856
    v_mfma_f32_16x16x32_bf16 v[224:227], a[96:99], a[152:155], v[224:227]
    ds_read_b64_tr_b16 a[92:93], v11 offset:19584
    v_mfma_f32_16x16x32_bf16 v[228:231], a[44:47], a[140:143], v[228:231]
    ds_read_b64_tr_b16 a[94:95], v11 offset:23168
    v_mfma_f32_16x16x32_bf16 v[228:231], a[96:99], a[156:159], v[228:231]
    v_mfma_f32_16x16x32_bf16 v[232:235], a[44:47], a[144:147], v[232:235]
    s_mov_b64 exec, 0xffff
    buffer_load_dwordx4 v5, s[16:19], s22 offen lds
    s_mov_b64 exec, -1
    v_mfma_f32_16x16x32_bf16 v[232:235], a[96:99], a[160:163], v[232:235]
    v_mfma_f32_16x16x32_bf16 v[236:239], a[44:47], a[148:151], v[236:239]
    s_add_u32 s22, s22, 229376
    v_mfma_f32_16x16x32_bf16 v[236:239], a[96:99], a[164:167], v[236:239]
    ds_read_b64_tr_b16 a[44:45], v11 offset:6304
    v_mfma_f32_16x16x32_bf16 v[240:243], a[48:51], a[136:139], v[240:243]
    ds_read_b64_tr_b16 a[46:47], v11 offset:9888
    v_mfma_f32_16x16x32_bf16 v[240:243], a[100:103], a[152:155], v[240:243]
    ds_read_b64_tr_b16 a[96:97], v11 offset:19616
    v_mfma_f32_16x16x32_bf16 v[244:247], a[48:51], a[140:143], v[244:247]
    ds_read_b64_tr_b16 a[98:99], v11 offset:23200
    v_mfma_f32_16x16x32_bf16 v[244:247], a[100:103], a[156:159], v[244:247]
    buffer_load_dwordx4 v[16:19], v15, s[44:47], s48 offen
    v_mfma_f32_16x16x32_bf16 v[248:251], a[48:51], a[144:147], v[248:251]
    v_mfma_f32_16x16x32_bf16 v[248:251], a[100:103], a[160:163], v[248:251]
    s_add_u32 s48, s48, 1048576
    v_mfma_f32_16x16x32_bf16 v[252:255], a[48:51], a[148:151], v[252:255]
    v_mfma_f32_16x16x32_bf16 v[252:255], a[100:103], a[164:167], v[252:255]
    ds_read_b64_tr_b16 a[48:49], v11 offset:6336
    ds_read_b64_tr_b16 a[50:51], v11 offset:9920
    ds_read_b64_tr_b16 a[100:101], v11 offset:19648
    ds_read_b64_tr_b16 a[102:103], v11 offset:23232
    s_waitcnt vmcnt(18)
    s_barrier
    s_waitcnt lgkmcnt(8)
    v_mfma_f32_16x16x32_bf16 v[48:51], a[0:3], a[168:171], v[48:51]
    v_mfma_f32_16x16x32_bf16 v[48:51], a[52:55], a[184:187], v[48:51]
    v_mfma_f32_16x16x32_bf16 v[52:55], a[0:3], a[172:175], v[52:55]
    v_mfma_f32_16x16x32_bf16 v[52:55], a[52:55], a[188:191], v[52:55]
    buffer_load_dwordx4 a[104:107], v1, s[8:11], s20 offen offset:0 sc1
    v_mfma_f32_16x16x32_bf16 v[56:59], a[0:3], a[176:179], v[56:59]
    buffer_load_dwordx4 a[108:111], v1, s[8:11], s20 offen offset:1024 sc1
    v_mfma_f32_16x16x32_bf16 v[56:59], a[52:55], a[192:195], v[56:59]
    v_mfma_f32_16x16x32_bf16 v[60:63], a[0:3], a[180:183], v[60:63]
    buffer_load_dwordx4 a[112:115], v1, s[8:11], s20 offen offset:2048 sc1
    v_mfma_f32_16x16x32_bf16 v[60:63], a[52:55], a[196:199], v[60:63]
    ds_read_b64_tr_b16 a[0:1], v9 offset:26624
    v_mfma_f32_16x16x32_bf16 v[64:67], a[4:7], a[168:171], v[64:67]
    ds_read_b64_tr_b16 a[2:3], v9 offset:29696
    v_mfma_f32_16x16x32_bf16 v[64:67], a[56:59], a[184:187], v[64:67]
    ds_read_b64_tr_b16 a[52:53], v9 offset:39936
    v_mfma_f32_16x16x32_bf16 v[68:71], a[4:7], a[172:175], v[68:71]
    ds_read_b64_tr_b16 a[54:55], v9 offset:43008
    v_mfma_f32_16x16x32_bf16 v[68:71], a[56:59], a[188:191], v[68:71]
    v_mfma_f32_16x16x32_bf16 v[72:75], a[4:7], a[176:179], v[72:75]
    buffer_load_dwordx4 a[116:119], v1, s[8:11], s20 offen offset:3072 sc1
    v_mfma_f32_16x16x32_bf16 v[72:75], a[56:59], a[192:195], v[72:75]
    s_add_u32 s20, s20, 4096
    v_mfma_f32_16x16x32_bf16 v[76:79], a[4:7], a[180:183], v[76:79]
    v_mfma_f32_16x16x32_bf16 v[76:79], a[56:59], a[196:199], v[76:79]
    ds_read_b64_tr_b16 a[4:5], v10 offset:26656
    v_mfma_f32_16x16x32_bf16 v[80:83], a[8:11], a[168:171], v[80:83]
    ds_read_b64_tr_b16 a[6:7], v10 offset:29728
    v_mfma_f32_16x16x32_bf16 v[80:83], a[60:63], a[184:187], v[80:83]
    ds_read_b64_tr_b16 a[56:57], v10 offset:39968
    v_mfma_f32_16x16x32_bf16 v[84:87], a[8:11], a[172:175], v[84:87]
    ds_read_b64_tr_b16 a[58:59], v10 offset:43040
    v_mfma_f32_16x16x32_bf16 v[84:87], a[60:63], a[188:191], v[84:87]
    s_add_u32 m0, s27, 26624
    v_mfma_f32_16x16x32_bf16 v[88:91], a[8:11], a[176:179], v[88:91]
    v_mfma_f32_16x16x32_bf16 v[88:91], a[60:63], a[192:195], v[88:91]
    buffer_load_dwordx4 v2, s[12:15], s21 offen lds
    v_mfma_f32_16x16x32_bf16 v[92:95], a[8:11], a[180:183], v[92:95]
    v_mfma_f32_16x16x32_bf16 v[92:95], a[60:63], a[196:199], v[92:95]
    ds_read_b64_tr_b16 a[8:9], v9 offset:26688
    v_mfma_f32_16x16x32_bf16 v[96:99], a[12:15], a[168:171], v[96:99]
    ds_read_b64_tr_b16 a[10:11], v9 offset:29760
    v_mfma_f32_16x16x32_bf16 v[96:99], a[64:67], a[184:187], v[96:99]
    ds_read_b64_tr_b16 a[60:61], v9 offset:40000
    v_mfma_f32_16x16x32_bf16 v[100:103], a[12:15], a[172:175], v[100:103]
    ds_read_b64_tr_b16 a[62:63], v9 offset:43072
    v_mfma_f32_16x16x32_bf16 v[100:103], a[64:67], a[188:191], v[100:103]
    s_add_u32 m0, s27, 27648
    v_mfma_f32_16x16x32_bf16 v[104:107], a[12:15], a[176:179], v[104:107]
    buffer_load_dwordx4 v3, s[12:15], s21 offen lds
    v_mfma_f32_16x16x32_bf16 v[104:107], a[64:67], a[192:195], v[104:107]
    v_mfma_f32_16x16x32_bf16 v[108:111], a[12:15], a[180:183], v[108:111]
    s_add_u32 m0, s27, 28672
    v_mfma_f32_16x16x32_bf16 v[108:111], a[64:67], a[196:199], v[108:111]
    ds_read_b64_tr_b16 a[12:13], v10 offset:26720
    v_mfma_f32_16x16x32_bf16 v[112:115], a[168:171], a[16:19], v[112:115]
    ds_read_b64_tr_b16 a[14:15], v10 offset:29792
    v_mfma_f32_16x16x32_bf16 v[112:115], a[184:187], a[68:71], v[112:115]
    ds_read_b64_tr_b16 a[64:65], v10 offset:40032
    v_mfma_f32_16x16x32_bf16 v[116:119], a[172:175], a[16:19], v[116:119]
    ds_read_b64_tr_b16 a[66:67], v10 offset:43104
    v_mfma_f32_16x16x32_bf16 v[116:119], a[188:191], a[68:71], v[116:119]
    v_mfma_f32_16x16x32_bf16 v[120:123], a[176:179], a[16:19], v[120:123]
    buffer_load_dwordx4 v4, s[12:15], s21 offen lds
    v_mfma_f32_16x16x32_bf16 v[120:123], a[192:195], a[68:71], v[120:123]
    v_mfma_f32_16x16x32_bf16 v[124:127], a[180:183], a[16:19], v[124:127]
    s_add_u32 s21, s21, s23
    v_mfma_f32_16x16x32_bf16 v[124:127], a[196:199], a[68:71], v[124:127]
    ds_read_b64_tr_b16 a[16:17], v9 offset:26752
    v_mfma_f32_16x16x32_bf16 v[128:131], a[168:171], a[20:23], v[128:131]
    ds_read_b64_tr_b16 a[18:19], v9 offset:29824
    v_mfma_f32_16x16x32_bf16 v[128:131], a[184:187], a[72:75], v[128:131]
    ds_read_b64_tr_b16 a[68:69], v9 offset:40064
    v_mfma_f32_16x16x32_bf16 v[132:135], a[172:175], a[20:23], v[132:135]
    ds_read_b64_tr_b16 a[70:71], v9 offset:43136
    v_mfma_f32_16x16x32_bf16 v[132:135], a[188:191], a[72:75], v[132:135]
    s_add_u32 m0, s30, 26624
    v_mfma_f32_16x16x32_bf16 v[136:139], a[176:179], a[20:23], v[136:139]
    v_mfma_f32_16x16x32_bf16 v[136:139], a[192:195], a[72:75], v[136:139]
    s_mov_b64 exec, 0xffff
    buffer_load_dwordx4 v5, s[16:19], s22 offen lds
    s_mov_b64 exec, -1
    v_mfma_f32_16x16x32_bf16 v[140:143], a[180:183], a[20:23], v[140:143]
    v_mfma_f32_16x16x32_bf16 v[140:143], a[196:199], a[72:75], v[140:143]
    ds_read_b64_tr_b16 a[20:21], v10 offset:26784
    v_mfma_f32_16x16x32_bf16 v[144:147], a[24:27], a[168:171], v[144:147]
    ds_read_b64_tr_b16 a[22:23], v10 offset:29856
    v_mfma_f32_16x16x32_bf16 v[144:147], a[76:79], a[184:187], v[144:147]
    ds_read_b64_tr_b16 a[72:73], v10 offset:40096
    v_mfma_f32_16x16x32_bf16 v[148:151], a[24:27], a[172:175], v[148:151]
    ds_read_b64_tr_b16 a[74:75], v10 offset:43168
    v_mfma_f32_16x16x32_bf16 v[148:151], a[76:79], a[188:191], v[148:151]
    s_add_u32 s22, s22, 229376
    v_mfma_f32_16x16x32_bf16 v[152:155], a[24:27], a[176:179], v[152:155]
    v_mfma_f32_16x16x32_bf16 v[152:155], a[76:79], a[192:195], v[152:155]
    buffer_load_dwordx4 a[120:123], v1, s[8:11], s20 offen offset:0 sc1
    v_mfma_f32_16x16x32_bf16 v[156:159], a[24:27], a[180:183], v[156:159]
    buffer_load_dwordx4 a[124:127], v1, s[8:11], s20 offen offset:1024 sc1
    v_mfma_f32_16x16x32_bf16 v[156:159], a[76:79], a[196:199], v[156:159]
    ds_read_b64_tr_b16 a[24:25], v11 offset:32768
    v_mfma_f32_16x16x32_bf16 v[160:163], a[28:31], a[168:171], v[160:163]
    ds_read_b64_tr_b16 a[26:27], v11 offset:36352
    v_mfma_f32_16x16x32_bf16 v[160:163], a[80:83], a[184:187], v[160:163]
    ds_read_b64_tr_b16 a[76:77], v11 offset:46080
    v_mfma_f32_16x16x32_bf16 v[164:167], a[28:31], a[172:175], v[164:167]
    ds_read_b64_tr_b16 a[78:79], v11 offset:49664
    v_mfma_f32_16x16x32_bf16 v[164:167], a[80:83], a[188:191], v[164:167]
    v_mfma_f32_16x16x32_bf16 v[168:171], a[28:31], a[176:179], v[168:171]
    buffer_load_dwordx4 a[128:131], v1, s[8:11], s20 offen offset:2048 sc1
    v_mfma_f32_16x16x32_bf16 v[168:171], a[80:83], a[192:195], v[168:171]
    v_mfma_f32_16x16x32_bf16 v[172:175], a[28:31], a[180:183], v[172:175]
    buffer_load_dwordx4 a[132:135], v1, s[8:11], s20 offen offset:3072 sc1
    v_mfma_f32_16x16x32_bf16 v[172:175], a[80:83], a[196:199], v[172:175]
    ds_read_b64_tr_b16 a[28:29], v11 offset:32800
    s_waitcnt lgkmcnt(8)
    v_mfma_f32_16x16x32_bf16 v[176:179], a[32:35], a[168:171], v[176:179]
    ds_read_b64_tr_b16 a[30:31], v11 offset:36384
    v_mfma_f32_16x16x32_bf16 v[176:179], a[84:87], a[184:187], v[176:179]
    ds_read_b64_tr_b16 a[80:81], v11 offset:46112
    v_mfma_f32_16x16x32_bf16 v[180:183], a[32:35], a[172:175], v[180:183]
    ds_read_b64_tr_b16 a[82:83], v11 offset:49696
    v_mfma_f32_16x16x32_bf16 v[180:183], a[84:87], a[188:191], v[180:183]
    s_add_u32 s20, s20, 4096
    v_mfma_f32_16x16x32_bf16 v[184:187], a[32:35], a[176:179], v[184:187]
    v_mfma_f32_16x16x32_bf16 v[184:187], a[84:87], a[192:195], v[184:187]
    s_add_u32 m0, s27, 39936
    v_mfma_f32_16x16x32_bf16 v[188:191], a[32:35], a[180:183], v[188:191]
    v_mfma_f32_16x16x32_bf16 v[188:191], a[84:87], a[196:199], v[188:191]
    ds_read_b64_tr_b16 a[32:33], v11 offset:32832
    v_mfma_f32_16x16x32_bf16 v[192:195], a[36:39], a[168:171], v[192:195]
    ds_read_b64_tr_b16 a[34:35], v11 offset:36416
    v_mfma_f32_16x16x32_bf16 v[192:195], a[88:91], a[184:187], v[192:195]
    ds_read_b64_tr_b16 a[84:85], v11 offset:46144
    v_mfma_f32_16x16x32_bf16 v[196:199], a[36:39], a[172:175], v[196:199]
    ds_read_b64_tr_b16 a[86:87], v11 offset:49728
    v_mfma_f32_16x16x32_bf16 v[196:199], a[88:91], a[188:191], v[196:199]
    buffer_load_dwordx4 v2, s[12:15], s21 offen lds
    v_mfma_f32_16x16x32_bf16 v[200:203], a[36:39], a[176:179], v[200:203]
    v_mfma_f32_16x16x32_bf16 v[200:203], a[88:91], a[192:195], v[200:203]
    s_add_u32 m0, s27, 40960
    v_mfma_f32_16x16x32_bf16 v[204:207], a[36:39], a[180:183], v[204:207]
    buffer_load_dwordx4 v3, s[12:15], s21 offen lds
    v_mfma_f32_16x16x32_bf16 v[204:207], a[88:91], a[196:199], v[204:207]
    ds_read_b64_tr_b16 a[36:37], v11 offset:32864
    v_mfma_f32_16x16x32_bf16 v[208:211], a[40:43], a[168:171], v[208:211]
    ds_read_b64_tr_b16 a[38:39], v11 offset:36448
    v_mfma_f32_16x16x32_bf16 v[208:211], a[92:95], a[184:187], v[208:211]
    ds_read_b64_tr_b16 a[88:89], v11 offset:46176
    v_mfma_f32_16x16x32_bf16 v[212:215], a[40:43], a[172:175], v[212:215]
    ds_read_b64_tr_b16 a[90:91], v11 offset:49760
    v_mfma_f32_16x16x32_bf16 v[212:215], a[92:95], a[188:191], v[212:215]
    v_mfma_f32_16x16x32_bf16 v[216:219], a[40:43], a[176:179], v[216:219]
    s_add_u32 m0, s27, 41984
    v_mfma_f32_16x16x32_bf16 v[216:219], a[92:95], a[192:195], v[216:219]
    v_mfma_f32_16x16x32_bf16 v[220:223], a[40:43], a[180:183], v[220:223]
    buffer_load_dwordx4 v4, s[12:15], s21 offen lds
    v_mfma_f32_16x16x32_bf16 v[220:223], a[92:95], a[196:199], v[220:223]
    ds_read_b64_tr_b16 a[40:41], v11 offset:32896
    v_mfma_f32_16x16x32_bf16 v[224:227], a[44:47], a[168:171], v[224:227]
    ds_read_b64_tr_b16 a[42:43], v11 offset:36480
    v_mfma_f32_16x16x32_bf16 v[224:227], a[96:99], a[184:187], v[224:227]
    ds_read_b64_tr_b16 a[92:93], v11 offset:46208
    v_mfma_f32_16x16x32_bf16 v[228:231], a[44:47], a[172:175], v[228:231]
    ds_read_b64_tr_b16 a[94:95], v11 offset:49792
    v_mfma_f32_16x16x32_bf16 v[228:231], a[96:99], a[188:191], v[228:231]
    v_mfma_f32_16x16x32_bf16 v[232:235], a[44:47], a[176:179], v[232:235]
    s_add_u32 s21, s21, s23
    v_mfma_f32_16x16x32_bf16 v[232:235], a[96:99], a[192:195], v[232:235]
    s_add_u32 m0, s30, 39936
    v_mfma_f32_16x16x32_bf16 v[236:239], a[44:47], a[180:183], v[236:239]
    v_mfma_f32_16x16x32_bf16 v[236:239], a[96:99], a[196:199], v[236:239]
    ds_read_b64_tr_b16 a[44:45], v11 offset:32928
    v_mfma_f32_16x16x32_bf16 v[240:243], a[48:51], a[168:171], v[240:243]
    ds_read_b64_tr_b16 a[46:47], v11 offset:36512
    v_mfma_f32_16x16x32_bf16 v[240:243], a[100:103], a[184:187], v[240:243]
    ds_read_b64_tr_b16 a[96:97], v11 offset:46240
    v_mfma_f32_16x16x32_bf16 v[244:247], a[48:51], a[172:175], v[244:247]
    ds_read_b64_tr_b16 a[98:99], v11 offset:49824
    v_mfma_f32_16x16x32_bf16 v[244:247], a[100:103], a[188:191], v[244:247]
    s_mov_b64 exec, 0xffff
    buffer_load_dwordx4 v5, s[16:19], s22 offen lds
    s_mov_b64 exec, -1
    v_mfma_f32_16x16x32_bf16 v[248:251], a[48:51], a[176:179], v[248:251]
    v_mfma_f32_16x16x32_bf16 v[248:251], a[100:103], a[192:195], v[248:251]
    s_add_u32 s22, s22, 229376
    v_mfma_f32_16x16x32_bf16 v[252:255], a[48:51], a[180:183], v[252:255]
    v_mfma_f32_16x16x32_bf16 v[252:255], a[100:103], a[196:199], v[252:255]
    ds_read_b64_tr_b16 a[48:49], v11 offset:32960
    ds_read_b64_tr_b16 a[50:51], v11 offset:36544
    ds_read_b64_tr_b16 a[100:101], v11 offset:46272
    ds_read_b64_tr_b16 a[102:103], v11 offset:49856
    s_waitcnt vmcnt(17)
    s_barrier
    s_waitcnt lgkmcnt(8)
    v_mfma_f32_16x16x32_bf16 v[48:51], a[0:3], a[200:203], v[48:51]
    v_mfma_f32_16x16x32_bf16 v[48:51], a[52:55], a[216:219], v[48:51]
    v_mfma_f32_16x16x32_bf16 v[52:55], a[0:3], a[204:207], v[52:55]
    v_mfma_f32_16x16x32_bf16 v[52:55], a[52:55], a[220:223], v[52:55]
    buffer_load_dwordx4 a[136:139], v1, s[8:11], s20 offen offset:0 sc1
    v_mfma_f32_16x16x32_bf16 v[56:59], a[0:3], a[208:211], v[56:59]
    buffer_load_dwordx4 a[140:143], v1, s[8:11], s20 offen offset:1024 sc1
    v_mfma_f32_16x16x32_bf16 v[56:59], a[52:55], a[224:227], v[56:59]
    v_mfma_f32_16x16x32_bf16 v[60:63], a[0:3], a[212:215], v[60:63]
    buffer_load_dwordx4 a[144:147], v1, s[8:11], s20 offen offset:2048 sc1
    v_mfma_f32_16x16x32_bf16 v[60:63], a[52:55], a[228:231], v[60:63]
    ds_read_b64_tr_b16 a[0:1], v6 offset:0
    v_mfma_f32_16x16x32_bf16 v[64:67], a[4:7], a[200:203], v[64:67]
    ds_read_b64_tr_b16 a[2:3], v6 offset:3072
    v_mfma_f32_16x16x32_bf16 v[64:67], a[56:59], a[216:219], v[64:67]
    ds_read_b64_tr_b16 a[52:53], v6 offset:13312
    v_mfma_f32_16x16x32_bf16 v[68:71], a[4:7], a[204:207], v[68:71]
    ds_read_b64_tr_b16 a[54:55], v6 offset:16384
    v_mfma_f32_16x16x32_bf16 v[68:71], a[56:59], a[220:223], v[68:71]
    buffer_load_dwordx4 a[148:151], v1, s[8:11], s20 offen offset:3072 sc1
    v_mfma_f32_16x16x32_bf16 v[72:75], a[4:7], a[208:211], v[72:75]
    v_mfma_f32_16x16x32_bf16 v[72:75], a[56:59], a[224:227], v[72:75]
    s_add_u32 s20, s20, 4096
    v_mfma_f32_16x16x32_bf16 v[76:79], a[4:7], a[212:215], v[76:79]
    s_add_u32 m0, s27, 53248
    v_mfma_f32_16x16x32_bf16 v[76:79], a[56:59], a[228:231], v[76:79]
    ds_read_b64_tr_b16 a[4:5], v7 offset:32
    v_mfma_f32_16x16x32_bf16 v[80:83], a[8:11], a[200:203], v[80:83]
    ds_read_b64_tr_b16 a[6:7], v7 offset:3104
    v_mfma_f32_16x16x32_bf16 v[80:83], a[60:63], a[216:219], v[80:83]
    ds_read_b64_tr_b16 a[56:57], v7 offset:13344
    v_mfma_f32_16x16x32_bf16 v[84:87], a[8:11], a[204:207], v[84:87]
    ds_read_b64_tr_b16 a[58:59], v7 offset:16416
    v_mfma_f32_16x16x32_bf16 v[84:87], a[60:63], a[220:223], v[84:87]
    v_mfma_f32_16x16x32_bf16 v[88:91], a[8:11], a[208:211], v[88:91]
    buffer_load_dwordx4 v2, s[12:15], s21 offen lds
    v_mfma_f32_16x16x32_bf16 v[88:91], a[60:63], a[224:227], v[88:91]
    s_add_u32 m0, s27, 54272
    v_mfma_f32_16x16x32_bf16 v[92:95], a[8:11], a[212:215], v[92:95]
    v_mfma_f32_16x16x32_bf16 v[92:95], a[60:63], a[228:231], v[92:95]
    ds_read_b64_tr_b16 a[8:9], v6 offset:64
    v_mfma_f32_16x16x32_bf16 v[96:99], a[12:15], a[200:203], v[96:99]
    ds_read_b64_tr_b16 a[10:11], v6 offset:3136
    v_mfma_f32_16x16x32_bf16 v[96:99], a[64:67], a[216:219], v[96:99]
    ds_read_b64_tr_b16 a[60:61], v6 offset:13376
    v_mfma_f32_16x16x32_bf16 v[100:103], a[12:15], a[204:207], v[100:103]
    ds_read_b64_tr_b16 a[62:63], v6 offset:16448
    v_mfma_f32_16x16x32_bf16 v[100:103], a[64:67], a[220:223], v[100:103]
    buffer_load_dwordx4 v3, s[12:15], s21 offen lds
    v_mfma_f32_16x16x32_bf16 v[104:107], a[12:15], a[208:211], v[104:107]
    s_add_u32 m0, s27, 55296
    v_mfma_f32_16x16x32_bf16 v[104:107], a[64:67], a[224:227], v[104:107]
    v_mfma_f32_16x16x32_bf16 v[108:111], a[12:15], a[212:215], v[108:111]
    buffer_load_dwordx4 v4, s[12:15], s21 offen lds
    v_mfma_f32_16x16x32_bf16 v[108:111], a[64:67], a[228:231], v[108:111]
    ds_read_b64_tr_b16 a[12:13], v7 offset:96
    v_mfma_f32_16x16x32_bf16 v[112:115], a[200:203], a[16:19], v[112:115]
    ds_read_b64_tr_b16 a[14:15], v7 offset:3168
    v_mfma_f32_16x16x32_bf16 v[112:115], a[216:219], a[68:71], v[112:115]
    ds_read_b64_tr_b16 a[64:65], v7 offset:13408
    v_mfma_f32_16x16x32_bf16 v[116:119], a[204:207], a[16:19], v[116:119]
    ds_read_b64_tr_b16 a[66:67], v7 offset:16480
    v_mfma_f32_16x16x32_bf16 v[116:119], a[220:223], a[68:71], v[116:119]
    s_add_u32 s21, s21, s23
    v_mfma_f32_16x16x32_bf16 v[120:123], a[208:211], a[16:19], v[120:123]
    v_mfma_f32_16x16x32_bf16 v[120:123], a[224:227], a[68:71], v[120:123]
    s_add_u32 m0, s30, 53248
    v_mfma_f32_16x16x32_bf16 v[124:127], a[212:215], a[16:19], v[124:127]
    s_mov_b64 exec, 0xffff
    buffer_load_dwordx4 v5, s[16:19], s22 offen lds
    s_mov_b64 exec, -1
    v_mfma_f32_16x16x32_bf16 v[124:127], a[228:231], a[68:71], v[124:127]
    ds_read_b64_tr_b16 a[16:17], v6 offset:128
    v_mfma_f32_16x16x32_bf16 v[128:131], a[200:203], a[20:23], v[128:131]
    ds_read_b64_tr_b16 a[18:19], v6 offset:3200
    v_mfma_f32_16x16x32_bf16 v[128:131], a[216:219], a[72:75], v[128:131]
    ds_read_b64_tr_b16 a[68:69], v6 offset:13440
    v_mfma_f32_16x16x32_bf16 v[132:135], a[204:207], a[20:23], v[132:135]
    ds_read_b64_tr_b16 a[70:71], v6 offset:16512
    v_mfma_f32_16x16x32_bf16 v[132:135], a[220:223], a[72:75], v[132:135]
    v_mfma_f32_16x16x32_bf16 v[136:139], a[208:211], a[20:23], v[136:139]
    s_add_u32 s22, s22, 229376
    v_mfma_f32_16x16x32_bf16 v[136:139], a[224:227], a[72:75], v[136:139]
    buffer_load_dwordx4 a[152:155], v1, s[8:11], s20 offen offset:0 sc1
    v_mfma_f32_16x16x32_bf16 v[140:143], a[212:215], a[20:23], v[140:143]
    v_mfma_f32_16x16x32_bf16 v[140:143], a[228:231], a[72:75], v[140:143]
    ds_read_b64_tr_b16 a[20:21], v7 offset:160
    v_mfma_f32_16x16x32_bf16 v[144:147], a[24:27], a[200:203], v[144:147]
    ds_read_b64_tr_b16 a[22:23], v7 offset:3232
    v_mfma_f32_16x16x32_bf16 v[144:147], a[76:79], a[216:219], v[144:147]
    ds_read_b64_tr_b16 a[72:73], v7 offset:13472
    v_mfma_f32_16x16x32_bf16 v[148:151], a[24:27], a[204:207], v[148:151]
    ds_read_b64_tr_b16 a[74:75], v7 offset:16544
    v_mfma_f32_16x16x32_bf16 v[148:151], a[76:79], a[220:223], v[148:151]
    buffer_load_dwordx4 a[156:159], v1, s[8:11], s20 offen offset:1024 sc1
    v_mfma_f32_16x16x32_bf16 v[152:155], a[24:27], a[208:211], v[152:155]
    v_mfma_f32_16x16x32_bf16 v[152:155], a[76:79], a[224:227], v[152:155]
    buffer_load_dwordx4 a[160:163], v1, s[8:11], s20 offen offset:2048 sc1
    v_mfma_f32_16x16x32_bf16 v[156:159], a[24:27], a[212:215], v[156:159]
    buffer_load_dwordx4 a[164:167], v1, s[8:11], s20 offen offset:3072 sc1
    v_mfma_f32_16x16x32_bf16 v[156:159], a[76:79], a[228:231], v[156:159]
    ds_read_b64_tr_b16 a[24:25], v8 offset:6144
    v_mfma_f32_16x16x32_bf16 v[160:163], a[28:31], a[200:203], v[160:163]
    ds_read_b64_tr_b16 a[26:27], v8 offset:9728
    v_mfma_f32_16x16x32_bf16 v[160:163], a[80:83], a[216:219], v[160:163]
    ds_read_b64_tr_b16 a[76:77], v8 offset:19456
    v_mfma_f32_16x16x32_bf16 v[164:167], a[28:31], a[204:207], v[164:167]
    ds_read_b64_tr_b16 a[78:79], v8 offset:23040
    v_mfma_f32_16x16x32_bf16 v[164:167], a[80:83], a[220:223], v[164:167]
    v_mfma_f32_16x16x32_bf16 v[168:171], a[28:31], a[208:211], v[168:171]
    s_add_u32 s20, s20, 4096
    v_mfma_f32_16x16x32_bf16 v[168:171], a[80:83], a[224:227], v[168:171]
    s_add_u32 m0, s27, 66560
    v_mfma_f32_16x16x32_bf16 v[172:175], a[28:31], a[212:215], v[172:175]
    v_mfma_f32_16x16x32_bf16 v[172:175], a[80:83], a[228:231], v[172:175]
    ds_read_b64_tr_b16 a[28:29], v8 offset:6176
    s_waitcnt lgkmcnt(8)
    v_mfma_f32_16x16x32_bf16 v[176:179], a[32:35], a[200:203], v[176:179]
    ds_read_b64_tr_b16 a[30:31], v8 offset:9760
    v_mfma_f32_16x16x32_bf16 v[176:179], a[84:87], a[216:219], v[176:179]
    ds_read_b64_tr_b16 a[80:81], v8 offset:19488
    v_mfma_f32_16x16x32_bf16 v[180:183], a[32:35], a[204:207], v[180:183]
    ds_read_b64_tr_b16 a[82:83], v8 offset:23072
    v_mfma_f32_16x16x32_bf16 v[180:183], a[84:87], a[220:223], v[180:183]
    buffer_load_dwordx4 v2, s[12:15], s21 offen lds
    v_mfma_f32_16x16x32_bf16 v[184:187], a[32:35], a[208:211], v[184:187]
    s_add_u32 m0, s27, 67584
    v_mfma_f32_16x16x32_bf16 v[184:187], a[84:87], a[224:227], v[184:187]
    v_mfma_f32_16x16x32_bf16 v[188:191], a[32:35], a[212:215], v[188:191]
    buffer_load_dwordx4 v3, s[12:15], s21 offen lds
    v_mfma_f32_16x16x32_bf16 v[188:191], a[84:87], a[228:231], v[188:191]
    ds_read_b64_tr_b16 a[32:33], v8 offset:6208
    v_mfma_f32_16x16x32_bf16 v[192:195], a[36:39], a[200:203], v[192:195]
    ds_read_b64_tr_b16 a[34:35], v8 offset:9792
    v_mfma_f32_16x16x32_bf16 v[192:195], a[88:91], a[216:219], v[192:195]
    ds_read_b64_tr_b16 a[84:85], v8 offset:19520
    v_mfma_f32_16x16x32_bf16 v[196:199], a[36:39], a[204:207], v[196:199]
    ds_read_b64_tr_b16 a[86:87], v8 offset:23104
    v_mfma_f32_16x16x32_bf16 v[196:199], a[88:91], a[220:223], v[196:199]
    s_add_u32 m0, s27, 68608
    v_mfma_f32_16x16x32_bf16 v[200:203], a[36:39], a[208:211], v[200:203]
    v_mfma_f32_16x16x32_bf16 v[200:203], a[88:91], a[224:227], v[200:203]
    buffer_load_dwordx4 v4, s[12:15], s21 offen lds
    v_mfma_f32_16x16x32_bf16 v[204:207], a[36:39], a[212:215], v[204:207]
    s_add_u32 s21, s21, s23
    v_mfma_f32_16x16x32_bf16 v[204:207], a[88:91], a[228:231], v[204:207]
    ds_read_b64_tr_b16 a[36:37], v8 offset:6240
    v_mfma_f32_16x16x32_bf16 v[208:211], a[40:43], a[200:203], v[208:211]
    ds_read_b64_tr_b16 a[38:39], v8 offset:9824
    v_mfma_f32_16x16x32_bf16 v[208:211], a[92:95], a[216:219], v[208:211]
    ds_read_b64_tr_b16 a[88:89], v8 offset:19552
    v_mfma_f32_16x16x32_bf16 v[212:215], a[40:43], a[204:207], v[212:215]
    ds_read_b64_tr_b16 a[90:91], v8 offset:23136
    v_mfma_f32_16x16x32_bf16 v[212:215], a[92:95], a[220:223], v[212:215]
    v_mfma_f32_16x16x32_bf16 v[216:219], a[40:43], a[208:211], v[216:219]
    s_add_u32 m0, s30, 66560
    v_mfma_f32_16x16x32_bf16 v[216:219], a[92:95], a[224:227], v[216:219]
    s_mov_b64 exec, 0xffff
    buffer_load_dwordx4 v5, s[16:19], s22 offen lds
    s_mov_b64 exec, -1
    v_mfma_f32_16x16x32_bf16 v[220:223], a[40:43], a[212:215], v[220:223]
    v_mfma_f32_16x16x32_bf16 v[220:223], a[92:95], a[228:231], v[220:223]
    ds_read_b64_tr_b16 a[40:41], v8 offset:6272
    v_mfma_f32_16x16x32_bf16 v[224:227], a[44:47], a[200:203], v[224:227]
    ds_read_b64_tr_b16 a[42:43], v8 offset:9856
    v_mfma_f32_16x16x32_bf16 v[224:227], a[96:99], a[216:219], v[224:227]
    ds_read_b64_tr_b16 a[92:93], v8 offset:19584
    v_mfma_f32_16x16x32_bf16 v[228:231], a[44:47], a[204:207], v[228:231]
    ds_read_b64_tr_b16 a[94:95], v8 offset:23168
    v_mfma_f32_16x16x32_bf16 v[228:231], a[96:99], a[220:223], v[228:231]
    s_add_u32 s22, s22, 229376
    v_mfma_f32_16x16x32_bf16 v[232:235], a[44:47], a[208:211], v[232:235]
    buffer_load_dwordx4 v[16:19], v15, s[16:19], s49 offen
    v_mfma_f32_16x16x32_bf16 v[232:235], a[96:99], a[224:227], v[232:235]
    v_mfma_f32_16x16x32_bf16 v[236:239], a[44:47], a[212:215], v[236:239]
    s_add_u32 s49, s49, 1048576
    v_mfma_f32_16x16x32_bf16 v[236:239], a[96:99], a[228:231], v[236:239]
    ds_read_b64_tr_b16 a[44:45], v8 offset:6304
    v_mfma_f32_16x16x32_bf16 v[240:243], a[48:51], a[200:203], v[240:243]
    ds_read_b64_tr_b16 a[46:47], v8 offset:9888
    v_mfma_f32_16x16x32_bf16 v[240:243], a[100:103], a[216:219], v[240:243]
    ds_read_b64_tr_b16 a[96:97], v8 offset:19616
    v_mfma_f32_16x16x32_bf16 v[244:247], a[48:51], a[204:207], v[244:247]
    ds_read_b64_tr_b16 a[98:99], v8 offset:23200
    v_mfma_f32_16x16x32_bf16 v[244:247], a[100:103], a[220:223], v[244:247]
    buffer_load_dwordx4 v[16:19], v15, s[44:47], s48 offen
    v_mfma_f32_16x16x32_bf16 v[248:251], a[48:51], a[208:211], v[248:251]
    v_mfma_f32_16x16x32_bf16 v[248:251], a[100:103], a[224:227], v[248:251]
    s_add_u32 s48, s48, 1048576
    v_mfma_f32_16x16x32_bf16 v[252:255], a[48:51], a[212:215], v[252:255]
    v_mfma_f32_16x16x32_bf16 v[252:255], a[100:103], a[228:231], v[252:255]
    ds_read_b64_tr_b16 a[48:49], v8 offset:6336
    ds_read_b64_tr_b16 a[50:51], v8 offset:9920
    ds_read_b64_tr_b16 a[100:101], v8 offset:19648
    ds_read_b64_tr_b16 a[102:103], v8 offset:23232
    s_mov_b32 s31, 2
parallel_sum__softmax_full_mha__dense_activation_silu__prompt_kernel_g1loop:
    s_waitcnt vmcnt(18)
    s_barrier
    s_waitcnt lgkmcnt(8)
    v_mfma_f32_16x16x32_bf16 v[48:51], a[0:3], a[104:107], v[48:51]
    v_mfma_f32_16x16x32_bf16 v[48:51], a[52:55], a[120:123], v[48:51]
    v_mfma_f32_16x16x32_bf16 v[52:55], a[0:3], a[108:111], v[52:55]
    v_mfma_f32_16x16x32_bf16 v[52:55], a[52:55], a[124:127], v[52:55]
    buffer_load_dwordx4 a[168:171], v1, s[8:11], s20 offen offset:0 sc1
    v_mfma_f32_16x16x32_bf16 v[56:59], a[0:3], a[112:115], v[56:59]
    buffer_load_dwordx4 a[172:175], v1, s[8:11], s20 offen offset:1024 sc1
    v_mfma_f32_16x16x32_bf16 v[56:59], a[52:55], a[128:131], v[56:59]
    v_mfma_f32_16x16x32_bf16 v[60:63], a[0:3], a[116:119], v[60:63]
    buffer_load_dwordx4 a[176:179], v1, s[8:11], s20 offen offset:2048 sc1
    v_mfma_f32_16x16x32_bf16 v[60:63], a[52:55], a[132:135], v[60:63]
    ds_read_b64_tr_b16 a[0:1], v6 offset:26624
    v_mfma_f32_16x16x32_bf16 v[64:67], a[4:7], a[104:107], v[64:67]
    ds_read_b64_tr_b16 a[2:3], v6 offset:29696
    v_mfma_f32_16x16x32_bf16 v[64:67], a[56:59], a[120:123], v[64:67]
    ds_read_b64_tr_b16 a[52:53], v6 offset:39936
    v_mfma_f32_16x16x32_bf16 v[68:71], a[4:7], a[108:111], v[68:71]
    ds_read_b64_tr_b16 a[54:55], v6 offset:43008
    v_mfma_f32_16x16x32_bf16 v[68:71], a[56:59], a[124:127], v[68:71]
    buffer_load_dwordx4 a[180:183], v1, s[8:11], s20 offen offset:3072 sc1
    v_mfma_f32_16x16x32_bf16 v[72:75], a[4:7], a[112:115], v[72:75]
    v_mfma_f32_16x16x32_bf16 v[72:75], a[56:59], a[128:131], v[72:75]
    s_add_u32 s20, s20, 4096
    v_mfma_f32_16x16x32_bf16 v[76:79], a[4:7], a[116:119], v[76:79]
    v_mfma_f32_16x16x32_bf16 v[76:79], a[56:59], a[132:135], v[76:79]
    ds_read_b64_tr_b16 a[4:5], v7 offset:26656
    v_mfma_f32_16x16x32_bf16 v[80:83], a[8:11], a[104:107], v[80:83]
    ds_read_b64_tr_b16 a[6:7], v7 offset:29728
    v_mfma_f32_16x16x32_bf16 v[80:83], a[60:63], a[120:123], v[80:83]
    ds_read_b64_tr_b16 a[56:57], v7 offset:39968
    v_mfma_f32_16x16x32_bf16 v[84:87], a[8:11], a[108:111], v[84:87]
    ds_read_b64_tr_b16 a[58:59], v7 offset:43040
    v_mfma_f32_16x16x32_bf16 v[84:87], a[60:63], a[124:127], v[84:87]
    s_add_u32 m0, s27, 79872
    v_mfma_f32_16x16x32_bf16 v[88:91], a[8:11], a[112:115], v[88:91]
    buffer_load_dwordx4 v2, s[12:15], s21 offen lds
    v_mfma_f32_16x16x32_bf16 v[88:91], a[60:63], a[128:131], v[88:91]
    v_mfma_f32_16x16x32_bf16 v[92:95], a[8:11], a[116:119], v[92:95]
    s_add_u32 m0, s27, 80896
    v_mfma_f32_16x16x32_bf16 v[92:95], a[60:63], a[132:135], v[92:95]
    ds_read_b64_tr_b16 a[8:9], v6 offset:26688
    v_mfma_f32_16x16x32_bf16 v[96:99], a[12:15], a[104:107], v[96:99]
    ds_read_b64_tr_b16 a[10:11], v6 offset:29760
    v_mfma_f32_16x16x32_bf16 v[96:99], a[64:67], a[120:123], v[96:99]
    ds_read_b64_tr_b16 a[60:61], v6 offset:40000
    v_mfma_f32_16x16x32_bf16 v[100:103], a[12:15], a[108:111], v[100:103]
    ds_read_b64_tr_b16 a[62:63], v6 offset:43072
    v_mfma_f32_16x16x32_bf16 v[100:103], a[64:67], a[124:127], v[100:103]
    v_mfma_f32_16x16x32_bf16 v[104:107], a[12:15], a[112:115], v[104:107]
    buffer_load_dwordx4 v3, s[12:15], s21 offen lds
    v_mfma_f32_16x16x32_bf16 v[104:107], a[64:67], a[128:131], v[104:107]
    s_add_u32 m0, s27, 81920
    v_mfma_f32_16x16x32_bf16 v[108:111], a[12:15], a[116:119], v[108:111]
    v_mfma_f32_16x16x32_bf16 v[108:111], a[64:67], a[132:135], v[108:111]
    ds_read_b64_tr_b16 a[12:13], v7 offset:26720
    v_mfma_f32_16x16x32_bf16 v[112:115], a[104:107], a[16:19], v[112:115]
    ds_read_b64_tr_b16 a[14:15], v7 offset:29792
    v_mfma_f32_16x16x32_bf16 v[112:115], a[120:123], a[68:71], v[112:115]
    ds_read_b64_tr_b16 a[64:65], v7 offset:40032
    v_mfma_f32_16x16x32_bf16 v[116:119], a[108:111], a[16:19], v[116:119]
    ds_read_b64_tr_b16 a[66:67], v7 offset:43104
    v_mfma_f32_16x16x32_bf16 v[116:119], a[124:127], a[68:71], v[116:119]
    buffer_load_dwordx4 v4, s[12:15], s21 offen lds
    v_mfma_f32_16x16x32_bf16 v[120:123], a[112:115], a[16:19], v[120:123]
    s_add_u32 s21, s21, s23
    v_mfma_f32_16x16x32_bf16 v[120:123], a[128:131], a[68:71], v[120:123]
    v_mfma_f32_16x16x32_bf16 v[124:127], a[116:119], a[16:19], v[124:127]
    s_add_u32 m0, s30, 79872
    v_mfma_f32_16x16x32_bf16 v[124:127], a[132:135], a[68:71], v[124:127]
    ds_read_b64_tr_b16 a[16:17], v6 offset:26752
    v_mfma_f32_16x16x32_bf16 v[128:131], a[104:107], a[20:23], v[128:131]
    ds_read_b64_tr_b16 a[18:19], v6 offset:29824
    v_mfma_f32_16x16x32_bf16 v[128:131], a[120:123], a[72:75], v[128:131]
    ds_read_b64_tr_b16 a[68:69], v6 offset:40064
    v_mfma_f32_16x16x32_bf16 v[132:135], a[108:111], a[20:23], v[132:135]
    ds_read_b64_tr_b16 a[70:71], v6 offset:43136
    v_mfma_f32_16x16x32_bf16 v[132:135], a[124:127], a[72:75], v[132:135]
    v_mfma_f32_16x16x32_bf16 v[136:139], a[112:115], a[20:23], v[136:139]
    s_mov_b64 exec, 0xffff
    buffer_load_dwordx4 v5, s[16:19], s22 offen lds
    s_mov_b64 exec, -1
    v_mfma_f32_16x16x32_bf16 v[136:139], a[128:131], a[72:75], v[136:139]
    s_add_u32 s22, s22, 229376
    v_mfma_f32_16x16x32_bf16 v[140:143], a[116:119], a[20:23], v[140:143]
    v_mfma_f32_16x16x32_bf16 v[140:143], a[132:135], a[72:75], v[140:143]
    ds_read_b64_tr_b16 a[20:21], v7 offset:26784
    v_mfma_f32_16x16x32_bf16 v[144:147], a[24:27], a[104:107], v[144:147]
    ds_read_b64_tr_b16 a[22:23], v7 offset:29856
    v_mfma_f32_16x16x32_bf16 v[144:147], a[76:79], a[120:123], v[144:147]
    ds_read_b64_tr_b16 a[72:73], v7 offset:40096
    v_mfma_f32_16x16x32_bf16 v[148:151], a[24:27], a[108:111], v[148:151]
    ds_read_b64_tr_b16 a[74:75], v7 offset:43168
    v_mfma_f32_16x16x32_bf16 v[148:151], a[76:79], a[124:127], v[148:151]
    buffer_load_dwordx4 a[184:187], v1, s[8:11], s20 offen offset:0 sc1
    v_mfma_f32_16x16x32_bf16 v[152:155], a[24:27], a[112:115], v[152:155]
    v_mfma_f32_16x16x32_bf16 v[152:155], a[76:79], a[128:131], v[152:155]
    buffer_load_dwordx4 a[188:191], v1, s[8:11], s20 offen offset:1024 sc1
    v_mfma_f32_16x16x32_bf16 v[156:159], a[24:27], a[116:119], v[156:159]
    buffer_load_dwordx4 a[192:195], v1, s[8:11], s20 offen offset:2048 sc1
    v_mfma_f32_16x16x32_bf16 v[156:159], a[76:79], a[132:135], v[156:159]
    ds_read_b64_tr_b16 a[24:25], v8 offset:32768
    v_mfma_f32_16x16x32_bf16 v[160:163], a[28:31], a[104:107], v[160:163]
    ds_read_b64_tr_b16 a[26:27], v8 offset:36352
    v_mfma_f32_16x16x32_bf16 v[160:163], a[80:83], a[120:123], v[160:163]
    ds_read_b64_tr_b16 a[76:77], v8 offset:46080
    v_mfma_f32_16x16x32_bf16 v[164:167], a[28:31], a[108:111], v[164:167]
    ds_read_b64_tr_b16 a[78:79], v8 offset:49664
    v_mfma_f32_16x16x32_bf16 v[164:167], a[80:83], a[124:127], v[164:167]
    v_mfma_f32_16x16x32_bf16 v[168:171], a[28:31], a[112:115], v[168:171]
    buffer_load_dwordx4 a[196:199], v1, s[8:11], s20 offen offset:3072 sc1
    v_mfma_f32_16x16x32_bf16 v[168:171], a[80:83], a[128:131], v[168:171]
    s_add_u32 s20, s20, 4096
    v_mfma_f32_16x16x32_bf16 v[172:175], a[28:31], a[116:119], v[172:175]
    v_mfma_f32_16x16x32_bf16 v[172:175], a[80:83], a[132:135], v[172:175]
    ds_read_b64_tr_b16 a[28:29], v8 offset:32800
    s_waitcnt lgkmcnt(8)
    v_mfma_f32_16x16x32_bf16 v[176:179], a[32:35], a[104:107], v[176:179]
    ds_read_b64_tr_b16 a[30:31], v8 offset:36384
    v_mfma_f32_16x16x32_bf16 v[176:179], a[84:87], a[120:123], v[176:179]
    ds_read_b64_tr_b16 a[80:81], v8 offset:46112
    v_mfma_f32_16x16x32_bf16 v[180:183], a[32:35], a[108:111], v[180:183]
    ds_read_b64_tr_b16 a[82:83], v8 offset:49696
    v_mfma_f32_16x16x32_bf16 v[180:183], a[84:87], a[124:127], v[180:183]
    s_add_u32 m0, s27, 93184
    v_mfma_f32_16x16x32_bf16 v[184:187], a[32:35], a[112:115], v[184:187]
    v_mfma_f32_16x16x32_bf16 v[184:187], a[84:87], a[128:131], v[184:187]
    buffer_load_dwordx4 v2, s[12:15], s21 offen lds
    v_mfma_f32_16x16x32_bf16 v[188:191], a[32:35], a[116:119], v[188:191]
    s_add_u32 m0, s27, 94208
    v_mfma_f32_16x16x32_bf16 v[188:191], a[84:87], a[132:135], v[188:191]
    ds_read_b64_tr_b16 a[32:33], v8 offset:32832
    v_mfma_f32_16x16x32_bf16 v[192:195], a[36:39], a[104:107], v[192:195]
    ds_read_b64_tr_b16 a[34:35], v8 offset:36416
    v_mfma_f32_16x16x32_bf16 v[192:195], a[88:91], a[120:123], v[192:195]
    ds_read_b64_tr_b16 a[84:85], v8 offset:46144
    v_mfma_f32_16x16x32_bf16 v[196:199], a[36:39], a[108:111], v[196:199]
    ds_read_b64_tr_b16 a[86:87], v8 offset:49728
    v_mfma_f32_16x16x32_bf16 v[196:199], a[88:91], a[124:127], v[196:199]
    v_mfma_f32_16x16x32_bf16 v[200:203], a[36:39], a[112:115], v[200:203]
    buffer_load_dwordx4 v3, s[12:15], s21 offen lds
    v_mfma_f32_16x16x32_bf16 v[200:203], a[88:91], a[128:131], v[200:203]
    v_mfma_f32_16x16x32_bf16 v[204:207], a[36:39], a[116:119], v[204:207]
    s_add_u32 m0, s27, 95232
    v_mfma_f32_16x16x32_bf16 v[204:207], a[88:91], a[132:135], v[204:207]
    ds_read_b64_tr_b16 a[36:37], v8 offset:32864
    v_mfma_f32_16x16x32_bf16 v[208:211], a[40:43], a[104:107], v[208:211]
    ds_read_b64_tr_b16 a[38:39], v8 offset:36448
    v_mfma_f32_16x16x32_bf16 v[208:211], a[92:95], a[120:123], v[208:211]
    ds_read_b64_tr_b16 a[88:89], v8 offset:46176
    v_mfma_f32_16x16x32_bf16 v[212:215], a[40:43], a[108:111], v[212:215]
    ds_read_b64_tr_b16 a[90:91], v8 offset:49760
    v_mfma_f32_16x16x32_bf16 v[212:215], a[92:95], a[124:127], v[212:215]
    buffer_load_dwordx4 v4, s[12:15], s21 offen lds
    v_mfma_f32_16x16x32_bf16 v[216:219], a[40:43], a[112:115], v[216:219]
    v_mfma_f32_16x16x32_bf16 v[216:219], a[92:95], a[128:131], v[216:219]
    s_add_u32 s21, s21, s23
    v_mfma_f32_16x16x32_bf16 v[220:223], a[40:43], a[116:119], v[220:223]
    s_add_u32 m0, s30, 93184
    v_mfma_f32_16x16x32_bf16 v[220:223], a[92:95], a[132:135], v[220:223]
    ds_read_b64_tr_b16 a[40:41], v8 offset:32896
    v_mfma_f32_16x16x32_bf16 v[224:227], a[44:47], a[104:107], v[224:227]
    ds_read_b64_tr_b16 a[42:43], v8 offset:36480
    v_mfma_f32_16x16x32_bf16 v[224:227], a[96:99], a[120:123], v[224:227]
    ds_read_b64_tr_b16 a[92:93], v8 offset:46208
    v_mfma_f32_16x16x32_bf16 v[228:231], a[44:47], a[108:111], v[228:231]
    ds_read_b64_tr_b16 a[94:95], v8 offset:49792
    v_mfma_f32_16x16x32_bf16 v[228:231], a[96:99], a[124:127], v[228:231]
    v_mfma_f32_16x16x32_bf16 v[232:235], a[44:47], a[112:115], v[232:235]
    s_mov_b64 exec, 0xffff
    buffer_load_dwordx4 v5, s[16:19], s22 offen lds
    s_mov_b64 exec, -1
    v_mfma_f32_16x16x32_bf16 v[232:235], a[96:99], a[128:131], v[232:235]
    v_mfma_f32_16x16x32_bf16 v[236:239], a[44:47], a[116:119], v[236:239]
    s_add_u32 s22, s22, 229376
    v_mfma_f32_16x16x32_bf16 v[236:239], a[96:99], a[132:135], v[236:239]
    ds_read_b64_tr_b16 a[44:45], v8 offset:32928
    v_mfma_f32_16x16x32_bf16 v[240:243], a[48:51], a[104:107], v[240:243]
    ds_read_b64_tr_b16 a[46:47], v8 offset:36512
    v_mfma_f32_16x16x32_bf16 v[240:243], a[100:103], a[120:123], v[240:243]
    ds_read_b64_tr_b16 a[96:97], v8 offset:46240
    v_mfma_f32_16x16x32_bf16 v[244:247], a[48:51], a[108:111], v[244:247]
    ds_read_b64_tr_b16 a[98:99], v8 offset:49824
    v_mfma_f32_16x16x32_bf16 v[244:247], a[100:103], a[124:127], v[244:247]
    buffer_load_dwordx4 v[16:19], v15, s[16:19], s49 offen
    v_mfma_f32_16x16x32_bf16 v[248:251], a[48:51], a[112:115], v[248:251]
    v_mfma_f32_16x16x32_bf16 v[248:251], a[100:103], a[128:131], v[248:251]
    s_add_u32 s49, s49, 1048576
    v_mfma_f32_16x16x32_bf16 v[252:255], a[48:51], a[116:119], v[252:255]
    v_mfma_f32_16x16x32_bf16 v[252:255], a[100:103], a[132:135], v[252:255]
    ds_read_b64_tr_b16 a[48:49], v8 offset:32960
    ds_read_b64_tr_b16 a[50:51], v8 offset:36544
    ds_read_b64_tr_b16 a[100:101], v8 offset:46272
    ds_read_b64_tr_b16 a[102:103], v8 offset:49856
    s_waitcnt vmcnt(19)
    s_barrier
    s_waitcnt lgkmcnt(8)
    v_mfma_f32_16x16x32_bf16 v[48:51], a[0:3], a[136:139], v[48:51]
    v_mfma_f32_16x16x32_bf16 v[48:51], a[52:55], a[152:155], v[48:51]
    v_mfma_f32_16x16x32_bf16 v[52:55], a[0:3], a[140:143], v[52:55]
    v_mfma_f32_16x16x32_bf16 v[52:55], a[52:55], a[156:159], v[52:55]
    buffer_load_dwordx4 a[200:203], v1, s[8:11], s20 offen offset:0 sc1
    v_mfma_f32_16x16x32_bf16 v[56:59], a[0:3], a[144:147], v[56:59]
    buffer_load_dwordx4 a[204:207], v1, s[8:11], s20 offen offset:1024 sc1
    v_mfma_f32_16x16x32_bf16 v[56:59], a[52:55], a[160:163], v[56:59]
    v_mfma_f32_16x16x32_bf16 v[60:63], a[0:3], a[148:151], v[60:63]
    buffer_load_dwordx4 a[208:211], v1, s[8:11], s20 offen offset:2048 sc1
    v_mfma_f32_16x16x32_bf16 v[60:63], a[52:55], a[164:167], v[60:63]
    ds_read_b64_tr_b16 a[0:1], v9 offset:0
    v_mfma_f32_16x16x32_bf16 v[64:67], a[4:7], a[136:139], v[64:67]
    ds_read_b64_tr_b16 a[2:3], v9 offset:3072
    v_mfma_f32_16x16x32_bf16 v[64:67], a[56:59], a[152:155], v[64:67]
    ds_read_b64_tr_b16 a[52:53], v9 offset:13312
    v_mfma_f32_16x16x32_bf16 v[68:71], a[4:7], a[140:143], v[68:71]
    ds_read_b64_tr_b16 a[54:55], v9 offset:16384
    v_mfma_f32_16x16x32_bf16 v[68:71], a[56:59], a[156:159], v[68:71]
    buffer_load_dwordx4 a[212:215], v1, s[8:11], s20 offen offset:3072 sc1
    v_mfma_f32_16x16x32_bf16 v[72:75], a[4:7], a[144:147], v[72:75]
    v_mfma_f32_16x16x32_bf16 v[72:75], a[56:59], a[160:163], v[72:75]
    s_add_u32 s20, s20, 4096
    v_mfma_f32_16x16x32_bf16 v[76:79], a[4:7], a[148:151], v[76:79]
    v_mfma_f32_16x16x32_bf16 v[76:79], a[56:59], a[164:167], v[76:79]
    ds_read_b64_tr_b16 a[4:5], v10 offset:32
    v_mfma_f32_16x16x32_bf16 v[80:83], a[8:11], a[136:139], v[80:83]
    ds_read_b64_tr_b16 a[6:7], v10 offset:3104
    v_mfma_f32_16x16x32_bf16 v[80:83], a[60:63], a[152:155], v[80:83]
    ds_read_b64_tr_b16 a[56:57], v10 offset:13344
    v_mfma_f32_16x16x32_bf16 v[84:87], a[8:11], a[140:143], v[84:87]
    ds_read_b64_tr_b16 a[58:59], v10 offset:16416
    v_mfma_f32_16x16x32_bf16 v[84:87], a[60:63], a[156:159], v[84:87]
    s_add_u32 m0, s27, 0
    v_mfma_f32_16x16x32_bf16 v[88:91], a[8:11], a[144:147], v[88:91]
    buffer_load_dwordx4 v2, s[12:15], s21 offen lds
    v_mfma_f32_16x16x32_bf16 v[88:91], a[60:63], a[160:163], v[88:91]
    v_mfma_f32_16x16x32_bf16 v[92:95], a[8:11], a[148:151], v[92:95]
    s_add_u32 m0, s27, 1024
    v_mfma_f32_16x16x32_bf16 v[92:95], a[60:63], a[164:167], v[92:95]
    ds_read_b64_tr_b16 a[8:9], v9 offset:64
    v_mfma_f32_16x16x32_bf16 v[96:99], a[12:15], a[136:139], v[96:99]
    ds_read_b64_tr_b16 a[10:11], v9 offset:3136
    v_mfma_f32_16x16x32_bf16 v[96:99], a[64:67], a[152:155], v[96:99]
    ds_read_b64_tr_b16 a[60:61], v9 offset:13376
    v_mfma_f32_16x16x32_bf16 v[100:103], a[12:15], a[140:143], v[100:103]
    ds_read_b64_tr_b16 a[62:63], v9 offset:16448
    v_mfma_f32_16x16x32_bf16 v[100:103], a[64:67], a[156:159], v[100:103]
    v_mfma_f32_16x16x32_bf16 v[104:107], a[12:15], a[144:147], v[104:107]
    buffer_load_dwordx4 v3, s[12:15], s21 offen lds
    v_mfma_f32_16x16x32_bf16 v[104:107], a[64:67], a[160:163], v[104:107]
    s_add_u32 m0, s27, 2048
    v_mfma_f32_16x16x32_bf16 v[108:111], a[12:15], a[148:151], v[108:111]
    v_mfma_f32_16x16x32_bf16 v[108:111], a[64:67], a[164:167], v[108:111]
    ds_read_b64_tr_b16 a[12:13], v10 offset:96
    v_mfma_f32_16x16x32_bf16 v[112:115], a[136:139], a[16:19], v[112:115]
    ds_read_b64_tr_b16 a[14:15], v10 offset:3168
    v_mfma_f32_16x16x32_bf16 v[112:115], a[152:155], a[68:71], v[112:115]
    ds_read_b64_tr_b16 a[64:65], v10 offset:13408
    v_mfma_f32_16x16x32_bf16 v[116:119], a[140:143], a[16:19], v[116:119]
    ds_read_b64_tr_b16 a[66:67], v10 offset:16480
    v_mfma_f32_16x16x32_bf16 v[116:119], a[156:159], a[68:71], v[116:119]
    buffer_load_dwordx4 v4, s[12:15], s21 offen lds
    v_mfma_f32_16x16x32_bf16 v[120:123], a[144:147], a[16:19], v[120:123]
    s_add_u32 s21, s21, s23
    v_mfma_f32_16x16x32_bf16 v[120:123], a[160:163], a[68:71], v[120:123]
    v_mfma_f32_16x16x32_bf16 v[124:127], a[148:151], a[16:19], v[124:127]
    s_add_u32 m0, s30, 0
    v_mfma_f32_16x16x32_bf16 v[124:127], a[164:167], a[68:71], v[124:127]
    ds_read_b64_tr_b16 a[16:17], v9 offset:128
    v_mfma_f32_16x16x32_bf16 v[128:131], a[136:139], a[20:23], v[128:131]
    ds_read_b64_tr_b16 a[18:19], v9 offset:3200
    v_mfma_f32_16x16x32_bf16 v[128:131], a[152:155], a[72:75], v[128:131]
    ds_read_b64_tr_b16 a[68:69], v9 offset:13440
    v_mfma_f32_16x16x32_bf16 v[132:135], a[140:143], a[20:23], v[132:135]
    ds_read_b64_tr_b16 a[70:71], v9 offset:16512
    v_mfma_f32_16x16x32_bf16 v[132:135], a[156:159], a[72:75], v[132:135]
    v_mfma_f32_16x16x32_bf16 v[136:139], a[144:147], a[20:23], v[136:139]
    s_mov_b64 exec, 0xffff
    buffer_load_dwordx4 v5, s[16:19], s22 offen lds
    s_mov_b64 exec, -1
    v_mfma_f32_16x16x32_bf16 v[136:139], a[160:163], a[72:75], v[136:139]
    s_add_u32 s22, s22, 229376
    v_mfma_f32_16x16x32_bf16 v[140:143], a[148:151], a[20:23], v[140:143]
    v_mfma_f32_16x16x32_bf16 v[140:143], a[164:167], a[72:75], v[140:143]
    ds_read_b64_tr_b16 a[20:21], v10 offset:160
    v_mfma_f32_16x16x32_bf16 v[144:147], a[24:27], a[136:139], v[144:147]
    ds_read_b64_tr_b16 a[22:23], v10 offset:3232
    v_mfma_f32_16x16x32_bf16 v[144:147], a[76:79], a[152:155], v[144:147]
    ds_read_b64_tr_b16 a[72:73], v10 offset:13472
    v_mfma_f32_16x16x32_bf16 v[148:151], a[24:27], a[140:143], v[148:151]
    ds_read_b64_tr_b16 a[74:75], v10 offset:16544
    v_mfma_f32_16x16x32_bf16 v[148:151], a[76:79], a[156:159], v[148:151]
    buffer_load_dwordx4 a[216:219], v1, s[8:11], s20 offen offset:0 sc1
    v_mfma_f32_16x16x32_bf16 v[152:155], a[24:27], a[144:147], v[152:155]
    v_mfma_f32_16x16x32_bf16 v[152:155], a[76:79], a[160:163], v[152:155]
    buffer_load_dwordx4 a[220:223], v1, s[8:11], s20 offen offset:1024 sc1
    v_mfma_f32_16x16x32_bf16 v[156:159], a[24:27], a[148:151], v[156:159]
    buffer_load_dwordx4 a[224:227], v1, s[8:11], s20 offen offset:2048 sc1
    v_mfma_f32_16x16x32_bf16 v[156:159], a[76:79], a[164:167], v[156:159]
    ds_read_b64_tr_b16 a[24:25], v11 offset:6144
    v_mfma_f32_16x16x32_bf16 v[160:163], a[28:31], a[136:139], v[160:163]
    ds_read_b64_tr_b16 a[26:27], v11 offset:9728
    v_mfma_f32_16x16x32_bf16 v[160:163], a[80:83], a[152:155], v[160:163]
    ds_read_b64_tr_b16 a[76:77], v11 offset:19456
    v_mfma_f32_16x16x32_bf16 v[164:167], a[28:31], a[140:143], v[164:167]
    ds_read_b64_tr_b16 a[78:79], v11 offset:23040
    v_mfma_f32_16x16x32_bf16 v[164:167], a[80:83], a[156:159], v[164:167]
    v_mfma_f32_16x16x32_bf16 v[168:171], a[28:31], a[144:147], v[168:171]
    buffer_load_dwordx4 a[228:231], v1, s[8:11], s20 offen offset:3072 sc1
    v_mfma_f32_16x16x32_bf16 v[168:171], a[80:83], a[160:163], v[168:171]
    s_add_u32 s20, s20, 4096
    v_mfma_f32_16x16x32_bf16 v[172:175], a[28:31], a[148:151], v[172:175]
    v_mfma_f32_16x16x32_bf16 v[172:175], a[80:83], a[164:167], v[172:175]
    ds_read_b64_tr_b16 a[28:29], v11 offset:6176
    s_waitcnt lgkmcnt(8)
    v_mfma_f32_16x16x32_bf16 v[176:179], a[32:35], a[136:139], v[176:179]
    ds_read_b64_tr_b16 a[30:31], v11 offset:9760
    v_mfma_f32_16x16x32_bf16 v[176:179], a[84:87], a[152:155], v[176:179]
    ds_read_b64_tr_b16 a[80:81], v11 offset:19488
    v_mfma_f32_16x16x32_bf16 v[180:183], a[32:35], a[140:143], v[180:183]
    ds_read_b64_tr_b16 a[82:83], v11 offset:23072
    v_mfma_f32_16x16x32_bf16 v[180:183], a[84:87], a[156:159], v[180:183]
    s_add_u32 m0, s27, 13312
    v_mfma_f32_16x16x32_bf16 v[184:187], a[32:35], a[144:147], v[184:187]
    v_mfma_f32_16x16x32_bf16 v[184:187], a[84:87], a[160:163], v[184:187]
    buffer_load_dwordx4 v2, s[12:15], s21 offen lds
    v_mfma_f32_16x16x32_bf16 v[188:191], a[32:35], a[148:151], v[188:191]
    s_add_u32 m0, s27, 14336
    v_mfma_f32_16x16x32_bf16 v[188:191], a[84:87], a[164:167], v[188:191]
    ds_read_b64_tr_b16 a[32:33], v11 offset:6208
    v_mfma_f32_16x16x32_bf16 v[192:195], a[36:39], a[136:139], v[192:195]
    ds_read_b64_tr_b16 a[34:35], v11 offset:9792
    v_mfma_f32_16x16x32_bf16 v[192:195], a[88:91], a[152:155], v[192:195]
    ds_read_b64_tr_b16 a[84:85], v11 offset:19520
    v_mfma_f32_16x16x32_bf16 v[196:199], a[36:39], a[140:143], v[196:199]
    ds_read_b64_tr_b16 a[86:87], v11 offset:23104
    v_mfma_f32_16x16x32_bf16 v[196:199], a[88:91], a[156:159], v[196:199]
    v_mfma_f32_16x16x32_bf16 v[200:203], a[36:39], a[144:147], v[200:203]
    buffer_load_dwordx4 v3, s[12:15], s21 offen lds
    v_mfma_f32_16x16x32_bf16 v[200:203], a[88:91], a[160:163], v[200:203]
    v_mfma_f32_16x16x32_bf16 v[204:207], a[36:39], a[148:151], v[204:207]
    s_add_u32 m0, s27, 15360
    v_mfma_f32_16x16x32_bf16 v[204:207], a[88:91], a[164:167], v[204:207]
    ds_read_b64_tr_b16 a[36:37], v11 offset:6240
    v_mfma_f32_16x16x32_bf16 v[208:211], a[40:43], a[136:139], v[208:211]
    ds_read_b64_tr_b16 a[38:39], v11 offset:9824
    v_mfma_f32_16x16x32_bf16 v[208:211], a[92:95], a[152:155], v[208:211]
    ds_read_b64_tr_b16 a[88:89], v11 offset:19552
    v_mfma_f32_16x16x32_bf16 v[212:215], a[40:43], a[140:143], v[212:215]
    ds_read_b64_tr_b16 a[90:91], v11 offset:23136
    v_mfma_f32_16x16x32_bf16 v[212:215], a[92:95], a[156:159], v[212:215]
    buffer_load_dwordx4 v4, s[12:15], s21 offen lds
    v_mfma_f32_16x16x32_bf16 v[216:219], a[40:43], a[144:147], v[216:219]
    v_mfma_f32_16x16x32_bf16 v[216:219], a[92:95], a[160:163], v[216:219]
    s_add_u32 s21, s21, s23
    v_mfma_f32_16x16x32_bf16 v[220:223], a[40:43], a[148:151], v[220:223]
    s_add_u32 m0, s30, 13312
    v_mfma_f32_16x16x32_bf16 v[220:223], a[92:95], a[164:167], v[220:223]
    ds_read_b64_tr_b16 a[40:41], v11 offset:6272
    v_mfma_f32_16x16x32_bf16 v[224:227], a[44:47], a[136:139], v[224:227]
    ds_read_b64_tr_b16 a[42:43], v11 offset:9856
    v_mfma_f32_16x16x32_bf16 v[224:227], a[96:99], a[152:155], v[224:227]
    ds_read_b64_tr_b16 a[92:93], v11 offset:19584
    v_mfma_f32_16x16x32_bf16 v[228:231], a[44:47], a[140:143], v[228:231]
    ds_read_b64_tr_b16 a[94:95], v11 offset:23168
    v_mfma_f32_16x16x32_bf16 v[228:231], a[96:99], a[156:159], v[228:231]
    v_mfma_f32_16x16x32_bf16 v[232:235], a[44:47], a[144:147], v[232:235]
    s_mov_b64 exec, 0xffff
    buffer_load_dwordx4 v5, s[16:19], s22 offen lds
    s_mov_b64 exec, -1
    v_mfma_f32_16x16x32_bf16 v[232:235], a[96:99], a[160:163], v[232:235]
    v_mfma_f32_16x16x32_bf16 v[236:239], a[44:47], a[148:151], v[236:239]
    s_add_u32 s22, s22, 229376
    v_mfma_f32_16x16x32_bf16 v[236:239], a[96:99], a[164:167], v[236:239]
    ds_read_b64_tr_b16 a[44:45], v11 offset:6304
    v_mfma_f32_16x16x32_bf16 v[240:243], a[48:51], a[136:139], v[240:243]
    ds_read_b64_tr_b16 a[46:47], v11 offset:9888
    v_mfma_f32_16x16x32_bf16 v[240:243], a[100:103], a[152:155], v[240:243]
    ds_read_b64_tr_b16 a[96:97], v11 offset:19616
    v_mfma_f32_16x16x32_bf16 v[244:247], a[48:51], a[140:143], v[244:247]
    ds_read_b64_tr_b16 a[98:99], v11 offset:23200
    v_mfma_f32_16x16x32_bf16 v[244:247], a[100:103], a[156:159], v[244:247]
    buffer_load_dwordx4 v[16:19], v15, s[44:47], s48 offen
    v_mfma_f32_16x16x32_bf16 v[248:251], a[48:51], a[144:147], v[248:251]
    v_mfma_f32_16x16x32_bf16 v[248:251], a[100:103], a[160:163], v[248:251]
    s_add_u32 s48, s48, 1048576
    v_mfma_f32_16x16x32_bf16 v[252:255], a[48:51], a[148:151], v[252:255]
    v_mfma_f32_16x16x32_bf16 v[252:255], a[100:103], a[164:167], v[252:255]
    ds_read_b64_tr_b16 a[48:49], v11 offset:6336
    ds_read_b64_tr_b16 a[50:51], v11 offset:9920
    ds_read_b64_tr_b16 a[100:101], v11 offset:19648
    ds_read_b64_tr_b16 a[102:103], v11 offset:23232
    s_waitcnt vmcnt(18)
    s_barrier
    s_waitcnt lgkmcnt(8)
    v_mfma_f32_16x16x32_bf16 v[48:51], a[0:3], a[168:171], v[48:51]
    v_mfma_f32_16x16x32_bf16 v[48:51], a[52:55], a[184:187], v[48:51]
    v_mfma_f32_16x16x32_bf16 v[52:55], a[0:3], a[172:175], v[52:55]
    v_mfma_f32_16x16x32_bf16 v[52:55], a[52:55], a[188:191], v[52:55]
    buffer_load_dwordx4 a[104:107], v1, s[8:11], s20 offen offset:0 sc1
    v_mfma_f32_16x16x32_bf16 v[56:59], a[0:3], a[176:179], v[56:59]
    buffer_load_dwordx4 a[108:111], v1, s[8:11], s20 offen offset:1024 sc1
    v_mfma_f32_16x16x32_bf16 v[56:59], a[52:55], a[192:195], v[56:59]
    v_mfma_f32_16x16x32_bf16 v[60:63], a[0:3], a[180:183], v[60:63]
    buffer_load_dwordx4 a[112:115], v1, s[8:11], s20 offen offset:2048 sc1
    v_mfma_f32_16x16x32_bf16 v[60:63], a[52:55], a[196:199], v[60:63]
    ds_read_b64_tr_b16 a[0:1], v9 offset:26624
    v_mfma_f32_16x16x32_bf16 v[64:67], a[4:7], a[168:171], v[64:67]
    ds_read_b64_tr_b16 a[2:3], v9 offset:29696
    v_mfma_f32_16x16x32_bf16 v[64:67], a[56:59], a[184:187], v[64:67]
    ds_read_b64_tr_b16 a[52:53], v9 offset:39936
    v_mfma_f32_16x16x32_bf16 v[68:71], a[4:7], a[172:175], v[68:71]
    ds_read_b64_tr_b16 a[54:55], v9 offset:43008
    v_mfma_f32_16x16x32_bf16 v[68:71], a[56:59], a[188:191], v[68:71]
    v_mfma_f32_16x16x32_bf16 v[72:75], a[4:7], a[176:179], v[72:75]
    buffer_load_dwordx4 a[116:119], v1, s[8:11], s20 offen offset:3072 sc1
    v_mfma_f32_16x16x32_bf16 v[72:75], a[56:59], a[192:195], v[72:75]
    s_add_u32 s20, s20, 4096
    v_mfma_f32_16x16x32_bf16 v[76:79], a[4:7], a[180:183], v[76:79]
    v_mfma_f32_16x16x32_bf16 v[76:79], a[56:59], a[196:199], v[76:79]
    ds_read_b64_tr_b16 a[4:5], v10 offset:26656
    v_mfma_f32_16x16x32_bf16 v[80:83], a[8:11], a[168:171], v[80:83]
    ds_read_b64_tr_b16 a[6:7], v10 offset:29728
    v_mfma_f32_16x16x32_bf16 v[80:83], a[60:63], a[184:187], v[80:83]
    ds_read_b64_tr_b16 a[56:57], v10 offset:39968
    v_mfma_f32_16x16x32_bf16 v[84:87], a[8:11], a[172:175], v[84:87]
    ds_read_b64_tr_b16 a[58:59], v10 offset:43040
    v_mfma_f32_16x16x32_bf16 v[84:87], a[60:63], a[188:191], v[84:87]
    s_add_u32 m0, s27, 26624
    v_mfma_f32_16x16x32_bf16 v[88:91], a[8:11], a[176:179], v[88:91]
    v_mfma_f32_16x16x32_bf16 v[88:91], a[60:63], a[192:195], v[88:91]
    buffer_load_dwordx4 v2, s[12:15], s21 offen lds
    v_mfma_f32_16x16x32_bf16 v[92:95], a[8:11], a[180:183], v[92:95]
    v_mfma_f32_16x16x32_bf16 v[92:95], a[60:63], a[196:199], v[92:95]
    ds_read_b64_tr_b16 a[8:9], v9 offset:26688
    v_mfma_f32_16x16x32_bf16 v[96:99], a[12:15], a[168:171], v[96:99]
    ds_read_b64_tr_b16 a[10:11], v9 offset:29760
    v_mfma_f32_16x16x32_bf16 v[96:99], a[64:67], a[184:187], v[96:99]
    ds_read_b64_tr_b16 a[60:61], v9 offset:40000
    v_mfma_f32_16x16x32_bf16 v[100:103], a[12:15], a[172:175], v[100:103]
    ds_read_b64_tr_b16 a[62:63], v9 offset:43072
    v_mfma_f32_16x16x32_bf16 v[100:103], a[64:67], a[188:191], v[100:103]
    s_add_u32 m0, s27, 27648
    v_mfma_f32_16x16x32_bf16 v[104:107], a[12:15], a[176:179], v[104:107]
    buffer_load_dwordx4 v3, s[12:15], s21 offen lds
    v_mfma_f32_16x16x32_bf16 v[104:107], a[64:67], a[192:195], v[104:107]
    v_mfma_f32_16x16x32_bf16 v[108:111], a[12:15], a[180:183], v[108:111]
    s_add_u32 m0, s27, 28672
    v_mfma_f32_16x16x32_bf16 v[108:111], a[64:67], a[196:199], v[108:111]
    ds_read_b64_tr_b16 a[12:13], v10 offset:26720
    v_mfma_f32_16x16x32_bf16 v[112:115], a[168:171], a[16:19], v[112:115]
    ds_read_b64_tr_b16 a[14:15], v10 offset:29792
    v_mfma_f32_16x16x32_bf16 v[112:115], a[184:187], a[68:71], v[112:115]
    ds_read_b64_tr_b16 a[64:65], v10 offset:40032
    v_mfma_f32_16x16x32_bf16 v[116:119], a[172:175], a[16:19], v[116:119]
    ds_read_b64_tr_b16 a[66:67], v10 offset:43104
    v_mfma_f32_16x16x32_bf16 v[116:119], a[188:191], a[68:71], v[116:119]
    v_mfma_f32_16x16x32_bf16 v[120:123], a[176:179], a[16:19], v[120:123]
    buffer_load_dwordx4 v4, s[12:15], s21 offen lds
    v_mfma_f32_16x16x32_bf16 v[120:123], a[192:195], a[68:71], v[120:123]
    v_mfma_f32_16x16x32_bf16 v[124:127], a[180:183], a[16:19], v[124:127]
    s_add_u32 s21, s21, s23
    v_mfma_f32_16x16x32_bf16 v[124:127], a[196:199], a[68:71], v[124:127]
    ds_read_b64_tr_b16 a[16:17], v9 offset:26752
    v_mfma_f32_16x16x32_bf16 v[128:131], a[168:171], a[20:23], v[128:131]
    ds_read_b64_tr_b16 a[18:19], v9 offset:29824
    v_mfma_f32_16x16x32_bf16 v[128:131], a[184:187], a[72:75], v[128:131]
    ds_read_b64_tr_b16 a[68:69], v9 offset:40064
    v_mfma_f32_16x16x32_bf16 v[132:135], a[172:175], a[20:23], v[132:135]
    ds_read_b64_tr_b16 a[70:71], v9 offset:43136
    v_mfma_f32_16x16x32_bf16 v[132:135], a[188:191], a[72:75], v[132:135]
    s_add_u32 m0, s30, 26624
    v_mfma_f32_16x16x32_bf16 v[136:139], a[176:179], a[20:23], v[136:139]
    v_mfma_f32_16x16x32_bf16 v[136:139], a[192:195], a[72:75], v[136:139]
    s_mov_b64 exec, 0xffff
    buffer_load_dwordx4 v5, s[16:19], s22 offen lds
    s_mov_b64 exec, -1
    v_mfma_f32_16x16x32_bf16 v[140:143], a[180:183], a[20:23], v[140:143]
    v_mfma_f32_16x16x32_bf16 v[140:143], a[196:199], a[72:75], v[140:143]
    ds_read_b64_tr_b16 a[20:21], v10 offset:26784
    v_mfma_f32_16x16x32_bf16 v[144:147], a[24:27], a[168:171], v[144:147]
    ds_read_b64_tr_b16 a[22:23], v10 offset:29856
    v_mfma_f32_16x16x32_bf16 v[144:147], a[76:79], a[184:187], v[144:147]
    ds_read_b64_tr_b16 a[72:73], v10 offset:40096
    v_mfma_f32_16x16x32_bf16 v[148:151], a[24:27], a[172:175], v[148:151]
    ds_read_b64_tr_b16 a[74:75], v10 offset:43168
    v_mfma_f32_16x16x32_bf16 v[148:151], a[76:79], a[188:191], v[148:151]
    s_add_u32 s22, s22, 229376
    v_mfma_f32_16x16x32_bf16 v[152:155], a[24:27], a[176:179], v[152:155]
    v_mfma_f32_16x16x32_bf16 v[152:155], a[76:79], a[192:195], v[152:155]
    buffer_load_dwordx4 a[120:123], v1, s[8:11], s20 offen offset:0 sc1
    v_mfma_f32_16x16x32_bf16 v[156:159], a[24:27], a[180:183], v[156:159]
    buffer_load_dwordx4 a[124:127], v1, s[8:11], s20 offen offset:1024 sc1
    v_mfma_f32_16x16x32_bf16 v[156:159], a[76:79], a[196:199], v[156:159]
    ds_read_b64_tr_b16 a[24:25], v11 offset:32768
    v_mfma_f32_16x16x32_bf16 v[160:163], a[28:31], a[168:171], v[160:163]
    ds_read_b64_tr_b16 a[26:27], v11 offset:36352
    v_mfma_f32_16x16x32_bf16 v[160:163], a[80:83], a[184:187], v[160:163]
    ds_read_b64_tr_b16 a[76:77], v11 offset:46080
    v_mfma_f32_16x16x32_bf16 v[164:167], a[28:31], a[172:175], v[164:167]
    ds_read_b64_tr_b16 a[78:79], v11 offset:49664
    v_mfma_f32_16x16x32_bf16 v[164:167], a[80:83], a[188:191], v[164:167]
    v_mfma_f32_16x16x32_bf16 v[168:171], a[28:31], a[176:179], v[168:171]
    buffer_load_dwordx4 a[128:131], v1, s[8:11], s20 offen offset:2048 sc1
    v_mfma_f32_16x16x32_bf16 v[168:171], a[80:83], a[192:195], v[168:171]
    v_mfma_f32_16x16x32_bf16 v[172:175], a[28:31], a[180:183], v[172:175]
    buffer_load_dwordx4 a[132:135], v1, s[8:11], s20 offen offset:3072 sc1
    v_mfma_f32_16x16x32_bf16 v[172:175], a[80:83], a[196:199], v[172:175]
    ds_read_b64_tr_b16 a[28:29], v11 offset:32800
    s_waitcnt lgkmcnt(8)
    v_mfma_f32_16x16x32_bf16 v[176:179], a[32:35], a[168:171], v[176:179]
    ds_read_b64_tr_b16 a[30:31], v11 offset:36384
    v_mfma_f32_16x16x32_bf16 v[176:179], a[84:87], a[184:187], v[176:179]
    ds_read_b64_tr_b16 a[80:81], v11 offset:46112
    v_mfma_f32_16x16x32_bf16 v[180:183], a[32:35], a[172:175], v[180:183]
    ds_read_b64_tr_b16 a[82:83], v11 offset:49696
    v_mfma_f32_16x16x32_bf16 v[180:183], a[84:87], a[188:191], v[180:183]
    s_add_u32 s20, s20, 4096
    v_mfma_f32_16x16x32_bf16 v[184:187], a[32:35], a[176:179], v[184:187]
    v_mfma_f32_16x16x32_bf16 v[184:187], a[84:87], a[192:195], v[184:187]
    s_add_u32 m0, s27, 39936
    v_mfma_f32_16x16x32_bf16 v[188:191], a[32:35], a[180:183], v[188:191]
    v_mfma_f32_16x16x32_bf16 v[188:191], a[84:87], a[196:199], v[188:191]
    ds_read_b64_tr_b16 a[32:33], v11 offset:32832
    v_mfma_f32_16x16x32_bf16 v[192:195], a[36:39], a[168:171], v[192:195]
    ds_read_b64_tr_b16 a[34:35], v11 offset:36416
    v_mfma_f32_16x16x32_bf16 v[192:195], a[88:91], a[184:187], v[192:195]
    ds_read_b64_tr_b16 a[84:85], v11 offset:46144
    v_mfma_f32_16x16x32_bf16 v[196:199], a[36:39], a[172:175], v[196:199]
    ds_read_b64_tr_b16 a[86:87], v11 offset:49728
    v_mfma_f32_16x16x32_bf16 v[196:199], a[88:91], a[188:191], v[196:199]
    buffer_load_dwordx4 v2, s[12:15], s21 offen lds
    v_mfma_f32_16x16x32_bf16 v[200:203], a[36:39], a[176:179], v[200:203]
    v_mfma_f32_16x16x32_bf16 v[200:203], a[88:91], a[192:195], v[200:203]
    s_add_u32 m0, s27, 40960
    v_mfma_f32_16x16x32_bf16 v[204:207], a[36:39], a[180:183], v[204:207]
    buffer_load_dwordx4 v3, s[12:15], s21 offen lds
    v_mfma_f32_16x16x32_bf16 v[204:207], a[88:91], a[196:199], v[204:207]
    ds_read_b64_tr_b16 a[36:37], v11 offset:32864
    v_mfma_f32_16x16x32_bf16 v[208:211], a[40:43], a[168:171], v[208:211]
    ds_read_b64_tr_b16 a[38:39], v11 offset:36448
    v_mfma_f32_16x16x32_bf16 v[208:211], a[92:95], a[184:187], v[208:211]
    ds_read_b64_tr_b16 a[88:89], v11 offset:46176
    v_mfma_f32_16x16x32_bf16 v[212:215], a[40:43], a[172:175], v[212:215]
    ds_read_b64_tr_b16 a[90:91], v11 offset:49760
    v_mfma_f32_16x16x32_bf16 v[212:215], a[92:95], a[188:191], v[212:215]
    v_mfma_f32_16x16x32_bf16 v[216:219], a[40:43], a[176:179], v[216:219]
    s_add_u32 m0, s27, 41984
    v_mfma_f32_16x16x32_bf16 v[216:219], a[92:95], a[192:195], v[216:219]
    v_mfma_f32_16x16x32_bf16 v[220:223], a[40:43], a[180:183], v[220:223]
    buffer_load_dwordx4 v4, s[12:15], s21 offen lds
    v_mfma_f32_16x16x32_bf16 v[220:223], a[92:95], a[196:199], v[220:223]
    ds_read_b64_tr_b16 a[40:41], v11 offset:32896
    v_mfma_f32_16x16x32_bf16 v[224:227], a[44:47], a[168:171], v[224:227]
    ds_read_b64_tr_b16 a[42:43], v11 offset:36480
    v_mfma_f32_16x16x32_bf16 v[224:227], a[96:99], a[184:187], v[224:227]
    ds_read_b64_tr_b16 a[92:93], v11 offset:46208
    v_mfma_f32_16x16x32_bf16 v[228:231], a[44:47], a[172:175], v[228:231]
    ds_read_b64_tr_b16 a[94:95], v11 offset:49792
    v_mfma_f32_16x16x32_bf16 v[228:231], a[96:99], a[188:191], v[228:231]
    v_mfma_f32_16x16x32_bf16 v[232:235], a[44:47], a[176:179], v[232:235]
    s_add_u32 s21, s21, s23
    v_mfma_f32_16x16x32_bf16 v[232:235], a[96:99], a[192:195], v[232:235]
    s_add_u32 m0, s30, 39936
    v_mfma_f32_16x16x32_bf16 v[236:239], a[44:47], a[180:183], v[236:239]
    v_mfma_f32_16x16x32_bf16 v[236:239], a[96:99], a[196:199], v[236:239]
    ds_read_b64_tr_b16 a[44:45], v11 offset:32928
    v_mfma_f32_16x16x32_bf16 v[240:243], a[48:51], a[168:171], v[240:243]
    ds_read_b64_tr_b16 a[46:47], v11 offset:36512
    v_mfma_f32_16x16x32_bf16 v[240:243], a[100:103], a[184:187], v[240:243]
    ds_read_b64_tr_b16 a[96:97], v11 offset:46240
    v_mfma_f32_16x16x32_bf16 v[244:247], a[48:51], a[172:175], v[244:247]
    ds_read_b64_tr_b16 a[98:99], v11 offset:49824
    v_mfma_f32_16x16x32_bf16 v[244:247], a[100:103], a[188:191], v[244:247]
    s_mov_b64 exec, 0xffff
    buffer_load_dwordx4 v5, s[16:19], s22 offen lds
    s_mov_b64 exec, -1
    v_mfma_f32_16x16x32_bf16 v[248:251], a[48:51], a[176:179], v[248:251]
    v_mfma_f32_16x16x32_bf16 v[248:251], a[100:103], a[192:195], v[248:251]
    s_add_u32 s22, s22, 229376
    v_mfma_f32_16x16x32_bf16 v[252:255], a[48:51], a[180:183], v[252:255]
    v_mfma_f32_16x16x32_bf16 v[252:255], a[100:103], a[196:199], v[252:255]
    ds_read_b64_tr_b16 a[48:49], v11 offset:32960
    ds_read_b64_tr_b16 a[50:51], v11 offset:36544
    ds_read_b64_tr_b16 a[100:101], v11 offset:46272
    ds_read_b64_tr_b16 a[102:103], v11 offset:49856
    s_waitcnt vmcnt(17)
    s_barrier
    s_waitcnt lgkmcnt(8)
    v_mfma_f32_16x16x32_bf16 v[48:51], a[0:3], a[200:203], v[48:51]
    v_mfma_f32_16x16x32_bf16 v[48:51], a[52:55], a[216:219], v[48:51]
    v_mfma_f32_16x16x32_bf16 v[52:55], a[0:3], a[204:207], v[52:55]
    v_mfma_f32_16x16x32_bf16 v[52:55], a[52:55], a[220:223], v[52:55]
    buffer_load_dwordx4 a[136:139], v1, s[8:11], s20 offen offset:0 sc1
    v_mfma_f32_16x16x32_bf16 v[56:59], a[0:3], a[208:211], v[56:59]
    buffer_load_dwordx4 a[140:143], v1, s[8:11], s20 offen offset:1024 sc1
    v_mfma_f32_16x16x32_bf16 v[56:59], a[52:55], a[224:227], v[56:59]
    v_mfma_f32_16x16x32_bf16 v[60:63], a[0:3], a[212:215], v[60:63]
    buffer_load_dwordx4 a[144:147], v1, s[8:11], s20 offen offset:2048 sc1
    v_mfma_f32_16x16x32_bf16 v[60:63], a[52:55], a[228:231], v[60:63]
    ds_read_b64_tr_b16 a[0:1], v6 offset:0
    v_mfma_f32_16x16x32_bf16 v[64:67], a[4:7], a[200:203], v[64:67]
    ds_read_b64_tr_b16 a[2:3], v6 offset:3072
    v_mfma_f32_16x16x32_bf16 v[64:67], a[56:59], a[216:219], v[64:67]
    ds_read_b64_tr_b16 a[52:53], v6 offset:13312
    v_mfma_f32_16x16x32_bf16 v[68:71], a[4:7], a[204:207], v[68:71]
    ds_read_b64_tr_b16 a[54:55], v6 offset:16384
    v_mfma_f32_16x16x32_bf16 v[68:71], a[56:59], a[220:223], v[68:71]
    buffer_load_dwordx4 a[148:151], v1, s[8:11], s20 offen offset:3072 sc1
    v_mfma_f32_16x16x32_bf16 v[72:75], a[4:7], a[208:211], v[72:75]
    v_mfma_f32_16x16x32_bf16 v[72:75], a[56:59], a[224:227], v[72:75]
    s_add_u32 s20, s20, 4096
    v_mfma_f32_16x16x32_bf16 v[76:79], a[4:7], a[212:215], v[76:79]
    s_add_u32 m0, s27, 53248
    v_mfma_f32_16x16x32_bf16 v[76:79], a[56:59], a[228:231], v[76:79]
    ds_read_b64_tr_b16 a[4:5], v7 offset:32
    v_mfma_f32_16x16x32_bf16 v[80:83], a[8:11], a[200:203], v[80:83]
    ds_read_b64_tr_b16 a[6:7], v7 offset:3104
    v_mfma_f32_16x16x32_bf16 v[80:83], a[60:63], a[216:219], v[80:83]
    ds_read_b64_tr_b16 a[56:57], v7 offset:13344
    v_mfma_f32_16x16x32_bf16 v[84:87], a[8:11], a[204:207], v[84:87]
    ds_read_b64_tr_b16 a[58:59], v7 offset:16416
    v_mfma_f32_16x16x32_bf16 v[84:87], a[60:63], a[220:223], v[84:87]
    v_mfma_f32_16x16x32_bf16 v[88:91], a[8:11], a[208:211], v[88:91]
    buffer_load_dwordx4 v2, s[12:15], s21 offen lds
    v_mfma_f32_16x16x32_bf16 v[88:91], a[60:63], a[224:227], v[88:91]
    s_add_u32 m0, s27, 54272
    v_mfma_f32_16x16x32_bf16 v[92:95], a[8:11], a[212:215], v[92:95]
    v_mfma_f32_16x16x32_bf16 v[92:95], a[60:63], a[228:231], v[92:95]
    ds_read_b64_tr_b16 a[8:9], v6 offset:64
    v_mfma_f32_16x16x32_bf16 v[96:99], a[12:15], a[200:203], v[96:99]
    ds_read_b64_tr_b16 a[10:11], v6 offset:3136
    v_mfma_f32_16x16x32_bf16 v[96:99], a[64:67], a[216:219], v[96:99]
    ds_read_b64_tr_b16 a[60:61], v6 offset:13376
    v_mfma_f32_16x16x32_bf16 v[100:103], a[12:15], a[204:207], v[100:103]
    ds_read_b64_tr_b16 a[62:63], v6 offset:16448
    v_mfma_f32_16x16x32_bf16 v[100:103], a[64:67], a[220:223], v[100:103]
    buffer_load_dwordx4 v3, s[12:15], s21 offen lds
    v_mfma_f32_16x16x32_bf16 v[104:107], a[12:15], a[208:211], v[104:107]
    s_add_u32 m0, s27, 55296
    v_mfma_f32_16x16x32_bf16 v[104:107], a[64:67], a[224:227], v[104:107]
    v_mfma_f32_16x16x32_bf16 v[108:111], a[12:15], a[212:215], v[108:111]
    buffer_load_dwordx4 v4, s[12:15], s21 offen lds
    v_mfma_f32_16x16x32_bf16 v[108:111], a[64:67], a[228:231], v[108:111]
    ds_read_b64_tr_b16 a[12:13], v7 offset:96
    v_mfma_f32_16x16x32_bf16 v[112:115], a[200:203], a[16:19], v[112:115]
    ds_read_b64_tr_b16 a[14:15], v7 offset:3168
    v_mfma_f32_16x16x32_bf16 v[112:115], a[216:219], a[68:71], v[112:115]
    ds_read_b64_tr_b16 a[64:65], v7 offset:13408
    v_mfma_f32_16x16x32_bf16 v[116:119], a[204:207], a[16:19], v[116:119]
    ds_read_b64_tr_b16 a[66:67], v7 offset:16480
    v_mfma_f32_16x16x32_bf16 v[116:119], a[220:223], a[68:71], v[116:119]
    s_add_u32 s21, s21, s23
    v_mfma_f32_16x16x32_bf16 v[120:123], a[208:211], a[16:19], v[120:123]
    v_mfma_f32_16x16x32_bf16 v[120:123], a[224:227], a[68:71], v[120:123]
    s_add_u32 m0, s30, 53248
    v_mfma_f32_16x16x32_bf16 v[124:127], a[212:215], a[16:19], v[124:127]
    s_mov_b64 exec, 0xffff
    buffer_load_dwordx4 v5, s[16:19], s22 offen lds
    s_mov_b64 exec, -1
    v_mfma_f32_16x16x32_bf16 v[124:127], a[228:231], a[68:71], v[124:127]
    ds_read_b64_tr_b16 a[16:17], v6 offset:128
    v_mfma_f32_16x16x32_bf16 v[128:131], a[200:203], a[20:23], v[128:131]
    ds_read_b64_tr_b16 a[18:19], v6 offset:3200
    v_mfma_f32_16x16x32_bf16 v[128:131], a[216:219], a[72:75], v[128:131]
    ds_read_b64_tr_b16 a[68:69], v6 offset:13440
    v_mfma_f32_16x16x32_bf16 v[132:135], a[204:207], a[20:23], v[132:135]
    ds_read_b64_tr_b16 a[70:71], v6 offset:16512
    v_mfma_f32_16x16x32_bf16 v[132:135], a[220:223], a[72:75], v[132:135]
    v_mfma_f32_16x16x32_bf16 v[136:139], a[208:211], a[20:23], v[136:139]
    s_add_u32 s22, s22, 229376
    v_mfma_f32_16x16x32_bf16 v[136:139], a[224:227], a[72:75], v[136:139]
    buffer_load_dwordx4 a[152:155], v1, s[8:11], s20 offen offset:0 sc1
    v_mfma_f32_16x16x32_bf16 v[140:143], a[212:215], a[20:23], v[140:143]
    v_mfma_f32_16x16x32_bf16 v[140:143], a[228:231], a[72:75], v[140:143]
    ds_read_b64_tr_b16 a[20:21], v7 offset:160
    v_mfma_f32_16x16x32_bf16 v[144:147], a[24:27], a[200:203], v[144:147]
    ds_read_b64_tr_b16 a[22:23], v7 offset:3232
    v_mfma_f32_16x16x32_bf16 v[144:147], a[76:79], a[216:219], v[144:147]
    ds_read_b64_tr_b16 a[72:73], v7 offset:13472
    v_mfma_f32_16x16x32_bf16 v[148:151], a[24:27], a[204:207], v[148:151]
    ds_read_b64_tr_b16 a[74:75], v7 offset:16544
    v_mfma_f32_16x16x32_bf16 v[148:151], a[76:79], a[220:223], v[148:151]
    buffer_load_dwordx4 a[156:159], v1, s[8:11], s20 offen offset:1024 sc1
    v_mfma_f32_16x16x32_bf16 v[152:155], a[24:27], a[208:211], v[152:155]
    v_mfma_f32_16x16x32_bf16 v[152:155], a[76:79], a[224:227], v[152:155]
    buffer_load_dwordx4 a[160:163], v1, s[8:11], s20 offen offset:2048 sc1
    v_mfma_f32_16x16x32_bf16 v[156:159], a[24:27], a[212:215], v[156:159]
    buffer_load_dwordx4 a[164:167], v1, s[8:11], s20 offen offset:3072 sc1
    v_mfma_f32_16x16x32_bf16 v[156:159], a[76:79], a[228:231], v[156:159]
    ds_read_b64_tr_b16 a[24:25], v8 offset:6144
    v_mfma_f32_16x16x32_bf16 v[160:163], a[28:31], a[200:203], v[160:163]
    ds_read_b64_tr_b16 a[26:27], v8 offset:9728
    v_mfma_f32_16x16x32_bf16 v[160:163], a[80:83], a[216:219], v[160:163]
    ds_read_b64_tr_b16 a[76:77], v8 offset:19456
    v_mfma_f32_16x16x32_bf16 v[164:167], a[28:31], a[204:207], v[164:167]
    ds_read_b64_tr_b16 a[78:79], v8 offset:23040
    v_mfma_f32_16x16x32_bf16 v[164:167], a[80:83], a[220:223], v[164:167]
    v_mfma_f32_16x16x32_bf16 v[168:171], a[28:31], a[208:211], v[168:171]
    s_add_u32 s20, s20, 4096
    v_mfma_f32_16x16x32_bf16 v[168:171], a[80:83], a[224:227], v[168:171]
    s_add_u32 m0, s27, 66560
    v_mfma_f32_16x16x32_bf16 v[172:175], a[28:31], a[212:215], v[172:175]
    v_mfma_f32_16x16x32_bf16 v[172:175], a[80:83], a[228:231], v[172:175]
    ds_read_b64_tr_b16 a[28:29], v8 offset:6176
    s_waitcnt lgkmcnt(8)
    v_mfma_f32_16x16x32_bf16 v[176:179], a[32:35], a[200:203], v[176:179]
    ds_read_b64_tr_b16 a[30:31], v8 offset:9760
    v_mfma_f32_16x16x32_bf16 v[176:179], a[84:87], a[216:219], v[176:179]
    ds_read_b64_tr_b16 a[80:81], v8 offset:19488
    v_mfma_f32_16x16x32_bf16 v[180:183], a[32:35], a[204:207], v[180:183]
    ds_read_b64_tr_b16 a[82:83], v8 offset:23072
    v_mfma_f32_16x16x32_bf16 v[180:183], a[84:87], a[220:223], v[180:183]
    buffer_load_dwordx4 v2, s[12:15], s21 offen lds
    v_mfma_f32_16x16x32_bf16 v[184:187], a[32:35], a[208:211], v[184:187]
    s_add_u32 m0, s27, 67584
    v_mfma_f32_16x16x32_bf16 v[184:187], a[84:87], a[224:227], v[184:187]
    v_mfma_f32_16x16x32_bf16 v[188:191], a[32:35], a[212:215], v[188:191]
    buffer_load_dwordx4 v3, s[12:15], s21 offen lds
    v_mfma_f32_16x16x32_bf16 v[188:191], a[84:87], a[228:231], v[188:191]
    ds_read_b64_tr_b16 a[32:33], v8 offset:6208
    v_mfma_f32_16x16x32_bf16 v[192:195], a[36:39], a[200:203], v[192:195]
    ds_read_b64_tr_b16 a[34:35], v8 offset:9792
    v_mfma_f32_16x16x32_bf16 v[192:195], a[88:91], a[216:219], v[192:195]
    ds_read_b64_tr_b16 a[84:85], v8 offset:19520
    v_mfma_f32_16x16x32_bf16 v[196:199], a[36:39], a[204:207], v[196:199]
    ds_read_b64_tr_b16 a[86:87], v8 offset:23104
    v_mfma_f32_16x16x32_bf16 v[196:199], a[88:91], a[220:223], v[196:199]
    s_add_u32 m0, s27, 68608
    v_mfma_f32_16x16x32_bf16 v[200:203], a[36:39], a[208:211], v[200:203]
    v_mfma_f32_16x16x32_bf16 v[200:203], a[88:91], a[224:227], v[200:203]
    buffer_load_dwordx4 v4, s[12:15], s21 offen lds
    v_mfma_f32_16x16x32_bf16 v[204:207], a[36:39], a[212:215], v[204:207]
    s_add_u32 s21, s21, s23
    v_mfma_f32_16x16x32_bf16 v[204:207], a[88:91], a[228:231], v[204:207]
    ds_read_b64_tr_b16 a[36:37], v8 offset:6240
    v_mfma_f32_16x16x32_bf16 v[208:211], a[40:43], a[200:203], v[208:211]
    ds_read_b64_tr_b16 a[38:39], v8 offset:9824
    v_mfma_f32_16x16x32_bf16 v[208:211], a[92:95], a[216:219], v[208:211]
    ds_read_b64_tr_b16 a[88:89], v8 offset:19552
    v_mfma_f32_16x16x32_bf16 v[212:215], a[40:43], a[204:207], v[212:215]
    ds_read_b64_tr_b16 a[90:91], v8 offset:23136
    v_mfma_f32_16x16x32_bf16 v[212:215], a[92:95], a[220:223], v[212:215]
    v_mfma_f32_16x16x32_bf16 v[216:219], a[40:43], a[208:211], v[216:219]
    s_add_u32 m0, s30, 66560
    v_mfma_f32_16x16x32_bf16 v[216:219], a[92:95], a[224:227], v[216:219]
    s_mov_b64 exec, 0xffff
    buffer_load_dwordx4 v5, s[16:19], s22 offen lds
    s_mov_b64 exec, -1
    v_mfma_f32_16x16x32_bf16 v[220:223], a[40:43], a[212:215], v[220:223]
    v_mfma_f32_16x16x32_bf16 v[220:223], a[92:95], a[228:231], v[220:223]
    ds_read_b64_tr_b16 a[40:41], v8 offset:6272
    v_mfma_f32_16x16x32_bf16 v[224:227], a[44:47], a[200:203], v[224:227]
    ds_read_b64_tr_b16 a[42:43], v8 offset:9856
    v_mfma_f32_16x16x32_bf16 v[224:227], a[96:99], a[216:219], v[224:227]
    ds_read_b64_tr_b16 a[92:93], v8 offset:19584
    v_mfma_f32_16x16x32_bf16 v[228:231], a[44:47], a[204:207], v[228:231]
    ds_read_b64_tr_b16 a[94:95], v8 offset:23168
    v_mfma_f32_16x16x32_bf16 v[228:231], a[96:99], a[220:223], v[228:231]
    s_add_u32 s22, s22, 229376
    v_mfma_f32_16x16x32_bf16 v[232:235], a[44:47], a[208:211], v[232:235]
    buffer_load_dwordx4 v[16:19], v15, s[16:19], s49 offen
    v_mfma_f32_16x16x32_bf16 v[232:235], a[96:99], a[224:227], v[232:235]
    v_mfma_f32_16x16x32_bf16 v[236:239], a[44:47], a[212:215], v[236:239]
    s_add_u32 s49, s49, 1048576
    v_mfma_f32_16x16x32_bf16 v[236:239], a[96:99], a[228:231], v[236:239]
    ds_read_b64_tr_b16 a[44:45], v8 offset:6304
    v_mfma_f32_16x16x32_bf16 v[240:243], a[48:51], a[200:203], v[240:243]
    ds_read_b64_tr_b16 a[46:47], v8 offset:9888
    v_mfma_f32_16x16x32_bf16 v[240:243], a[100:103], a[216:219], v[240:243]
    ds_read_b64_tr_b16 a[96:97], v8 offset:19616
    v_mfma_f32_16x16x32_bf16 v[244:247], a[48:51], a[204:207], v[244:247]
    ds_read_b64_tr_b16 a[98:99], v8 offset:23200
    v_mfma_f32_16x16x32_bf16 v[244:247], a[100:103], a[220:223], v[244:247]
    buffer_load_dwordx4 v[16:19], v15, s[44:47], s48 offen
    v_mfma_f32_16x16x32_bf16 v[248:251], a[48:51], a[208:211], v[248:251]
    v_mfma_f32_16x16x32_bf16 v[248:251], a[100:103], a[224:227], v[248:251]
    s_add_u32 s48, s48, 1048576
    v_mfma_f32_16x16x32_bf16 v[252:255], a[48:51], a[212:215], v[252:255]
    v_mfma_f32_16x16x32_bf16 v[252:255], a[100:103], a[228:231], v[252:255]
    ds_read_b64_tr_b16 a[48:49], v8 offset:6336
    ds_read_b64_tr_b16 a[50:51], v8 offset:9920
    ds_read_b64_tr_b16 a[100:101], v8 offset:19648
    ds_read_b64_tr_b16 a[102:103], v8 offset:23232
    s_sub_u32 s31, s31, 1
    s_cmp_lg_u32 s31, 0
    s_cbranch_scc1 parallel_sum__softmax_full_mha__dense_activation_silu__prompt_kernel_g1loop
    s_waitcnt vmcnt(18)
    s_barrier
    s_waitcnt lgkmcnt(8)
    v_mfma_f32_16x16x32_bf16 v[48:51], a[0:3], a[104:107], v[48:51]
    v_mfma_f32_16x16x32_bf16 v[48:51], a[52:55], a[120:123], v[48:51]
    v_mfma_f32_16x16x32_bf16 v[52:55], a[0:3], a[108:111], v[52:55]
    v_mfma_f32_16x16x32_bf16 v[52:55], a[52:55], a[124:127], v[52:55]
    buffer_load_dwordx4 a[168:171], v1, s[8:11], s20 offen offset:0 sc1
    v_mfma_f32_16x16x32_bf16 v[56:59], a[0:3], a[112:115], v[56:59]
    buffer_load_dwordx4 a[172:175], v1, s[8:11], s20 offen offset:1024 sc1
    v_mfma_f32_16x16x32_bf16 v[56:59], a[52:55], a[128:131], v[56:59]
    v_mfma_f32_16x16x32_bf16 v[60:63], a[0:3], a[116:119], v[60:63]
    buffer_load_dwordx4 a[176:179], v1, s[8:11], s20 offen offset:2048 sc1
    v_mfma_f32_16x16x32_bf16 v[60:63], a[52:55], a[132:135], v[60:63]
    ds_read_b64_tr_b16 a[0:1], v6 offset:26624
    v_mfma_f32_16x16x32_bf16 v[64:67], a[4:7], a[104:107], v[64:67]
    ds_read_b64_tr_b16 a[2:3], v6 offset:29696
    v_mfma_f32_16x16x32_bf16 v[64:67], a[56:59], a[120:123], v[64:67]
    ds_read_b64_tr_b16 a[52:53], v6 offset:39936
    v_mfma_f32_16x16x32_bf16 v[68:71], a[4:7], a[108:111], v[68:71]
    ds_read_b64_tr_b16 a[54:55], v6 offset:43008
    v_mfma_f32_16x16x32_bf16 v[68:71], a[56:59], a[124:127], v[68:71]
    v_mfma_f32_16x16x32_bf16 v[72:75], a[4:7], a[112:115], v[72:75]
    buffer_load_dwordx4 a[180:183], v1, s[8:11], s20 offen offset:3072 sc1
    v_mfma_f32_16x16x32_bf16 v[72:75], a[56:59], a[128:131], v[72:75]
    s_add_u32 s20, s20, 4096
    v_mfma_f32_16x16x32_bf16 v[76:79], a[4:7], a[116:119], v[76:79]
    v_mfma_f32_16x16x32_bf16 v[76:79], a[56:59], a[132:135], v[76:79]
    ds_read_b64_tr_b16 a[4:5], v7 offset:26656
    v_mfma_f32_16x16x32_bf16 v[80:83], a[8:11], a[104:107], v[80:83]
    ds_read_b64_tr_b16 a[6:7], v7 offset:29728
    v_mfma_f32_16x16x32_bf16 v[80:83], a[60:63], a[120:123], v[80:83]
    ds_read_b64_tr_b16 a[56:57], v7 offset:39968
    v_mfma_f32_16x16x32_bf16 v[84:87], a[8:11], a[108:111], v[84:87]
    ds_read_b64_tr_b16 a[58:59], v7 offset:43040
    v_mfma_f32_16x16x32_bf16 v[84:87], a[60:63], a[124:127], v[84:87]
    s_add_u32 m0, s27, 79872
    v_mfma_f32_16x16x32_bf16 v[88:91], a[8:11], a[112:115], v[88:91]
    v_mfma_f32_16x16x32_bf16 v[88:91], a[60:63], a[128:131], v[88:91]
    buffer_load_dwordx4 v2, s[12:15], s21 offen lds
    v_mfma_f32_16x16x32_bf16 v[92:95], a[8:11], a[116:119], v[92:95]
    v_mfma_f32_16x16x32_bf16 v[92:95], a[60:63], a[132:135], v[92:95]
    ds_read_b64_tr_b16 a[8:9], v6 offset:26688
    v_mfma_f32_16x16x32_bf16 v[96:99], a[12:15], a[104:107], v[96:99]
    ds_read_b64_tr_b16 a[10:11], v6 offset:29760
    v_mfma_f32_16x16x32_bf16 v[96:99], a[64:67], a[120:123], v[96:99]
    ds_read_b64_tr_b16 a[60:61], v6 offset:40000
    v_mfma_f32_16x16x32_bf16 v[100:103], a[12:15], a[108:111], v[100:103]
    ds_read_b64_tr_b16 a[62:63], v6 offset:43072
    v_mfma_f32_16x16x32_bf16 v[100:103], a[64:67], a[124:127], v[100:103]
    s_add_u32 m0, s27, 80896
    v_mfma_f32_16x16x32_bf16 v[104:107], a[12:15], a[112:115], v[104:107]
    buffer_load_dwordx4 v3, s[12:15], s21 offen lds
    v_mfma_f32_16x16x32_bf16 v[104:107], a[64:67], a[128:131], v[104:107]
    v_mfma_f32_16x16x32_bf16 v[108:111], a[12:15], a[116:119], v[108:111]
    s_add_u32 m0, s27, 81920
    v_mfma_f32_16x16x32_bf16 v[108:111], a[64:67], a[132:135], v[108:111]
    ds_read_b64_tr_b16 a[12:13], v7 offset:26720
    v_mfma_f32_16x16x32_bf16 v[112:115], a[104:107], a[16:19], v[112:115]
    ds_read_b64_tr_b16 a[14:15], v7 offset:29792
    v_mfma_f32_16x16x32_bf16 v[112:115], a[120:123], a[68:71], v[112:115]
    ds_read_b64_tr_b16 a[64:65], v7 offset:40032
    v_mfma_f32_16x16x32_bf16 v[116:119], a[108:111], a[16:19], v[116:119]
    ds_read_b64_tr_b16 a[66:67], v7 offset:43104
    v_mfma_f32_16x16x32_bf16 v[116:119], a[124:127], a[68:71], v[116:119]
    v_mfma_f32_16x16x32_bf16 v[120:123], a[112:115], a[16:19], v[120:123]
    buffer_load_dwordx4 v4, s[12:15], s21 offen lds
    v_mfma_f32_16x16x32_bf16 v[120:123], a[128:131], a[68:71], v[120:123]
    v_mfma_f32_16x16x32_bf16 v[124:127], a[116:119], a[16:19], v[124:127]
    s_add_u32 s21, s21, s23
    v_mfma_f32_16x16x32_bf16 v[124:127], a[132:135], a[68:71], v[124:127]
    ds_read_b64_tr_b16 a[16:17], v6 offset:26752
    v_mfma_f32_16x16x32_bf16 v[128:131], a[104:107], a[20:23], v[128:131]
    ds_read_b64_tr_b16 a[18:19], v6 offset:29824
    v_mfma_f32_16x16x32_bf16 v[128:131], a[120:123], a[72:75], v[128:131]
    ds_read_b64_tr_b16 a[68:69], v6 offset:40064
    v_mfma_f32_16x16x32_bf16 v[132:135], a[108:111], a[20:23], v[132:135]
    ds_read_b64_tr_b16 a[70:71], v6 offset:43136
    v_mfma_f32_16x16x32_bf16 v[132:135], a[124:127], a[72:75], v[132:135]
    s_add_u32 m0, s30, 79872
    v_mfma_f32_16x16x32_bf16 v[136:139], a[112:115], a[20:23], v[136:139]
    v_mfma_f32_16x16x32_bf16 v[136:139], a[128:131], a[72:75], v[136:139]
    s_mov_b64 exec, 0xffff
    buffer_load_dwordx4 v5, s[16:19], s22 offen lds
    s_mov_b64 exec, -1
    v_mfma_f32_16x16x32_bf16 v[140:143], a[116:119], a[20:23], v[140:143]
    v_mfma_f32_16x16x32_bf16 v[140:143], a[132:135], a[72:75], v[140:143]
    ds_read_b64_tr_b16 a[20:21], v7 offset:26784
    v_mfma_f32_16x16x32_bf16 v[144:147], a[24:27], a[104:107], v[144:147]
    ds_read_b64_tr_b16 a[22:23], v7 offset:29856
    v_mfma_f32_16x16x32_bf16 v[144:147], a[76:79], a[120:123], v[144:147]
    ds_read_b64_tr_b16 a[72:73], v7 offset:40096
    v_mfma_f32_16x16x32_bf16 v[148:151], a[24:27], a[108:111], v[148:151]
    ds_read_b64_tr_b16 a[74:75], v7 offset:43168
    v_mfma_f32_16x16x32_bf16 v[148:151], a[76:79], a[124:127], v[148:151]
    s_add_u32 s22, s22, 229376
    v_mfma_f32_16x16x32_bf16 v[152:155], a[24:27], a[112:115], v[152:155]
    v_mfma_f32_16x16x32_bf16 v[152:155], a[76:79], a[128:131], v[152:155]
    buffer_load_dwordx4 a[184:187], v1, s[8:11], s20 offen offset:0 sc1
    v_mfma_f32_16x16x32_bf16 v[156:159], a[24:27], a[116:119], v[156:159]
    buffer_load_dwordx4 a[188:191], v1, s[8:11], s20 offen offset:1024 sc1
    v_mfma_f32_16x16x32_bf16 v[156:159], a[76:79], a[132:135], v[156:159]
    ds_read_b64_tr_b16 a[24:25], v8 offset:32768
    v_mfma_f32_16x16x32_bf16 v[160:163], a[28:31], a[104:107], v[160:163]
    ds_read_b64_tr_b16 a[26:27], v8 offset:36352
    v_mfma_f32_16x16x32_bf16 v[160:163], a[80:83], a[120:123], v[160:163]
    ds_read_b64_tr_b16 a[76:77], v8 offset:46080
    v_mfma_f32_16x16x32_bf16 v[164:167], a[28:31], a[108:111], v[164:167]
    ds_read_b64_tr_b16 a[78:79], v8 offset:49664
    v_mfma_f32_16x16x32_bf16 v[164:167], a[80:83], a[124:127], v[164:167]
    v_mfma_f32_16x16x32_bf16 v[168:171], a[28:31], a[112:115], v[168:171]
    buffer_load_dwordx4 a[192:195], v1, s[8:11], s20 offen offset:2048 sc1
    v_mfma_f32_16x16x32_bf16 v[168:171], a[80:83], a[128:131], v[168:171]
    v_mfma_f32_16x16x32_bf16 v[172:175], a[28:31], a[116:119], v[172:175]
    buffer_load_dwordx4 a[196:199], v1, s[8:11], s20 offen offset:3072 sc1
    v_mfma_f32_16x16x32_bf16 v[172:175], a[80:83], a[132:135], v[172:175]
    ds_read_b64_tr_b16 a[28:29], v8 offset:32800
    s_waitcnt lgkmcnt(8)
    v_mfma_f32_16x16x32_bf16 v[176:179], a[32:35], a[104:107], v[176:179]
    ds_read_b64_tr_b16 a[30:31], v8 offset:36384
    v_mfma_f32_16x16x32_bf16 v[176:179], a[84:87], a[120:123], v[176:179]
    ds_read_b64_tr_b16 a[80:81], v8 offset:46112
    v_mfma_f32_16x16x32_bf16 v[180:183], a[32:35], a[108:111], v[180:183]
    ds_read_b64_tr_b16 a[82:83], v8 offset:49696
    v_mfma_f32_16x16x32_bf16 v[180:183], a[84:87], a[124:127], v[180:183]
    s_add_u32 s20, s20, 4096
    v_mfma_f32_16x16x32_bf16 v[184:187], a[32:35], a[112:115], v[184:187]
    v_mfma_f32_16x16x32_bf16 v[184:187], a[84:87], a[128:131], v[184:187]
    s_add_u32 m0, s27, 93184
    v_mfma_f32_16x16x32_bf16 v[188:191], a[32:35], a[116:119], v[188:191]
    v_mfma_f32_16x16x32_bf16 v[188:191], a[84:87], a[132:135], v[188:191]
    ds_read_b64_tr_b16 a[32:33], v8 offset:32832
    v_mfma_f32_16x16x32_bf16 v[192:195], a[36:39], a[104:107], v[192:195]
    ds_read_b64_tr_b16 a[34:35], v8 offset:36416
    v_mfma_f32_16x16x32_bf16 v[192:195], a[88:91], a[120:123], v[192:195]
    ds_read_b64_tr_b16 a[84:85], v8 offset:46144
    v_mfma_f32_16x16x32_bf16 v[196:199], a[36:39], a[108:111], v[196:199]
    ds_read_b64_tr_b16 a[86:87], v8 offset:49728
    v_mfma_f32_16x16x32_bf16 v[196:199], a[88:91], a[124:127], v[196:199]
    buffer_load_dwordx4 v2, s[12:15], s21 offen lds
    v_mfma_f32_16x16x32_bf16 v[200:203], a[36:39], a[112:115], v[200:203]
    v_mfma_f32_16x16x32_bf16 v[200:203], a[88:91], a[128:131], v[200:203]
    s_add_u32 m0, s27, 94208
    v_mfma_f32_16x16x32_bf16 v[204:207], a[36:39], a[116:119], v[204:207]
    buffer_load_dwordx4 v3, s[12:15], s21 offen lds
    v_mfma_f32_16x16x32_bf16 v[204:207], a[88:91], a[132:135], v[204:207]
    ds_read_b64_tr_b16 a[36:37], v8 offset:32864
    v_mfma_f32_16x16x32_bf16 v[208:211], a[40:43], a[104:107], v[208:211]
    ds_read_b64_tr_b16 a[38:39], v8 offset:36448
    v_mfma_f32_16x16x32_bf16 v[208:211], a[92:95], a[120:123], v[208:211]
    ds_read_b64_tr_b16 a[88:89], v8 offset:46176
    v_mfma_f32_16x16x32_bf16 v[212:215], a[40:43], a[108:111], v[212:215]
    ds_read_b64_tr_b16 a[90:91], v8 offset:49760
    v_mfma_f32_16x16x32_bf16 v[212:215], a[92:95], a[124:127], v[212:215]
    v_mfma_f32_16x16x32_bf16 v[216:219], a[40:43], a[112:115], v[216:219]
    s_add_u32 m0, s27, 95232
    v_mfma_f32_16x16x32_bf16 v[216:219], a[92:95], a[128:131], v[216:219]
    v_mfma_f32_16x16x32_bf16 v[220:223], a[40:43], a[116:119], v[220:223]
    buffer_load_dwordx4 v4, s[12:15], s21 offen lds
    v_mfma_f32_16x16x32_bf16 v[220:223], a[92:95], a[132:135], v[220:223]
    ds_read_b64_tr_b16 a[40:41], v8 offset:32896
    v_mfma_f32_16x16x32_bf16 v[224:227], a[44:47], a[104:107], v[224:227]
    ds_read_b64_tr_b16 a[42:43], v8 offset:36480
    v_mfma_f32_16x16x32_bf16 v[224:227], a[96:99], a[120:123], v[224:227]
    ds_read_b64_tr_b16 a[92:93], v8 offset:46208
    v_mfma_f32_16x16x32_bf16 v[228:231], a[44:47], a[108:111], v[228:231]
    ds_read_b64_tr_b16 a[94:95], v8 offset:49792
    v_mfma_f32_16x16x32_bf16 v[228:231], a[96:99], a[124:127], v[228:231]
    v_mfma_f32_16x16x32_bf16 v[232:235], a[44:47], a[112:115], v[232:235]
    s_add_u32 s21, s21, s23
    v_mfma_f32_16x16x32_bf16 v[232:235], a[96:99], a[128:131], v[232:235]
    s_add_u32 m0, s30, 93184
    v_mfma_f32_16x16x32_bf16 v[236:239], a[44:47], a[116:119], v[236:239]
    v_mfma_f32_16x16x32_bf16 v[236:239], a[96:99], a[132:135], v[236:239]
    ds_read_b64_tr_b16 a[44:45], v8 offset:32928
    v_mfma_f32_16x16x32_bf16 v[240:243], a[48:51], a[104:107], v[240:243]
    ds_read_b64_tr_b16 a[46:47], v8 offset:36512
    v_mfma_f32_16x16x32_bf16 v[240:243], a[100:103], a[120:123], v[240:243]
    ds_read_b64_tr_b16 a[96:97], v8 offset:46240
    v_mfma_f32_16x16x32_bf16 v[244:247], a[48:51], a[108:111], v[244:247]
    ds_read_b64_tr_b16 a[98:99], v8 offset:49824
    v_mfma_f32_16x16x32_bf16 v[244:247], a[100:103], a[124:127], v[244:247]
    s_mov_b64 exec, 0xffff
    buffer_load_dwordx4 v5, s[16:19], s22 offen lds
    s_mov_b64 exec, -1
    v_mfma_f32_16x16x32_bf16 v[248:251], a[48:51], a[112:115], v[248:251]
    v_mfma_f32_16x16x32_bf16 v[248:251], a[100:103], a[128:131], v[248:251]
    s_add_u32 s22, s22, 229376
    v_mfma_f32_16x16x32_bf16 v[252:255], a[48:51], a[116:119], v[252:255]
    v_mfma_f32_16x16x32_bf16 v[252:255], a[100:103], a[132:135], v[252:255]
    ds_read_b64_tr_b16 a[48:49], v8 offset:32960
    ds_read_b64_tr_b16 a[50:51], v8 offset:36544
    ds_read_b64_tr_b16 a[100:101], v8 offset:46272
    ds_read_b64_tr_b16 a[102:103], v8 offset:49856
    s_waitcnt vmcnt(18)
    s_barrier
    s_waitcnt lgkmcnt(8)
    v_mfma_f32_16x16x32_bf16 v[48:51], a[0:3], a[136:139], v[48:51]
    v_mfma_f32_16x16x32_bf16 v[48:51], a[52:55], a[152:155], v[48:51]
    v_mfma_f32_16x16x32_bf16 v[52:55], a[0:3], a[140:143], v[52:55]
    v_mfma_f32_16x16x32_bf16 v[52:55], a[52:55], a[156:159], v[52:55]
    buffer_load_dwordx4 a[200:203], v1, s[8:11], s20 offen offset:0 sc1
    v_mfma_f32_16x16x32_bf16 v[56:59], a[0:3], a[144:147], v[56:59]
    v_mfma_f32_16x16x32_bf16 v[56:59], a[52:55], a[160:163], v[56:59]
    v_mfma_f32_16x16x32_bf16 v[60:63], a[0:3], a[148:151], v[60:63]
    v_mfma_f32_16x16x32_bf16 v[60:63], a[52:55], a[164:167], v[60:63]
    ds_read_b64_tr_b16 a[0:1], v9 offset:0
    v_mfma_f32_16x16x32_bf16 v[64:67], a[4:7], a[136:139], v[64:67]
    ds_read_b64_tr_b16 a[2:3], v9 offset:3072
    v_mfma_f32_16x16x32_bf16 v[64:67], a[56:59], a[152:155], v[64:67]
    ds_read_b64_tr_b16 a[52:53], v9 offset:13312
    v_mfma_f32_16x16x32_bf16 v[68:71], a[4:7], a[140:143], v[68:71]
    ds_read_b64_tr_b16 a[54:55], v9 offset:16384
    v_mfma_f32_16x16x32_bf16 v[68:71], a[56:59], a[156:159], v[68:71]
    v_mfma_f32_16x16x32_bf16 v[72:75], a[4:7], a[144:147], v[72:75]
    buffer_load_dwordx4 a[204:207], v1, s[8:11], s20 offen offset:1024 sc1
    v_mfma_f32_16x16x32_bf16 v[72:75], a[56:59], a[160:163], v[72:75]
    v_mfma_f32_16x16x32_bf16 v[76:79], a[4:7], a[148:151], v[76:79]
    v_mfma_f32_16x16x32_bf16 v[76:79], a[56:59], a[164:167], v[76:79]
    ds_read_b64_tr_b16 a[4:5], v10 offset:32
    v_mfma_f32_16x16x32_bf16 v[80:83], a[8:11], a[136:139], v[80:83]
    ds_read_b64_tr_b16 a[6:7], v10 offset:3104
    v_mfma_f32_16x16x32_bf16 v[80:83], a[60:63], a[152:155], v[80:83]
    ds_read_b64_tr_b16 a[56:57], v10 offset:13344
    v_mfma_f32_16x16x32_bf16 v[84:87], a[8:11], a[140:143], v[84:87]
    ds_read_b64_tr_b16 a[58:59], v10 offset:16416
    v_mfma_f32_16x16x32_bf16 v[84:87], a[60:63], a[156:159], v[84:87]
    v_mfma_f32_16x16x32_bf16 v[88:91], a[8:11], a[144:147], v[88:91]
    v_mfma_f32_16x16x32_bf16 v[88:91], a[60:63], a[160:163], v[88:91]
    buffer_load_dwordx4 a[208:211], v1, s[8:11], s20 offen offset:2048 sc1
    v_mfma_f32_16x16x32_bf16 v[92:95], a[8:11], a[148:151], v[92:95]
    v_mfma_f32_16x16x32_bf16 v[92:95], a[60:63], a[164:167], v[92:95]
    ds_read_b64_tr_b16 a[8:9], v9 offset:64
    v_mfma_f32_16x16x32_bf16 v[96:99], a[12:15], a[136:139], v[96:99]
    ds_read_b64_tr_b16 a[10:11], v9 offset:3136
    v_mfma_f32_16x16x32_bf16 v[96:99], a[64:67], a[152:155], v[96:99]
    ds_read_b64_tr_b16 a[60:61], v9 offset:13376
    v_mfma_f32_16x16x32_bf16 v[100:103], a[12:15], a[140:143], v[100:103]
    ds_read_b64_tr_b16 a[62:63], v9 offset:16448
    v_mfma_f32_16x16x32_bf16 v[100:103], a[64:67], a[156:159], v[100:103]
    v_mfma_f32_16x16x32_bf16 v[104:107], a[12:15], a[144:147], v[104:107]
    v_mfma_f32_16x16x32_bf16 v[104:107], a[64:67], a[160:163], v[104:107]
    v_mfma_f32_16x16x32_bf16 v[108:111], a[12:15], a[148:151], v[108:111]
    buffer_load_dwordx4 a[212:215], v1, s[8:11], s20 offen offset:3072 sc1
    v_mfma_f32_16x16x32_bf16 v[108:111], a[64:67], a[164:167], v[108:111]
    ds_read_b64_tr_b16 a[12:13], v10 offset:96
    v_mfma_f32_16x16x32_bf16 v[112:115], a[136:139], a[16:19], v[112:115]
    ds_read_b64_tr_b16 a[14:15], v10 offset:3168
    v_mfma_f32_16x16x32_bf16 v[112:115], a[152:155], a[68:71], v[112:115]
    ds_read_b64_tr_b16 a[64:65], v10 offset:13408
    v_mfma_f32_16x16x32_bf16 v[116:119], a[140:143], a[16:19], v[116:119]
    ds_read_b64_tr_b16 a[66:67], v10 offset:16480
    v_mfma_f32_16x16x32_bf16 v[116:119], a[156:159], a[68:71], v[116:119]
    v_mfma_f32_16x16x32_bf16 v[120:123], a[144:147], a[16:19], v[120:123]
    v_mfma_f32_16x16x32_bf16 v[120:123], a[160:163], a[68:71], v[120:123]
    v_mfma_f32_16x16x32_bf16 v[124:127], a[148:151], a[16:19], v[124:127]
    v_mfma_f32_16x16x32_bf16 v[124:127], a[164:167], a[68:71], v[124:127]
    ds_read_b64_tr_b16 a[16:17], v9 offset:128
    v_mfma_f32_16x16x32_bf16 v[128:131], a[136:139], a[20:23], v[128:131]
    ds_read_b64_tr_b16 a[18:19], v9 offset:3200
    v_mfma_f32_16x16x32_bf16 v[128:131], a[152:155], a[72:75], v[128:131]
    ds_read_b64_tr_b16 a[68:69], v9 offset:13440
    v_mfma_f32_16x16x32_bf16 v[132:135], a[140:143], a[20:23], v[132:135]
    ds_read_b64_tr_b16 a[70:71], v9 offset:16512
    v_mfma_f32_16x16x32_bf16 v[132:135], a[156:159], a[72:75], v[132:135]
    s_add_u32 s20, s20, 4096
    v_mfma_f32_16x16x32_bf16 v[136:139], a[144:147], a[20:23], v[136:139]
    v_mfma_f32_16x16x32_bf16 v[136:139], a[160:163], a[72:75], v[136:139]
    v_mfma_f32_16x16x32_bf16 v[140:143], a[148:151], a[20:23], v[140:143]
    v_mfma_f32_16x16x32_bf16 v[140:143], a[164:167], a[72:75], v[140:143]
    ds_read_b64_tr_b16 a[20:21], v10 offset:160
    v_mfma_f32_16x16x32_bf16 v[144:147], a[24:27], a[136:139], v[144:147]
    ds_read_b64_tr_b16 a[22:23], v10 offset:3232
    v_mfma_f32_16x16x32_bf16 v[144:147], a[76:79], a[152:155], v[144:147]
    ds_read_b64_tr_b16 a[72:73], v10 offset:13472
    v_mfma_f32_16x16x32_bf16 v[148:151], a[24:27], a[140:143], v[148:151]
    ds_read_b64_tr_b16 a[74:75], v10 offset:16544
    v_mfma_f32_16x16x32_bf16 v[148:151], a[76:79], a[156:159], v[148:151]
    v_mfma_f32_16x16x32_bf16 v[152:155], a[24:27], a[144:147], v[152:155]
    v_mfma_f32_16x16x32_bf16 v[152:155], a[76:79], a[160:163], v[152:155]
    buffer_load_dwordx4 a[216:219], v1, s[8:11], s20 offen offset:0 sc1
    v_mfma_f32_16x16x32_bf16 v[156:159], a[24:27], a[148:151], v[156:159]
    v_mfma_f32_16x16x32_bf16 v[156:159], a[76:79], a[164:167], v[156:159]
    ds_read_b64_tr_b16 a[24:25], v11 offset:6144
    v_mfma_f32_16x16x32_bf16 v[160:163], a[28:31], a[136:139], v[160:163]
    ds_read_b64_tr_b16 a[26:27], v11 offset:9728
    v_mfma_f32_16x16x32_bf16 v[160:163], a[80:83], a[152:155], v[160:163]
    ds_read_b64_tr_b16 a[76:77], v11 offset:19456
    v_mfma_f32_16x16x32_bf16 v[164:167], a[28:31], a[140:143], v[164:167]
    ds_read_b64_tr_b16 a[78:79], v11 offset:23040
    v_mfma_f32_16x16x32_bf16 v[164:167], a[80:83], a[156:159], v[164:167]
    v_mfma_f32_16x16x32_bf16 v[168:171], a[28:31], a[144:147], v[168:171]
    v_mfma_f32_16x16x32_bf16 v[168:171], a[80:83], a[160:163], v[168:171]
    v_mfma_f32_16x16x32_bf16 v[172:175], a[28:31], a[148:151], v[172:175]
    buffer_load_dwordx4 a[220:223], v1, s[8:11], s20 offen offset:1024 sc1
    v_mfma_f32_16x16x32_bf16 v[172:175], a[80:83], a[164:167], v[172:175]
    ds_read_b64_tr_b16 a[28:29], v11 offset:6176
    s_waitcnt lgkmcnt(8)
    v_mfma_f32_16x16x32_bf16 v[176:179], a[32:35], a[136:139], v[176:179]
    ds_read_b64_tr_b16 a[30:31], v11 offset:9760
    v_mfma_f32_16x16x32_bf16 v[176:179], a[84:87], a[152:155], v[176:179]
    ds_read_b64_tr_b16 a[80:81], v11 offset:19488
    v_mfma_f32_16x16x32_bf16 v[180:183], a[32:35], a[140:143], v[180:183]
    ds_read_b64_tr_b16 a[82:83], v11 offset:23072
    v_mfma_f32_16x16x32_bf16 v[180:183], a[84:87], a[156:159], v[180:183]
    v_mfma_f32_16x16x32_bf16 v[184:187], a[32:35], a[144:147], v[184:187]
    v_mfma_f32_16x16x32_bf16 v[184:187], a[84:87], a[160:163], v[184:187]
    v_mfma_f32_16x16x32_bf16 v[188:191], a[32:35], a[148:151], v[188:191]
    v_mfma_f32_16x16x32_bf16 v[188:191], a[84:87], a[164:167], v[188:191]
    ds_read_b64_tr_b16 a[32:33], v11 offset:6208
    v_mfma_f32_16x16x32_bf16 v[192:195], a[36:39], a[136:139], v[192:195]
    ds_read_b64_tr_b16 a[34:35], v11 offset:9792
    v_mfma_f32_16x16x32_bf16 v[192:195], a[88:91], a[152:155], v[192:195]
    ds_read_b64_tr_b16 a[84:85], v11 offset:19520
    v_mfma_f32_16x16x32_bf16 v[196:199], a[36:39], a[140:143], v[196:199]
    ds_read_b64_tr_b16 a[86:87], v11 offset:23104
    v_mfma_f32_16x16x32_bf16 v[196:199], a[88:91], a[156:159], v[196:199]
    buffer_load_dwordx4 a[224:227], v1, s[8:11], s20 offen offset:2048 sc1
    v_mfma_f32_16x16x32_bf16 v[200:203], a[36:39], a[144:147], v[200:203]
    v_mfma_f32_16x16x32_bf16 v[200:203], a[88:91], a[160:163], v[200:203]
    v_mfma_f32_16x16x32_bf16 v[204:207], a[36:39], a[148:151], v[204:207]
    v_mfma_f32_16x16x32_bf16 v[204:207], a[88:91], a[164:167], v[204:207]
    ds_read_b64_tr_b16 a[36:37], v11 offset:6240
    v_mfma_f32_16x16x32_bf16 v[208:211], a[40:43], a[136:139], v[208:211]
    ds_read_b64_tr_b16 a[38:39], v11 offset:9824
    v_mfma_f32_16x16x32_bf16 v[208:211], a[92:95], a[152:155], v[208:211]
    ds_read_b64_tr_b16 a[88:89], v11 offset:19552
    v_mfma_f32_16x16x32_bf16 v[212:215], a[40:43], a[140:143], v[212:215]
    ds_read_b64_tr_b16 a[90:91], v11 offset:23136
    v_mfma_f32_16x16x32_bf16 v[212:215], a[92:95], a[156:159], v[212:215]
    v_mfma_f32_16x16x32_bf16 v[216:219], a[40:43], a[144:147], v[216:219]
    buffer_load_dwordx4 a[228:231], v1, s[8:11], s20 offen offset:3072 sc1
    v_mfma_f32_16x16x32_bf16 v[216:219], a[92:95], a[160:163], v[216:219]
    v_mfma_f32_16x16x32_bf16 v[220:223], a[40:43], a[148:151], v[220:223]
    v_mfma_f32_16x16x32_bf16 v[220:223], a[92:95], a[164:167], v[220:223]
    ds_read_b64_tr_b16 a[40:41], v11 offset:6272
    v_mfma_f32_16x16x32_bf16 v[224:227], a[44:47], a[136:139], v[224:227]
    ds_read_b64_tr_b16 a[42:43], v11 offset:9856
    v_mfma_f32_16x16x32_bf16 v[224:227], a[96:99], a[152:155], v[224:227]
    ds_read_b64_tr_b16 a[92:93], v11 offset:19584
    v_mfma_f32_16x16x32_bf16 v[228:231], a[44:47], a[140:143], v[228:231]
    ds_read_b64_tr_b16 a[94:95], v11 offset:23168
    v_mfma_f32_16x16x32_bf16 v[228:231], a[96:99], a[156:159], v[228:231]
    v_mfma_f32_16x16x32_bf16 v[232:235], a[44:47], a[144:147], v[232:235]
    v_mfma_f32_16x16x32_bf16 v[232:235], a[96:99], a[160:163], v[232:235]
    s_add_u32 s20, s20, 4096
    v_mfma_f32_16x16x32_bf16 v[236:239], a[44:47], a[148:151], v[236:239]
    v_mfma_f32_16x16x32_bf16 v[236:239], a[96:99], a[164:167], v[236:239]
    ds_read_b64_tr_b16 a[44:45], v11 offset:6304
    v_mfma_f32_16x16x32_bf16 v[240:243], a[48:51], a[136:139], v[240:243]
    ds_read_b64_tr_b16 a[46:47], v11 offset:9888
    v_mfma_f32_16x16x32_bf16 v[240:243], a[100:103], a[152:155], v[240:243]
    ds_read_b64_tr_b16 a[96:97], v11 offset:19616
    v_mfma_f32_16x16x32_bf16 v[244:247], a[48:51], a[140:143], v[244:247]
    ds_read_b64_tr_b16 a[98:99], v11 offset:23200
    v_mfma_f32_16x16x32_bf16 v[244:247], a[100:103], a[156:159], v[244:247]
    v_mfma_f32_16x16x32_bf16 v[248:251], a[48:51], a[144:147], v[248:251]
    v_mfma_f32_16x16x32_bf16 v[248:251], a[100:103], a[160:163], v[248:251]
    v_mfma_f32_16x16x32_bf16 v[252:255], a[48:51], a[148:151], v[252:255]
    v_mfma_f32_16x16x32_bf16 v[252:255], a[100:103], a[164:167], v[252:255]
    ds_read_b64_tr_b16 a[48:49], v11 offset:6336
    ds_read_b64_tr_b16 a[50:51], v11 offset:9920
    ds_read_b64_tr_b16 a[100:101], v11 offset:19648
    ds_read_b64_tr_b16 a[102:103], v11 offset:23232
    s_waitcnt vmcnt(8)
    s_barrier
    s_waitcnt lgkmcnt(8)
    v_mfma_f32_16x16x32_bf16 v[48:51], a[0:3], a[168:171], v[48:51]
    v_mfma_f32_16x16x32_bf16 v[48:51], a[52:55], a[184:187], v[48:51]
    v_mfma_f32_16x16x32_bf16 v[52:55], a[0:3], a[172:175], v[52:55]
    v_mfma_f32_16x16x32_bf16 v[52:55], a[52:55], a[188:191], v[52:55]
    v_mfma_f32_16x16x32_bf16 v[56:59], a[0:3], a[176:179], v[56:59]
    v_mfma_f32_16x16x32_bf16 v[56:59], a[52:55], a[192:195], v[56:59]
    v_mfma_f32_16x16x32_bf16 v[60:63], a[0:3], a[180:183], v[60:63]
    v_mfma_f32_16x16x32_bf16 v[60:63], a[52:55], a[196:199], v[60:63]
    ds_read_b64_tr_b16 a[0:1], v9 offset:26624
    v_mfma_f32_16x16x32_bf16 v[64:67], a[4:7], a[168:171], v[64:67]
    ds_read_b64_tr_b16 a[2:3], v9 offset:29696
    v_mfma_f32_16x16x32_bf16 v[64:67], a[56:59], a[184:187], v[64:67]
    ds_read_b64_tr_b16 a[52:53], v9 offset:39936
    v_mfma_f32_16x16x32_bf16 v[68:71], a[4:7], a[172:175], v[68:71]
    ds_read_b64_tr_b16 a[54:55], v9 offset:43008
    v_mfma_f32_16x16x32_bf16 v[68:71], a[56:59], a[188:191], v[68:71]
    v_mfma_f32_16x16x32_bf16 v[72:75], a[4:7], a[176:179], v[72:75]
    v_mfma_f32_16x16x32_bf16 v[72:75], a[56:59], a[192:195], v[72:75]
    v_mfma_f32_16x16x32_bf16 v[76:79], a[4:7], a[180:183], v[76:79]
    v_mfma_f32_16x16x32_bf16 v[76:79], a[56:59], a[196:199], v[76:79]
    ds_read_b64_tr_b16 a[4:5], v10 offset:26656
    v_mfma_f32_16x16x32_bf16 v[80:83], a[8:11], a[168:171], v[80:83]
    ds_read_b64_tr_b16 a[6:7], v10 offset:29728
    v_mfma_f32_16x16x32_bf16 v[80:83], a[60:63], a[184:187], v[80:83]
    ds_read_b64_tr_b16 a[56:57], v10 offset:39968
    v_mfma_f32_16x16x32_bf16 v[84:87], a[8:11], a[172:175], v[84:87]
    ds_read_b64_tr_b16 a[58:59], v10 offset:43040
    v_mfma_f32_16x16x32_bf16 v[84:87], a[60:63], a[188:191], v[84:87]
    v_mfma_f32_16x16x32_bf16 v[88:91], a[8:11], a[176:179], v[88:91]
    v_mfma_f32_16x16x32_bf16 v[88:91], a[60:63], a[192:195], v[88:91]
    v_mfma_f32_16x16x32_bf16 v[92:95], a[8:11], a[180:183], v[92:95]
    v_mfma_f32_16x16x32_bf16 v[92:95], a[60:63], a[196:199], v[92:95]
    ds_read_b64_tr_b16 a[8:9], v9 offset:26688
    v_mfma_f32_16x16x32_bf16 v[96:99], a[12:15], a[168:171], v[96:99]
    ds_read_b64_tr_b16 a[10:11], v9 offset:29760
    v_mfma_f32_16x16x32_bf16 v[96:99], a[64:67], a[184:187], v[96:99]
    ds_read_b64_tr_b16 a[60:61], v9 offset:40000
    v_mfma_f32_16x16x32_bf16 v[100:103], a[12:15], a[172:175], v[100:103]
    ds_read_b64_tr_b16 a[62:63], v9 offset:43072
    v_mfma_f32_16x16x32_bf16 v[100:103], a[64:67], a[188:191], v[100:103]
    v_mfma_f32_16x16x32_bf16 v[104:107], a[12:15], a[176:179], v[104:107]
    v_mfma_f32_16x16x32_bf16 v[104:107], a[64:67], a[192:195], v[104:107]
    v_mfma_f32_16x16x32_bf16 v[108:111], a[12:15], a[180:183], v[108:111]
    v_mfma_f32_16x16x32_bf16 v[108:111], a[64:67], a[196:199], v[108:111]
    ds_read_b64_tr_b16 a[12:13], v10 offset:26720
    v_mfma_f32_16x16x32_bf16 v[112:115], a[168:171], a[16:19], v[112:115]
    ds_read_b64_tr_b16 a[14:15], v10 offset:29792
    v_mfma_f32_16x16x32_bf16 v[112:115], a[184:187], a[68:71], v[112:115]
    ds_read_b64_tr_b16 a[64:65], v10 offset:40032
    v_mfma_f32_16x16x32_bf16 v[116:119], a[172:175], a[16:19], v[116:119]
    ds_read_b64_tr_b16 a[66:67], v10 offset:43104
    v_mfma_f32_16x16x32_bf16 v[116:119], a[188:191], a[68:71], v[116:119]
    v_mfma_f32_16x16x32_bf16 v[120:123], a[176:179], a[16:19], v[120:123]
    v_mfma_f32_16x16x32_bf16 v[120:123], a[192:195], a[68:71], v[120:123]
    v_mfma_f32_16x16x32_bf16 v[124:127], a[180:183], a[16:19], v[124:127]
    v_mfma_f32_16x16x32_bf16 v[124:127], a[196:199], a[68:71], v[124:127]
    ds_read_b64_tr_b16 a[16:17], v9 offset:26752
    v_mfma_f32_16x16x32_bf16 v[128:131], a[168:171], a[20:23], v[128:131]
    ds_read_b64_tr_b16 a[18:19], v9 offset:29824
    v_mfma_f32_16x16x32_bf16 v[128:131], a[184:187], a[72:75], v[128:131]
    ds_read_b64_tr_b16 a[68:69], v9 offset:40064
    v_mfma_f32_16x16x32_bf16 v[132:135], a[172:175], a[20:23], v[132:135]
    ds_read_b64_tr_b16 a[70:71], v9 offset:43136
    v_mfma_f32_16x16x32_bf16 v[132:135], a[188:191], a[72:75], v[132:135]
    v_mfma_f32_16x16x32_bf16 v[136:139], a[176:179], a[20:23], v[136:139]
    v_mfma_f32_16x16x32_bf16 v[136:139], a[192:195], a[72:75], v[136:139]
    v_mfma_f32_16x16x32_bf16 v[140:143], a[180:183], a[20:23], v[140:143]
    v_mfma_f32_16x16x32_bf16 v[140:143], a[196:199], a[72:75], v[140:143]
    ds_read_b64_tr_b16 a[20:21], v10 offset:26784
    v_mfma_f32_16x16x32_bf16 v[144:147], a[24:27], a[168:171], v[144:147]
    ds_read_b64_tr_b16 a[22:23], v10 offset:29856
    v_mfma_f32_16x16x32_bf16 v[144:147], a[76:79], a[184:187], v[144:147]
    ds_read_b64_tr_b16 a[72:73], v10 offset:40096
    v_mfma_f32_16x16x32_bf16 v[148:151], a[24:27], a[172:175], v[148:151]
    ds_read_b64_tr_b16 a[74:75], v10 offset:43168
    v_mfma_f32_16x16x32_bf16 v[148:151], a[76:79], a[188:191], v[148:151]
    v_mfma_f32_16x16x32_bf16 v[152:155], a[24:27], a[176:179], v[152:155]
    v_mfma_f32_16x16x32_bf16 v[152:155], a[76:79], a[192:195], v[152:155]
    v_mfma_f32_16x16x32_bf16 v[156:159], a[24:27], a[180:183], v[156:159]
    v_mfma_f32_16x16x32_bf16 v[156:159], a[76:79], a[196:199], v[156:159]
    ds_read_b64_tr_b16 a[24:25], v11 offset:32768
    v_mfma_f32_16x16x32_bf16 v[160:163], a[28:31], a[168:171], v[160:163]
    ds_read_b64_tr_b16 a[26:27], v11 offset:36352
    v_mfma_f32_16x16x32_bf16 v[160:163], a[80:83], a[184:187], v[160:163]
    ds_read_b64_tr_b16 a[76:77], v11 offset:46080
    v_mfma_f32_16x16x32_bf16 v[164:167], a[28:31], a[172:175], v[164:167]
    ds_read_b64_tr_b16 a[78:79], v11 offset:49664
    v_mfma_f32_16x16x32_bf16 v[164:167], a[80:83], a[188:191], v[164:167]
    v_mfma_f32_16x16x32_bf16 v[168:171], a[28:31], a[176:179], v[168:171]
    v_mfma_f32_16x16x32_bf16 v[168:171], a[80:83], a[192:195], v[168:171]
    v_mfma_f32_16x16x32_bf16 v[172:175], a[28:31], a[180:183], v[172:175]
    v_mfma_f32_16x16x32_bf16 v[172:175], a[80:83], a[196:199], v[172:175]
    ds_read_b64_tr_b16 a[28:29], v11 offset:32800
    s_waitcnt lgkmcnt(8)
    v_mfma_f32_16x16x32_bf16 v[176:179], a[32:35], a[168:171], v[176:179]
    ds_read_b64_tr_b16 a[30:31], v11 offset:36384
    v_mfma_f32_16x16x32_bf16 v[176:179], a[84:87], a[184:187], v[176:179]
    ds_read_b64_tr_b16 a[80:81], v11 offset:46112
    v_mfma_f32_16x16x32_bf16 v[180:183], a[32:35], a[172:175], v[180:183]
    ds_read_b64_tr_b16 a[82:83], v11 offset:49696
    v_mfma_f32_16x16x32_bf16 v[180:183], a[84:87], a[188:191], v[180:183]
    v_mfma_f32_16x16x32_bf16 v[184:187], a[32:35], a[176:179], v[184:187]
    v_mfma_f32_16x16x32_bf16 v[184:187], a[84:87], a[192:195], v[184:187]
    v_mfma_f32_16x16x32_bf16 v[188:191], a[32:35], a[180:183], v[188:191]
    v_mfma_f32_16x16x32_bf16 v[188:191], a[84:87], a[196:199], v[188:191]
    ds_read_b64_tr_b16 a[32:33], v11 offset:32832
    v_mfma_f32_16x16x32_bf16 v[192:195], a[36:39], a[168:171], v[192:195]
    ds_read_b64_tr_b16 a[34:35], v11 offset:36416
    v_mfma_f32_16x16x32_bf16 v[192:195], a[88:91], a[184:187], v[192:195]
    ds_read_b64_tr_b16 a[84:85], v11 offset:46144
    v_mfma_f32_16x16x32_bf16 v[196:199], a[36:39], a[172:175], v[196:199]
    ds_read_b64_tr_b16 a[86:87], v11 offset:49728
    v_mfma_f32_16x16x32_bf16 v[196:199], a[88:91], a[188:191], v[196:199]
    v_mfma_f32_16x16x32_bf16 v[200:203], a[36:39], a[176:179], v[200:203]
    v_mfma_f32_16x16x32_bf16 v[200:203], a[88:91], a[192:195], v[200:203]
    v_mfma_f32_16x16x32_bf16 v[204:207], a[36:39], a[180:183], v[204:207]
    v_mfma_f32_16x16x32_bf16 v[204:207], a[88:91], a[196:199], v[204:207]
    ds_read_b64_tr_b16 a[36:37], v11 offset:32864
    v_mfma_f32_16x16x32_bf16 v[208:211], a[40:43], a[168:171], v[208:211]
    ds_read_b64_tr_b16 a[38:39], v11 offset:36448
    v_mfma_f32_16x16x32_bf16 v[208:211], a[92:95], a[184:187], v[208:211]
    ds_read_b64_tr_b16 a[88:89], v11 offset:46176
    v_mfma_f32_16x16x32_bf16 v[212:215], a[40:43], a[172:175], v[212:215]
    ds_read_b64_tr_b16 a[90:91], v11 offset:49760
    v_mfma_f32_16x16x32_bf16 v[212:215], a[92:95], a[188:191], v[212:215]
    v_mfma_f32_16x16x32_bf16 v[216:219], a[40:43], a[176:179], v[216:219]
    v_mfma_f32_16x16x32_bf16 v[216:219], a[92:95], a[192:195], v[216:219]
    v_mfma_f32_16x16x32_bf16 v[220:223], a[40:43], a[180:183], v[220:223]
    v_mfma_f32_16x16x32_bf16 v[220:223], a[92:95], a[196:199], v[220:223]
    ds_read_b64_tr_b16 a[40:41], v11 offset:32896
    v_mfma_f32_16x16x32_bf16 v[224:227], a[44:47], a[168:171], v[224:227]
    ds_read_b64_tr_b16 a[42:43], v11 offset:36480
    v_mfma_f32_16x16x32_bf16 v[224:227], a[96:99], a[184:187], v[224:227]
    ds_read_b64_tr_b16 a[92:93], v11 offset:46208
    v_mfma_f32_16x16x32_bf16 v[228:231], a[44:47], a[172:175], v[228:231]
    ds_read_b64_tr_b16 a[94:95], v11 offset:49792
    v_mfma_f32_16x16x32_bf16 v[228:231], a[96:99], a[188:191], v[228:231]
    v_mfma_f32_16x16x32_bf16 v[232:235], a[44:47], a[176:179], v[232:235]
    v_mfma_f32_16x16x32_bf16 v[232:235], a[96:99], a[192:195], v[232:235]
    v_mfma_f32_16x16x32_bf16 v[236:239], a[44:47], a[180:183], v[236:239]
    v_mfma_f32_16x16x32_bf16 v[236:239], a[96:99], a[196:199], v[236:239]
    ds_read_b64_tr_b16 a[44:45], v11 offset:32928
    v_mfma_f32_16x16x32_bf16 v[240:243], a[48:51], a[168:171], v[240:243]
    ds_read_b64_tr_b16 a[46:47], v11 offset:36512
    v_mfma_f32_16x16x32_bf16 v[240:243], a[100:103], a[184:187], v[240:243]
    ds_read_b64_tr_b16 a[96:97], v11 offset:46240
    v_mfma_f32_16x16x32_bf16 v[244:247], a[48:51], a[172:175], v[244:247]
    ds_read_b64_tr_b16 a[98:99], v11 offset:49824
    v_mfma_f32_16x16x32_bf16 v[244:247], a[100:103], a[188:191], v[244:247]
    v_mfma_f32_16x16x32_bf16 v[248:251], a[48:51], a[176:179], v[248:251]
    v_mfma_f32_16x16x32_bf16 v[248:251], a[100:103], a[192:195], v[248:251]
    v_mfma_f32_16x16x32_bf16 v[252:255], a[48:51], a[180:183], v[252:255]
    v_mfma_f32_16x16x32_bf16 v[252:255], a[100:103], a[196:199], v[252:255]
    ds_read_b64_tr_b16 a[48:49], v11 offset:32960
    ds_read_b64_tr_b16 a[50:51], v11 offset:36544
    ds_read_b64_tr_b16 a[100:101], v11 offset:46272
    ds_read_b64_tr_b16 a[102:103], v11 offset:49856
    s_waitcnt vmcnt(0)
    s_barrier
    s_waitcnt lgkmcnt(8)
    v_mfma_f32_16x16x32_bf16 v[48:51], a[0:3], a[200:203], v[48:51]
    v_mfma_f32_16x16x32_bf16 v[48:51], a[52:55], a[216:219], v[48:51]
    v_mfma_f32_16x16x32_bf16 v[52:55], a[0:3], a[204:207], v[52:55]
    v_mfma_f32_16x16x32_bf16 v[52:55], a[52:55], a[220:223], v[52:55]
    v_mfma_f32_16x16x32_bf16 v[56:59], a[0:3], a[208:211], v[56:59]
    v_mfma_f32_16x16x32_bf16 v[56:59], a[52:55], a[224:227], v[56:59]
    v_mfma_f32_16x16x32_bf16 v[60:63], a[0:3], a[212:215], v[60:63]
    v_mfma_f32_16x16x32_bf16 v[60:63], a[52:55], a[228:231], v[60:63]
    v_mfma_f32_16x16x32_bf16 v[64:67], a[4:7], a[200:203], v[64:67]
    v_mfma_f32_16x16x32_bf16 v[64:67], a[56:59], a[216:219], v[64:67]
    v_mfma_f32_16x16x32_bf16 v[68:71], a[4:7], a[204:207], v[68:71]
    v_mfma_f32_16x16x32_bf16 v[68:71], a[56:59], a[220:223], v[68:71]
    v_mfma_f32_16x16x32_bf16 v[72:75], a[4:7], a[208:211], v[72:75]
    v_mfma_f32_16x16x32_bf16 v[72:75], a[56:59], a[224:227], v[72:75]
    v_mfma_f32_16x16x32_bf16 v[76:79], a[4:7], a[212:215], v[76:79]
    v_mfma_f32_16x16x32_bf16 v[76:79], a[56:59], a[228:231], v[76:79]
    v_mfma_f32_16x16x32_bf16 v[80:83], a[8:11], a[200:203], v[80:83]
    v_mfma_f32_16x16x32_bf16 v[80:83], a[60:63], a[216:219], v[80:83]
    v_mfma_f32_16x16x32_bf16 v[84:87], a[8:11], a[204:207], v[84:87]
    v_mfma_f32_16x16x32_bf16 v[84:87], a[60:63], a[220:223], v[84:87]
    v_mfma_f32_16x16x32_bf16 v[88:91], a[8:11], a[208:211], v[88:91]
    v_mfma_f32_16x16x32_bf16 v[88:91], a[60:63], a[224:227], v[88:91]
    v_mfma_f32_16x16x32_bf16 v[92:95], a[8:11], a[212:215], v[92:95]
    v_mfma_f32_16x16x32_bf16 v[92:95], a[60:63], a[228:231], v[92:95]
    v_mfma_f32_16x16x32_bf16 v[96:99], a[12:15], a[200:203], v[96:99]
    v_mfma_f32_16x16x32_bf16 v[96:99], a[64:67], a[216:219], v[96:99]
    v_mfma_f32_16x16x32_bf16 v[100:103], a[12:15], a[204:207], v[100:103]
    v_mfma_f32_16x16x32_bf16 v[100:103], a[64:67], a[220:223], v[100:103]
    v_mfma_f32_16x16x32_bf16 v[104:107], a[12:15], a[208:211], v[104:107]
    v_mfma_f32_16x16x32_bf16 v[104:107], a[64:67], a[224:227], v[104:107]
    v_mfma_f32_16x16x32_bf16 v[108:111], a[12:15], a[212:215], v[108:111]
    v_mfma_f32_16x16x32_bf16 v[108:111], a[64:67], a[228:231], v[108:111]
    v_mfma_f32_16x16x32_bf16 v[112:115], a[200:203], a[16:19], v[112:115]
    v_mfma_f32_16x16x32_bf16 v[112:115], a[216:219], a[68:71], v[112:115]
    v_mfma_f32_16x16x32_bf16 v[116:119], a[204:207], a[16:19], v[116:119]
    v_mfma_f32_16x16x32_bf16 v[116:119], a[220:223], a[68:71], v[116:119]
    v_mfma_f32_16x16x32_bf16 v[120:123], a[208:211], a[16:19], v[120:123]
    v_mfma_f32_16x16x32_bf16 v[120:123], a[224:227], a[68:71], v[120:123]
    v_mfma_f32_16x16x32_bf16 v[124:127], a[212:215], a[16:19], v[124:127]
    v_mfma_f32_16x16x32_bf16 v[124:127], a[228:231], a[68:71], v[124:127]
    v_mfma_f32_16x16x32_bf16 v[128:131], a[200:203], a[20:23], v[128:131]
    v_mfma_f32_16x16x32_bf16 v[128:131], a[216:219], a[72:75], v[128:131]
    v_mfma_f32_16x16x32_bf16 v[132:135], a[204:207], a[20:23], v[132:135]
    v_mfma_f32_16x16x32_bf16 v[132:135], a[220:223], a[72:75], v[132:135]
    v_mfma_f32_16x16x32_bf16 v[136:139], a[208:211], a[20:23], v[136:139]
    v_mfma_f32_16x16x32_bf16 v[136:139], a[224:227], a[72:75], v[136:139]
    v_mfma_f32_16x16x32_bf16 v[140:143], a[212:215], a[20:23], v[140:143]
    v_mfma_f32_16x16x32_bf16 v[140:143], a[228:231], a[72:75], v[140:143]
    v_mfma_f32_16x16x32_bf16 v[144:147], a[24:27], a[200:203], v[144:147]
    v_mfma_f32_16x16x32_bf16 v[144:147], a[76:79], a[216:219], v[144:147]
    v_mfma_f32_16x16x32_bf16 v[148:151], a[24:27], a[204:207], v[148:151]
    v_mfma_f32_16x16x32_bf16 v[148:151], a[76:79], a[220:223], v[148:151]
    v_mfma_f32_16x16x32_bf16 v[152:155], a[24:27], a[208:211], v[152:155]
    v_mfma_f32_16x16x32_bf16 v[152:155], a[76:79], a[224:227], v[152:155]
    v_mfma_f32_16x16x32_bf16 v[156:159], a[24:27], a[212:215], v[156:159]
    v_mfma_f32_16x16x32_bf16 v[156:159], a[76:79], a[228:231], v[156:159]
    v_mfma_f32_16x16x32_bf16 v[160:163], a[28:31], a[200:203], v[160:163]
    v_mfma_f32_16x16x32_bf16 v[160:163], a[80:83], a[216:219], v[160:163]
    v_mfma_f32_16x16x32_bf16 v[164:167], a[28:31], a[204:207], v[164:167]
    v_mfma_f32_16x16x32_bf16 v[164:167], a[80:83], a[220:223], v[164:167]
    v_mfma_f32_16x16x32_bf16 v[168:171], a[28:31], a[208:211], v[168:171]
    v_mfma_f32_16x16x32_bf16 v[168:171], a[80:83], a[224:227], v[168:171]
    v_mfma_f32_16x16x32_bf16 v[172:175], a[28:31], a[212:215], v[172:175]
    v_mfma_f32_16x16x32_bf16 v[172:175], a[80:83], a[228:231], v[172:175]
    s_waitcnt lgkmcnt(0)
    v_mfma_f32_16x16x32_bf16 v[176:179], a[32:35], a[200:203], v[176:179]
    v_mfma_f32_16x16x32_bf16 v[176:179], a[84:87], a[216:219], v[176:179]
    v_mfma_f32_16x16x32_bf16 v[180:183], a[32:35], a[204:207], v[180:183]
    v_mfma_f32_16x16x32_bf16 v[180:183], a[84:87], a[220:223], v[180:183]
    v_mfma_f32_16x16x32_bf16 v[184:187], a[32:35], a[208:211], v[184:187]
    v_mfma_f32_16x16x32_bf16 v[184:187], a[84:87], a[224:227], v[184:187]
    v_mfma_f32_16x16x32_bf16 v[188:191], a[32:35], a[212:215], v[188:191]
    v_mfma_f32_16x16x32_bf16 v[188:191], a[84:87], a[228:231], v[188:191]
    v_mfma_f32_16x16x32_bf16 v[192:195], a[36:39], a[200:203], v[192:195]
    v_mfma_f32_16x16x32_bf16 v[192:195], a[88:91], a[216:219], v[192:195]
    v_mfma_f32_16x16x32_bf16 v[196:199], a[36:39], a[204:207], v[196:199]
    v_mfma_f32_16x16x32_bf16 v[196:199], a[88:91], a[220:223], v[196:199]
    v_mfma_f32_16x16x32_bf16 v[200:203], a[36:39], a[208:211], v[200:203]
    v_mfma_f32_16x16x32_bf16 v[200:203], a[88:91], a[224:227], v[200:203]
    v_mfma_f32_16x16x32_bf16 v[204:207], a[36:39], a[212:215], v[204:207]
    v_mfma_f32_16x16x32_bf16 v[204:207], a[88:91], a[228:231], v[204:207]
    v_mfma_f32_16x16x32_bf16 v[208:211], a[40:43], a[200:203], v[208:211]
    v_mfma_f32_16x16x32_bf16 v[208:211], a[92:95], a[216:219], v[208:211]
    v_mfma_f32_16x16x32_bf16 v[212:215], a[40:43], a[204:207], v[212:215]
    v_mfma_f32_16x16x32_bf16 v[212:215], a[92:95], a[220:223], v[212:215]
    v_mfma_f32_16x16x32_bf16 v[216:219], a[40:43], a[208:211], v[216:219]
    v_mfma_f32_16x16x32_bf16 v[216:219], a[92:95], a[224:227], v[216:219]
    v_mfma_f32_16x16x32_bf16 v[220:223], a[40:43], a[212:215], v[220:223]
    v_mfma_f32_16x16x32_bf16 v[220:223], a[92:95], a[228:231], v[220:223]
    v_mfma_f32_16x16x32_bf16 v[224:227], a[44:47], a[200:203], v[224:227]
    v_mfma_f32_16x16x32_bf16 v[224:227], a[96:99], a[216:219], v[224:227]
    v_mfma_f32_16x16x32_bf16 v[228:231], a[44:47], a[204:207], v[228:231]
    v_mfma_f32_16x16x32_bf16 v[228:231], a[96:99], a[220:223], v[228:231]
    v_mfma_f32_16x16x32_bf16 v[232:235], a[44:47], a[208:211], v[232:235]
    v_mfma_f32_16x16x32_bf16 v[232:235], a[96:99], a[224:227], v[232:235]
    v_mfma_f32_16x16x32_bf16 v[236:239], a[44:47], a[212:215], v[236:239]
    v_mfma_f32_16x16x32_bf16 v[236:239], a[96:99], a[228:231], v[236:239]
    v_mfma_f32_16x16x32_bf16 v[240:243], a[48:51], a[200:203], v[240:243]
    v_mfma_f32_16x16x32_bf16 v[240:243], a[100:103], a[216:219], v[240:243]
    v_mfma_f32_16x16x32_bf16 v[244:247], a[48:51], a[204:207], v[244:247]
    v_mfma_f32_16x16x32_bf16 v[244:247], a[100:103], a[220:223], v[244:247]
    v_mfma_f32_16x16x32_bf16 v[248:251], a[48:51], a[208:211], v[248:251]
    v_mfma_f32_16x16x32_bf16 v[248:251], a[100:103], a[224:227], v[248:251]
    v_mfma_f32_16x16x32_bf16 v[252:255], a[48:51], a[212:215], v[252:255]
    v_mfma_f32_16x16x32_bf16 v[252:255], a[100:103], a[228:231], v[252:255]
    s_load_dwordx2 s[4:5], s[0:1], 40
    s_load_dwordx2 s[6:7], s[0:1], 16
    s_load_dwordx2 s[40:41], s[0:1], 0
    s_load_dwordx2 s[42:43], s[0:1], 48
    s_add_u32 s12, s28, 8388608
    s_addc_u32 s13, s29, 0
    s_mov_b32 s14, 4194304
    s_mov_b32 s15, 0x00020000
    s_add_u32 s16, s28, 12582912
    s_addc_u32 s17, s29, 0
    s_mov_b32 s18, 4194304
    s_mov_b32 s19, 0x00020000
    s_add_u32 s20, s28, 16777216
    s_addc_u32 s21, s29, 0
    s_mov_b32 s22, 14680064
    s_mov_b32 s23, 0x00020000
    s_add_u32 s32, s28, 46137344
    s_addc_u32 s33, s29, 0
    s_mov_b32 s34, 196608
    s_mov_b32 s35, 0x00020000
    v_and_b32 v2, 15, v0
    v_lshrrev_b32 v3, 4, v0
    v_lshlrev_b32 v3, 9, v3
    s_lshl_b32 s3, s25, 3
    s_lshl_b32 s30, s24, 1
    s_add_u32 s3, s3, s30
    s_mov_b32 s31, s3
    s_lshl_b32 s30, s26, 17
    s_lshl_b32 s37, s3, 11
    s_add_u32 s30, s30, s37
    v_lshl_add_u32 v4, v2, 4, v3
    s_lshl_b32 s37, s24, 12
    s_add_u32 s37, s37, 131072
    v_add_u32 v8, s37, v4
    s_lshl_b32 s37, s24, 12
    s_add_u32 s37, s37, 16384
    v_add_u32 v15, s37, v4
    v_add_u32 v4, s30, v4
    v_and_b32 v5, 7, v2
    v_lshrrev_b32 v6, 3, v2
    v_lshl_add_u32 v5, v6, 4, v5
    v_lshl_add_u32 v5, v5, 4, v3
    s_lshl_b32 s37, s24, 12
    v_add_u32 v14, s37, v5
    v_add_u32 v5, s30, v5
    s_mul_i32 s37, s3, 229376
    s_mul_i32 s38, s26, 7
    s_add_u32 s38, s38, 1
    s_lshr_b32 s38, s38, 1
    s_lshl_b32 s38, s38, 11
    s_add_u32 s37, s37, s38
    v_lshl_add_u32 v6, v2, 4, v3
    v_add_u32 v6, s37, v6
    s_and_b32 s38, s26, 1
    s_cmp_eq_u32 s38, 0
    s_mov_b32 s39, 6144
    s_cselect_b32 s38, s39, -2040
    v_add_u32 v7, s38, v6
    s_mov_b32 s37, 0x3e8293ee
    s_mov_b32 s36, 0xbfb8aa3b
    v_cvt_pk_bf16_f32 v24, v80, v81
    v_cvt_pk_bf16_f32 v25, v82, v83
    v_cvt_pk_bf16_f32 v26, v96, v97
    v_cvt_pk_bf16_f32 v27, v98, v99
    buffer_store_dwordx4 v[24:27], v5, s[12:15], 0 offen offset:0 sc0 sc1
    ds_write_b128 v14, v[24:27] offset:0
    v_cvt_pk_bf16_f32 v28, v84, v85
    v_cvt_pk_bf16_f32 v29, v86, v87
    v_cvt_pk_bf16_f32 v30, v100, v101
    v_cvt_pk_bf16_f32 v31, v102, v103
    buffer_store_dwordx4 v[28:31], v5, s[12:15], 0 offen offset:128 sc0 sc1
    ds_write_b128 v14, v[28:31] offset:128
    v_mul_f32 v48, s37, v48
    v_mul_f32 v49, s37, v49
    v_mul_f32 v50, s37, v50
    v_mul_f32 v51, s37, v51
    v_mul_f32 v64, s37, v64
    v_mul_f32 v65, s37, v65
    v_mul_f32 v66, s37, v66
    v_mul_f32 v67, s37, v67
    v_cvt_pk_bf16_f32 v32, v48, v49
    v_cvt_pk_bf16_f32 v33, v50, v51
    v_cvt_pk_bf16_f32 v34, v64, v65
    v_cvt_pk_bf16_f32 v35, v66, v67
    ds_write_b128 v8, v[32:35] offset:0
    v_mul_f32 v52, s37, v52
    v_mul_f32 v53, s37, v53
    v_mul_f32 v54, s37, v54
    v_mul_f32 v55, s37, v55
    v_mul_f32 v68, s37, v68
    v_mul_f32 v69, s37, v69
    v_mul_f32 v70, s37, v70
    v_mul_f32 v71, s37, v71
    v_cvt_pk_bf16_f32 v36, v52, v53
    v_cvt_pk_bf16_f32 v37, v54, v55
    v_cvt_pk_bf16_f32 v38, v68, v69
    v_cvt_pk_bf16_f32 v39, v70, v71
    ds_write_b128 v8, v[36:39] offset:256
    v_mul_f32 v56, s37, v56
    v_mul_f32 v57, s37, v57
    v_mul_f32 v58, s37, v58
    v_mul_f32 v59, s37, v59
    v_mul_f32 v72, s37, v72
    v_mul_f32 v73, s37, v73
    v_mul_f32 v74, s37, v74
    v_mul_f32 v75, s37, v75
    v_cvt_pk_bf16_f32 v32, v56, v57
    v_cvt_pk_bf16_f32 v33, v58, v59
    v_cvt_pk_bf16_f32 v34, v72, v73
    v_cvt_pk_bf16_f32 v35, v74, v75
    ds_write_b128 v8, v[32:35] offset:2048
    v_mul_f32 v60, s37, v60
    v_mul_f32 v61, s37, v61
    v_mul_f32 v62, s37, v62
    v_mul_f32 v63, s37, v63
    v_mul_f32 v76, s37, v76
    v_mul_f32 v77, s37, v77
    v_mul_f32 v78, s37, v78
    v_mul_f32 v79, s37, v79
    v_cvt_pk_bf16_f32 v36, v60, v61
    v_cvt_pk_bf16_f32 v37, v62, v63
    v_cvt_pk_bf16_f32 v38, v76, v77
    v_cvt_pk_bf16_f32 v39, v78, v79
    ds_write_b128 v8, v[36:39] offset:2304
    s_mov_b32 s37, s36
    s_mov_b32 s38, 1.0
    s_mov_b32 s39, 1.0
    v_pk_mul_f32 v[16:17], v[144:145], s[36:37]
    v_pk_mul_f32 v[18:19], v[146:147], s[36:37]
    v_pk_mul_f32 v[20:21], v[160:161], s[36:37]
    v_pk_mul_f32 v[22:23], v[162:163], s[36:37]
    v_exp_f32 v16, v16
    v_exp_f32 v17, v17
    v_exp_f32 v18, v18
    v_exp_f32 v19, v19
    v_exp_f32 v20, v20
    v_exp_f32 v21, v21
    v_exp_f32 v22, v22
    v_exp_f32 v23, v23
    v_pk_add_f32 v[16:17], v[16:17], s[38:39]
    v_pk_add_f32 v[18:19], v[18:19], s[38:39]
    v_pk_add_f32 v[20:21], v[20:21], s[38:39]
    v_pk_add_f32 v[22:23], v[22:23], s[38:39]
    v_rcp_f32 v16, v16
    v_rcp_f32 v17, v17
    v_rcp_f32 v18, v18
    v_rcp_f32 v19, v19
    v_rcp_f32 v20, v20
    v_rcp_f32 v21, v21
    v_rcp_f32 v22, v22
    v_rcp_f32 v23, v23
    v_pk_mul_f32 v[144:145], v[144:145], v[16:17]
    v_pk_mul_f32 v[146:147], v[146:147], v[18:19]
    v_pk_mul_f32 v[160:161], v[160:161], v[20:21]
    v_pk_mul_f32 v[162:163], v[162:163], v[22:23]
    v_cvt_pk_bf16_f32 v144, v144, v145
    v_cvt_pk_bf16_f32 v145, v146, v147
    v_cvt_pk_bf16_f32 v146, v160, v161
    v_cvt_pk_bf16_f32 v147, v162, v163
    v_cvt_pk_bf16_f32 v24, v88, v89
    v_cvt_pk_bf16_f32 v25, v90, v91
    v_cvt_pk_bf16_f32 v26, v104, v105
    v_cvt_pk_bf16_f32 v27, v106, v107
    buffer_store_dwordx4 v[24:27], v5, s[12:15], 0 offen offset:2048 sc0 sc1
    ds_write_b128 v14, v[24:27] offset:2048
    v_pk_mul_f32 v[16:17], v[176:177], s[36:37]
    v_pk_mul_f32 v[18:19], v[178:179], s[36:37]
    v_pk_mul_f32 v[20:21], v[192:193], s[36:37]
    v_pk_mul_f32 v[22:23], v[194:195], s[36:37]
    v_exp_f32 v16, v16
    v_exp_f32 v17, v17
    v_exp_f32 v18, v18
    v_exp_f32 v19, v19
    v_exp_f32 v20, v20
    v_exp_f32 v21, v21
    v_exp_f32 v22, v22
    v_exp_f32 v23, v23
    v_pk_add_f32 v[16:17], v[16:17], s[38:39]
    v_pk_add_f32 v[18:19], v[18:19], s[38:39]
    v_pk_add_f32 v[20:21], v[20:21], s[38:39]
    v_pk_add_f32 v[22:23], v[22:23], s[38:39]
    v_rcp_f32 v16, v16
    v_rcp_f32 v17, v17
    v_rcp_f32 v18, v18
    v_rcp_f32 v19, v19
    v_rcp_f32 v20, v20
    v_rcp_f32 v21, v21
    v_rcp_f32 v22, v22
    v_rcp_f32 v23, v23
    v_pk_mul_f32 v[176:177], v[176:177], v[16:17]
    v_pk_mul_f32 v[178:179], v[178:179], v[18:19]
    v_pk_mul_f32 v[192:193], v[192:193], v[20:21]
    v_pk_mul_f32 v[194:195], v[194:195], v[22:23]
    v_cvt_pk_bf16_f32 v176, v176, v177
    v_cvt_pk_bf16_f32 v177, v178, v179
    v_cvt_pk_bf16_f32 v178, v192, v193
    v_cvt_pk_bf16_f32 v179, v194, v195
    v_cvt_pk_bf16_f32 v28, v92, v93
    v_cvt_pk_bf16_f32 v29, v94, v95
    v_cvt_pk_bf16_f32 v30, v108, v109
    v_cvt_pk_bf16_f32 v31, v110, v111
    buffer_store_dwordx4 v[28:31], v5, s[12:15], 0 offen offset:2176 sc0 sc1
    ds_write_b128 v14, v[28:31] offset:2176
    v_pk_mul_f32 v[16:17], v[208:209], s[36:37]
    v_pk_mul_f32 v[18:19], v[210:211], s[36:37]
    v_pk_mul_f32 v[20:21], v[224:225], s[36:37]
    v_pk_mul_f32 v[22:23], v[226:227], s[36:37]
    v_exp_f32 v16, v16
    v_exp_f32 v17, v17
    v_exp_f32 v18, v18
    v_exp_f32 v19, v19
    v_exp_f32 v20, v20
    v_exp_f32 v21, v21
    v_exp_f32 v22, v22
    v_exp_f32 v23, v23
    v_pk_add_f32 v[16:17], v[16:17], s[38:39]
    v_pk_add_f32 v[18:19], v[18:19], s[38:39]
    v_pk_add_f32 v[20:21], v[20:21], s[38:39]
    v_pk_add_f32 v[22:23], v[22:23], s[38:39]
    v_rcp_f32 v16, v16
    v_rcp_f32 v17, v17
    v_rcp_f32 v18, v18
    v_rcp_f32 v19, v19
    v_rcp_f32 v20, v20
    v_rcp_f32 v21, v21
    v_rcp_f32 v22, v22
    v_rcp_f32 v23, v23
    v_pk_mul_f32 v[208:209], v[208:209], v[16:17]
    v_pk_mul_f32 v[210:211], v[210:211], v[18:19]
    v_pk_mul_f32 v[224:225], v[224:225], v[20:21]
    v_pk_mul_f32 v[226:227], v[226:227], v[22:23]
    v_cvt_pk_bf16_f32 v208, v208, v209
    v_cvt_pk_bf16_f32 v209, v210, v211
    v_cvt_pk_bf16_f32 v210, v224, v225
    v_cvt_pk_bf16_f32 v211, v226, v227
    v_cvt_pk_bf16_f32 v24, v112, v113
    v_cvt_pk_bf16_f32 v25, v114, v115
    v_cvt_pk_bf16_f32 v26, v116, v117
    v_cvt_pk_bf16_f32 v27, v118, v119
    buffer_store_dwordx4 v[24:27], v4, s[16:19], 0 offen offset:0 sc0 sc1
    ds_write_b128 v15, v[24:27] offset:0
    v_pk_mul_f32 v[16:17], v[148:149], s[36:37]
    v_pk_mul_f32 v[18:19], v[150:151], s[36:37]
    v_pk_mul_f32 v[20:21], v[164:165], s[36:37]
    v_pk_mul_f32 v[22:23], v[166:167], s[36:37]
    v_exp_f32 v16, v16
    v_exp_f32 v17, v17
    v_exp_f32 v18, v18
    v_exp_f32 v19, v19
    v_exp_f32 v20, v20
    v_exp_f32 v21, v21
    v_exp_f32 v22, v22
    v_exp_f32 v23, v23
    v_pk_add_f32 v[16:17], v[16:17], s[38:39]
    v_pk_add_f32 v[18:19], v[18:19], s[38:39]
    v_pk_add_f32 v[20:21], v[20:21], s[38:39]
    v_pk_add_f32 v[22:23], v[22:23], s[38:39]
    v_rcp_f32 v16, v16
    v_rcp_f32 v17, v17
    v_rcp_f32 v18, v18
    v_rcp_f32 v19, v19
    v_rcp_f32 v20, v20
    v_rcp_f32 v21, v21
    v_rcp_f32 v22, v22
    v_rcp_f32 v23, v23
    v_pk_mul_f32 v[148:149], v[148:149], v[16:17]
    v_pk_mul_f32 v[150:151], v[150:151], v[18:19]
    v_pk_mul_f32 v[164:165], v[164:165], v[20:21]
    v_pk_mul_f32 v[166:167], v[166:167], v[22:23]
    v_cvt_pk_bf16_f32 v148, v148, v149
    v_cvt_pk_bf16_f32 v149, v150, v151
    v_cvt_pk_bf16_f32 v150, v164, v165
    v_cvt_pk_bf16_f32 v151, v166, v167
    v_cvt_pk_bf16_f32 v28, v128, v129
    v_cvt_pk_bf16_f32 v29, v130, v131
    v_cvt_pk_bf16_f32 v30, v132, v133
    v_cvt_pk_bf16_f32 v31, v134, v135
    buffer_store_dwordx4 v[28:31], v4, s[16:19], 0 offen offset:256 sc0 sc1
    ds_write_b128 v15, v[28:31] offset:256
    v_pk_mul_f32 v[16:17], v[180:181], s[36:37]
    v_pk_mul_f32 v[18:19], v[182:183], s[36:37]
    v_pk_mul_f32 v[20:21], v[196:197], s[36:37]
    v_pk_mul_f32 v[22:23], v[198:199], s[36:37]
    v_exp_f32 v16, v16
    v_exp_f32 v17, v17
    v_exp_f32 v18, v18
    v_exp_f32 v19, v19
    v_exp_f32 v20, v20
    v_exp_f32 v21, v21
    v_exp_f32 v22, v22
    v_exp_f32 v23, v23
    v_pk_add_f32 v[16:17], v[16:17], s[38:39]
    v_pk_add_f32 v[18:19], v[18:19], s[38:39]
    v_pk_add_f32 v[20:21], v[20:21], s[38:39]
    v_pk_add_f32 v[22:23], v[22:23], s[38:39]
    v_rcp_f32 v16, v16
    v_rcp_f32 v17, v17
    v_rcp_f32 v18, v18
    v_rcp_f32 v19, v19
    v_rcp_f32 v20, v20
    v_rcp_f32 v21, v21
    v_rcp_f32 v22, v22
    v_rcp_f32 v23, v23
    v_pk_mul_f32 v[180:181], v[180:181], v[16:17]
    v_pk_mul_f32 v[182:183], v[182:183], v[18:19]
    v_pk_mul_f32 v[196:197], v[196:197], v[20:21]
    v_pk_mul_f32 v[198:199], v[198:199], v[22:23]
    v_cvt_pk_bf16_f32 v180, v180, v181
    v_cvt_pk_bf16_f32 v181, v182, v183
    v_cvt_pk_bf16_f32 v182, v196, v197
    v_cvt_pk_bf16_f32 v183, v198, v199
    v_cvt_pk_bf16_f32 v24, v120, v121
    v_cvt_pk_bf16_f32 v25, v122, v123
    v_cvt_pk_bf16_f32 v26, v124, v125
    v_cvt_pk_bf16_f32 v27, v126, v127
    buffer_store_dwordx4 v[24:27], v4, s[16:19], 0 offen offset:2048 sc0 sc1
    ds_write_b128 v15, v[24:27] offset:2048
    v_pk_mul_f32 v[16:17], v[212:213], s[36:37]
    v_pk_mul_f32 v[18:19], v[214:215], s[36:37]
    v_pk_mul_f32 v[20:21], v[228:229], s[36:37]
    v_pk_mul_f32 v[22:23], v[230:231], s[36:37]
    v_exp_f32 v16, v16
    v_exp_f32 v17, v17
    v_exp_f32 v18, v18
    v_exp_f32 v19, v19
    v_exp_f32 v20, v20
    v_exp_f32 v21, v21
    v_exp_f32 v22, v22
    v_exp_f32 v23, v23
    v_pk_add_f32 v[16:17], v[16:17], s[38:39]
    v_pk_add_f32 v[18:19], v[18:19], s[38:39]
    v_pk_add_f32 v[20:21], v[20:21], s[38:39]
    v_pk_add_f32 v[22:23], v[22:23], s[38:39]
    v_rcp_f32 v16, v16
    v_rcp_f32 v17, v17
    v_rcp_f32 v18, v18
    v_rcp_f32 v19, v19
    v_rcp_f32 v20, v20
    v_rcp_f32 v21, v21
    v_rcp_f32 v22, v22
    v_rcp_f32 v23, v23
    v_pk_mul_f32 v[212:213], v[212:213], v[16:17]
    v_pk_mul_f32 v[214:215], v[214:215], v[18:19]
    v_pk_mul_f32 v[228:229], v[228:229], v[20:21]
    v_pk_mul_f32 v[230:231], v[230:231], v[22:23]
    v_cvt_pk_bf16_f32 v212, v212, v213
    v_cvt_pk_bf16_f32 v213, v214, v215
    v_cvt_pk_bf16_f32 v214, v228, v229
    v_cvt_pk_bf16_f32 v215, v230, v231
    v_cvt_pk_bf16_f32 v28, v136, v137
    v_cvt_pk_bf16_f32 v29, v138, v139
    v_cvt_pk_bf16_f32 v30, v140, v141
    v_cvt_pk_bf16_f32 v31, v142, v143
    buffer_store_dwordx4 v[28:31], v4, s[16:19], 0 offen offset:2304 sc0 sc1
    ds_write_b128 v15, v[28:31] offset:2304
    v_pk_mul_f32 v[16:17], v[240:241], s[36:37]
    v_pk_mul_f32 v[18:19], v[242:243], s[36:37]
    v_pk_mul_f32 v[20:21], v[244:245], s[36:37]
    v_pk_mul_f32 v[22:23], v[246:247], s[36:37]
    v_exp_f32 v16, v16
    v_exp_f32 v17, v17
    v_exp_f32 v18, v18
    v_exp_f32 v19, v19
    v_exp_f32 v20, v20
    v_exp_f32 v21, v21
    v_exp_f32 v22, v22
    v_exp_f32 v23, v23
    v_pk_add_f32 v[16:17], v[16:17], s[38:39]
    v_pk_add_f32 v[18:19], v[18:19], s[38:39]
    v_pk_add_f32 v[20:21], v[20:21], s[38:39]
    v_pk_add_f32 v[22:23], v[22:23], s[38:39]
    v_rcp_f32 v16, v16
    v_rcp_f32 v17, v17
    v_rcp_f32 v18, v18
    v_rcp_f32 v19, v19
    v_rcp_f32 v20, v20
    v_rcp_f32 v21, v21
    v_rcp_f32 v22, v22
    v_rcp_f32 v23, v23
    v_pk_mul_f32 v[240:241], v[240:241], v[16:17]
    v_pk_mul_f32 v[242:243], v[242:243], v[18:19]
    v_pk_mul_f32 v[244:245], v[244:245], v[20:21]
    v_pk_mul_f32 v[246:247], v[246:247], v[22:23]
    v_cvt_pk_bf16_f32 v240, v240, v241
    v_cvt_pk_bf16_f32 v241, v242, v243
    v_cvt_pk_bf16_f32 v244, v244, v245
    v_cvt_pk_bf16_f32 v245, v246, v247
    v_pk_mul_f32 v[16:17], v[152:153], s[36:37]
    v_pk_mul_f32 v[18:19], v[154:155], s[36:37]
    v_pk_mul_f32 v[20:21], v[168:169], s[36:37]
    v_pk_mul_f32 v[22:23], v[170:171], s[36:37]
    v_exp_f32 v16, v16
    v_exp_f32 v17, v17
    v_exp_f32 v18, v18
    v_exp_f32 v19, v19
    v_exp_f32 v20, v20
    v_exp_f32 v21, v21
    v_exp_f32 v22, v22
    v_exp_f32 v23, v23
    v_pk_add_f32 v[16:17], v[16:17], s[38:39]
    v_pk_add_f32 v[18:19], v[18:19], s[38:39]
    v_pk_add_f32 v[20:21], v[20:21], s[38:39]
    v_pk_add_f32 v[22:23], v[22:23], s[38:39]
    v_rcp_f32 v16, v16
    v_rcp_f32 v17, v17
    v_rcp_f32 v18, v18
    v_rcp_f32 v19, v19
    v_rcp_f32 v20, v20
    v_rcp_f32 v21, v21
    v_rcp_f32 v22, v22
    v_rcp_f32 v23, v23
    v_pk_mul_f32 v[152:153], v[152:153], v[16:17]
    v_pk_mul_f32 v[154:155], v[154:155], v[18:19]
    v_pk_mul_f32 v[168:169], v[168:169], v[20:21]
    v_pk_mul_f32 v[170:171], v[170:171], v[22:23]
    v_cvt_pk_bf16_f32 v152, v152, v153
    v_cvt_pk_bf16_f32 v153, v154, v155
    v_cvt_pk_bf16_f32 v154, v168, v169
    v_cvt_pk_bf16_f32 v155, v170, v171
    v_pk_mul_f32 v[16:17], v[184:185], s[36:37]
    v_pk_mul_f32 v[18:19], v[186:187], s[36:37]
    v_pk_mul_f32 v[20:21], v[200:201], s[36:37]
    v_pk_mul_f32 v[22:23], v[202:203], s[36:37]
    v_exp_f32 v16, v16
    v_exp_f32 v17, v17
    v_exp_f32 v18, v18
    v_exp_f32 v19, v19
    v_exp_f32 v20, v20
    v_exp_f32 v21, v21
    v_exp_f32 v22, v22
    v_exp_f32 v23, v23
    v_pk_add_f32 v[16:17], v[16:17], s[38:39]
    v_pk_add_f32 v[18:19], v[18:19], s[38:39]
    v_pk_add_f32 v[20:21], v[20:21], s[38:39]
    v_pk_add_f32 v[22:23], v[22:23], s[38:39]
    v_rcp_f32 v16, v16
    v_rcp_f32 v17, v17
    v_rcp_f32 v18, v18
    v_rcp_f32 v19, v19
    v_rcp_f32 v20, v20
    v_rcp_f32 v21, v21
    v_rcp_f32 v22, v22
    v_rcp_f32 v23, v23
    v_pk_mul_f32 v[184:185], v[184:185], v[16:17]
    v_pk_mul_f32 v[186:187], v[186:187], v[18:19]
    v_pk_mul_f32 v[200:201], v[200:201], v[20:21]
    v_pk_mul_f32 v[202:203], v[202:203], v[22:23]
    v_cvt_pk_bf16_f32 v184, v184, v185
    v_cvt_pk_bf16_f32 v185, v186, v187
    v_cvt_pk_bf16_f32 v186, v200, v201
    v_cvt_pk_bf16_f32 v187, v202, v203
    v_pk_mul_f32 v[16:17], v[216:217], s[36:37]
    v_pk_mul_f32 v[18:19], v[218:219], s[36:37]
    v_pk_mul_f32 v[20:21], v[232:233], s[36:37]
    v_pk_mul_f32 v[22:23], v[234:235], s[36:37]
    v_exp_f32 v16, v16
    v_exp_f32 v17, v17
    v_exp_f32 v18, v18
    v_exp_f32 v19, v19
    v_exp_f32 v20, v20
    v_exp_f32 v21, v21
    v_exp_f32 v22, v22
    v_exp_f32 v23, v23
    v_pk_add_f32 v[16:17], v[16:17], s[38:39]
    v_pk_add_f32 v[18:19], v[18:19], s[38:39]
    v_pk_add_f32 v[20:21], v[20:21], s[38:39]
    v_pk_add_f32 v[22:23], v[22:23], s[38:39]
    v_rcp_f32 v16, v16
    v_rcp_f32 v17, v17
    v_rcp_f32 v18, v18
    v_rcp_f32 v19, v19
    v_rcp_f32 v20, v20
    v_rcp_f32 v21, v21
    v_rcp_f32 v22, v22
    v_rcp_f32 v23, v23
    v_pk_mul_f32 v[216:217], v[216:217], v[16:17]
    v_pk_mul_f32 v[218:219], v[218:219], v[18:19]
    v_pk_mul_f32 v[232:233], v[232:233], v[20:21]
    v_pk_mul_f32 v[234:235], v[234:235], v[22:23]
    v_cvt_pk_bf16_f32 v216, v216, v217
    v_cvt_pk_bf16_f32 v217, v218, v219
    v_cvt_pk_bf16_f32 v218, v232, v233
    v_cvt_pk_bf16_f32 v219, v234, v235
    v_pk_mul_f32 v[16:17], v[156:157], s[36:37]
    v_pk_mul_f32 v[18:19], v[158:159], s[36:37]
    v_pk_mul_f32 v[20:21], v[172:173], s[36:37]
    v_pk_mul_f32 v[22:23], v[174:175], s[36:37]
    v_exp_f32 v16, v16
    v_exp_f32 v17, v17
    v_exp_f32 v18, v18
    v_exp_f32 v19, v19
    v_exp_f32 v20, v20
    v_exp_f32 v21, v21
    v_exp_f32 v22, v22
    v_exp_f32 v23, v23
    v_pk_add_f32 v[16:17], v[16:17], s[38:39]
    v_pk_add_f32 v[18:19], v[18:19], s[38:39]
    v_pk_add_f32 v[20:21], v[20:21], s[38:39]
    v_pk_add_f32 v[22:23], v[22:23], s[38:39]
    v_rcp_f32 v16, v16
    v_rcp_f32 v17, v17
    v_rcp_f32 v18, v18
    v_rcp_f32 v19, v19
    v_rcp_f32 v20, v20
    v_rcp_f32 v21, v21
    v_rcp_f32 v22, v22
    v_rcp_f32 v23, v23
    v_pk_mul_f32 v[156:157], v[156:157], v[16:17]
    v_pk_mul_f32 v[158:159], v[158:159], v[18:19]
    v_pk_mul_f32 v[172:173], v[172:173], v[20:21]
    v_pk_mul_f32 v[174:175], v[174:175], v[22:23]
    v_cvt_pk_bf16_f32 v156, v156, v157
    v_cvt_pk_bf16_f32 v157, v158, v159
    v_cvt_pk_bf16_f32 v158, v172, v173
    v_cvt_pk_bf16_f32 v159, v174, v175
    v_pk_mul_f32 v[16:17], v[188:189], s[36:37]
    v_pk_mul_f32 v[18:19], v[190:191], s[36:37]
    v_pk_mul_f32 v[20:21], v[204:205], s[36:37]
    v_pk_mul_f32 v[22:23], v[206:207], s[36:37]
    v_exp_f32 v16, v16
    v_exp_f32 v17, v17
    v_exp_f32 v18, v18
    v_exp_f32 v19, v19
    v_exp_f32 v20, v20
    v_exp_f32 v21, v21
    v_exp_f32 v22, v22
    v_exp_f32 v23, v23
    v_pk_add_f32 v[16:17], v[16:17], s[38:39]
    v_pk_add_f32 v[18:19], v[18:19], s[38:39]
    v_pk_add_f32 v[20:21], v[20:21], s[38:39]
    v_pk_add_f32 v[22:23], v[22:23], s[38:39]
    v_rcp_f32 v16, v16
    v_rcp_f32 v17, v17
    v_rcp_f32 v18, v18
    v_rcp_f32 v19, v19
    v_rcp_f32 v20, v20
    v_rcp_f32 v21, v21
    v_rcp_f32 v22, v22
    v_rcp_f32 v23, v23
    v_pk_mul_f32 v[188:189], v[188:189], v[16:17]
    v_pk_mul_f32 v[190:191], v[190:191], v[18:19]
    v_pk_mul_f32 v[204:205], v[204:205], v[20:21]
    v_pk_mul_f32 v[206:207], v[206:207], v[22:23]
    v_cvt_pk_bf16_f32 v188, v188, v189
    v_cvt_pk_bf16_f32 v189, v190, v191
    v_cvt_pk_bf16_f32 v190, v204, v205
    v_cvt_pk_bf16_f32 v191, v206, v207
    v_pk_mul_f32 v[16:17], v[220:221], s[36:37]
    v_pk_mul_f32 v[18:19], v[222:223], s[36:37]
    v_pk_mul_f32 v[20:21], v[236:237], s[36:37]
    v_pk_mul_f32 v[22:23], v[238:239], s[36:37]
    v_exp_f32 v16, v16
    v_exp_f32 v17, v17
    v_exp_f32 v18, v18
    v_exp_f32 v19, v19
    v_exp_f32 v20, v20
    v_exp_f32 v21, v21
    v_exp_f32 v22, v22
    v_exp_f32 v23, v23
    v_pk_add_f32 v[16:17], v[16:17], s[38:39]
    v_pk_add_f32 v[18:19], v[18:19], s[38:39]
    v_pk_add_f32 v[20:21], v[20:21], s[38:39]
    v_pk_add_f32 v[22:23], v[22:23], s[38:39]
    v_rcp_f32 v16, v16
    v_rcp_f32 v17, v17
    v_rcp_f32 v18, v18
    v_rcp_f32 v19, v19
    v_rcp_f32 v20, v20
    v_rcp_f32 v21, v21
    v_rcp_f32 v22, v22
    v_rcp_f32 v23, v23
    v_pk_mul_f32 v[220:221], v[220:221], v[16:17]
    v_pk_mul_f32 v[222:223], v[222:223], v[18:19]
    v_pk_mul_f32 v[236:237], v[236:237], v[20:21]
    v_pk_mul_f32 v[238:239], v[238:239], v[22:23]
    v_cvt_pk_bf16_f32 v220, v220, v221
    v_cvt_pk_bf16_f32 v221, v222, v223
    v_cvt_pk_bf16_f32 v222, v236, v237
    v_cvt_pk_bf16_f32 v223, v238, v239
    s_waitcnt vmcnt(0) lgkmcnt(0)
    s_barrier
    s_lshl_b32 s3, s2, 7
    s_cmp_lg_u32 s24, 0
    s_cbranch_scc1 parallel_sum__softmax_full_mha__dense_activation_silu__prompt_kernel_nf_qkv
    v_mov_b32 v10, s94
    v_mov_b32 v11, 0
    s_mov_b64 exec, 1
    buffer_store_dword v10, v11, s[32:35], s3 offen sc0 sc1
    s_mov_b64 exec, -1
parallel_sum__softmax_full_mha__dense_activation_silu__prompt_kernel_nf_qkv:
    v_pk_mul_f32 v[16:17], v[248:249], s[36:37]
    v_pk_mul_f32 v[18:19], v[250:251], s[36:37]
    v_pk_mul_f32 v[20:21], v[252:253], s[36:37]
    v_pk_mul_f32 v[22:23], v[254:255], s[36:37]
    v_exp_f32 v16, v16
    v_exp_f32 v17, v17
    v_exp_f32 v18, v18
    v_exp_f32 v19, v19
    v_exp_f32 v20, v20
    v_exp_f32 v21, v21
    v_exp_f32 v22, v22
    v_exp_f32 v23, v23
    v_pk_add_f32 v[16:17], v[16:17], s[38:39]
    v_pk_add_f32 v[18:19], v[18:19], s[38:39]
    v_pk_add_f32 v[20:21], v[20:21], s[38:39]
    v_pk_add_f32 v[22:23], v[22:23], s[38:39]
    v_rcp_f32 v16, v16
    v_rcp_f32 v17, v17
    v_rcp_f32 v18, v18
    v_rcp_f32 v19, v19
    v_rcp_f32 v20, v20
    v_rcp_f32 v21, v21
    v_rcp_f32 v22, v22
    v_rcp_f32 v23, v23
    v_pk_mul_f32 v[248:249], v[248:249], v[16:17]
    v_pk_mul_f32 v[250:251], v[250:251], v[18:19]
    v_pk_mul_f32 v[252:253], v[252:253], v[20:21]
    v_pk_mul_f32 v[254:255], v[254:255], v[22:23]
    v_cvt_pk_bf16_f32 v248, v248, v249
    v_cvt_pk_bf16_f32 v249, v250, v251
    v_cvt_pk_bf16_f32 v252, v252, v253
    v_cvt_pk_bf16_f32 v253, v254, v255
    s_lshl_b32 s3, s26, 17
    s_add_u32 s8, s28, 8388608
    s_addc_u32 s9, s29, 0
    s_add_u32 s8, s8, s3
    s_addc_u32 s9, s9, 0
    s_mov_b32 s10, 131072
    s_mov_b32 s11, 0x00020000
    s_add_u32 s12, s28, 12582912
    s_addc_u32 s13, s29, 0
    s_add_u32 s12, s12, s3
    s_addc_u32 s13, s13, 0
    s_mov_b32 s14, 131072
    s_mov_b32 s15, 0x00020000
    v_lshlrev_b32 v8, 4, v0
    s_lshl_b32 s30, s24, 12
    v_add_u32 v9, s30, v8
    v_lshlrev_b32 v12, 4, v0
    s_lshl_b32 s3, s24, 12
    s_add_u32 s3, s3, 131072
    v_add_u32 v12, s3, v12
    ds_read_b128 a[16:19], v12 offset:0
    ds_read_b128 a[20:23], v12 offset:1024
    ds_read_b128 a[24:27], v12 offset:2048
    ds_read_b128 a[28:31], v12 offset:3072
    s_waitcnt lgkmcnt(0)
    s_and_b32 s3, s2, 7
    s_lshr_b32 s44, s2, 3
    s_and_b32 s50, s3, 1
    s_lshr_b32 s51, s3, 1
    s_lshl_b32 s51, s51, 2
    s_and_b32 s45, s44, 3
    s_add_u32 s51, s51, s45
    s_lshr_b32 s52, s44, 2
    v_and_b32 v11, 15, v0
    v_lshrrev_b32 v12, 4, v0
    v_lshlrev_b32 v13, 9, v12
    v_lshl_add_u32 v13, v11, 4, v13
    s_lshl_b32 s44, s51, 2
    s_add_u32 s44, s44, s24
    s_mul_i32 s45, s44, 229376
    v_add_u32 v100, s45, v13
    s_lshl_b32 s45, s44, 16
    v_add_u32 v101, s45, v13
    v_lshrrev_b32 v13, 4, v0
    v_bfe_u32 v14, v0, 1, 3
    v_and_b32 v15, 1, v0
    v_lshlrev_b32 v15, 4, v15
    s_lshl_b32 s45, s52, 8
    s_add_u32 s47, s45, 128
    s_sub_u32 s49, s47, s45
    s_lshl_b32 s46, s24, 3
    v_add_u32 v10, 0, v13
    v_xor_b32 v11, v14, v10
    v_lshrrev_b32 v12, 2, v11
    v_xor_b32 v12, s50, v12
    v_mul_u32_u24 v12, s49, v12
    v_and_b32 v11, 3, v11
    v_lshl_add_u32 v11, v11, 5, v15
    v_add_u32 v11, v12, v11
    v_add_u32 v10, s46, v10
    v_lshl_add_u32 v11, v10, 11, v11
    v_add_u32 v102, s45, v11
    v_add_u32 v10, 4, v13
    v_xor_b32 v11, v14, v10
    v_lshrrev_b32 v12, 2, v11
    v_xor_b32 v12, s50, v12
    v_mul_u32_u24 v12, s49, v12
    v_and_b32 v11, 3, v11
    v_lshl_add_u32 v11, v11, 5, v15
    v_add_u32 v11, v12, v11
    v_add_u32 v10, s46, v10
    v_lshl_add_u32 v11, v10, 11, v11
    v_add_u32 v103, s45, v11
    s_cmp_eq_u32 s50, 0
    s_cselect_b32 s52, s45, s47
    v_lshrrev_b32 v13, 3, v0
    v_add_u32 v13, s46, v13
    v_bfe_u32 v14, v13, 1, 2
    v_bfe_u32 v12, v0, 1, 2
    v_xor_b32 v14, v14, v12
    v_lshl_add_u32 v14, v14, 5, v15
    v_lshl_add_u32 v14, v13, 11, v14
    v_add_u32 v104, s52, v14
    v_lshrrev_b32 v13, 2, v0
    v_and_b32 v14, 3, v0
    v_lshlrev_b32 v14, 3, v14
    v_and_b32 v15, 7, v13
    v_xor_b32 v10, 0, v15
    v_lshl_add_u32 v10, v10, 5, v14
    v_lshl_add_u32 v10, v13, 8, v10
    v_add_u32 v108, 32768, v10
    v_add_u32 v116, 98304, v10
    v_xor_b32 v10, 1, v15
    v_lshl_add_u32 v10, v10, 5, v14
    v_lshl_add_u32 v10, v13, 8, v10
    v_add_u32 v109, 32768, v10
    v_add_u32 v117, 98304, v10
    v_xor_b32 v10, 2, v15
    v_lshl_add_u32 v10, v10, 5, v14
    v_lshl_add_u32 v10, v13, 8, v10
    v_add_u32 v110, 32768, v10
    v_add_u32 v118, 98304, v10
    v_xor_b32 v10, 3, v15
    v_lshl_add_u32 v10, v10, 5, v14
    v_lshl_add_u32 v10, v13, 8, v10
    v_add_u32 v111, 32768, v10
    v_add_u32 v119, 98304, v10
    v_xor_b32 v10, 4, v15
    v_lshl_add_u32 v10, v10, 5, v14
    v_lshl_add_u32 v10, v13, 8, v10
    v_add_u32 v112, 32768, v10
    v_add_u32 v120, 98304, v10
    v_xor_b32 v10, 5, v15
    v_lshl_add_u32 v10, v10, 5, v14
    v_lshl_add_u32 v10, v13, 8, v10
    v_add_u32 v113, 32768, v10
    v_add_u32 v121, 98304, v10
    v_xor_b32 v10, 6, v15
    v_lshl_add_u32 v10, v10, 5, v14
    v_lshl_add_u32 v10, v13, 8, v10
    v_add_u32 v114, 32768, v10
    v_add_u32 v122, 98304, v10
    v_xor_b32 v10, 7, v15
    v_lshl_add_u32 v10, v10, 5, v14
    v_lshl_add_u32 v10, v13, 8, v10
    v_add_u32 v115, 32768, v10
    v_add_u32 v123, 98304, v10
    v_bfe_u32 v15, v13, 1, 2
    v_bfe_u32 v11, v0, 5, 1
    v_bfe_u32 v12, v0, 4, 1
    v_bfe_u32 v13, v0, 2, 2
    v_lshl_add_u32 v13, v12, 2, v13
    v_lshl_add_u32 v13, v11, 4, v13
    v_xor_b32 v10, 0, v15
    v_lshl_add_u32 v10, v10, 5, v14
    v_lshl_add_u32 v10, v13, 7, v10
    v_add_u32 v124, 32768, v10
    v_add_u32 v128, 98304, v10
    v_xor_b32 v10, 1, v15
    v_lshl_add_u32 v10, v10, 5, v14
    v_lshl_add_u32 v10, v13, 7, v10
    v_add_u32 v125, 32768, v10
    v_add_u32 v129, 98304, v10
    v_xor_b32 v10, 2, v15
    v_lshl_add_u32 v10, v10, 5, v14
    v_lshl_add_u32 v10, v13, 7, v10
    v_add_u32 v126, 32768, v10
    v_add_u32 v130, 98304, v10
    v_xor_b32 v10, 3, v15
    v_lshl_add_u32 v10, v10, 5, v14
    v_lshl_add_u32 v10, v13, 7, v10
    v_add_u32 v127, 32768, v10
    v_add_u32 v131, 98304, v10
    v_lshlrev_b32 v105, 4, v0
    s_lshl_b32 s53, s24, 11
    s_lshl_b32 s54, s24, 10
    s_mul_i32 s44, s50, 114688
    s_add_u32 s46, s44, 4096
    s_mul_i32 s48, s50, 3670016
    s_mov_b32 s45, 0
    s_mov_b32 s47, 4096
    s_mov_b32 s49, 0
    s_add_u32 s64, s28, 16777216
    s_addc_u32 s65, s29, 0
    s_mov_b32 s66, 14680064
    s_mov_b32 s67, 0x00020000
    s_mov_b32 s68, s4
    s_mov_b32 s69, s5
    s_mov_b32 s70, 7340032
    s_mov_b32 s71, 0x00020000
    v_and_b32 v4, 3, v0
    v_bfe_u32 v5, v0, 2, 1
    v_bfe_u32 v10, v0, 4, 1
    v_xor_b32 v5, v5, v10
    v_or_b32 v4, v4, v5
    v_cmp_eq_u32 vcc, 0, v4
    v_mov_b32 v5, 0x3f803f80
    s_nop 0
    v_cndmask_b32 v96, 0, v5, vcc
    v_cndmask_b32 v97, 0, v5, vcc
    v_cndmask_b32 v98, 0, v5, vcc
    v_cndmask_b32 v99, 0, v5, vcc
    v_accvgpr_write_b32 a32, 0
    v_accvgpr_write_b32 a33, 0
    v_accvgpr_write_b32 a34, 0
    v_accvgpr_write_b32 a35, 0
    v_accvgpr_write_b32 a36, 0
    v_accvgpr_write_b32 a37, 0
    v_accvgpr_write_b32 a38, 0
    v_accvgpr_write_b32 a39, 0
    v_accvgpr_write_b32 a40, 0
    v_accvgpr_write_b32 a41, 0
    v_accvgpr_write_b32 a42, 0
    v_accvgpr_write_b32 a43, 0
    v_accvgpr_write_b32 a44, 0
    v_accvgpr_write_b32 a45, 0
    v_accvgpr_write_b32 a46, 0
    v_accvgpr_write_b32 a47, 0
    v_accvgpr_write_b32 a48, 0
    v_accvgpr_write_b32 a49, 0
    v_accvgpr_write_b32 a50, 0
    v_accvgpr_write_b32 a51, 0
    v_accvgpr_write_b32 a52, 0
    v_accvgpr_write_b32 a53, 0
    v_accvgpr_write_b32 a54, 0
    v_accvgpr_write_b32 a55, 0
    v_accvgpr_write_b32 a56, 0
    v_accvgpr_write_b32 a57, 0
    v_accvgpr_write_b32 a58, 0
    v_accvgpr_write_b32 a59, 0
    v_accvgpr_write_b32 a60, 0
    v_accvgpr_write_b32 a61, 0
    v_accvgpr_write_b32 a62, 0
    v_accvgpr_write_b32 a63, 0
    v_accvgpr_write_b32 a64, 0
    v_accvgpr_write_b32 a65, 0
    v_accvgpr_write_b32 a66, 0
    v_accvgpr_write_b32 a67, 0
    v_accvgpr_write_b32 a68, 0
    v_accvgpr_write_b32 a69, 0
    v_accvgpr_write_b32 a70, 0
    v_accvgpr_write_b32 a71, 0
    v_accvgpr_write_b32 a8, 0
    v_accvgpr_write_b32 a9, 0
    v_accvgpr_write_b32 a10, 0
    v_accvgpr_write_b32 a11, 0
    v_accvgpr_write_b32 a12, 0
    v_accvgpr_write_b32 a13, 0
    v_accvgpr_write_b32 a14, 0
    v_accvgpr_write_b32 a15, 0
    v_mov_b32 v88, 0
    v_mov_b32 v89, 0
    v_mov_b32 v90, 0
    v_mov_b32 v91, 0
    v_mov_b32 v92, 0
    v_mov_b32 v93, 0
    v_mov_b32 v94, 0
    v_mov_b32 v95, 0
    v_mov_b32 v4, v8
    v_add_u32 v5, 32768, v8
    s_mov_b32 s60, 229376
    s_mov_b32 s61, 4096
    s_mov_b32 s101, 233472
    s_lshl_b32 s3, s24, 10
    v_add_u32 v13, s3, v8
    s_mul_i32 s62, s2, 28672
    s_mul_i32 s63, s2, 8192
    s_mov_b32 s56, s6
    s_mov_b32 s57, s7
    s_mov_b32 s58, 2097152
    s_mov_b32 s59, 0x00020000
    v_bfe_u32 v14, v0, 1, 3
    v_and_b32 v15, 1, v0
    s_lshl_b32 s3, s50, 1
    v_add_u32 v15, s3, v15
    s_lshr_b32 s3, s51, 1
    s_lshl_b32 s3, s3, 2
    v_add_u32 v15, s3, v15
    v_lshl_add_u32 v14, v15, 3, v14
    v_lshlrev_b32 v14, 7, v14
    s_mov_b32 s55, 32768
    v_and_b32 v15, 7, v0
    v_lshlrev_b32 v15, 5, v15
    s_and_b32 s3, s2, 31
    v_add_u32 v15, s3, v15
    v_lshlrev_b32 v15, 7, v15
    ds_read_b128 a[0:3], v4 offset:0
    ds_read_b128 a[4:7], v4 offset:1024
    s_waitcnt lgkmcnt(0)
    v_mfma_f32_32x32x16_bf16 v[16:31], a[0:3], a[16:19], 0
    v_mfma_f32_32x32x16_bf16 v[16:31], a[4:7], a[20:23], v[16:31]
    v_mfma_f32_32x32x16_bf16 v[32:47], a[0:3], a[24:27], 0
    v_mfma_f32_32x32x16_bf16 v[32:47], a[4:7], a[28:31], v[32:47]
    s_nop 15
    v_max3_f32 v10, v16, v17, v18
    v_max3_f32 v10, v10, v19, v20
    v_max3_f32 v10, v10, v21, v22
    v_max3_f32 v10, v10, v23, v24
    v_max3_f32 v10, v10, v25, v26
    v_max3_f32 v10, v10, v27, v28
    v_max3_f32 v10, v10, v29, v30
    v_max_f32 v10, v10, v31
    v_mov_b32 v11, v10
    s_nop 1
    v_permlane32_swap_b32 v10, v11
    s_nop 1
    v_max_f32 v10, v10, v11
    v_xor_b32 v10, 0x80000000, v10
    v_mov_b32 v48, v10
    v_mov_b32 v49, v10
    v_mov_b32 v50, v10
    v_mov_b32 v51, v10
    v_mov_b32 v52, v10
    v_mov_b32 v53, v10
    v_mov_b32 v54, v10
    v_mov_b32 v55, v10
    v_mov_b32 v56, v10
    v_mov_b32 v57, v10
    v_mov_b32 v58, v10
    v_mov_b32 v59, v10
    v_mov_b32 v60, v10
    v_mov_b32 v61, v10
    v_mov_b32 v62, v10
    v_mov_b32 v63, v10
    v_max3_f32 v10, v32, v33, v34
    v_max3_f32 v10, v10, v35, v36
    v_max3_f32 v10, v10, v37, v38
    v_max3_f32 v10, v10, v39, v40
    v_max3_f32 v10, v10, v41, v42
    v_max3_f32 v10, v10, v43, v44
    v_max3_f32 v10, v10, v45, v46
    v_max_f32 v10, v10, v47
    v_mov_b32 v11, v10
    s_nop 1
    v_permlane32_swap_b32 v10, v11
    s_nop 1
    v_max_f32 v10, v10, v11
    v_xor_b32 v10, 0x80000000, v10
    v_mov_b32 v64, v10
    v_mov_b32 v65, v10
    v_mov_b32 v66, v10
    v_mov_b32 v67, v10
    v_mov_b32 v68, v10
    v_mov_b32 v69, v10
    v_mov_b32 v70, v10
    v_mov_b32 v71, v10
    v_mov_b32 v72, v10
    v_mov_b32 v73, v10
    v_mov_b32 v74, v10
    v_mov_b32 v75, v10
    v_mov_b32 v76, v10
    v_mov_b32 v77, v10
    v_mov_b32 v78, v10
    v_mov_b32 v79, v10
    s_nop 1
    v_mfma_f32_32x32x16_bf16 v[16:31], a[0:3], a[16:19], v[48:63]
    v_mfma_f32_32x32x16_bf16 v[16:31], a[4:7], a[20:23], v[16:31]
    s_nop 15
    s_mov_b32 s36, 0
    s_mov_b32 s37, 65536
    s_add_u32 s38, s25, 1
    s_and_b32 s38, s38, 7
    s_lshl_b32 s38, s38, 14
    v_mfma_f32_32x32x16_bf16 a[48:63], a[8:11], v[88:91], a[48:63]
    v_exp_f32 v16, v16
    v_exp_f32 v17, v17
    v_exp_f32 v18, v18
    v_mfma_f32_32x32x16_bf16 a[48:63], a[12:15], v[92:95], a[48:63]
    v_exp_f32 v19, v19
    ds_read_b128 a[8:11], v4 offset:16384
    ds_read_b128 a[12:15], v4 offset:17408
    v_exp_f32 v20, v20
    v_exp_f32 v21, v21
    v_mfma_f32_32x32x16_bf16 v[32:47], a[0:3], a[24:27], v[64:79]
    v_exp_f32 v22, v22
    v_exp_f32 v23, v23
    v_cvt_pk_bf16_f32 v80, v16, v17
    v_cvt_pk_bf16_f32 v81, v18, v19
    v_mfma_f32_32x32x16_bf16 v[32:47], a[4:7], a[28:31], v[32:47]
    v_exp_f32 v24, v24
    ds_read_b128 a[0:3], v4 offset:2048
    ds_read_b128 a[4:7], v4 offset:3072
    v_exp_f32 v25, v25
    v_cvt_pk_bf16_f32 v82, v20, v21
    v_cvt_pk_bf16_f32 v83, v22, v23
    v_mfma_f32_16x16x32_bf16 a[68:71], v[96:99], v[88:91], a[68:71]
    v_exp_f32 v26, v26
    v_exp_f32 v27, v27
    v_mfma_f32_16x16x32_bf16 a[68:71], v[96:99], v[92:95], a[68:71]
    v_exp_f32 v28, v28
    v_exp_f32 v29, v29
    v_cvt_pk_bf16_f32 v84, v24, v25
    v_exp_f32 v30, v30
    v_exp_f32 v31, v31
    v_cvt_pk_bf16_f32 v85, v26, v27
    v_cvt_pk_bf16_f32 v86, v28, v29
    v_cvt_pk_bf16_f32 v87, v30, v31
    s_waitcnt lgkmcnt(0)
    v_mfma_f32_32x32x16_bf16 a[32:47], a[8:11], v[80:83], a[32:47]
    v_exp_f32 v32, v32
    v_exp_f32 v33, v33
    v_exp_f32 v34, v34
    v_mfma_f32_32x32x16_bf16 a[32:47], a[12:15], v[84:87], a[32:47]
    v_exp_f32 v35, v35
    v_exp_f32 v36, v36
    v_exp_f32 v37, v37
    v_mfma_f32_32x32x16_bf16 v[16:31], a[0:3], a[16:19], v[48:63]
    v_exp_f32 v38, v38
    v_exp_f32 v39, v39
    v_cvt_pk_bf16_f32 v88, v32, v33
    v_cvt_pk_bf16_f32 v89, v34, v35
    v_mfma_f32_32x32x16_bf16 v[16:31], a[4:7], a[20:23], v[16:31]
    v_exp_f32 v40, v40
    v_exp_f32 v41, v41
    v_cvt_pk_bf16_f32 v90, v36, v37
    v_cvt_pk_bf16_f32 v91, v38, v39
    v_mfma_f32_16x16x32_bf16 a[64:67], v[96:99], v[80:83], a[64:67]
    v_exp_f32 v42, v42
    v_exp_f32 v43, v43
    v_mfma_f32_16x16x32_bf16 a[64:67], v[96:99], v[84:87], a[64:67]
    v_exp_f32 v44, v44
    v_exp_f32 v45, v45
    v_cvt_pk_bf16_f32 v92, v40, v41
    v_exp_f32 v46, v46
    v_exp_f32 v47, v47
    v_cvt_pk_bf16_f32 v93, v42, v43
    v_cvt_pk_bf16_f32 v94, v44, v45
    v_cvt_pk_bf16_f32 v95, v46, v47
    v_mfma_f32_32x32x16_bf16 a[48:63], a[8:11], v[88:91], a[48:63]
    v_exp_f32 v16, v16
    v_exp_f32 v17, v17
    v_exp_f32 v18, v18
    v_mfma_f32_32x32x16_bf16 a[48:63], a[12:15], v[92:95], a[48:63]
    v_exp_f32 v19, v19
    ds_read_b128 a[8:11], v4 offset:18432
    ds_read_b128 a[12:15], v4 offset:19456
    v_exp_f32 v20, v20
    v_exp_f32 v21, v21
    v_mfma_f32_32x32x16_bf16 v[32:47], a[0:3], a[24:27], v[64:79]
    v_exp_f32 v22, v22
    v_exp_f32 v23, v23
    v_cvt_pk_bf16_f32 v80, v16, v17
    v_cvt_pk_bf16_f32 v81, v18, v19
    v_mfma_f32_32x32x16_bf16 v[32:47], a[4:7], a[28:31], v[32:47]
    v_exp_f32 v24, v24
    ds_read_b128 a[0:3], v4 offset:4096
    ds_read_b128 a[4:7], v4 offset:5120
    v_exp_f32 v25, v25
    v_cvt_pk_bf16_f32 v82, v20, v21
    v_cvt_pk_bf16_f32 v83, v22, v23
    v_mfma_f32_16x16x32_bf16 a[68:71], v[96:99], v[88:91], a[68:71]
    v_exp_f32 v26, v26
    v_exp_f32 v27, v27
    v_mfma_f32_16x16x32_bf16 a[68:71], v[96:99], v[92:95], a[68:71]
    v_exp_f32 v28, v28
    v_exp_f32 v29, v29
    v_cvt_pk_bf16_f32 v84, v24, v25
    v_exp_f32 v30, v30
    v_exp_f32 v31, v31
    v_cvt_pk_bf16_f32 v85, v26, v27
    v_cvt_pk_bf16_f32 v86, v28, v29
    v_cvt_pk_bf16_f32 v87, v30, v31
    s_waitcnt lgkmcnt(0)
    v_mfma_f32_32x32x16_bf16 a[32:47], a[8:11], v[80:83], a[32:47]
    v_exp_f32 v32, v32
    v_exp_f32 v33, v33
    v_exp_f32 v34, v34
    v_mfma_f32_32x32x16_bf16 a[32:47], a[12:15], v[84:87], a[32:47]
    v_exp_f32 v35, v35
    v_exp_f32 v36, v36
    v_exp_f32 v37, v37
    v_mfma_f32_32x32x16_bf16 v[16:31], a[0:3], a[16:19], v[48:63]
    buffer_load_dword v12, v15, s[32:35], 0 offen sc0 sc1
    v_exp_f32 v38, v38
    v_exp_f32 v39, v39
    v_cvt_pk_bf16_f32 v88, v32, v33
    v_cvt_pk_bf16_f32 v89, v34, v35
    v_mfma_f32_32x32x16_bf16 v[16:31], a[4:7], a[20:23], v[16:31]
    v_exp_f32 v40, v40
    v_exp_f32 v41, v41
    v_cvt_pk_bf16_f32 v90, v36, v37
    v_cvt_pk_bf16_f32 v91, v38, v39
    v_mfma_f32_16x16x32_bf16 a[64:67], v[96:99], v[80:83], a[64:67]
    v_exp_f32 v42, v42
    v_exp_f32 v43, v43
    v_mfma_f32_16x16x32_bf16 a[64:67], v[96:99], v[84:87], a[64:67]
    v_exp_f32 v44, v44
    v_exp_f32 v45, v45
    v_cvt_pk_bf16_f32 v92, v40, v41
    v_exp_f32 v46, v46
    v_exp_f32 v47, v47
    v_cvt_pk_bf16_f32 v93, v42, v43
    v_cvt_pk_bf16_f32 v94, v44, v45
    v_cvt_pk_bf16_f32 v95, v46, v47
    v_mfma_f32_32x32x16_bf16 a[48:63], a[8:11], v[88:91], a[48:63]
    v_exp_f32 v16, v16
    v_exp_f32 v17, v17
    v_exp_f32 v18, v18
    v_mfma_f32_32x32x16_bf16 a[48:63], a[12:15], v[92:95], a[48:63]
    v_exp_f32 v19, v19
    ds_read_b128 a[8:11], v4 offset:20480
    ds_read_b128 a[12:15], v4 offset:21504
    v_exp_f32 v20, v20
    v_exp_f32 v21, v21
    v_mfma_f32_32x32x16_bf16 v[32:47], a[0:3], a[24:27], v[64:79]
    v_exp_f32 v22, v22
    v_exp_f32 v23, v23
    v_cvt_pk_bf16_f32 v80, v16, v17
    v_cvt_pk_bf16_f32 v81, v18, v19
    v_mfma_f32_32x32x16_bf16 v[32:47], a[4:7], a[28:31], v[32:47]
    v_exp_f32 v24, v24
    ds_read_b128 a[0:3], v4 offset:6144
    ds_read_b128 a[4:7], v4 offset:7168
    v_exp_f32 v25, v25
    v_cvt_pk_bf16_f32 v82, v20, v21
    v_cvt_pk_bf16_f32 v83, v22, v23
    v_mfma_f32_16x16x32_bf16 a[68:71], v[96:99], v[88:91], a[68:71]
    v_exp_f32 v26, v26
    v_exp_f32 v27, v27
    v_mfma_f32_16x16x32_bf16 a[68:71], v[96:99], v[92:95], a[68:71]
    v_exp_f32 v28, v28
    v_exp_f32 v29, v29
    v_cvt_pk_bf16_f32 v84, v24, v25
    v_exp_f32 v30, v30
    v_exp_f32 v31, v31
    v_cvt_pk_bf16_f32 v85, v26, v27
    v_cvt_pk_bf16_f32 v86, v28, v29
    v_cvt_pk_bf16_f32 v87, v30, v31
    s_waitcnt lgkmcnt(0)
    v_mfma_f32_32x32x16_bf16 a[32:47], a[8:11], v[80:83], a[32:47]
    s_waitcnt vmcnt(0)
    v_cmp_ne_u32 vcc, s94, v12
    s_nop 1
    s_cbranch_vccz parallel_sum__softmax_full_mha__dense_activation_silu__prompt_kernel_ok_qkv
    s_mov_b32 s100, 0x40000
parallel_sum__softmax_full_mha__dense_activation_silu__prompt_kernel_poll_qkv:
    buffer_load_dword v12, v15, s[32:35], 0 offen sc0 sc1
    s_sub_u32 s100, s100, 1
    s_cmp_eq_u32 s100, 0
    s_cbranch_scc1 parallel_sum__softmax_full_mha__dense_activation_silu__prompt_kernel_pollx_qkv
    s_waitcnt vmcnt(0)
    v_cmp_ne_u32 vcc, s94, v12
    s_nop 1
    s_cbranch_vccnz parallel_sum__softmax_full_mha__dense_activation_silu__prompt_kernel_poll_qkv
parallel_sum__softmax_full_mha__dense_activation_silu__prompt_kernel_pollx_qkv:
parallel_sum__softmax_full_mha__dense_activation_silu__prompt_kernel_ok_qkv:
    v_exp_f32 v32, v32
    v_exp_f32 v33, v33
    v_exp_f32 v34, v34
    v_mfma_f32_32x32x16_bf16 a[32:47], a[12:15], v[84:87], a[32:47]
    v_exp_f32 v35, v35
    v_exp_f32 v36, v36
    v_exp_f32 v37, v37
    v_mfma_f32_32x32x16_bf16 v[16:31], a[0:3], a[16:19], v[48:63]
    s_add_u32 s39, s30, 32768
    s_add_u32 m0, s39, 0
    s_nop 0
    buffer_load_dwordx4 v9, s[8:11], s38 offen offset:0 sc1 lds
    v_exp_f32 v38, v38
    v_exp_f32 v39, v39
    v_cvt_pk_bf16_f32 v88, v32, v33
    v_cvt_pk_bf16_f32 v89, v34, v35
    v_mfma_f32_32x32x16_bf16 v[16:31], a[4:7], a[20:23], v[16:31]
    v_exp_f32 v40, v40
    v_exp_f32 v41, v41
    v_cvt_pk_bf16_f32 v90, v36, v37
    v_cvt_pk_bf16_f32 v91, v38, v39
    v_mfma_f32_16x16x32_bf16 a[64:67], v[96:99], v[80:83], a[64:67]
    buffer_load_dwordx4 v9, s[8:11], s38 offen offset:1024 sc1 lds
    v_exp_f32 v42, v42
    v_exp_f32 v43, v43
    v_mfma_f32_16x16x32_bf16 a[64:67], v[96:99], v[84:87], a[64:67]
    v_exp_f32 v44, v44
    v_exp_f32 v45, v45
    v_cvt_pk_bf16_f32 v92, v40, v41
    v_exp_f32 v46, v46
    v_exp_f32 v47, v47
    v_cvt_pk_bf16_f32 v93, v42, v43
    v_cvt_pk_bf16_f32 v94, v44, v45
    v_cvt_pk_bf16_f32 v95, v46, v47
    v_mfma_f32_32x32x16_bf16 a[48:63], a[8:11], v[88:91], a[48:63]
    buffer_load_dwordx4 v9, s[8:11], s38 offen offset:2048 sc1 lds
    v_exp_f32 v16, v16
    v_exp_f32 v17, v17
    v_exp_f32 v18, v18
    v_mfma_f32_32x32x16_bf16 a[48:63], a[12:15], v[92:95], a[48:63]
    v_exp_f32 v19, v19
    ds_read_b128 a[8:11], v4 offset:22528
    ds_read_b128 a[12:15], v4 offset:23552
    v_exp_f32 v20, v20
    v_exp_f32 v21, v21
    v_mfma_f32_32x32x16_bf16 v[32:47], a[0:3], a[24:27], v[64:79]
    buffer_load_dwordx4 v9, s[8:11], s38 offen offset:3072 sc1 lds
    v_exp_f32 v22, v22
    v_exp_f32 v23, v23
    v_cvt_pk_bf16_f32 v80, v16, v17
    v_cvt_pk_bf16_f32 v81, v18, v19
    v_mfma_f32_32x32x16_bf16 v[32:47], a[4:7], a[28:31], v[32:47]
    v_exp_f32 v24, v24
    ds_read_b128 a[0:3], v4 offset:8192
    ds_read_b128 a[4:7], v4 offset:9216
    v_exp_f32 v25, v25
    v_cvt_pk_bf16_f32 v82, v20, v21
    v_cvt_pk_bf16_f32 v83, v22, v23
    v_mfma_f32_16x16x32_bf16 a[68:71], v[96:99], v[88:91], a[68:71]
    s_add_u32 m0, s39, 16384
    s_nop 0
    buffer_load_dwordx4 v9, s[12:15], s38 offen offset:0 sc1 lds
    v_exp_f32 v26, v26
    v_exp_f32 v27, v27
    v_mfma_f32_16x16x32_bf16 a[68:71], v[96:99], v[92:95], a[68:71]
    v_exp_f32 v28, v28
    v_exp_f32 v29, v29
    v_cvt_pk_bf16_f32 v84, v24, v25
    v_exp_f32 v30, v30
    v_exp_f32 v31, v31
    v_cvt_pk_bf16_f32 v85, v26, v27
    v_cvt_pk_bf16_f32 v86, v28, v29
    v_cvt_pk_bf16_f32 v87, v30, v31
    s_waitcnt lgkmcnt(0)
    v_mfma_f32_32x32x16_bf16 a[32:47], a[8:11], v[80:83], a[32:47]
    buffer_load_dwordx4 v9, s[12:15], s38 offen offset:1024 sc1 lds
    v_exp_f32 v32, v32
    v_exp_f32 v33, v33
    v_exp_f32 v34, v34
    v_mfma_f32_32x32x16_bf16 a[32:47], a[12:15], v[84:87], a[32:47]
    v_exp_f32 v35, v35
    v_exp_f32 v36, v36
    v_exp_f32 v37, v37
    v_mfma_f32_32x32x16_bf16 v[16:31], a[0:3], a[16:19], v[48:63]
    buffer_load_dwordx4 v9, s[12:15], s38 offen offset:2048 sc1 lds
    v_exp_f32 v38, v38
    v_exp_f32 v39, v39
    v_cvt_pk_bf16_f32 v88, v32, v33
    v_cvt_pk_bf16_f32 v89, v34, v35
    v_mfma_f32_32x32x16_bf16 v[16:31], a[4:7], a[20:23], v[16:31]
    v_exp_f32 v40, v40
    v_exp_f32 v41, v41
    v_cvt_pk_bf16_f32 v90, v36, v37
    v_cvt_pk_bf16_f32 v91, v38, v39
    v_mfma_f32_16x16x32_bf16 a[64:67], v[96:99], v[80:83], a[64:67]
    buffer_load_dwordx4 v9, s[12:15], s38 offen offset:3072 sc1 lds
    v_exp_f32 v42, v42
    v_exp_f32 v43, v43
    v_mfma_f32_16x16x32_bf16 a[64:67], v[96:99], v[84:87], a[64:67]
    v_exp_f32 v44, v44
    v_exp_f32 v45, v45
    v_cvt_pk_bf16_f32 v92, v40, v41
    v_exp_f32 v46, v46
    v_exp_f32 v47, v47
    v_cvt_pk_bf16_f32 v93, v42, v43
    v_cvt_pk_bf16_f32 v94, v44, v45
    v_cvt_pk_bf16_f32 v95, v46, v47
    v_mfma_f32_32x32x16_bf16 a[48:63], a[8:11], v[88:91], a[48:63]
    s_add_u32 s39, s30, 65536
    s_add_u32 s38, s38, 16384
    s_and_b32 s38, s38, 0x1ffff
    s_add_u32 m0, s39, 0
    s_nop 0
    buffer_load_dwordx4 v9, s[8:11], s38 offen offset:0 sc1 lds
    v_exp_f32 v16, v16
    v_exp_f32 v17, v17
    v_exp_f32 v18, v18
    v_mfma_f32_32x32x16_bf16 a[48:63], a[12:15], v[92:95], a[48:63]
    v_exp_f32 v19, v19
    ds_read_b128 a[8:11], v4 offset:24576
    ds_read_b128 a[12:15], v4 offset:25600
    v_exp_f32 v20, v20
    v_exp_f32 v21, v21
    v_mfma_f32_32x32x16_bf16 v[32:47], a[0:3], a[24:27], v[64:79]
    buffer_load_dwordx4 v9, s[8:11], s38 offen offset:1024 sc1 lds
    v_exp_f32 v22, v22
    v_exp_f32 v23, v23
    v_cvt_pk_bf16_f32 v80, v16, v17
    v_cvt_pk_bf16_f32 v81, v18, v19
    v_mfma_f32_32x32x16_bf16 v[32:47], a[4:7], a[28:31], v[32:47]
    v_exp_f32 v24, v24
    ds_read_b128 a[0:3], v4 offset:10240
    ds_read_b128 a[4:7], v4 offset:11264
    v_exp_f32 v25, v25
    v_cvt_pk_bf16_f32 v82, v20, v21
    v_cvt_pk_bf16_f32 v83, v22, v23
    v_mfma_f32_16x16x32_bf16 a[68:71], v[96:99], v[88:91], a[68:71]
    buffer_load_dwordx4 v9, s[8:11], s38 offen offset:2048 sc1 lds
    v_exp_f32 v26, v26
    v_exp_f32 v27, v27
    v_mfma_f32_16x16x32_bf16 a[68:71], v[96:99], v[92:95], a[68:71]
    v_exp_f32 v28, v28
    v_exp_f32 v29, v29
    v_cvt_pk_bf16_f32 v84, v24, v25
    v_exp_f32 v30, v30
    v_exp_f32 v31, v31
    v_cvt_pk_bf16_f32 v85, v26, v27
    v_cvt_pk_bf16_f32 v86, v28, v29
    v_cvt_pk_bf16_f32 v87, v30, v31
    s_waitcnt lgkmcnt(0)
    v_mfma_f32_32x32x16_bf16 a[32:47], a[8:11], v[80:83], a[32:47]
    buffer_load_dwordx4 v9, s[8:11], s38 offen offset:3072 sc1 lds
    v_exp_f32 v32, v32
    v_exp_f32 v33, v33
    v_exp_f32 v34, v34
    v_mfma_f32_32x32x16_bf16 a[32:47], a[12:15], v[84:87], a[32:47]
    v_exp_f32 v35, v35
    v_exp_f32 v36, v36
    v_exp_f32 v37, v37
    v_mfma_f32_32x32x16_bf16 v[16:31], a[0:3], a[16:19], v[48:63]
    s_add_u32 m0, s39, 16384
    s_nop 0
    buffer_load_dwordx4 v9, s[12:15], s38 offen offset:0 sc1 lds
    v_exp_f32 v38, v38
    v_exp_f32 v39, v39
    v_cvt_pk_bf16_f32 v88, v32, v33
    v_cvt_pk_bf16_f32 v89, v34, v35
    v_mfma_f32_32x32x16_bf16 v[16:31], a[4:7], a[20:23], v[16:31]
    v_exp_f32 v40, v40
    v_exp_f32 v41, v41
    v_cvt_pk_bf16_f32 v90, v36, v37
    v_cvt_pk_bf16_f32 v91, v38, v39
    v_mfma_f32_16x16x32_bf16 a[64:67], v[96:99], v[80:83], a[64:67]
    buffer_load_dwordx4 v9, s[12:15], s38 offen offset:1024 sc1 lds
    v_exp_f32 v42, v42
    v_exp_f32 v43, v43
    v_mfma_f32_16x16x32_bf16 a[64:67], v[96:99], v[84:87], a[64:67]
    v_exp_f32 v44, v44
    v_exp_f32 v45, v45
    v_cvt_pk_bf16_f32 v92, v40, v41
    v_exp_f32 v46, v46
    v_exp_f32 v47, v47
    v_cvt_pk_bf16_f32 v93, v42, v43
    v_cvt_pk_bf16_f32 v94, v44, v45
    v_cvt_pk_bf16_f32 v95, v46, v47
    v_mfma_f32_32x32x16_bf16 a[48:63], a[8:11], v[88:91], a[48:63]
    buffer_load_dwordx4 v9, s[12:15], s38 offen offset:2048 sc1 lds
    v_exp_f32 v16, v16
    v_exp_f32 v17, v17
    v_exp_f32 v18, v18
    v_mfma_f32_32x32x16_bf16 a[48:63], a[12:15], v[92:95], a[48:63]
    v_exp_f32 v19, v19
    ds_read_b128 a[8:11], v4 offset:26624
    ds_read_b128 a[12:15], v4 offset:27648
    v_exp_f32 v20, v20
    v_exp_f32 v21, v21
    v_mfma_f32_32x32x16_bf16 v[32:47], a[0:3], a[24:27], v[64:79]
    buffer_load_dwordx4 v9, s[12:15], s38 offen offset:3072 sc1 lds
    v_exp_f32 v22, v22
    v_exp_f32 v23, v23
    v_cvt_pk_bf16_f32 v80, v16, v17
    v_cvt_pk_bf16_f32 v81, v18, v19
    v_mfma_f32_32x32x16_bf16 v[32:47], a[4:7], a[28:31], v[32:47]
    v_exp_f32 v24, v24
    ds_read_b128 a[0:3], v4 offset:12288
    ds_read_b128 a[4:7], v4 offset:13312
    v_exp_f32 v25, v25
    v_cvt_pk_bf16_f32 v82, v20, v21
    v_cvt_pk_bf16_f32 v83, v22, v23
    v_mfma_f32_16x16x32_bf16 a[68:71], v[96:99], v[88:91], a[68:71]
    v_exp_f32 v26, v26
    v_exp_f32 v27, v27
    v_mfma_f32_16x16x32_bf16 a[68:71], v[96:99], v[92:95], a[68:71]
    v_exp_f32 v28, v28
    v_exp_f32 v29, v29
    v_cvt_pk_bf16_f32 v84, v24, v25
    v_exp_f32 v30, v30
    v_exp_f32 v31, v31
    v_cvt_pk_bf16_f32 v85, v26, v27
    v_cvt_pk_bf16_f32 v86, v28, v29
    v_cvt_pk_bf16_f32 v87, v30, v31
    s_waitcnt lgkmcnt(0)
    v_mfma_f32_32x32x16_bf16 a[32:47], a[8:11], v[80:83], a[32:47]
    buffer_load_dwordx4 v[200:203], v13, s[68:71], s62 offen
    s_add_u32 s62, s62, 4096
    v_exp_f32 v32, v32
    v_exp_f32 v33, v33
    v_exp_f32 v34, v34
    v_mfma_f32_32x32x16_bf16 a[32:47], a[12:15], v[84:87], a[32:47]
    v_exp_f32 v35, v35
    v_exp_f32 v36, v36
    v_exp_f32 v37, v37
    v_mfma_f32_32x32x16_bf16 v[16:31], a[0:3], a[16:19], v[48:63]
    buffer_load_dwordx4 v[204:207], v13, s[56:59], s63 offen
    s_add_u32 s63, s63, 4096
    v_exp_f32 v38, v38
    v_exp_f32 v39, v39
    v_cvt_pk_bf16_f32 v88, v32, v33
    v_cvt_pk_bf16_f32 v89, v34, v35
    v_mfma_f32_32x32x16_bf16 v[16:31], a[4:7], a[20:23], v[16:31]
    v_exp_f32 v40, v40
    v_exp_f32 v41, v41
    v_cvt_pk_bf16_f32 v90, v36, v37
    v_cvt_pk_bf16_f32 v91, v38, v39
    v_mfma_f32_16x16x32_bf16 a[64:67], v[96:99], v[80:83], a[64:67]
    v_exp_f32 v42, v42
    v_exp_f32 v43, v43
    v_mfma_f32_16x16x32_bf16 a[64:67], v[96:99], v[84:87], a[64:67]
    v_exp_f32 v44, v44
    v_exp_f32 v45, v45
    v_cvt_pk_bf16_f32 v92, v40, v41
    v_exp_f32 v46, v46
    v_exp_f32 v47, v47
    v_cvt_pk_bf16_f32 v93, v42, v43
    v_cvt_pk_bf16_f32 v94, v44, v45
    v_cvt_pk_bf16_f32 v95, v46, v47
    v_mfma_f32_32x32x16_bf16 a[48:63], a[8:11], v[88:91], a[48:63]
    v_exp_f32 v16, v16
    v_exp_f32 v17, v17
    v_exp_f32 v18, v18
    v_mfma_f32_32x32x16_bf16 a[48:63], a[12:15], v[92:95], a[48:63]
    v_exp_f32 v19, v19
    ds_read_b128 a[8:11], v4 offset:28672
    ds_read_b128 a[12:15], v4 offset:29696
    v_exp_f32 v20, v20
    v_exp_f32 v21, v21
    v_mfma_f32_32x32x16_bf16 v[32:47], a[0:3], a[24:27], v[64:79]
    v_exp_f32 v22, v22
    v_exp_f32 v23, v23
    v_cvt_pk_bf16_f32 v80, v16, v17
    v_cvt_pk_bf16_f32 v81, v18, v19
    v_mfma_f32_32x32x16_bf16 v[32:47], a[4:7], a[28:31], v[32:47]
    v_exp_f32 v24, v24
    ds_read_b128 a[0:3], v4 offset:14336
    ds_read_b128 a[4:7], v4 offset:15360
    v_exp_f32 v25, v25
    v_cvt_pk_bf16_f32 v82, v20, v21
    v_cvt_pk_bf16_f32 v83, v22, v23
    v_mfma_f32_16x16x32_bf16 a[68:71], v[96:99], v[88:91], a[68:71]
    v_exp_f32 v26, v26
    v_exp_f32 v27, v27
    v_mfma_f32_16x16x32_bf16 a[68:71], v[96:99], v[92:95], a[68:71]
    v_exp_f32 v28, v28
    v_exp_f32 v29, v29
    v_cvt_pk_bf16_f32 v84, v24, v25
    v_exp_f32 v30, v30
    v_exp_f32 v31, v31
    v_cvt_pk_bf16_f32 v85, v26, v27
    v_cvt_pk_bf16_f32 v86, v28, v29
    v_cvt_pk_bf16_f32 v87, v30, v31
    s_waitcnt lgkmcnt(0)
    v_mfma_f32_32x32x16_bf16 a[32:47], a[8:11], v[80:83], a[32:47]
    v_exp_f32 v32, v32
    v_exp_f32 v33, v33
    v_exp_f32 v34, v34
    v_mfma_f32_32x32x16_bf16 a[32:47], a[12:15], v[84:87], a[32:47]
    v_exp_f32 v35, v35
    v_exp_f32 v36, v36
    v_exp_f32 v37, v37
    v_mfma_f32_32x32x16_bf16 v[16:31], a[0:3], a[16:19], v[48:63]
    v_exp_f32 v38, v38
    v_exp_f32 v39, v39
    v_cvt_pk_bf16_f32 v88, v32, v33
    v_cvt_pk_bf16_f32 v89, v34, v35
    v_mfma_f32_32x32x16_bf16 v[16:31], a[4:7], a[20:23], v[16:31]
    v_exp_f32 v40, v40
    v_exp_f32 v41, v41
    v_cvt_pk_bf16_f32 v90, v36, v37
    v_cvt_pk_bf16_f32 v91, v38, v39
    v_mfma_f32_16x16x32_bf16 a[64:67], v[96:99], v[80:83], a[64:67]
    v_exp_f32 v42, v42
    v_exp_f32 v43, v43
    v_mfma_f32_16x16x32_bf16 a[64:67], v[96:99], v[84:87], a[64:67]
    v_exp_f32 v44, v44
    v_exp_f32 v45, v45
    v_cvt_pk_bf16_f32 v92, v40, v41
    v_exp_f32 v46, v46
    v_exp_f32 v47, v47
    v_cvt_pk_bf16_f32 v93, v42, v43
    v_cvt_pk_bf16_f32 v94, v44, v45
    v_cvt_pk_bf16_f32 v95, v46, v47
    v_mfma_f32_32x32x16_bf16 a[48:63], a[8:11], v[88:91], a[48:63]
    s_waitcnt vmcnt(10)
    s_barrier
    v_exp_f32 v16, v16
    v_exp_f32 v17, v17
    v_exp_f32 v18, v18
    v_mfma_f32_32x32x16_bf16 a[48:63], a[12:15], v[92:95], a[48:63]
    v_exp_f32 v19, v19
    ds_read_b128 a[8:11], v4 offset:30720
    ds_read_b128 a[12:15], v4 offset:31744
    v_exp_f32 v20, v20
    v_exp_f32 v21, v21
    v_mfma_f32_32x32x16_bf16 v[32:47], a[0:3], a[24:27], v[64:79]
    v_exp_f32 v22, v22
    v_exp_f32 v23, v23
    v_cvt_pk_bf16_f32 v80, v16, v17
    v_cvt_pk_bf16_f32 v81, v18, v19
    v_mfma_f32_32x32x16_bf16 v[32:47], a[4:7], a[28:31], v[32:47]
    v_exp_f32 v24, v24
    ds_read_b128 a[0:3], v5 offset:0
    ds_read_b128 a[4:7], v5 offset:1024
    v_exp_f32 v25, v25
    v_cvt_pk_bf16_f32 v82, v20, v21
    v_cvt_pk_bf16_f32 v83, v22, v23
    v_mfma_f32_16x16x32_bf16 a[68:71], v[96:99], v[88:91], a[68:71]
    v_exp_f32 v26, v26
    v_exp_f32 v27, v27
    v_mfma_f32_16x16x32_bf16 a[68:71], v[96:99], v[92:95], a[68:71]
    v_exp_f32 v28, v28
    v_exp_f32 v29, v29
    v_cvt_pk_bf16_f32 v84, v24, v25
    v_exp_f32 v30, v30
    v_exp_f32 v31, v31
    v_cvt_pk_bf16_f32 v85, v26, v27
    v_cvt_pk_bf16_f32 v86, v28, v29
    v_cvt_pk_bf16_f32 v87, v30, v31
    s_waitcnt lgkmcnt(0)
    v_mfma_f32_32x32x16_bf16 a[32:47], a[8:11], v[80:83], a[32:47]
    v_exp_f32 v32, v32
    v_exp_f32 v33, v33
    v_exp_f32 v34, v34
    v_mfma_f32_32x32x16_bf16 a[32:47], a[12:15], v[84:87], a[32:47]
    v_exp_f32 v35, v35
    v_exp_f32 v36, v36
    v_exp_f32 v37, v37
    v_mfma_f32_32x32x16_bf16 v[16:31], a[0:3], a[16:19], v[48:63]
    v_exp_f32 v38, v38
    v_exp_f32 v39, v39
    v_cvt_pk_bf16_f32 v88, v32, v33
    v_cvt_pk_bf16_f32 v89, v34, v35
    v_mfma_f32_32x32x16_bf16 v[16:31], a[4:7], a[20:23], v[16:31]
    v_exp_f32 v40, v40
    v_exp_f32 v41, v41
    v_cvt_pk_bf16_f32 v90, v36, v37
    v_cvt_pk_bf16_f32 v91, v38, v39
    v_mfma_f32_16x16x32_bf16 a[64:67], v[96:99], v[80:83], a[64:67]
    v_exp_f32 v42, v42
    v_exp_f32 v43, v43
    v_mfma_f32_16x16x32_bf16 a[64:67], v[96:99], v[84:87], a[64:67]
    v_exp_f32 v44, v44
    v_exp_f32 v45, v45
    v_cvt_pk_bf16_f32 v92, v40, v41
    v_exp_f32 v46, v46
    v_exp_f32 v47, v47
    v_cvt_pk_bf16_f32 v93, v42, v43
    v_cvt_pk_bf16_f32 v94, v44, v45
    v_cvt_pk_bf16_f32 v95, v46, v47
    v_mov_b32 v4, v5
    s_mov_b32 s3, s37
    s_add_u32 s37, s37, 32768
    s_cmp_ge_u32 s37, 98304
    s_cselect_b32 s37, 0, s37
    v_add_u32 v5, s3, v8
    s_add_u32 s38, s38, 16384
    s_and_b32 s38, s38, 0x1ffff
    s_add_u32 s36, s36, 1
    s_waitcnt vmcnt(2)
    s_barrier
    s_add_u32 s39, s30, s37
    v_mfma_f32_32x32x16_bf16 a[48:63], a[8:11], v[88:91], a[48:63]
    s_add_u32 m0, s39, 0
    s_nop 0
    buffer_load_dwordx4 v9, s[8:11], s38 offen offset:0 sc1 lds
    v_exp_f32 v16, v16
    v_exp_f32 v17, v17
    v_exp_f32 v18, v18
    v_mfma_f32_32x32x16_bf16 a[48:63], a[12:15], v[92:95], a[48:63]
    v_exp_f32 v19, v19
    ds_read_b128 a[8:11], v4 offset:16384
    ds_read_b128 a[12:15], v4 offset:17408
    v_exp_f32 v20, v20
    v_exp_f32 v21, v21
    v_mfma_f32_32x32x16_bf16 v[32:47], a[0:3], a[24:27], v[64:79]
    v_exp_f32 v22, v22
    v_exp_f32 v23, v23
    v_cvt_pk_bf16_f32 v80, v16, v17
    v_cvt_pk_bf16_f32 v81, v18, v19
    v_mfma_f32_32x32x16_bf16 v[32:47], a[4:7], a[28:31], v[32:47]
    v_exp_f32 v24, v24
    ds_read_b128 a[0:3], v4 offset:2048
    ds_read_b128 a[4:7], v4 offset:3072
    v_exp_f32 v25, v25
    v_cvt_pk_bf16_f32 v82, v20, v21
    v_cvt_pk_bf16_f32 v83, v22, v23
    v_mfma_f32_16x16x32_bf16 a[68:71], v[96:99], v[88:91], a[68:71]
    buffer_load_dwordx4 v9, s[8:11], s38 offen offset:1024 sc1 lds
    v_exp_f32 v26, v26
    v_exp_f32 v27, v27
    v_mfma_f32_16x16x32_bf16 a[68:71], v[96:99], v[92:95], a[68:71]
    v_exp_f32 v28, v28
    v_exp_f32 v29, v29
    v_cvt_pk_bf16_f32 v84, v24, v25
    v_exp_f32 v30, v30
    v_exp_f32 v31, v31
    v_cvt_pk_bf16_f32 v85, v26, v27
    v_cvt_pk_bf16_f32 v86, v28, v29
    v_cvt_pk_bf16_f32 v87, v30, v31
    s_waitcnt lgkmcnt(0)
    v_mfma_f32_32x32x16_bf16 a[32:47], a[8:11], v[80:83], a[32:47]
    v_exp_f32 v32, v32
    v_exp_f32 v33, v33
    v_exp_f32 v34, v34
    v_mfma_f32_32x32x16_bf16 a[32:47], a[12:15], v[84:87], a[32:47]
    v_exp_f32 v35, v35
    v_exp_f32 v36, v36
    v_exp_f32 v37, v37
    v_mfma_f32_32x32x16_bf16 v[16:31], a[0:3], a[16:19], v[48:63]
    buffer_load_dwordx4 v9, s[8:11], s38 offen offset:2048 sc1 lds
    v_exp_f32 v38, v38
    v_exp_f32 v39, v39
    v_cvt_pk_bf16_f32 v88, v32, v33
    v_cvt_pk_bf16_f32 v89, v34, v35
    v_mfma_f32_32x32x16_bf16 v[16:31], a[4:7], a[20:23], v[16:31]
    v_exp_f32 v40, v40
    v_exp_f32 v41, v41
    v_cvt_pk_bf16_f32 v90, v36, v37
    v_cvt_pk_bf16_f32 v91, v38, v39
    v_mfma_f32_16x16x32_bf16 a[64:67], v[96:99], v[80:83], a[64:67]
    v_exp_f32 v42, v42
    v_exp_f32 v43, v43
    v_mfma_f32_16x16x32_bf16 a[64:67], v[96:99], v[84:87], a[64:67]
    v_exp_f32 v44, v44
    v_exp_f32 v45, v45
    v_cvt_pk_bf16_f32 v92, v40, v41
    v_exp_f32 v46, v46
    v_exp_f32 v47, v47
    v_cvt_pk_bf16_f32 v93, v42, v43
    v_cvt_pk_bf16_f32 v94, v44, v45
    v_cvt_pk_bf16_f32 v95, v46, v47
    v_mfma_f32_32x32x16_bf16 a[48:63], a[8:11], v[88:91], a[48:63]
    buffer_load_dwordx4 v9, s[8:11], s38 offen offset:3072 sc1 lds
    v_exp_f32 v16, v16
    v_exp_f32 v17, v17
    v_exp_f32 v18, v18
    v_mfma_f32_32x32x16_bf16 a[48:63], a[12:15], v[92:95], a[48:63]
    v_exp_f32 v19, v19
    ds_read_b128 a[8:11], v4 offset:18432
    ds_read_b128 a[12:15], v4 offset:19456
    v_exp_f32 v20, v20
    v_exp_f32 v21, v21
    v_mfma_f32_32x32x16_bf16 v[32:47], a[0:3], a[24:27], v[64:79]
    v_exp_f32 v22, v22
    v_exp_f32 v23, v23
    v_cvt_pk_bf16_f32 v80, v16, v17
    v_cvt_pk_bf16_f32 v81, v18, v19
    v_mfma_f32_32x32x16_bf16 v[32:47], a[4:7], a[28:31], v[32:47]
    v_exp_f32 v24, v24
    ds_read_b128 a[0:3], v4 offset:4096
    ds_read_b128 a[4:7], v4 offset:5120
    v_exp_f32 v25, v25
    v_cvt_pk_bf16_f32 v82, v20, v21
    v_cvt_pk_bf16_f32 v83, v22, v23
    v_mfma_f32_16x16x32_bf16 a[68:71], v[96:99], v[88:91], a[68:71]
    s_add_u32 m0, s39, 16384
    s_nop 0
    buffer_load_dwordx4 v9, s[12:15], s38 offen offset:0 sc1 lds
    v_exp_f32 v26, v26
    v_exp_f32 v27, v27
    v_mfma_f32_16x16x32_bf16 a[68:71], v[96:99], v[92:95], a[68:71]
    v_exp_f32 v28, v28
    v_exp_f32 v29, v29
    v_cvt_pk_bf16_f32 v84, v24, v25
    v_exp_f32 v30, v30
    v_exp_f32 v31, v31
    v_cvt_pk_bf16_f32 v85, v26, v27
    v_cvt_pk_bf16_f32 v86, v28, v29
    v_cvt_pk_bf16_f32 v87, v30, v31
    s_waitcnt lgkmcnt(0)
    v_mfma_f32_32x32x16_bf16 a[32:47], a[8:11], v[80:83], a[32:47]
    v_exp_f32 v32, v32
    v_exp_f32 v33, v33
    v_exp_f32 v34, v34
    v_mfma_f32_32x32x16_bf16 a[32:47], a[12:15], v[84:87], a[32:47]
    v_exp_f32 v35, v35
    v_exp_f32 v36, v36
    v_exp_f32 v37, v37
    v_mfma_f32_32x32x16_bf16 v[16:31], a[0:3], a[16:19], v[48:63]
    buffer_load_dwordx4 v9, s[12:15], s38 offen offset:1024 sc1 lds
    v_exp_f32 v38, v38
    v_exp_f32 v39, v39
    v_cvt_pk_bf16_f32 v88, v32, v33
    v_cvt_pk_bf16_f32 v89, v34, v35
    v_mfma_f32_32x32x16_bf16 v[16:31], a[4:7], a[20:23], v[16:31]
    v_exp_f32 v40, v40
    v_exp_f32 v41, v41
    v_cvt_pk_bf16_f32 v90, v36, v37
    v_cvt_pk_bf16_f32 v91, v38, v39
    v_mfma_f32_16x16x32_bf16 a[64:67], v[96:99], v[80:83], a[64:67]
    v_exp_f32 v42, v42
    v_exp_f32 v43, v43
    v_mfma_f32_16x16x32_bf16 a[64:67], v[96:99], v[84:87], a[64:67]
    v_exp_f32 v44, v44
    v_exp_f32 v45, v45
    v_cvt_pk_bf16_f32 v92, v40, v41
    v_exp_f32 v46, v46
    v_exp_f32 v47, v47
    v_cvt_pk_bf16_f32 v93, v42, v43
    v_cvt_pk_bf16_f32 v94, v44, v45
    v_cvt_pk_bf16_f32 v95, v46, v47
    v_mfma_f32_32x32x16_bf16 a[48:63], a[8:11], v[88:91], a[48:63]
    buffer_load_dwordx4 v9, s[12:15], s38 offen offset:2048 sc1 lds
    v_exp_f32 v16, v16
    v_exp_f32 v17, v17
    v_exp_f32 v18, v18
    v_mfma_f32_32x32x16_bf16 a[48:63], a[12:15], v[92:95], a[48:63]
    v_exp_f32 v19, v19
    ds_read_b128 a[8:11], v4 offset:20480
    ds_read_b128 a[12:15], v4 offset:21504
    v_exp_f32 v20, v20
    v_exp_f32 v21, v21
    v_mfma_f32_32x32x16_bf16 v[32:47], a[0:3], a[24:27], v[64:79]
    v_exp_f32 v22, v22
    v_exp_f32 v23, v23
    v_cvt_pk_bf16_f32 v80, v16, v17
    v_cvt_pk_bf16_f32 v81, v18, v19
    v_mfma_f32_32x32x16_bf16 v[32:47], a[4:7], a[28:31], v[32:47]
    v_exp_f32 v24, v24
    ds_read_b128 a[0:3], v4 offset:6144
    ds_read_b128 a[4:7], v4 offset:7168
    v_exp_f32 v25, v25
    v_cvt_pk_bf16_f32 v82, v20, v21
    v_cvt_pk_bf16_f32 v83, v22, v23
    v_mfma_f32_16x16x32_bf16 a[68:71], v[96:99], v[88:91], a[68:71]
    buffer_load_dwordx4 v9, s[12:15], s38 offen offset:3072 sc1 lds
    v_exp_f32 v26, v26
    v_exp_f32 v27, v27
    v_mfma_f32_16x16x32_bf16 a[68:71], v[96:99], v[92:95], a[68:71]
    v_exp_f32 v28, v28
    v_exp_f32 v29, v29
    v_cvt_pk_bf16_f32 v84, v24, v25
    v_exp_f32 v30, v30
    v_exp_f32 v31, v31
    v_cvt_pk_bf16_f32 v85, v26, v27
    v_cvt_pk_bf16_f32 v86, v28, v29
    v_cvt_pk_bf16_f32 v87, v30, v31
    s_waitcnt lgkmcnt(0)
    v_mfma_f32_32x32x16_bf16 a[32:47], a[8:11], v[80:83], a[32:47]
    v_exp_f32 v32, v32
    v_exp_f32 v33, v33
    v_exp_f32 v34, v34
    v_mfma_f32_32x32x16_bf16 a[32:47], a[12:15], v[84:87], a[32:47]
    v_exp_f32 v35, v35
    v_exp_f32 v36, v36
    v_exp_f32 v37, v37
    v_mfma_f32_32x32x16_bf16 v[16:31], a[0:3], a[16:19], v[48:63]
    buffer_load_dwordx4 v[200:203], v13, s[68:71], s62 offen
    s_add_u32 s62, s62, 4096
    v_exp_f32 v38, v38
    v_exp_f32 v39, v39
    v_cvt_pk_bf16_f32 v88, v32, v33
    v_cvt_pk_bf16_f32 v89, v34, v35
    v_mfma_f32_32x32x16_bf16 v[16:31], a[4:7], a[20:23], v[16:31]
    v_exp_f32 v40, v40
    v_exp_f32 v41, v41
    v_cvt_pk_bf16_f32 v90, v36, v37
    v_cvt_pk_bf16_f32 v91, v38, v39
    v_mfma_f32_16x16x32_bf16 a[64:67], v[96:99], v[80:83], a[64:67]
    buffer_load_dwordx4 v[204:207], v13, s[56:59], s63 offen
    s_add_u32 s63, s63, 4096
    v_exp_f32 v42, v42
    v_exp_f32 v43, v43
    v_mfma_f32_16x16x32_bf16 a[64:67], v[96:99], v[84:87], a[64:67]
    v_exp_f32 v44, v44
    v_exp_f32 v45, v45
    v_cvt_pk_bf16_f32 v92, v40, v41
    v_exp_f32 v46, v46
    v_exp_f32 v47, v47
    v_cvt_pk_bf16_f32 v93, v42, v43
    v_cvt_pk_bf16_f32 v94, v44, v45
    v_cvt_pk_bf16_f32 v95, v46, v47
    v_mfma_f32_32x32x16_bf16 a[48:63], a[8:11], v[88:91], a[48:63]
    v_exp_f32 v16, v16
    v_exp_f32 v17, v17
    v_exp_f32 v18, v18
    v_mfma_f32_32x32x16_bf16 a[48:63], a[12:15], v[92:95], a[48:63]
    v_exp_f32 v19, v19
    ds_read_b128 a[8:11], v4 offset:22528
    ds_read_b128 a[12:15], v4 offset:23552
    v_exp_f32 v20, v20
    v_exp_f32 v21, v21
    v_mfma_f32_32x32x16_bf16 v[32:47], a[0:3], a[24:27], v[64:79]
    buffer_store_dwordx4 v[144:147], v6, s[20:23], 0 offen offset:0 sc0 sc1
    v_exp_f32 v22, v22
    v_exp_f32 v23, v23
    v_cvt_pk_bf16_f32 v80, v16, v17
    v_cvt_pk_bf16_f32 v81, v18, v19
    v_mfma_f32_32x32x16_bf16 v[32:47], a[4:7], a[28:31], v[32:47]
    v_exp_f32 v24, v24
    ds_read_b128 a[0:3], v4 offset:8192
    ds_read_b128 a[4:7], v4 offset:9216
    v_exp_f32 v25, v25
    v_cvt_pk_bf16_f32 v82, v20, v21
    v_cvt_pk_bf16_f32 v83, v22, v23
    v_mfma_f32_16x16x32_bf16 a[68:71], v[96:99], v[88:91], a[68:71]
    v_exp_f32 v26, v26
    v_exp_f32 v27, v27
    v_mfma_f32_16x16x32_bf16 a[68:71], v[96:99], v[92:95], a[68:71]
    v_exp_f32 v28, v28
    v_exp_f32 v29, v29
    v_cvt_pk_bf16_f32 v84, v24, v25
    v_exp_f32 v30, v30
    v_exp_f32 v31, v31
    v_cvt_pk_bf16_f32 v85, v26, v27
    v_cvt_pk_bf16_f32 v86, v28, v29
    v_cvt_pk_bf16_f32 v87, v30, v31
    s_waitcnt lgkmcnt(0)
    v_mfma_f32_32x32x16_bf16 a[32:47], a[8:11], v[80:83], a[32:47]
    buffer_store_dwordx4 v[176:179], v6, s[20:23], 0 offen offset:2048 sc0 sc1
    v_exp_f32 v32, v32
    v_exp_f32 v33, v33
    v_exp_f32 v34, v34
    v_mfma_f32_32x32x16_bf16 a[32:47], a[12:15], v[84:87], a[32:47]
    v_exp_f32 v35, v35
    v_exp_f32 v36, v36
    v_exp_f32 v37, v37
    v_mfma_f32_32x32x16_bf16 v[16:31], a[0:3], a[16:19], v[48:63]
    v_exp_f32 v38, v38
    v_exp_f32 v39, v39
    v_cvt_pk_bf16_f32 v88, v32, v33
    v_cvt_pk_bf16_f32 v89, v34, v35
    v_mfma_f32_32x32x16_bf16 v[16:31], a[4:7], a[20:23], v[16:31]
    v_exp_f32 v40, v40
    v_exp_f32 v41, v41
    v_cvt_pk_bf16_f32 v90, v36, v37
    v_cvt_pk_bf16_f32 v91, v38, v39
    v_mfma_f32_16x16x32_bf16 a[64:67], v[96:99], v[80:83], a[64:67]
    v_exp_f32 v42, v42
    v_exp_f32 v43, v43
    v_mfma_f32_16x16x32_bf16 a[64:67], v[96:99], v[84:87], a[64:67]
    v_exp_f32 v44, v44
    v_exp_f32 v45, v45
    v_cvt_pk_bf16_f32 v92, v40, v41
    v_exp_f32 v46, v46
    v_exp_f32 v47, v47
    v_cvt_pk_bf16_f32 v93, v42, v43
    v_cvt_pk_bf16_f32 v94, v44, v45
    v_cvt_pk_bf16_f32 v95, v46, v47
    v_mfma_f32_32x32x16_bf16 a[48:63], a[8:11], v[88:91], a[48:63]
    buffer_store_dwordx4 v[208:211], v6, s[20:23], s61 offen offset:0 sc0 sc1
    v_exp_f32 v16, v16
    v_exp_f32 v17, v17
    v_exp_f32 v18, v18
    v_mfma_f32_32x32x16_bf16 a[48:63], a[12:15], v[92:95], a[48:63]
    v_exp_f32 v19, v19
    ds_read_b128 a[8:11], v4 offset:24576
    ds_read_b128 a[12:15], v4 offset:25600
    v_exp_f32 v20, v20
    v_exp_f32 v21, v21
    v_mfma_f32_32x32x16_bf16 v[32:47], a[0:3], a[24:27], v[64:79]
    v_exp_f32 v22, v22
    v_exp_f32 v23, v23
    v_cvt_pk_bf16_f32 v80, v16, v17
    v_cvt_pk_bf16_f32 v81, v18, v19
    v_mfma_f32_32x32x16_bf16 v[32:47], a[4:7], a[28:31], v[32:47]
    v_exp_f32 v24, v24
    ds_read_b128 a[0:3], v4 offset:10240
    ds_read_b128 a[4:7], v4 offset:11264
    v_exp_f32 v25, v25
    v_cvt_pk_bf16_f32 v82, v20, v21
    v_cvt_pk_bf16_f32 v83, v22, v23
    v_mfma_f32_16x16x32_bf16 a[68:71], v[96:99], v[88:91], a[68:71]
    v_exp_f32 v26, v26
    v_exp_f32 v27, v27
    v_mfma_f32_16x16x32_bf16 a[68:71], v[96:99], v[92:95], a[68:71]
    v_exp_f32 v28, v28
    v_exp_f32 v29, v29
    v_cvt_pk_bf16_f32 v84, v24, v25
    v_exp_f32 v30, v30
    v_exp_f32 v31, v31
    v_cvt_pk_bf16_f32 v85, v26, v27
    v_cvt_pk_bf16_f32 v86, v28, v29
    v_cvt_pk_bf16_f32 v87, v30, v31
    s_waitcnt lgkmcnt(0)
    v_mfma_f32_32x32x16_bf16 a[32:47], a[8:11], v[80:83], a[32:47]
    buffer_store_dwordx2 v[240:241], v7, s[20:23], 0 offen offset:0 sc0 sc1
    v_exp_f32 v32, v32
    v_exp_f32 v33, v33
    v_exp_f32 v34, v34
    v_mfma_f32_32x32x16_bf16 a[32:47], a[12:15], v[84:87], a[32:47]
    v_exp_f32 v35, v35
    v_exp_f32 v36, v36
    v_exp_f32 v37, v37
    v_mfma_f32_32x32x16_bf16 v[16:31], a[0:3], a[16:19], v[48:63]
    v_exp_f32 v38, v38
    v_exp_f32 v39, v39
    v_cvt_pk_bf16_f32 v88, v32, v33
    v_cvt_pk_bf16_f32 v89, v34, v35
    v_mfma_f32_32x32x16_bf16 v[16:31], a[4:7], a[20:23], v[16:31]
    v_exp_f32 v40, v40
    v_exp_f32 v41, v41
    v_cvt_pk_bf16_f32 v90, v36, v37
    v_cvt_pk_bf16_f32 v91, v38, v39
    v_mfma_f32_16x16x32_bf16 a[64:67], v[96:99], v[80:83], a[64:67]
    v_exp_f32 v42, v42
    v_exp_f32 v43, v43
    v_mfma_f32_16x16x32_bf16 a[64:67], v[96:99], v[84:87], a[64:67]
    v_exp_f32 v44, v44
    v_exp_f32 v45, v45
    v_cvt_pk_bf16_f32 v92, v40, v41
    v_exp_f32 v46, v46
    v_exp_f32 v47, v47
    v_cvt_pk_bf16_f32 v93, v42, v43
    v_cvt_pk_bf16_f32 v94, v44, v45
    v_cvt_pk_bf16_f32 v95, v46, v47
    v_mfma_f32_32x32x16_bf16 a[48:63], a[8:11], v[88:91], a[48:63]
    buffer_store_dwordx4 v[148:151], v6, s[20:23], 0 offen offset:256 sc0 sc1
    v_exp_f32 v16, v16
    v_exp_f32 v17, v17
    v_exp_f32 v18, v18
    v_mfma_f32_32x32x16_bf16 a[48:63], a[12:15], v[92:95], a[48:63]
    v_exp_f32 v19, v19
    ds_read_b128 a[8:11], v4 offset:26624
    ds_read_b128 a[12:15], v4 offset:27648
    v_exp_f32 v20, v20
    v_exp_f32 v21, v21
    v_mfma_f32_32x32x16_bf16 v[32:47], a[0:3], a[24:27], v[64:79]
    v_exp_f32 v22, v22
    v_exp_f32 v23, v23
    v_cvt_pk_bf16_f32 v80, v16, v17
    v_cvt_pk_bf16_f32 v81, v18, v19
    v_mfma_f32_32x32x16_bf16 v[32:47], a[4:7], a[28:31], v[32:47]
    v_exp_f32 v24, v24
    ds_read_b128 a[0:3], v4 offset:12288
    ds_read_b128 a[4:7], v4 offset:13312
    v_exp_f32 v25, v25
    v_cvt_pk_bf16_f32 v82, v20, v21
    v_cvt_pk_bf16_f32 v83, v22, v23
    v_mfma_f32_16x16x32_bf16 a[68:71], v[96:99], v[88:91], a[68:71]
    buffer_store_dwordx4 v[180:183], v6, s[20:23], 0 offen offset:2304 sc0 sc1
    v_exp_f32 v26, v26
    v_exp_f32 v27, v27
    v_mfma_f32_16x16x32_bf16 a[68:71], v[96:99], v[92:95], a[68:71]
    v_exp_f32 v28, v28
    v_exp_f32 v29, v29
    v_cvt_pk_bf16_f32 v84, v24, v25
    v_exp_f32 v30, v30
    v_exp_f32 v31, v31
    v_cvt_pk_bf16_f32 v85, v26, v27
    v_cvt_pk_bf16_f32 v86, v28, v29
    v_cvt_pk_bf16_f32 v87, v30, v31
    s_waitcnt lgkmcnt(0)
    v_mfma_f32_32x32x16_bf16 a[32:47], a[8:11], v[80:83], a[32:47]
    v_exp_f32 v32, v32
    v_exp_f32 v33, v33
    v_exp_f32 v34, v34
    v_mfma_f32_32x32x16_bf16 a[32:47], a[12:15], v[84:87], a[32:47]
    v_exp_f32 v35, v35
    v_exp_f32 v36, v36
    v_exp_f32 v37, v37
    v_mfma_f32_32x32x16_bf16 v[16:31], a[0:3], a[16:19], v[48:63]
    v_exp_f32 v38, v38
    v_exp_f32 v39, v39
    v_cvt_pk_bf16_f32 v88, v32, v33
    v_cvt_pk_bf16_f32 v89, v34, v35
    v_mfma_f32_32x32x16_bf16 v[16:31], a[4:7], a[20:23], v[16:31]
    v_exp_f32 v40, v40
    v_exp_f32 v41, v41
    v_cvt_pk_bf16_f32 v90, v36, v37
    v_cvt_pk_bf16_f32 v91, v38, v39
    v_mfma_f32_16x16x32_bf16 a[64:67], v[96:99], v[80:83], a[64:67]
    buffer_store_dwordx4 v[212:215], v6, s[20:23], s61 offen offset:256 sc0 sc1
    v_exp_f32 v42, v42
    v_exp_f32 v43, v43
    v_mfma_f32_16x16x32_bf16 a[64:67], v[96:99], v[84:87], a[64:67]
    v_exp_f32 v44, v44
    v_exp_f32 v45, v45
    v_cvt_pk_bf16_f32 v92, v40, v41
    v_exp_f32 v46, v46
    v_exp_f32 v47, v47
    v_cvt_pk_bf16_f32 v93, v42, v43
    v_cvt_pk_bf16_f32 v94, v44, v45
    v_cvt_pk_bf16_f32 v95, v46, v47
    v_mfma_f32_32x32x16_bf16 a[48:63], a[8:11], v[88:91], a[48:63]
    v_exp_f32 v16, v16
    v_exp_f32 v17, v17
    v_exp_f32 v18, v18
    v_mfma_f32_32x32x16_bf16 a[48:63], a[12:15], v[92:95], a[48:63]
    v_exp_f32 v19, v19
    ds_read_b128 a[8:11], v4 offset:28672
    ds_read_b128 a[12:15], v4 offset:29696
    v_exp_f32 v20, v20
    v_exp_f32 v21, v21
    v_mfma_f32_32x32x16_bf16 v[32:47], a[0:3], a[24:27], v[64:79]
    v_exp_f32 v22, v22
    v_exp_f32 v23, v23
    v_cvt_pk_bf16_f32 v80, v16, v17
    v_cvt_pk_bf16_f32 v81, v18, v19
    v_mfma_f32_32x32x16_bf16 v[32:47], a[4:7], a[28:31], v[32:47]
    v_exp_f32 v24, v24
    ds_read_b128 a[0:3], v4 offset:14336
    ds_read_b128 a[4:7], v4 offset:15360
    v_exp_f32 v25, v25
    v_cvt_pk_bf16_f32 v82, v20, v21
    v_cvt_pk_bf16_f32 v83, v22, v23
    v_mfma_f32_16x16x32_bf16 a[68:71], v[96:99], v[88:91], a[68:71]
    buffer_store_dwordx2 v[244:245], v7, s[20:23], 0 offen offset:256 sc0 sc1
    v_exp_f32 v26, v26
    v_exp_f32 v27, v27
    v_mfma_f32_16x16x32_bf16 a[68:71], v[96:99], v[92:95], a[68:71]
    v_exp_f32 v28, v28
    v_exp_f32 v29, v29
    v_cvt_pk_bf16_f32 v84, v24, v25
    v_exp_f32 v30, v30
    v_exp_f32 v31, v31
    v_cvt_pk_bf16_f32 v85, v26, v27
    v_cvt_pk_bf16_f32 v86, v28, v29
    v_cvt_pk_bf16_f32 v87, v30, v31
    s_waitcnt lgkmcnt(0)
    v_mfma_f32_32x32x16_bf16 a[32:47], a[8:11], v[80:83], a[32:47]
    v_exp_f32 v32, v32
    v_exp_f32 v33, v33
    v_exp_f32 v34, v34
    v_mfma_f32_32x32x16_bf16 a[32:47], a[12:15], v[84:87], a[32:47]
    v_exp_f32 v35, v35
    v_exp_f32 v36, v36
    v_exp_f32 v37, v37
    v_mfma_f32_32x32x16_bf16 v[16:31], a[0:3], a[16:19], v[48:63]
    v_exp_f32 v38, v38
    v_exp_f32 v39, v39
    v_cvt_pk_bf16_f32 v88, v32, v33
    v_cvt_pk_bf16_f32 v89, v34, v35
    v_mfma_f32_32x32x16_bf16 v[16:31], a[4:7], a[20:23], v[16:31]
    v_exp_f32 v40, v40
    v_exp_f32 v41, v41
    v_cvt_pk_bf16_f32 v90, v36, v37
    v_cvt_pk_bf16_f32 v91, v38, v39
    v_mfma_f32_16x16x32_bf16 a[64:67], v[96:99], v[80:83], a[64:67]
    v_exp_f32 v42, v42
    v_exp_f32 v43, v43
    v_mfma_f32_16x16x32_bf16 a[64:67], v[96:99], v[84:87], a[64:67]
    v_exp_f32 v44, v44
    v_exp_f32 v45, v45
    v_cvt_pk_bf16_f32 v92, v40, v41
    v_exp_f32 v46, v46
    v_exp_f32 v47, v47
    v_cvt_pk_bf16_f32 v93, v42, v43
    v_cvt_pk_bf16_f32 v94, v44, v45
    v_cvt_pk_bf16_f32 v95, v46, v47
    v_mfma_f32_32x32x16_bf16 a[48:63], a[8:11], v[88:91], a[48:63]
    v_exp_f32 v16, v16
    v_exp_f32 v17, v17
    v_exp_f32 v18, v18
    v_mfma_f32_32x32x16_bf16 a[48:63], a[12:15], v[92:95], a[48:63]
    v_exp_f32 v19, v19
    ds_read_b128 a[8:11], v4 offset:30720
    ds_read_b128 a[12:15], v4 offset:31744
    v_exp_f32 v20, v20
    v_exp_f32 v21, v21
    v_mfma_f32_32x32x16_bf16 v[32:47], a[0:3], a[24:27], v[64:79]
    v_exp_f32 v22, v22
    v_exp_f32 v23, v23
    v_cvt_pk_bf16_f32 v80, v16, v17
    v_cvt_pk_bf16_f32 v81, v18, v19
    v_mfma_f32_32x32x16_bf16 v[32:47], a[4:7], a[28:31], v[32:47]
    v_exp_f32 v24, v24
    ds_read_b128 a[0:3], v5 offset:0
    ds_read_b128 a[4:7], v5 offset:1024
    v_exp_f32 v25, v25
    v_cvt_pk_bf16_f32 v82, v20, v21
    v_cvt_pk_bf16_f32 v83, v22, v23
    v_mfma_f32_16x16x32_bf16 a[68:71], v[96:99], v[88:91], a[68:71]
    v_exp_f32 v26, v26
    v_exp_f32 v27, v27
    v_mfma_f32_16x16x32_bf16 a[68:71], v[96:99], v[92:95], a[68:71]
    v_exp_f32 v28, v28
    v_exp_f32 v29, v29
    v_cvt_pk_bf16_f32 v84, v24, v25
    v_exp_f32 v30, v30
    v_exp_f32 v31, v31
    v_cvt_pk_bf16_f32 v85, v26, v27
    v_cvt_pk_bf16_f32 v86, v28, v29
    v_cvt_pk_bf16_f32 v87, v30, v31
    s_waitcnt lgkmcnt(0)
    v_mfma_f32_32x32x16_bf16 a[32:47], a[8:11], v[80:83], a[32:47]
    v_exp_f32 v32, v32
    v_exp_f32 v33, v33
    v_exp_f32 v34, v34
    v_mfma_f32_32x32x16_bf16 a[32:47], a[12:15], v[84:87], a[32:47]
    v_exp_f32 v35, v35
    v_exp_f32 v36, v36
    v_exp_f32 v37, v37
    v_mfma_f32_32x32x16_bf16 v[16:31], a[0:3], a[16:19], v[48:63]
    v_exp_f32 v38, v38
    v_exp_f32 v39, v39
    v_cvt_pk_bf16_f32 v88, v32, v33
    v_cvt_pk_bf16_f32 v89, v34, v35
    v_mfma_f32_32x32x16_bf16 v[16:31], a[4:7], a[20:23], v[16:31]
    v_exp_f32 v40, v40
    v_exp_f32 v41, v41
    v_cvt_pk_bf16_f32 v90, v36, v37
    v_cvt_pk_bf16_f32 v91, v38, v39
    v_mfma_f32_16x16x32_bf16 a[64:67], v[96:99], v[80:83], a[64:67]
    v_exp_f32 v42, v42
    v_exp_f32 v43, v43
    v_mfma_f32_16x16x32_bf16 a[64:67], v[96:99], v[84:87], a[64:67]
    v_exp_f32 v44, v44
    v_exp_f32 v45, v45
    v_cvt_pk_bf16_f32 v92, v40, v41
    v_exp_f32 v46, v46
    v_exp_f32 v47, v47
    v_cvt_pk_bf16_f32 v93, v42, v43
    v_cvt_pk_bf16_f32 v94, v44, v45
    v_cvt_pk_bf16_f32 v95, v46, v47
    v_mov_b32 v4, v5
    s_mov_b32 s3, s37
    s_add_u32 s37, s37, 32768
    s_cmp_ge_u32 s37, 98304
    s_cselect_b32 s37, 0, s37
    v_add_u32 v5, s3, v8
    s_add_u32 s38, s38, 16384
    s_and_b32 s38, s38, 0x1ffff
    s_add_u32 s36, s36, 1
    s_waitcnt vmcnt(10)
    s_barrier
    s_add_u32 s39, s30, s37
    v_mfma_f32_32x32x16_bf16 a[48:63], a[8:11], v[88:91], a[48:63]
    s_add_u32 m0, s39, 0
    s_nop 0
    buffer_load_dwordx4 v9, s[8:11], s38 offen offset:0 sc1 lds
    v_exp_f32 v16, v16
    v_exp_f32 v17, v17
    v_exp_f32 v18, v18
    v_mfma_f32_32x32x16_bf16 a[48:63], a[12:15], v[92:95], a[48:63]
    v_exp_f32 v19, v19
    ds_read_b128 a[8:11], v4 offset:16384
    ds_read_b128 a[12:15], v4 offset:17408
    v_exp_f32 v20, v20
    v_exp_f32 v21, v21
    v_mfma_f32_32x32x16_bf16 v[32:47], a[0:3], a[24:27], v[64:79]
    v_exp_f32 v22, v22
    v_exp_f32 v23, v23
    v_cvt_pk_bf16_f32 v80, v16, v17
    v_cvt_pk_bf16_f32 v81, v18, v19
    v_mfma_f32_32x32x16_bf16 v[32:47], a[4:7], a[28:31], v[32:47]
    v_exp_f32 v24, v24
    ds_read_b128 a[0:3], v4 offset:2048
    ds_read_b128 a[4:7], v4 offset:3072
    v_exp_f32 v25, v25
    v_cvt_pk_bf16_f32 v82, v20, v21
    v_cvt_pk_bf16_f32 v83, v22, v23
    v_mfma_f32_16x16x32_bf16 a[68:71], v[96:99], v[88:91], a[68:71]
    buffer_load_dwordx4 v9, s[8:11], s38 offen offset:1024 sc1 lds
    v_exp_f32 v26, v26
    v_exp_f32 v27, v27
    v_mfma_f32_16x16x32_bf16 a[68:71], v[96:99], v[92:95], a[68:71]
    v_exp_f32 v28, v28
    v_exp_f32 v29, v29
    v_cvt_pk_bf16_f32 v84, v24, v25
    v_exp_f32 v30, v30
    v_exp_f32 v31, v31
    v_cvt_pk_bf16_f32 v85, v26, v27
    v_cvt_pk_bf16_f32 v86, v28, v29
    v_cvt_pk_bf16_f32 v87, v30, v31
    s_waitcnt lgkmcnt(0)
    v_mfma_f32_32x32x16_bf16 a[32:47], a[8:11], v[80:83], a[32:47]
    v_exp_f32 v32, v32
    v_exp_f32 v33, v33
    v_exp_f32 v34, v34
    v_mfma_f32_32x32x16_bf16 a[32:47], a[12:15], v[84:87], a[32:47]
    v_exp_f32 v35, v35
    v_exp_f32 v36, v36
    v_exp_f32 v37, v37
    v_mfma_f32_32x32x16_bf16 v[16:31], a[0:3], a[16:19], v[48:63]
    buffer_load_dwordx4 v9, s[8:11], s38 offen offset:2048 sc1 lds
    v_exp_f32 v38, v38
    v_exp_f32 v39, v39
    v_cvt_pk_bf16_f32 v88, v32, v33
    v_cvt_pk_bf16_f32 v89, v34, v35
    v_mfma_f32_32x32x16_bf16 v[16:31], a[4:7], a[20:23], v[16:31]
    v_exp_f32 v40, v40
    v_exp_f32 v41, v41
    v_cvt_pk_bf16_f32 v90, v36, v37
    v_cvt_pk_bf16_f32 v91, v38, v39
    v_mfma_f32_16x16x32_bf16 a[64:67], v[96:99], v[80:83], a[64:67]
    v_exp_f32 v42, v42
    v_exp_f32 v43, v43
    v_mfma_f32_16x16x32_bf16 a[64:67], v[96:99], v[84:87], a[64:67]
    v_exp_f32 v44, v44
    v_exp_f32 v45, v45
    v_cvt_pk_bf16_f32 v92, v40, v41
    v_exp_f32 v46, v46
    v_exp_f32 v47, v47
    v_cvt_pk_bf16_f32 v93, v42, v43
    v_cvt_pk_bf16_f32 v94, v44, v45
    v_cvt_pk_bf16_f32 v95, v46, v47
    v_mfma_f32_32x32x16_bf16 a[48:63], a[8:11], v[88:91], a[48:63]
    buffer_load_dwordx4 v9, s[8:11], s38 offen offset:3072 sc1 lds
    v_exp_f32 v16, v16
    v_exp_f32 v17, v17
    v_exp_f32 v18, v18
    v_mfma_f32_32x32x16_bf16 a[48:63], a[12:15], v[92:95], a[48:63]
    v_exp_f32 v19, v19
    ds_read_b128 a[8:11], v4 offset:18432
    ds_read_b128 a[12:15], v4 offset:19456
    v_exp_f32 v20, v20
    v_exp_f32 v21, v21
    v_mfma_f32_32x32x16_bf16 v[32:47], a[0:3], a[24:27], v[64:79]
    v_exp_f32 v22, v22
    v_exp_f32 v23, v23
    v_cvt_pk_bf16_f32 v80, v16, v17
    v_cvt_pk_bf16_f32 v81, v18, v19
    v_mfma_f32_32x32x16_bf16 v[32:47], a[4:7], a[28:31], v[32:47]
    v_exp_f32 v24, v24
    ds_read_b128 a[0:3], v4 offset:4096
    ds_read_b128 a[4:7], v4 offset:5120
    v_exp_f32 v25, v25
    v_cvt_pk_bf16_f32 v82, v20, v21
    v_cvt_pk_bf16_f32 v83, v22, v23
    v_mfma_f32_16x16x32_bf16 a[68:71], v[96:99], v[88:91], a[68:71]
    s_add_u32 m0, s39, 16384
    s_nop 0
    buffer_load_dwordx4 v9, s[12:15], s38 offen offset:0 sc1 lds
    v_exp_f32 v26, v26
    v_exp_f32 v27, v27
    v_mfma_f32_16x16x32_bf16 a[68:71], v[96:99], v[92:95], a[68:71]
    v_exp_f32 v28, v28
    v_exp_f32 v29, v29
    v_cvt_pk_bf16_f32 v84, v24, v25
    v_exp_f32 v30, v30
    v_exp_f32 v31, v31
    v_cvt_pk_bf16_f32 v85, v26, v27
    v_cvt_pk_bf16_f32 v86, v28, v29
    v_cvt_pk_bf16_f32 v87, v30, v31
    s_waitcnt lgkmcnt(0)
    v_mfma_f32_32x32x16_bf16 a[32:47], a[8:11], v[80:83], a[32:47]
    v_exp_f32 v32, v32
    v_exp_f32 v33, v33
    v_exp_f32 v34, v34
    v_mfma_f32_32x32x16_bf16 a[32:47], a[12:15], v[84:87], a[32:47]
    v_exp_f32 v35, v35
    v_exp_f32 v36, v36
    v_exp_f32 v37, v37
    v_mfma_f32_32x32x16_bf16 v[16:31], a[0:3], a[16:19], v[48:63]
    buffer_load_dwordx4 v9, s[12:15], s38 offen offset:1024 sc1 lds
    v_exp_f32 v38, v38
    v_exp_f32 v39, v39
    v_cvt_pk_bf16_f32 v88, v32, v33
    v_cvt_pk_bf16_f32 v89, v34, v35
    v_mfma_f32_32x32x16_bf16 v[16:31], a[4:7], a[20:23], v[16:31]
    v_exp_f32 v40, v40
    v_exp_f32 v41, v41
    v_cvt_pk_bf16_f32 v90, v36, v37
    v_cvt_pk_bf16_f32 v91, v38, v39
    v_mfma_f32_16x16x32_bf16 a[64:67], v[96:99], v[80:83], a[64:67]
    v_exp_f32 v42, v42
    v_exp_f32 v43, v43
    v_mfma_f32_16x16x32_bf16 a[64:67], v[96:99], v[84:87], a[64:67]
    v_exp_f32 v44, v44
    v_exp_f32 v45, v45
    v_cvt_pk_bf16_f32 v92, v40, v41
    v_exp_f32 v46, v46
    v_exp_f32 v47, v47
    v_cvt_pk_bf16_f32 v93, v42, v43
    v_cvt_pk_bf16_f32 v94, v44, v45
    v_cvt_pk_bf16_f32 v95, v46, v47
    v_mfma_f32_32x32x16_bf16 a[48:63], a[8:11], v[88:91], a[48:63]
    buffer_load_dwordx4 v9, s[12:15], s38 offen offset:2048 sc1 lds
    v_exp_f32 v16, v16
    v_exp_f32 v17, v17
    v_exp_f32 v18, v18
    v_mfma_f32_32x32x16_bf16 a[48:63], a[12:15], v[92:95], a[48:63]
    v_exp_f32 v19, v19
    ds_read_b128 a[8:11], v4 offset:20480
    ds_read_b128 a[12:15], v4 offset:21504
    v_exp_f32 v20, v20
    v_exp_f32 v21, v21
    v_mfma_f32_32x32x16_bf16 v[32:47], a[0:3], a[24:27], v[64:79]
    v_exp_f32 v22, v22
    v_exp_f32 v23, v23
    v_cvt_pk_bf16_f32 v80, v16, v17
    v_cvt_pk_bf16_f32 v81, v18, v19
    v_mfma_f32_32x32x16_bf16 v[32:47], a[4:7], a[28:31], v[32:47]
    v_exp_f32 v24, v24
    ds_read_b128 a[0:3], v4 offset:6144
    ds_read_b128 a[4:7], v4 offset:7168
    v_exp_f32 v25, v25
    v_cvt_pk_bf16_f32 v82, v20, v21
    v_cvt_pk_bf16_f32 v83, v22, v23
    v_mfma_f32_16x16x32_bf16 a[68:71], v[96:99], v[88:91], a[68:71]
    buffer_load_dwordx4 v9, s[12:15], s38 offen offset:3072 sc1 lds
    v_exp_f32 v26, v26
    v_exp_f32 v27, v27
    v_mfma_f32_16x16x32_bf16 a[68:71], v[96:99], v[92:95], a[68:71]
    v_exp_f32 v28, v28
    v_exp_f32 v29, v29
    v_cvt_pk_bf16_f32 v84, v24, v25
    v_exp_f32 v30, v30
    v_exp_f32 v31, v31
    v_cvt_pk_bf16_f32 v85, v26, v27
    v_cvt_pk_bf16_f32 v86, v28, v29
    v_cvt_pk_bf16_f32 v87, v30, v31
    s_waitcnt lgkmcnt(0)
    v_mfma_f32_32x32x16_bf16 a[32:47], a[8:11], v[80:83], a[32:47]
    v_exp_f32 v32, v32
    v_exp_f32 v33, v33
    v_exp_f32 v34, v34
    v_mfma_f32_32x32x16_bf16 a[32:47], a[12:15], v[84:87], a[32:47]
    v_exp_f32 v35, v35
    v_exp_f32 v36, v36
    v_exp_f32 v37, v37
    v_mfma_f32_32x32x16_bf16 v[16:31], a[0:3], a[16:19], v[48:63]
    buffer_load_dwordx4 v[200:203], v13, s[68:71], s62 offen
    s_add_u32 s62, s62, 4096
    v_exp_f32 v38, v38
    v_exp_f32 v39, v39
    v_cvt_pk_bf16_f32 v88, v32, v33
    v_cvt_pk_bf16_f32 v89, v34, v35
    v_mfma_f32_32x32x16_bf16 v[16:31], a[4:7], a[20:23], v[16:31]
    v_exp_f32 v40, v40
    v_exp_f32 v41, v41
    v_cvt_pk_bf16_f32 v90, v36, v37
    v_cvt_pk_bf16_f32 v91, v38, v39
    v_mfma_f32_16x16x32_bf16 a[64:67], v[96:99], v[80:83], a[64:67]
    v_exp_f32 v42, v42
    v_exp_f32 v43, v43
    v_mfma_f32_16x16x32_bf16 a[64:67], v[96:99], v[84:87], a[64:67]
    v_exp_f32 v44, v44
    v_exp_f32 v45, v45
    v_cvt_pk_bf16_f32 v92, v40, v41
    v_exp_f32 v46, v46
    v_exp_f32 v47, v47
    v_cvt_pk_bf16_f32 v93, v42, v43
    v_cvt_pk_bf16_f32 v94, v44, v45
    v_cvt_pk_bf16_f32 v95, v46, v47
    v_mfma_f32_32x32x16_bf16 a[48:63], a[8:11], v[88:91], a[48:63]
    v_exp_f32 v16, v16
    v_exp_f32 v17, v17
    v_exp_f32 v18, v18
    v_mfma_f32_32x32x16_bf16 a[48:63], a[12:15], v[92:95], a[48:63]
    v_exp_f32 v19, v19
    ds_read_b128 a[8:11], v4 offset:22528
    ds_read_b128 a[12:15], v4 offset:23552
    v_exp_f32 v20, v20
    v_exp_f32 v21, v21
    v_mfma_f32_32x32x16_bf16 v[32:47], a[0:3], a[24:27], v[64:79]
    buffer_store_dwordx4 v[152:155], v6, s[20:23], s60 offen offset:0 sc0 sc1
    v_exp_f32 v22, v22
    v_exp_f32 v23, v23
    v_cvt_pk_bf16_f32 v80, v16, v17
    v_cvt_pk_bf16_f32 v81, v18, v19
    v_mfma_f32_32x32x16_bf16 v[32:47], a[4:7], a[28:31], v[32:47]
    v_exp_f32 v24, v24
    ds_read_b128 a[0:3], v4 offset:8192
    ds_read_b128 a[4:7], v4 offset:9216
    v_exp_f32 v25, v25
    v_cvt_pk_bf16_f32 v82, v20, v21
    v_cvt_pk_bf16_f32 v83, v22, v23
    v_mfma_f32_16x16x32_bf16 a[68:71], v[96:99], v[88:91], a[68:71]
    v_exp_f32 v26, v26
    v_exp_f32 v27, v27
    v_mfma_f32_16x16x32_bf16 a[68:71], v[96:99], v[92:95], a[68:71]
    v_exp_f32 v28, v28
    v_exp_f32 v29, v29
    v_cvt_pk_bf16_f32 v84, v24, v25
    v_exp_f32 v30, v30
    v_exp_f32 v31, v31
    v_cvt_pk_bf16_f32 v85, v26, v27
    v_cvt_pk_bf16_f32 v86, v28, v29
    v_cvt_pk_bf16_f32 v87, v30, v31
    s_waitcnt lgkmcnt(0)
    v_mfma_f32_32x32x16_bf16 a[32:47], a[8:11], v[80:83], a[32:47]
    buffer_store_dwordx4 v[184:187], v6, s[20:23], s60 offen offset:2048 sc0 sc1
    v_exp_f32 v32, v32
    v_exp_f32 v33, v33
    v_exp_f32 v34, v34
    v_mfma_f32_32x32x16_bf16 a[32:47], a[12:15], v[84:87], a[32:47]
    v_exp_f32 v35, v35
    v_exp_f32 v36, v36
    v_exp_f32 v37, v37
    v_mfma_f32_32x32x16_bf16 v[16:31], a[0:3], a[16:19], v[48:63]
    v_exp_f32 v38, v38
    v_exp_f32 v39, v39
    v_cvt_pk_bf16_f32 v88, v32, v33
    v_cvt_pk_bf16_f32 v89, v34, v35
    v_mfma_f32_32x32x16_bf16 v[16:31], a[4:7], a[20:23], v[16:31]
    v_exp_f32 v40, v40
    v_exp_f32 v41, v41
    v_cvt_pk_bf16_f32 v90, v36, v37
    v_cvt_pk_bf16_f32 v91, v38, v39
    v_mfma_f32_16x16x32_bf16 a[64:67], v[96:99], v[80:83], a[64:67]
    buffer_store_dwordx4 v[216:219], v6, s[20:23], s101 offen offset:0 sc0 sc1
    v_exp_f32 v42, v42
    v_exp_f32 v43, v43
    v_mfma_f32_16x16x32_bf16 a[64:67], v[96:99], v[84:87], a[64:67]
    v_exp_f32 v44, v44
    v_exp_f32 v45, v45
    v_cvt_pk_bf16_f32 v92, v40, v41
    v_exp_f32 v46, v46
    v_exp_f32 v47, v47
    v_cvt_pk_bf16_f32 v93, v42, v43
    v_cvt_pk_bf16_f32 v94, v44, v45
    v_cvt_pk_bf16_f32 v95, v46, v47
    v_mfma_f32_32x32x16_bf16 a[48:63], a[8:11], v[88:91], a[48:63]
    v_exp_f32 v16, v16
    v_exp_f32 v17, v17
    v_exp_f32 v18, v18
    v_mfma_f32_32x32x16_bf16 a[48:63], a[12:15], v[92:95], a[48:63]
    v_exp_f32 v19, v19
    ds_read_b128 a[8:11], v4 offset:24576
    ds_read_b128 a[12:15], v4 offset:25600
    v_exp_f32 v20, v20
    v_exp_f32 v21, v21
    v_mfma_f32_32x32x16_bf16 v[32:47], a[0:3], a[24:27], v[64:79]
    buffer_store_dwordx2 v[248:249], v7, s[20:23], s60 offen offset:0 sc0 sc1
    v_exp_f32 v22, v22
    v_exp_f32 v23, v23
    v_cvt_pk_bf16_f32 v80, v16, v17
    v_cvt_pk_bf16_f32 v81, v18, v19
    v_mfma_f32_32x32x16_bf16 v[32:47], a[4:7], a[28:31], v[32:47]
    v_exp_f32 v24, v24
    ds_read_b128 a[0:3], v4 offset:10240
    ds_read_b128 a[4:7], v4 offset:11264
    v_exp_f32 v25, v25
    v_cvt_pk_bf16_f32 v82, v20, v21
    v_cvt_pk_bf16_f32 v83, v22, v23
    v_mfma_f32_16x16x32_bf16 a[68:71], v[96:99], v[88:91], a[68:71]
    v_exp_f32 v26, v26
    v_exp_f32 v27, v27
    v_mfma_f32_16x16x32_bf16 a[68:71], v[96:99], v[92:95], a[68:71]
    v_exp_f32 v28, v28
    v_exp_f32 v29, v29
    v_cvt_pk_bf16_f32 v84, v24, v25
    v_exp_f32 v30, v30
    v_exp_f32 v31, v31
    v_cvt_pk_bf16_f32 v85, v26, v27
    v_cvt_pk_bf16_f32 v86, v28, v29
    v_cvt_pk_bf16_f32 v87, v30, v31
    s_waitcnt lgkmcnt(0)
    v_mfma_f32_32x32x16_bf16 a[32:47], a[8:11], v[80:83], a[32:47]
    buffer_store_dwordx4 v[156:159], v6, s[20:23], s60 offen offset:256 sc0 sc1
    v_exp_f32 v32, v32
    v_exp_f32 v33, v33
    v_exp_f32 v34, v34
    v_mfma_f32_32x32x16_bf16 a[32:47], a[12:15], v[84:87], a[32:47]
    v_exp_f32 v35, v35
    v_exp_f32 v36, v36
    v_exp_f32 v37, v37
    v_mfma_f32_32x32x16_bf16 v[16:31], a[0:3], a[16:19], v[48:63]
    v_exp_f32 v38, v38
    v_exp_f32 v39, v39
    v_cvt_pk_bf16_f32 v88, v32, v33
    v_cvt_pk_bf16_f32 v89, v34, v35
    v_mfma_f32_32x32x16_bf16 v[16:31], a[4:7], a[20:23], v[16:31]
    v_exp_f32 v40, v40
    v_exp_f32 v41, v41
    v_cvt_pk_bf16_f32 v90, v36, v37
    v_cvt_pk_bf16_f32 v91, v38, v39
    v_mfma_f32_16x16x32_bf16 a[64:67], v[96:99], v[80:83], a[64:67]
    buffer_store_dwordx4 v[188:191], v6, s[20:23], s60 offen offset:2304 sc0 sc1
    v_exp_f32 v42, v42
    v_exp_f32 v43, v43
    v_mfma_f32_16x16x32_bf16 a[64:67], v[96:99], v[84:87], a[64:67]
    v_exp_f32 v44, v44
    v_exp_f32 v45, v45
    v_cvt_pk_bf16_f32 v92, v40, v41
    v_exp_f32 v46, v46
    v_exp_f32 v47, v47
    v_cvt_pk_bf16_f32 v93, v42, v43
    v_cvt_pk_bf16_f32 v94, v44, v45
    v_cvt_pk_bf16_f32 v95, v46, v47
    v_mfma_f32_32x32x16_bf16 a[48:63], a[8:11], v[88:91], a[48:63]
    v_exp_f32 v16, v16
    v_exp_f32 v17, v17
    v_exp_f32 v18, v18
    v_mfma_f32_32x32x16_bf16 a[48:63], a[12:15], v[92:95], a[48:63]
    v_exp_f32 v19, v19
    ds_read_b128 a[8:11], v4 offset:26624
    ds_read_b128 a[12:15], v4 offset:27648
    v_exp_f32 v20, v20
    v_exp_f32 v21, v21
    v_mfma_f32_32x32x16_bf16 v[32:47], a[0:3], a[24:27], v[64:79]
    buffer_store_dwordx4 v[220:223], v6, s[20:23], s101 offen offset:256 sc0 sc1
    v_exp_f32 v22, v22
    v_exp_f32 v23, v23
    v_cvt_pk_bf16_f32 v80, v16, v17
    v_cvt_pk_bf16_f32 v81, v18, v19
    v_mfma_f32_32x32x16_bf16 v[32:47], a[4:7], a[28:31], v[32:47]
    v_exp_f32 v24, v24
    ds_read_b128 a[0:3], v4 offset:12288
    ds_read_b128 a[4:7], v4 offset:13312
    v_exp_f32 v25, v25
    v_cvt_pk_bf16_f32 v82, v20, v21
    v_cvt_pk_bf16_f32 v83, v22, v23
    v_mfma_f32_16x16x32_bf16 a[68:71], v[96:99], v[88:91], a[68:71]
    v_exp_f32 v26, v26
    v_exp_f32 v27, v27
    v_mfma_f32_16x16x32_bf16 a[68:71], v[96:99], v[92:95], a[68:71]
    v_exp_f32 v28, v28
    v_exp_f32 v29, v29
    v_cvt_pk_bf16_f32 v84, v24, v25
    v_exp_f32 v30, v30
    v_exp_f32 v31, v31
    v_cvt_pk_bf16_f32 v85, v26, v27
    v_cvt_pk_bf16_f32 v86, v28, v29
    v_cvt_pk_bf16_f32 v87, v30, v31
    s_waitcnt lgkmcnt(0)
    v_mfma_f32_32x32x16_bf16 a[32:47], a[8:11], v[80:83], a[32:47]
    buffer_store_dwordx2 v[252:253], v7, s[20:23], s60 offen offset:256 sc0 sc1
    v_exp_f32 v32, v32
    v_exp_f32 v33, v33
    v_exp_f32 v34, v34
    v_mfma_f32_32x32x16_bf16 a[32:47], a[12:15], v[84:87], a[32:47]
    v_exp_f32 v35, v35
    v_exp_f32 v36, v36
    v_exp_f32 v37, v37
    v_mfma_f32_32x32x16_bf16 v[16:31], a[0:3], a[16:19], v[48:63]
    v_exp_f32 v38, v38
    v_exp_f32 v39, v39
    v_cvt_pk_bf16_f32 v88, v32, v33
    v_cvt_pk_bf16_f32 v89, v34, v35
    v_mfma_f32_32x32x16_bf16 v[16:31], a[4:7], a[20:23], v[16:31]
    v_exp_f32 v40, v40
    v_exp_f32 v41, v41
    v_cvt_pk_bf16_f32 v90, v36, v37
    v_cvt_pk_bf16_f32 v91, v38, v39
    v_mfma_f32_16x16x32_bf16 a[64:67], v[96:99], v[80:83], a[64:67]
    v_exp_f32 v42, v42
    v_exp_f32 v43, v43
    v_mfma_f32_16x16x32_bf16 a[64:67], v[96:99], v[84:87], a[64:67]
    v_exp_f32 v44, v44
    v_exp_f32 v45, v45
    v_cvt_pk_bf16_f32 v92, v40, v41
    v_exp_f32 v46, v46
    v_exp_f32 v47, v47
    v_cvt_pk_bf16_f32 v93, v42, v43
    v_cvt_pk_bf16_f32 v94, v44, v45
    v_cvt_pk_bf16_f32 v95, v46, v47
    v_mfma_f32_32x32x16_bf16 a[48:63], a[8:11], v[88:91], a[48:63]
    v_exp_f32 v16, v16
    v_exp_f32 v17, v17
    v_exp_f32 v18, v18
    v_mfma_f32_32x32x16_bf16 a[48:63], a[12:15], v[92:95], a[48:63]
    v_exp_f32 v19, v19
    ds_read_b128 a[8:11], v4 offset:28672
    ds_read_b128 a[12:15], v4 offset:29696
    v_exp_f32 v20, v20
    v_exp_f32 v21, v21
    v_mfma_f32_32x32x16_bf16 v[32:47], a[0:3], a[24:27], v[64:79]
    v_exp_f32 v22, v22
    v_exp_f32 v23, v23
    v_cvt_pk_bf16_f32 v80, v16, v17
    v_cvt_pk_bf16_f32 v81, v18, v19
    v_mfma_f32_32x32x16_bf16 v[32:47], a[4:7], a[28:31], v[32:47]
    v_exp_f32 v24, v24
    ds_read_b128 a[0:3], v4 offset:14336
    ds_read_b128 a[4:7], v4 offset:15360
    v_exp_f32 v25, v25
    v_cvt_pk_bf16_f32 v82, v20, v21
    v_cvt_pk_bf16_f32 v83, v22, v23
    v_mfma_f32_16x16x32_bf16 a[68:71], v[96:99], v[88:91], a[68:71]
    v_exp_f32 v26, v26
    v_exp_f32 v27, v27
    v_mfma_f32_16x16x32_bf16 a[68:71], v[96:99], v[92:95], a[68:71]
    v_exp_f32 v28, v28
    v_exp_f32 v29, v29
    v_cvt_pk_bf16_f32 v84, v24, v25
    v_exp_f32 v30, v30
    v_exp_f32 v31, v31
    v_cvt_pk_bf16_f32 v85, v26, v27
    v_cvt_pk_bf16_f32 v86, v28, v29
    v_cvt_pk_bf16_f32 v87, v30, v31
    s_waitcnt lgkmcnt(0)
    v_mfma_f32_32x32x16_bf16 a[32:47], a[8:11], v[80:83], a[32:47]
    v_exp_f32 v32, v32
    v_exp_f32 v33, v33
    v_exp_f32 v34, v34
    v_mfma_f32_32x32x16_bf16 a[32:47], a[12:15], v[84:87], a[32:47]
    v_exp_f32 v35, v35
    v_exp_f32 v36, v36
    v_exp_f32 v37, v37
    v_mfma_f32_32x32x16_bf16 v[16:31], a[0:3], a[16:19], v[48:63]
    v_exp_f32 v38, v38
    v_exp_f32 v39, v39
    v_cvt_pk_bf16_f32 v88, v32, v33
    v_cvt_pk_bf16_f32 v89, v34, v35
    v_mfma_f32_32x32x16_bf16 v[16:31], a[4:7], a[20:23], v[16:31]
    v_exp_f32 v40, v40
    v_exp_f32 v41, v41
    v_cvt_pk_bf16_f32 v90, v36, v37
    v_cvt_pk_bf16_f32 v91, v38, v39
    v_mfma_f32_16x16x32_bf16 a[64:67], v[96:99], v[80:83], a[64:67]
    v_exp_f32 v42, v42
    v_exp_f32 v43, v43
    v_mfma_f32_16x16x32_bf16 a[64:67], v[96:99], v[84:87], a[64:67]
    v_exp_f32 v44, v44
    v_exp_f32 v45, v45
    v_cvt_pk_bf16_f32 v92, v40, v41
    v_exp_f32 v46, v46
    v_exp_f32 v47, v47
    v_cvt_pk_bf16_f32 v93, v42, v43
    v_cvt_pk_bf16_f32 v94, v44, v45
    v_cvt_pk_bf16_f32 v95, v46, v47
    v_mfma_f32_32x32x16_bf16 a[48:63], a[8:11], v[88:91], a[48:63]
    v_exp_f32 v16, v16
    v_exp_f32 v17, v17
    v_exp_f32 v18, v18
    v_mfma_f32_32x32x16_bf16 a[48:63], a[12:15], v[92:95], a[48:63]
    v_exp_f32 v19, v19
    ds_read_b128 a[8:11], v4 offset:30720
    ds_read_b128 a[12:15], v4 offset:31744
    v_exp_f32 v20, v20
    v_exp_f32 v21, v21
    v_mfma_f32_32x32x16_bf16 v[32:47], a[0:3], a[24:27], v[64:79]
    v_exp_f32 v22, v22
    v_exp_f32 v23, v23
    v_cvt_pk_bf16_f32 v80, v16, v17
    v_cvt_pk_bf16_f32 v81, v18, v19
    v_mfma_f32_32x32x16_bf16 v[32:47], a[4:7], a[28:31], v[32:47]
    v_exp_f32 v24, v24
    ds_read_b128 a[0:3], v5 offset:0
    ds_read_b128 a[4:7], v5 offset:1024
    v_exp_f32 v25, v25
    v_cvt_pk_bf16_f32 v82, v20, v21
    v_cvt_pk_bf16_f32 v83, v22, v23
    v_mfma_f32_16x16x32_bf16 a[68:71], v[96:99], v[88:91], a[68:71]
    v_exp_f32 v26, v26
    v_exp_f32 v27, v27
    v_mfma_f32_16x16x32_bf16 a[68:71], v[96:99], v[92:95], a[68:71]
    v_exp_f32 v28, v28
    v_exp_f32 v29, v29
    v_cvt_pk_bf16_f32 v84, v24, v25
    v_exp_f32 v30, v30
    v_exp_f32 v31, v31
    v_cvt_pk_bf16_f32 v85, v26, v27
    v_cvt_pk_bf16_f32 v86, v28, v29
    v_cvt_pk_bf16_f32 v87, v30, v31
    s_waitcnt lgkmcnt(0)
    v_mfma_f32_32x32x16_bf16 a[32:47], a[8:11], v[80:83], a[32:47]
    v_exp_f32 v32, v32
    v_exp_f32 v33, v33
    v_exp_f32 v34, v34
    v_mfma_f32_32x32x16_bf16 a[32:47], a[12:15], v[84:87], a[32:47]
    v_exp_f32 v35, v35
    v_exp_f32 v36, v36
    v_exp_f32 v37, v37
    v_mfma_f32_32x32x16_bf16 v[16:31], a[0:3], a[16:19], v[48:63]
    v_exp_f32 v38, v38
    v_exp_f32 v39, v39
    v_cvt_pk_bf16_f32 v88, v32, v33
    v_cvt_pk_bf16_f32 v89, v34, v35
    v_mfma_f32_32x32x16_bf16 v[16:31], a[4:7], a[20:23], v[16:31]
    v_exp_f32 v40, v40
    v_exp_f32 v41, v41
    v_cvt_pk_bf16_f32 v90, v36, v37
    v_cvt_pk_bf16_f32 v91, v38, v39
    v_mfma_f32_16x16x32_bf16 a[64:67], v[96:99], v[80:83], a[64:67]
    v_exp_f32 v42, v42
    v_exp_f32 v43, v43
    v_mfma_f32_16x16x32_bf16 a[64:67], v[96:99], v[84:87], a[64:67]
    v_exp_f32 v44, v44
    v_exp_f32 v45, v45
    v_cvt_pk_bf16_f32 v92, v40, v41
    v_exp_f32 v46, v46
    v_exp_f32 v47, v47
    v_cvt_pk_bf16_f32 v93, v42, v43
    v_cvt_pk_bf16_f32 v94, v44, v45
    v_cvt_pk_bf16_f32 v95, v46, v47
    v_mov_b32 v4, v5
    s_mov_b32 s3, s37
    s_add_u32 s37, s37, 32768
    s_cmp_ge_u32 s37, 98304
    s_cselect_b32 s37, 0, s37
    v_add_u32 v5, s3, v8
    s_add_u32 s38, s38, 16384
    s_and_b32 s38, s38, 0x1ffff
    s_add_u32 s36, s36, 1
    s_waitcnt vmcnt(9)
    s_branch parallel_sum__softmax_full_mha__dense_activation_silu__prompt_kernel_attstage1
parallel_sum__softmax_full_mha__dense_activation_silu__prompt_kernel_attstage:
    s_waitcnt vmcnt(1)
parallel_sum__softmax_full_mha__dense_activation_silu__prompt_kernel_attstage1:
    s_barrier
    s_cmp_lg_u32 s36, 4
    s_cbranch_scc1 parallel_sum__softmax_full_mha__dense_activation_silu__prompt_kernel_noh
    s_lshl_b32 s3, s2, 7
    s_add_u32 s3, s3, 32768
    s_cmp_lg_u32 s24, 0
    s_cbranch_scc1 parallel_sum__softmax_full_mha__dense_activation_silu__prompt_kernel_nf_h
    v_mov_b32 v10, s94
    v_mov_b32 v11, 0
    s_mov_b64 exec, 1
    buffer_store_dword v10, v11, s[32:35], s3 offen sc0 sc1
    s_mov_b64 exec, -1
parallel_sum__softmax_full_mha__dense_activation_silu__prompt_kernel_nf_h:
parallel_sum__softmax_full_mha__dense_activation_silu__prompt_kernel_noh:
    s_add_u32 s39, s30, s37
    s_cmp_lt_u32 s36, 6
    s_cselect_b32 s10, 131072, 0
    s_cselect_b32 s14, 131072, 0
    v_mfma_f32_32x32x16_bf16 a[48:63], a[8:11], v[88:91], a[48:63]
    s_add_u32 m0, s39, 0
    s_nop 0
    buffer_load_dwordx4 v9, s[8:11], s38 offen offset:0 sc1 lds
    v_exp_f32 v16, v16
    v_exp_f32 v17, v17
    v_exp_f32 v18, v18
    v_mfma_f32_32x32x16_bf16 a[48:63], a[12:15], v[92:95], a[48:63]
    v_exp_f32 v19, v19
    ds_read_b128 a[8:11], v4 offset:16384
    ds_read_b128 a[12:15], v4 offset:17408
    v_exp_f32 v20, v20
    v_exp_f32 v21, v21
    v_mfma_f32_32x32x16_bf16 v[32:47], a[0:3], a[24:27], v[64:79]
    v_exp_f32 v22, v22
    v_exp_f32 v23, v23
    v_cvt_pk_bf16_f32 v80, v16, v17
    v_cvt_pk_bf16_f32 v81, v18, v19
    v_mfma_f32_32x32x16_bf16 v[32:47], a[4:7], a[28:31], v[32:47]
    v_exp_f32 v24, v24
    ds_read_b128 a[0:3], v4 offset:2048
    ds_read_b128 a[4:7], v4 offset:3072
    v_exp_f32 v25, v25
    v_cvt_pk_bf16_f32 v82, v20, v21
    v_cvt_pk_bf16_f32 v83, v22, v23
    v_mfma_f32_16x16x32_bf16 a[68:71], v[96:99], v[88:91], a[68:71]
    v_exp_f32 v26, v26
    v_exp_f32 v27, v27
    v_mfma_f32_16x16x32_bf16 a[68:71], v[96:99], v[92:95], a[68:71]
    v_exp_f32 v28, v28
    v_exp_f32 v29, v29
    v_cvt_pk_bf16_f32 v84, v24, v25
    v_exp_f32 v30, v30
    v_exp_f32 v31, v31
    v_cvt_pk_bf16_f32 v85, v26, v27
    v_cvt_pk_bf16_f32 v86, v28, v29
    v_cvt_pk_bf16_f32 v87, v30, v31
    s_waitcnt lgkmcnt(0)
    v_mfma_f32_32x32x16_bf16 a[32:47], a[8:11], v[80:83], a[32:47]
    buffer_load_dwordx4 v9, s[8:11], s38 offen offset:1024 sc1 lds
    v_exp_f32 v32, v32
    v_exp_f32 v33, v33
    v_exp_f32 v34, v34
    v_mfma_f32_32x32x16_bf16 a[32:47], a[12:15], v[84:87], a[32:47]
    v_exp_f32 v35, v35
    v_exp_f32 v36, v36
    v_exp_f32 v37, v37
    v_mfma_f32_32x32x16_bf16 v[16:31], a[0:3], a[16:19], v[48:63]
    v_exp_f32 v38, v38
    v_exp_f32 v39, v39
    v_cvt_pk_bf16_f32 v88, v32, v33
    v_cvt_pk_bf16_f32 v89, v34, v35
    v_mfma_f32_32x32x16_bf16 v[16:31], a[4:7], a[20:23], v[16:31]
    v_exp_f32 v40, v40
    v_exp_f32 v41, v41
    v_cvt_pk_bf16_f32 v90, v36, v37
    v_cvt_pk_bf16_f32 v91, v38, v39
    v_mfma_f32_16x16x32_bf16 a[64:67], v[96:99], v[80:83], a[64:67]
    v_exp_f32 v42, v42
    v_exp_f32 v43, v43
    v_mfma_f32_16x16x32_bf16 a[64:67], v[96:99], v[84:87], a[64:67]
    v_exp_f32 v44, v44
    v_exp_f32 v45, v45
    v_cvt_pk_bf16_f32 v92, v40, v41
    v_exp_f32 v46, v46
    v_exp_f32 v47, v47
    v_cvt_pk_bf16_f32 v93, v42, v43
    v_cvt_pk_bf16_f32 v94, v44, v45
    v_cvt_pk_bf16_f32 v95, v46, v47
    v_mfma_f32_32x32x16_bf16 a[48:63], a[8:11], v[88:91], a[48:63]
    buffer_load_dwordx4 v9, s[8:11], s38 offen offset:2048 sc1 lds
    v_exp_f32 v16, v16
    v_exp_f32 v17, v17
    v_exp_f32 v18, v18
    v_mfma_f32_32x32x16_bf16 a[48:63], a[12:15], v[92:95], a[48:63]
    v_exp_f32 v19, v19
    ds_read_b128 a[8:11], v4 offset:18432
    ds_read_b128 a[12:15], v4 offset:19456
    v_exp_f32 v20, v20
    v_exp_f32 v21, v21
    v_mfma_f32_32x32x16_bf16 v[32:47], a[0:3], a[24:27], v[64:79]
    v_exp_f32 v22, v22
    v_exp_f32 v23, v23
    v_cvt_pk_bf16_f32 v80, v16, v17
    v_cvt_pk_bf16_f32 v81, v18, v19
    v_mfma_f32_32x32x16_bf16 v[32:47], a[4:7], a[28:31], v[32:47]
    v_exp_f32 v24, v24
    ds_read_b128 a[0:3], v4 offset:4096
    ds_read_b128 a[4:7], v4 offset:5120
    v_exp_f32 v25, v25
    v_cvt_pk_bf16_f32 v82, v20, v21
    v_cvt_pk_bf16_f32 v83, v22, v23
    v_mfma_f32_16x16x32_bf16 a[68:71], v[96:99], v[88:91], a[68:71]
    v_exp_f32 v26, v26
    v_exp_f32 v27, v27
    v_mfma_f32_16x16x32_bf16 a[68:71], v[96:99], v[92:95], a[68:71]
    v_exp_f32 v28, v28
    v_exp_f32 v29, v29
    v_cvt_pk_bf16_f32 v84, v24, v25
    v_exp_f32 v30, v30
    v_exp_f32 v31, v31
    v_cvt_pk_bf16_f32 v85, v26, v27
    v_cvt_pk_bf16_f32 v86, v28, v29
    v_cvt_pk_bf16_f32 v87, v30, v31
    s_waitcnt lgkmcnt(0)
    v_mfma_f32_32x32x16_bf16 a[32:47], a[8:11], v[80:83], a[32:47]
    buffer_load_dwordx4 v9, s[8:11], s38 offen offset:3072 sc1 lds
    v_exp_f32 v32, v32
    v_exp_f32 v33, v33
    v_exp_f32 v34, v34
    v_mfma_f32_32x32x16_bf16 a[32:47], a[12:15], v[84:87], a[32:47]
    v_exp_f32 v35, v35
    v_exp_f32 v36, v36
    v_exp_f32 v37, v37
    v_mfma_f32_32x32x16_bf16 v[16:31], a[0:3], a[16:19], v[48:63]
    v_exp_f32 v38, v38
    v_exp_f32 v39, v39
    v_cvt_pk_bf16_f32 v88, v32, v33
    v_cvt_pk_bf16_f32 v89, v34, v35
    v_mfma_f32_32x32x16_bf16 v[16:31], a[4:7], a[20:23], v[16:31]
    v_exp_f32 v40, v40
    v_exp_f32 v41, v41
    v_cvt_pk_bf16_f32 v90, v36, v37
    v_cvt_pk_bf16_f32 v91, v38, v39
    v_mfma_f32_16x16x32_bf16 a[64:67], v[96:99], v[80:83], a[64:67]
    v_exp_f32 v42, v42
    v_exp_f32 v43, v43
    v_mfma_f32_16x16x32_bf16 a[64:67], v[96:99], v[84:87], a[64:67]
    v_exp_f32 v44, v44
    v_exp_f32 v45, v45
    v_cvt_pk_bf16_f32 v92, v40, v41
    v_exp_f32 v46, v46
    v_exp_f32 v47, v47
    v_cvt_pk_bf16_f32 v93, v42, v43
    v_cvt_pk_bf16_f32 v94, v44, v45
    v_cvt_pk_bf16_f32 v95, v46, v47
    v_mfma_f32_32x32x16_bf16 a[48:63], a[8:11], v[88:91], a[48:63]
    s_add_u32 m0, s39, 16384
    s_nop 0
    buffer_load_dwordx4 v9, s[12:15], s38 offen offset:0 sc1 lds
    v_exp_f32 v16, v16
    v_exp_f32 v17, v17
    v_exp_f32 v18, v18
    v_mfma_f32_32x32x16_bf16 a[48:63], a[12:15], v[92:95], a[48:63]
    v_exp_f32 v19, v19
    ds_read_b128 a[8:11], v4 offset:20480
    ds_read_b128 a[12:15], v4 offset:21504
    v_exp_f32 v20, v20
    v_exp_f32 v21, v21
    v_mfma_f32_32x32x16_bf16 v[32:47], a[0:3], a[24:27], v[64:79]
    v_exp_f32 v22, v22
    v_exp_f32 v23, v23
    v_cvt_pk_bf16_f32 v80, v16, v17
    v_cvt_pk_bf16_f32 v81, v18, v19
    v_mfma_f32_32x32x16_bf16 v[32:47], a[4:7], a[28:31], v[32:47]
    v_exp_f32 v24, v24
    ds_read_b128 a[0:3], v4 offset:6144
    ds_read_b128 a[4:7], v4 offset:7168
    v_exp_f32 v25, v25
    v_cvt_pk_bf16_f32 v82, v20, v21
    v_cvt_pk_bf16_f32 v83, v22, v23
    v_mfma_f32_16x16x32_bf16 a[68:71], v[96:99], v[88:91], a[68:71]
    v_exp_f32 v26, v26
    v_exp_f32 v27, v27
    v_mfma_f32_16x16x32_bf16 a[68:71], v[96:99], v[92:95], a[68:71]
    v_exp_f32 v28, v28
    v_exp_f32 v29, v29
    v_cvt_pk_bf16_f32 v84, v24, v25
    v_exp_f32 v30, v30
    v_exp_f32 v31, v31
    v_cvt_pk_bf16_f32 v85, v26, v27
    v_cvt_pk_bf16_f32 v86, v28, v29
    v_cvt_pk_bf16_f32 v87, v30, v31
    s_waitcnt lgkmcnt(0)
    v_mfma_f32_32x32x16_bf16 a[32:47], a[8:11], v[80:83], a[32:47]
    buffer_load_dwordx4 v9, s[12:15], s38 offen offset:1024 sc1 lds
    v_exp_f32 v32, v32
    v_exp_f32 v33, v33
    v_exp_f32 v34, v34
    v_mfma_f32_32x32x16_bf16 a[32:47], a[12:15], v[84:87], a[32:47]
    v_exp_f32 v35, v35
    v_exp_f32 v36, v36
    v_exp_f32 v37, v37
    v_mfma_f32_32x32x16_bf16 v[16:31], a[0:3], a[16:19], v[48:63]
    v_exp_f32 v38, v38
    v_exp_f32 v39, v39
    v_cvt_pk_bf16_f32 v88, v32, v33
    v_cvt_pk_bf16_f32 v89, v34, v35
    v_mfma_f32_32x32x16_bf16 v[16:31], a[4:7], a[20:23], v[16:31]
    v_exp_f32 v40, v40
    v_exp_f32 v41, v41
    v_cvt_pk_bf16_f32 v90, v36, v37
    v_cvt_pk_bf16_f32 v91, v38, v39
    v_mfma_f32_16x16x32_bf16 a[64:67], v[96:99], v[80:83], a[64:67]
    v_exp_f32 v42, v42
    v_exp_f32 v43, v43
    v_mfma_f32_16x16x32_bf16 a[64:67], v[96:99], v[84:87], a[64:67]
    v_exp_f32 v44, v44
    v_exp_f32 v45, v45
    v_cvt_pk_bf16_f32 v92, v40, v41
    v_exp_f32 v46, v46
    v_exp_f32 v47, v47
    v_cvt_pk_bf16_f32 v93, v42, v43
    v_cvt_pk_bf16_f32 v94, v44, v45
    v_cvt_pk_bf16_f32 v95, v46, v47
    v_mfma_f32_32x32x16_bf16 a[48:63], a[8:11], v[88:91], a[48:63]
    buffer_load_dwordx4 v9, s[12:15], s38 offen offset:2048 sc1 lds
    v_exp_f32 v16, v16
    v_exp_f32 v17, v17
    v_exp_f32 v18, v18
    v_mfma_f32_32x32x16_bf16 a[48:63], a[12:15], v[92:95], a[48:63]
    v_exp_f32 v19, v19
    ds_read_b128 a[8:11], v4 offset:22528
    ds_read_b128 a[12:15], v4 offset:23552
    v_exp_f32 v20, v20
    v_exp_f32 v21, v21
    v_mfma_f32_32x32x16_bf16 v[32:47], a[0:3], a[24:27], v[64:79]
    v_exp_f32 v22, v22
    v_exp_f32 v23, v23
    v_cvt_pk_bf16_f32 v80, v16, v17
    v_cvt_pk_bf16_f32 v81, v18, v19
    v_mfma_f32_32x32x16_bf16 v[32:47], a[4:7], a[28:31], v[32:47]
    v_exp_f32 v24, v24
    ds_read_b128 a[0:3], v4 offset:8192
    ds_read_b128 a[4:7], v4 offset:9216
    v_exp_f32 v25, v25
    v_cvt_pk_bf16_f32 v82, v20, v21
    v_cvt_pk_bf16_f32 v83, v22, v23
    v_mfma_f32_16x16x32_bf16 a[68:71], v[96:99], v[88:91], a[68:71]
    v_exp_f32 v26, v26
    v_exp_f32 v27, v27
    v_mfma_f32_16x16x32_bf16 a[68:71], v[96:99], v[92:95], a[68:71]
    v_exp_f32 v28, v28
    v_exp_f32 v29, v29
    v_cvt_pk_bf16_f32 v84, v24, v25
    v_exp_f32 v30, v30
    v_exp_f32 v31, v31
    v_cvt_pk_bf16_f32 v85, v26, v27
    v_cvt_pk_bf16_f32 v86, v28, v29
    v_cvt_pk_bf16_f32 v87, v30, v31
    s_waitcnt lgkmcnt(0)
    v_mfma_f32_32x32x16_bf16 a[32:47], a[8:11], v[80:83], a[32:47]
    buffer_load_dwordx4 v9, s[12:15], s38 offen offset:3072 sc1 lds
    v_exp_f32 v32, v32
    v_exp_f32 v33, v33
    v_exp_f32 v34, v34
    v_mfma_f32_32x32x16_bf16 a[32:47], a[12:15], v[84:87], a[32:47]
    v_exp_f32 v35, v35
    v_exp_f32 v36, v36
    v_exp_f32 v37, v37
    v_mfma_f32_32x32x16_bf16 v[16:31], a[0:3], a[16:19], v[48:63]
    v_exp_f32 v38, v38
    v_exp_f32 v39, v39
    v_cvt_pk_bf16_f32 v88, v32, v33
    v_cvt_pk_bf16_f32 v89, v34, v35
    v_mfma_f32_32x32x16_bf16 v[16:31], a[4:7], a[20:23], v[16:31]
    v_exp_f32 v40, v40
    v_exp_f32 v41, v41
    v_cvt_pk_bf16_f32 v90, v36, v37
    v_cvt_pk_bf16_f32 v91, v38, v39
    v_mfma_f32_16x16x32_bf16 a[64:67], v[96:99], v[80:83], a[64:67]
    v_exp_f32 v42, v42
    v_exp_f32 v43, v43
    v_mfma_f32_16x16x32_bf16 a[64:67], v[96:99], v[84:87], a[64:67]
    v_exp_f32 v44, v44
    v_exp_f32 v45, v45
    v_cvt_pk_bf16_f32 v92, v40, v41
    v_exp_f32 v46, v46
    v_exp_f32 v47, v47
    v_cvt_pk_bf16_f32 v93, v42, v43
    v_cvt_pk_bf16_f32 v94, v44, v45
    v_cvt_pk_bf16_f32 v95, v46, v47
    v_mfma_f32_32x32x16_bf16 a[48:63], a[8:11], v[88:91], a[48:63]
    buffer_load_dword v12, v14, s[32:35], s55 offen sc0 sc1
    v_exp_f32 v16, v16
    v_exp_f32 v17, v17
    v_exp_f32 v18, v18
    v_mfma_f32_32x32x16_bf16 a[48:63], a[12:15], v[92:95], a[48:63]
    v_exp_f32 v19, v19
    ds_read_b128 a[8:11], v4 offset:24576
    ds_read_b128 a[12:15], v4 offset:25600
    v_exp_f32 v20, v20
    v_exp_f32 v21, v21
    v_mfma_f32_32x32x16_bf16 v[32:47], a[0:3], a[24:27], v[64:79]
    v_exp_f32 v22, v22
    v_exp_f32 v23, v23
    v_cvt_pk_bf16_f32 v80, v16, v17
    v_cvt_pk_bf16_f32 v81, v18, v19
    v_mfma_f32_32x32x16_bf16 v[32:47], a[4:7], a[28:31], v[32:47]
    v_exp_f32 v24, v24
    ds_read_b128 a[0:3], v4 offset:10240
    ds_read_b128 a[4:7], v4 offset:11264
    v_exp_f32 v25, v25
    v_cvt_pk_bf16_f32 v82, v20, v21
    v_cvt_pk_bf16_f32 v83, v22, v23
    v_mfma_f32_16x16x32_bf16 a[68:71], v[96:99], v[88:91], a[68:71]
    v_exp_f32 v26, v26
    v_exp_f32 v27, v27
    v_mfma_f32_16x16x32_bf16 a[68:71], v[96:99], v[92:95], a[68:71]
    v_exp_f32 v28, v28
    v_exp_f32 v29, v29
    v_cvt_pk_bf16_f32 v84, v24, v25
    v_exp_f32 v30, v30
    v_exp_f32 v31, v31
    v_cvt_pk_bf16_f32 v85, v26, v27
    v_cvt_pk_bf16_f32 v86, v28, v29
    v_cvt_pk_bf16_f32 v87, v30, v31
    s_waitcnt lgkmcnt(0)
    v_mfma_f32_32x32x16_bf16 a[32:47], a[8:11], v[80:83], a[32:47]
    buffer_load_dwordx4 v[200:203], v13, s[68:71], s62 offen
    s_add_u32 s62, s62, 4096
    v_exp_f32 v32, v32
    v_exp_f32 v33, v33
    v_exp_f32 v34, v34
    v_mfma_f32_32x32x16_bf16 a[32:47], a[12:15], v[84:87], a[32:47]
    v_exp_f32 v35, v35
    v_exp_f32 v36, v36
    v_exp_f32 v37, v37
    v_mfma_f32_32x32x16_bf16 v[16:31], a[0:3], a[16:19], v[48:63]
    v_exp_f32 v38, v38
    v_exp_f32 v39, v39
    v_cvt_pk_bf16_f32 v88, v32, v33
    v_cvt_pk_bf16_f32 v89, v34, v35
    v_mfma_f32_32x32x16_bf16 v[16:31], a[4:7], a[20:23], v[16:31]
    v_exp_f32 v40, v40
    v_exp_f32 v41, v41
    v_cvt_pk_bf16_f32 v90, v36, v37
    v_cvt_pk_bf16_f32 v91, v38, v39
    v_mfma_f32_16x16x32_bf16 a[64:67], v[96:99], v[80:83], a[64:67]
    v_exp_f32 v42, v42
    v_exp_f32 v43, v43
    v_mfma_f32_16x16x32_bf16 a[64:67], v[96:99], v[84:87], a[64:67]
    v_exp_f32 v44, v44
    v_exp_f32 v45, v45
    v_cvt_pk_bf16_f32 v92, v40, v41
    v_exp_f32 v46, v46
    v_exp_f32 v47, v47
    v_cvt_pk_bf16_f32 v93, v42, v43
    v_cvt_pk_bf16_f32 v94, v44, v45
    v_cvt_pk_bf16_f32 v95, v46, v47
    v_mfma_f32_32x32x16_bf16 a[48:63], a[8:11], v[88:91], a[48:63]
    v_exp_f32 v16, v16
    v_exp_f32 v17, v17
    v_exp_f32 v18, v18
    v_mfma_f32_32x32x16_bf16 a[48:63], a[12:15], v[92:95], a[48:63]
    v_exp_f32 v19, v19
    ds_read_b128 a[8:11], v4 offset:26624
    ds_read_b128 a[12:15], v4 offset:27648
    v_exp_f32 v20, v20
    v_exp_f32 v21, v21
    v_mfma_f32_32x32x16_bf16 v[32:47], a[0:3], a[24:27], v[64:79]
    v_exp_f32 v22, v22
    v_exp_f32 v23, v23
    v_cvt_pk_bf16_f32 v80, v16, v17
    v_cvt_pk_bf16_f32 v81, v18, v19
    v_mfma_f32_32x32x16_bf16 v[32:47], a[4:7], a[28:31], v[32:47]
    v_exp_f32 v24, v24
    ds_read_b128 a[0:3], v4 offset:12288
    ds_read_b128 a[4:7], v4 offset:13312
    v_exp_f32 v25, v25
    v_cvt_pk_bf16_f32 v82, v20, v21
    v_cvt_pk_bf16_f32 v83, v22, v23
    v_mfma_f32_16x16x32_bf16 a[68:71], v[96:99], v[88:91], a[68:71]
    v_exp_f32 v26, v26
    v_exp_f32 v27, v27
    v_mfma_f32_16x16x32_bf16 a[68:71], v[96:99], v[92:95], a[68:71]
    v_exp_f32 v28, v28
    v_exp_f32 v29, v29
    v_cvt_pk_bf16_f32 v84, v24, v25
    v_exp_f32 v30, v30
    v_exp_f32 v31, v31
    v_cvt_pk_bf16_f32 v85, v26, v27
    v_cvt_pk_bf16_f32 v86, v28, v29
    v_cvt_pk_bf16_f32 v87, v30, v31
    s_waitcnt lgkmcnt(0)
    v_mfma_f32_32x32x16_bf16 a[32:47], a[8:11], v[80:83], a[32:47]
    v_exp_f32 v32, v32
    v_exp_f32 v33, v33
    v_exp_f32 v34, v34
    v_mfma_f32_32x32x16_bf16 a[32:47], a[12:15], v[84:87], a[32:47]
    v_exp_f32 v35, v35
    v_exp_f32 v36, v36
    v_exp_f32 v37, v37
    v_mfma_f32_32x32x16_bf16 v[16:31], a[0:3], a[16:19], v[48:63]
    v_exp_f32 v38, v38
    v_exp_f32 v39, v39
    v_cvt_pk_bf16_f32 v88, v32, v33
    v_cvt_pk_bf16_f32 v89, v34, v35
    v_mfma_f32_32x32x16_bf16 v[16:31], a[4:7], a[20:23], v[16:31]
    v_exp_f32 v40, v40
    v_exp_f32 v41, v41
    v_cvt_pk_bf16_f32 v90, v36, v37
    v_cvt_pk_bf16_f32 v91, v38, v39
    v_mfma_f32_16x16x32_bf16 a[64:67], v[96:99], v[80:83], a[64:67]
    v_exp_f32 v42, v42
    v_exp_f32 v43, v43
    v_mfma_f32_16x16x32_bf16 a[64:67], v[96:99], v[84:87], a[64:67]
    v_exp_f32 v44, v44
    v_exp_f32 v45, v45
    v_cvt_pk_bf16_f32 v92, v40, v41
    v_exp_f32 v46, v46
    v_exp_f32 v47, v47
    v_cvt_pk_bf16_f32 v93, v42, v43
    v_cvt_pk_bf16_f32 v94, v44, v45
    v_cvt_pk_bf16_f32 v95, v46, v47
    v_mfma_f32_32x32x16_bf16 a[48:63], a[8:11], v[88:91], a[48:63]
    v_exp_f32 v16, v16
    v_exp_f32 v17, v17
    v_exp_f32 v18, v18
    v_mfma_f32_32x32x16_bf16 a[48:63], a[12:15], v[92:95], a[48:63]
    v_exp_f32 v19, v19
    ds_read_b128 a[8:11], v4 offset:28672
    ds_read_b128 a[12:15], v4 offset:29696
    v_exp_f32 v20, v20
    v_exp_f32 v21, v21
    v_mfma_f32_32x32x16_bf16 v[32:47], a[0:3], a[24:27], v[64:79]
    v_exp_f32 v22, v22
    v_exp_f32 v23, v23
    v_cvt_pk_bf16_f32 v80, v16, v17
    v_cvt_pk_bf16_f32 v81, v18, v19
    v_mfma_f32_32x32x16_bf16 v[32:47], a[4:7], a[28:31], v[32:47]
    v_exp_f32 v24, v24
    ds_read_b128 a[0:3], v4 offset:14336
    ds_read_b128 a[4:7], v4 offset:15360
    v_exp_f32 v25, v25
    v_cvt_pk_bf16_f32 v82, v20, v21
    v_cvt_pk_bf16_f32 v83, v22, v23
    v_mfma_f32_16x16x32_bf16 a[68:71], v[96:99], v[88:91], a[68:71]
    v_exp_f32 v26, v26
    v_exp_f32 v27, v27
    v_mfma_f32_16x16x32_bf16 a[68:71], v[96:99], v[92:95], a[68:71]
    v_exp_f32 v28, v28
    v_exp_f32 v29, v29
    v_cvt_pk_bf16_f32 v84, v24, v25
    v_exp_f32 v30, v30
    v_exp_f32 v31, v31
    v_cvt_pk_bf16_f32 v85, v26, v27
    v_cvt_pk_bf16_f32 v86, v28, v29
    v_cvt_pk_bf16_f32 v87, v30, v31
    s_waitcnt lgkmcnt(0)
    v_mfma_f32_32x32x16_bf16 a[32:47], a[8:11], v[80:83], a[32:47]
    v_exp_f32 v32, v32
    v_exp_f32 v33, v33
    v_exp_f32 v34, v34
    v_mfma_f32_32x32x16_bf16 a[32:47], a[12:15], v[84:87], a[32:47]
    v_exp_f32 v35, v35
    v_exp_f32 v36, v36
    v_exp_f32 v37, v37
    v_mfma_f32_32x32x16_bf16 v[16:31], a[0:3], a[16:19], v[48:63]
    v_exp_f32 v38, v38
    v_exp_f32 v39, v39
    v_cvt_pk_bf16_f32 v88, v32, v33
    v_cvt_pk_bf16_f32 v89, v34, v35
    v_mfma_f32_32x32x16_bf16 v[16:31], a[4:7], a[20:23], v[16:31]
    v_exp_f32 v40, v40
    v_exp_f32 v41, v41
    v_cvt_pk_bf16_f32 v90, v36, v37
    v_cvt_pk_bf16_f32 v91, v38, v39
    v_mfma_f32_16x16x32_bf16 a[64:67], v[96:99], v[80:83], a[64:67]
    v_exp_f32 v42, v42
    v_exp_f32 v43, v43
    v_mfma_f32_16x16x32_bf16 a[64:67], v[96:99], v[84:87], a[64:67]
    v_exp_f32 v44, v44
    v_exp_f32 v45, v45
    v_cvt_pk_bf16_f32 v92, v40, v41
    v_exp_f32 v46, v46
    v_exp_f32 v47, v47
    v_cvt_pk_bf16_f32 v93, v42, v43
    v_cvt_pk_bf16_f32 v94, v44, v45
    v_cvt_pk_bf16_f32 v95, v46, v47
    v_mfma_f32_32x32x16_bf16 a[48:63], a[8:11], v[88:91], a[48:63]
    v_exp_f32 v16, v16
    v_exp_f32 v17, v17
    v_exp_f32 v18, v18
    v_mfma_f32_32x32x16_bf16 a[48:63], a[12:15], v[92:95], a[48:63]
    v_exp_f32 v19, v19
    ds_read_b128 a[8:11], v4 offset:30720
    ds_read_b128 a[12:15], v4 offset:31744
    v_exp_f32 v20, v20
    v_exp_f32 v21, v21
    v_mfma_f32_32x32x16_bf16 v[32:47], a[0:3], a[24:27], v[64:79]
    v_exp_f32 v22, v22
    v_exp_f32 v23, v23
    v_cvt_pk_bf16_f32 v80, v16, v17
    v_cvt_pk_bf16_f32 v81, v18, v19
    v_mfma_f32_32x32x16_bf16 v[32:47], a[4:7], a[28:31], v[32:47]
    v_exp_f32 v24, v24
    ds_read_b128 a[0:3], v5 offset:0
    ds_read_b128 a[4:7], v5 offset:1024
    v_exp_f32 v25, v25
    v_cvt_pk_bf16_f32 v82, v20, v21
    v_cvt_pk_bf16_f32 v83, v22, v23
    v_mfma_f32_16x16x32_bf16 a[68:71], v[96:99], v[88:91], a[68:71]
    v_exp_f32 v26, v26
    v_exp_f32 v27, v27
    v_mfma_f32_16x16x32_bf16 a[68:71], v[96:99], v[92:95], a[68:71]
    v_exp_f32 v28, v28
    v_exp_f32 v29, v29
    v_cvt_pk_bf16_f32 v84, v24, v25
    v_exp_f32 v30, v30
    v_exp_f32 v31, v31
    v_cvt_pk_bf16_f32 v85, v26, v27
    v_cvt_pk_bf16_f32 v86, v28, v29
    v_cvt_pk_bf16_f32 v87, v30, v31
    s_waitcnt lgkmcnt(0)
    v_mfma_f32_32x32x16_bf16 a[32:47], a[8:11], v[80:83], a[32:47]
    v_exp_f32 v32, v32
    v_exp_f32 v33, v33
    v_exp_f32 v34, v34
    v_mfma_f32_32x32x16_bf16 a[32:47], a[12:15], v[84:87], a[32:47]
    v_exp_f32 v35, v35
    v_exp_f32 v36, v36
    v_exp_f32 v37, v37
    v_mfma_f32_32x32x16_bf16 v[16:31], a[0:3], a[16:19], v[48:63]
    v_exp_f32 v38, v38
    v_exp_f32 v39, v39
    v_cvt_pk_bf16_f32 v88, v32, v33
    v_cvt_pk_bf16_f32 v89, v34, v35
    v_mfma_f32_32x32x16_bf16 v[16:31], a[4:7], a[20:23], v[16:31]
    v_exp_f32 v40, v40
    v_exp_f32 v41, v41
    v_cvt_pk_bf16_f32 v90, v36, v37
    v_cvt_pk_bf16_f32 v91, v38, v39
    v_mfma_f32_16x16x32_bf16 a[64:67], v[96:99], v[80:83], a[64:67]
    v_exp_f32 v42, v42
    v_exp_f32 v43, v43
    v_mfma_f32_16x16x32_bf16 a[64:67], v[96:99], v[84:87], a[64:67]
    v_exp_f32 v44, v44
    v_exp_f32 v45, v45
    v_cvt_pk_bf16_f32 v92, v40, v41
    v_exp_f32 v46, v46
    v_exp_f32 v47, v47
    v_cvt_pk_bf16_f32 v93, v42, v43
    v_cvt_pk_bf16_f32 v94, v44, v45
    v_cvt_pk_bf16_f32 v95, v46, v47
    v_mov_b32 v4, v5
    s_mov_b32 s3, s37
    s_add_u32 s37, s37, 32768
    s_cmp_ge_u32 s37, 98304
    s_cselect_b32 s37, 0, s37
    v_add_u32 v5, s3, v8
    s_add_u32 s38, s38, 16384
    s_and_b32 s38, s38, 0x1ffff
    s_add_u32 s36, s36, 1
    s_cmp_lt_u32 s36, 7
    s_cbranch_scc1 parallel_sum__softmax_full_mha__dense_activation_silu__prompt_kernel_attstage
    s_waitcnt vmcnt(1)
    s_barrier
    v_cmp_ne_u32 vcc, s94, v12
    s_nop 1
    s_cbranch_vccz parallel_sum__softmax_full_mha__dense_activation_silu__prompt_kernel_ok_h
    s_mov_b32 s100, 0x40000
parallel_sum__softmax_full_mha__dense_activation_silu__prompt_kernel_poll_h:
    buffer_load_dword v12, v14, s[32:35], s55 offen sc0 sc1
    s_sub_u32 s100, s100, 1
    s_cmp_eq_u32 s100, 0
    s_cbranch_scc1 parallel_sum__softmax_full_mha__dense_activation_silu__prompt_kernel_pollx_h
    s_waitcnt vmcnt(0)
    v_cmp_ne_u32 vcc, s94, v12
    s_nop 1
    s_cbranch_vccnz parallel_sum__softmax_full_mha__dense_activation_silu__prompt_kernel_poll_h
parallel_sum__softmax_full_mha__dense_activation_silu__prompt_kernel_pollx_h:
parallel_sum__softmax_full_mha__dense_activation_silu__prompt_kernel_ok_h:
    v_mfma_f32_32x32x16_bf16 a[48:63], a[8:11], v[88:91], a[48:63]
    s_add_u32 m0, s53, 65536
    s_nop 0
    buffer_load_dwordx4 v102, s[68:71], s48 offen lds
    v_exp_f32 v16, v16
    v_exp_f32 v17, v17
    v_exp_f32 v18, v18
    v_mfma_f32_32x32x16_bf16 a[48:63], a[12:15], v[92:95], a[48:63]
    v_exp_f32 v19, v19
    ds_read_b128 a[8:11], v4 offset:16384
    ds_read_b128 a[12:15], v4 offset:17408
    v_exp_f32 v20, v20
    v_exp_f32 v21, v21
    v_mfma_f32_32x32x16_bf16 v[32:47], a[0:3], a[24:27], v[64:79]
    s_add_u32 m0, s53, 66560
    s_nop 0
    buffer_load_dwordx4 v103, s[68:71], s48 offen lds
    s_add_u32 s48, s48, 65536
    v_exp_f32 v22, v22
    v_exp_f32 v23, v23
    v_cvt_pk_bf16_f32 v80, v16, v17
    v_cvt_pk_bf16_f32 v81, v18, v19
    v_mfma_f32_32x32x16_bf16 v[32:47], a[4:7], a[28:31], v[32:47]
    v_exp_f32 v24, v24
    ds_read_b128 a[0:3], v4 offset:2048
    ds_read_b128 a[4:7], v4 offset:3072
    v_exp_f32 v25, v25
    v_cvt_pk_bf16_f32 v82, v20, v21
    v_cvt_pk_bf16_f32 v83, v22, v23
    v_mfma_f32_16x16x32_bf16 a[68:71], v[96:99], v[88:91], a[68:71]
    s_add_u32 m0, s53, 73728
    s_nop 0
    buffer_load_dwordx4 v102, s[68:71], s48 offen lds
    v_exp_f32 v26, v26
    v_exp_f32 v27, v27
    v_mfma_f32_16x16x32_bf16 a[68:71], v[96:99], v[92:95], a[68:71]
    v_exp_f32 v28, v28
    v_exp_f32 v29, v29
    v_cvt_pk_bf16_f32 v84, v24, v25
    v_exp_f32 v30, v30
    v_exp_f32 v31, v31
    v_cvt_pk_bf16_f32 v85, v26, v27
    v_cvt_pk_bf16_f32 v86, v28, v29
    v_cvt_pk_bf16_f32 v87, v30, v31
    s_waitcnt lgkmcnt(0)
    v_mfma_f32_32x32x16_bf16 a[32:47], a[8:11], v[80:83], a[32:47]
    s_add_u32 m0, s53, 74752
    s_nop 0
    buffer_load_dwordx4 v103, s[68:71], s48 offen lds
    s_add_u32 s48, s48, 65536
    v_exp_f32 v32, v32
    v_exp_f32 v33, v33
    v_exp_f32 v34, v34
    v_mfma_f32_32x32x16_bf16 a[32:47], a[12:15], v[84:87], a[32:47]
    v_exp_f32 v35, v35
    v_exp_f32 v36, v36
    v_exp_f32 v37, v37
    v_mfma_f32_32x32x16_bf16 v[16:31], a[0:3], a[16:19], v[48:63]
    s_add_u32 m0, s53, 81920
    s_nop 0
    buffer_load_dwordx4 v102, s[68:71], s48 offen lds
    v_exp_f32 v38, v38
    v_exp_f32 v39, v39
    v_cvt_pk_bf16_f32 v88, v32, v33
    v_cvt_pk_bf16_f32 v89, v34, v35
    v_mfma_f32_32x32x16_bf16 v[16:31], a[4:7], a[20:23], v[16:31]
    v_exp_f32 v40, v40
    v_exp_f32 v41, v41
    v_cvt_pk_bf16_f32 v90, v36, v37
    v_cvt_pk_bf16_f32 v91, v38, v39
    v_mfma_f32_16x16x32_bf16 a[64:67], v[96:99], v[80:83], a[64:67]
    v_exp_f32 v42, v42
    v_exp_f32 v43, v43
    v_mfma_f32_16x16x32_bf16 a[64:67], v[96:99], v[84:87], a[64:67]
    v_exp_f32 v44, v44
    v_exp_f32 v45, v45
    v_cvt_pk_bf16_f32 v92, v40, v41
    v_exp_f32 v46, v46
    v_exp_f32 v47, v47
    v_cvt_pk_bf16_f32 v93, v42, v43
    v_cvt_pk_bf16_f32 v94, v44, v45
    v_cvt_pk_bf16_f32 v95, v46, v47
    v_mfma_f32_32x32x16_bf16 a[48:63], a[8:11], v[88:91], a[48:63]
    s_add_u32 m0, s53, 82944
    s_nop 0
    buffer_load_dwordx4 v103, s[68:71], s48 offen lds
    s_add_u32 s48, s48, 65536
    v_exp_f32 v16, v16
    v_exp_f32 v17, v17
    v_exp_f32 v18, v18
    v_mfma_f32_32x32x16_bf16 a[48:63], a[12:15], v[92:95], a[48:63]
    v_exp_f32 v19, v19
    ds_read_b128 a[8:11], v4 offset:18432
    ds_read_b128 a[12:15], v4 offset:19456
    v_exp_f32 v20, v20
    v_exp_f32 v21, v21
    v_mfma_f32_32x32x16_bf16 v[32:47], a[0:3], a[24:27], v[64:79]
    s_add_u32 m0, s53, 90112
    s_nop 0
    buffer_load_dwordx4 v102, s[68:71], s48 offen lds
    v_exp_f32 v22, v22
    v_exp_f32 v23, v23
    v_cvt_pk_bf16_f32 v80, v16, v17
    v_cvt_pk_bf16_f32 v81, v18, v19
    v_mfma_f32_32x32x16_bf16 v[32:47], a[4:7], a[28:31], v[32:47]
    v_exp_f32 v24, v24
    ds_read_b128 a[0:3], v4 offset:4096
    ds_read_b128 a[4:7], v4 offset:5120
    v_exp_f32 v25, v25
    v_cvt_pk_bf16_f32 v82, v20, v21
    v_cvt_pk_bf16_f32 v83, v22, v23
    v_mfma_f32_16x16x32_bf16 a[68:71], v[96:99], v[88:91], a[68:71]
    s_add_u32 m0, s53, 91136
    s_nop 0
    buffer_load_dwordx4 v103, s[68:71], s48 offen lds
    s_add_u32 s48, s48, 65536
    v_exp_f32 v26, v26
    v_exp_f32 v27, v27
    v_mfma_f32_16x16x32_bf16 a[68:71], v[96:99], v[92:95], a[68:71]
    v_exp_f32 v28, v28
    v_exp_f32 v29, v29
    v_cvt_pk_bf16_f32 v84, v24, v25
    v_exp_f32 v30, v30
    v_exp_f32 v31, v31
    v_cvt_pk_bf16_f32 v85, v26, v27
    v_cvt_pk_bf16_f32 v86, v28, v29
    v_cvt_pk_bf16_f32 v87, v30, v31
    s_waitcnt lgkmcnt(0)
    v_mfma_f32_32x32x16_bf16 a[32:47], a[8:11], v[80:83], a[32:47]
    buffer_load_dwordx4 a[128:131], v100, s[64:67], s44 offen offset:0 sc1
    v_exp_f32 v32, v32
    v_exp_f32 v33, v33
    v_exp_f32 v34, v34
    v_mfma_f32_32x32x16_bf16 a[32:47], a[12:15], v[84:87], a[32:47]
    v_exp_f32 v35, v35
    v_exp_f32 v36, v36
    v_exp_f32 v37, v37
    v_mfma_f32_32x32x16_bf16 v[16:31], a[0:3], a[16:19], v[48:63]
    buffer_load_dwordx4 a[132:135], v100, s[64:67], s44 offen offset:256 sc1
    v_exp_f32 v38, v38
    v_exp_f32 v39, v39
    v_cvt_pk_bf16_f32 v88, v32, v33
    v_cvt_pk_bf16_f32 v89, v34, v35
    v_mfma_f32_32x32x16_bf16 v[16:31], a[4:7], a[20:23], v[16:31]
    v_exp_f32 v40, v40
    v_exp_f32 v41, v41
    v_cvt_pk_bf16_f32 v90, v36, v37
    v_cvt_pk_bf16_f32 v91, v38, v39
    v_mfma_f32_16x16x32_bf16 a[64:67], v[96:99], v[80:83], a[64:67]
    v_exp_f32 v42, v42
    v_exp_f32 v43, v43
    v_mfma_f32_16x16x32_bf16 a[64:67], v[96:99], v[84:87], a[64:67]
    v_exp_f32 v44, v44
    v_exp_f32 v45, v45
    v_cvt_pk_bf16_f32 v92, v40, v41
    v_exp_f32 v46, v46
    v_exp_f32 v47, v47
    v_cvt_pk_bf16_f32 v93, v42, v43
    v_cvt_pk_bf16_f32 v94, v44, v45
    v_cvt_pk_bf16_f32 v95, v46, v47
    v_mfma_f32_32x32x16_bf16 a[48:63], a[8:11], v[88:91], a[48:63]
    buffer_load_dwordx4 a[136:139], v100, s[64:67], s44 offen offset:2048 sc1
    v_exp_f32 v16, v16
    v_exp_f32 v17, v17
    v_exp_f32 v18, v18
    v_mfma_f32_32x32x16_bf16 a[48:63], a[12:15], v[92:95], a[48:63]
    v_exp_f32 v19, v19
    ds_read_b128 a[8:11], v4 offset:20480
    ds_read_b128 a[12:15], v4 offset:21504
    v_exp_f32 v20, v20
    v_exp_f32 v21, v21
    v_mfma_f32_32x32x16_bf16 v[32:47], a[0:3], a[24:27], v[64:79]
    buffer_load_dwordx4 a[140:143], v100, s[64:67], s44 offen offset:2304 sc1
    v_exp_f32 v22, v22
    v_exp_f32 v23, v23
    v_cvt_pk_bf16_f32 v80, v16, v17
    v_cvt_pk_bf16_f32 v81, v18, v19
    v_mfma_f32_32x32x16_bf16 v[32:47], a[4:7], a[28:31], v[32:47]
    v_exp_f32 v24, v24
    ds_read_b128 a[0:3], v4 offset:6144
    ds_read_b128 a[4:7], v4 offset:7168
    v_exp_f32 v25, v25
    v_cvt_pk_bf16_f32 v82, v20, v21
    v_cvt_pk_bf16_f32 v83, v22, v23
    v_mfma_f32_16x16x32_bf16 a[68:71], v[96:99], v[88:91], a[68:71]
    buffer_load_dwordx4 a[144:147], v100, s[64:67], s46 offen offset:0 sc1
    v_exp_f32 v26, v26
    v_exp_f32 v27, v27
    v_mfma_f32_16x16x32_bf16 a[68:71], v[96:99], v[92:95], a[68:71]
    v_exp_f32 v28, v28
    v_exp_f32 v29, v29
    v_cvt_pk_bf16_f32 v84, v24, v25
    v_exp_f32 v30, v30
    v_exp_f32 v31, v31
    v_cvt_pk_bf16_f32 v85, v26, v27
    v_cvt_pk_bf16_f32 v86, v28, v29
    v_cvt_pk_bf16_f32 v87, v30, v31
    s_waitcnt lgkmcnt(0)
    v_mfma_f32_32x32x16_bf16 a[32:47], a[8:11], v[80:83], a[32:47]
    buffer_load_dwordx4 a[148:151], v100, s[64:67], s46 offen offset:256 sc1
    v_exp_f32 v32, v32
    v_exp_f32 v33, v33
    v_exp_f32 v34, v34
    v_mfma_f32_32x32x16_bf16 a[32:47], a[12:15], v[84:87], a[32:47]
    v_exp_f32 v35, v35
    v_exp_f32 v36, v36
    v_exp_f32 v37, v37
    v_mfma_f32_32x32x16_bf16 v[16:31], a[0:3], a[16:19], v[48:63]
    buffer_load_dwordx4 a[152:155], v100, s[64:67], s46 offen offset:2048 sc1
    v_exp_f32 v38, v38
    v_exp_f32 v39, v39
    v_cvt_pk_bf16_f32 v88, v32, v33
    v_cvt_pk_bf16_f32 v89, v34, v35
    v_mfma_f32_32x32x16_bf16 v[16:31], a[4:7], a[20:23], v[16:31]
    v_exp_f32 v40, v40
    v_exp_f32 v41, v41
    v_cvt_pk_bf16_f32 v90, v36, v37
    v_cvt_pk_bf16_f32 v91, v38, v39
    v_mfma_f32_16x16x32_bf16 a[64:67], v[96:99], v[80:83], a[64:67]
    v_exp_f32 v42, v42
    v_exp_f32 v43, v43
    v_mfma_f32_16x16x32_bf16 a[64:67], v[96:99], v[84:87], a[64:67]
    v_exp_f32 v44, v44
    v_exp_f32 v45, v45
    v_cvt_pk_bf16_f32 v92, v40, v41
    v_exp_f32 v46, v46
    v_exp_f32 v47, v47
    v_cvt_pk_bf16_f32 v93, v42, v43
    v_cvt_pk_bf16_f32 v94, v44, v45
    v_cvt_pk_bf16_f32 v95, v46, v47
    v_mfma_f32_32x32x16_bf16 a[48:63], a[8:11], v[88:91], a[48:63]
    buffer_load_dwordx4 a[156:159], v100, s[64:67], s46 offen offset:2304 sc1
    s_add_u32 s44, s44, 8192
    s_add_u32 s46, s46, 8192
    v_exp_f32 v16, v16
    v_exp_f32 v17, v17
    v_exp_f32 v18, v18
    v_mfma_f32_32x32x16_bf16 a[48:63], a[12:15], v[92:95], a[48:63]
    v_exp_f32 v19, v19
    ds_read_b128 a[8:11], v4 offset:22528
    ds_read_b128 a[12:15], v4 offset:23552
    v_exp_f32 v20, v20
    v_exp_f32 v21, v21
    v_mfma_f32_32x32x16_bf16 v[32:47], a[0:3], a[24:27], v[64:79]
    s_add_u32 m0, s53, 98304
    s_nop 0
    buffer_load_dwordx4 v102, s[68:71], s48 offen lds
    v_exp_f32 v22, v22
    v_exp_f32 v23, v23
    v_cvt_pk_bf16_f32 v80, v16, v17
    v_cvt_pk_bf16_f32 v81, v18, v19
    v_mfma_f32_32x32x16_bf16 v[32:47], a[4:7], a[28:31], v[32:47]
    v_exp_f32 v24, v24
    ds_read_b128 a[0:3], v4 offset:8192
    ds_read_b128 a[4:7], v4 offset:9216
    v_exp_f32 v25, v25
    v_cvt_pk_bf16_f32 v82, v20, v21
    v_cvt_pk_bf16_f32 v83, v22, v23
    v_mfma_f32_16x16x32_bf16 a[68:71], v[96:99], v[88:91], a[68:71]
    s_add_u32 m0, s53, 99328
    s_nop 0
    buffer_load_dwordx4 v103, s[68:71], s48 offen lds
    s_add_u32 s48, s48, 65536
    v_exp_f32 v26, v26
    v_exp_f32 v27, v27
    v_mfma_f32_16x16x32_bf16 a[68:71], v[96:99], v[92:95], a[68:71]
    v_exp_f32 v28, v28
    v_exp_f32 v29, v29
    v_cvt_pk_bf16_f32 v84, v24, v25
    v_exp_f32 v30, v30
    v_exp_f32 v31, v31
    v_cvt_pk_bf16_f32 v85, v26, v27
    v_cvt_pk_bf16_f32 v86, v28, v29
    v_cvt_pk_bf16_f32 v87, v30, v31
    s_waitcnt lgkmcnt(0)
    v_mfma_f32_32x32x16_bf16 a[32:47], a[8:11], v[80:83], a[32:47]
    s_add_u32 m0, s53, 106496
    s_nop 0
    buffer_load_dwordx4 v102, s[68:71], s48 offen lds
    v_exp_f32 v32, v32
    v_exp_f32 v33, v33
    v_exp_f32 v34, v34
    v_mfma_f32_32x32x16_bf16 a[32:47], a[12:15], v[84:87], a[32:47]
    v_exp_f32 v35, v35
    v_exp_f32 v36, v36
    v_exp_f32 v37, v37
    v_mfma_f32_32x32x16_bf16 v[16:31], a[0:3], a[16:19], v[48:63]
    s_add_u32 m0, s53, 107520
    s_nop 0
    buffer_load_dwordx4 v103, s[68:71], s48 offen lds
    s_add_u32 s48, s48, 65536
    v_exp_f32 v38, v38
    v_exp_f32 v39, v39
    v_cvt_pk_bf16_f32 v88, v32, v33
    v_cvt_pk_bf16_f32 v89, v34, v35
    v_mfma_f32_32x32x16_bf16 v[16:31], a[4:7], a[20:23], v[16:31]
    v_exp_f32 v40, v40
    v_exp_f32 v41, v41
    v_cvt_pk_bf16_f32 v90, v36, v37
    v_cvt_pk_bf16_f32 v91, v38, v39
    v_mfma_f32_16x16x32_bf16 a[64:67], v[96:99], v[80:83], a[64:67]
    v_exp_f32 v42, v42
    v_exp_f32 v43, v43
    v_mfma_f32_16x16x32_bf16 a[64:67], v[96:99], v[84:87], a[64:67]
    v_exp_f32 v44, v44
    v_exp_f32 v45, v45
    v_cvt_pk_bf16_f32 v92, v40, v41
    v_exp_f32 v46, v46
    v_exp_f32 v47, v47
    v_cvt_pk_bf16_f32 v93, v42, v43
    v_cvt_pk_bf16_f32 v94, v44, v45
    v_cvt_pk_bf16_f32 v95, v46, v47
    v_mfma_f32_32x32x16_bf16 a[48:63], a[8:11], v[88:91], a[48:63]
    s_add_u32 m0, s53, 114688
    s_nop 0
    buffer_load_dwordx4 v102, s[68:71], s48 offen lds
    v_exp_f32 v16, v16
    v_exp_f32 v17, v17
    v_exp_f32 v18, v18
    v_mfma_f32_32x32x16_bf16 a[48:63], a[12:15], v[92:95], a[48:63]
    v_exp_f32 v19, v19
    ds_read_b128 a[8:11], v4 offset:24576
    ds_read_b128 a[12:15], v4 offset:25600
    v_exp_f32 v20, v20
    v_exp_f32 v21, v21
    v_mfma_f32_32x32x16_bf16 v[32:47], a[0:3], a[24:27], v[64:79]
    s_add_u32 m0, s53, 115712
    s_nop 0
    buffer_load_dwordx4 v103, s[68:71], s48 offen lds
    s_add_u32 s48, s48, 65536
    v_exp_f32 v22, v22
    v_exp_f32 v23, v23
    v_cvt_pk_bf16_f32 v80, v16, v17
    v_cvt_pk_bf16_f32 v81, v18, v19
    v_mfma_f32_32x32x16_bf16 v[32:47], a[4:7], a[28:31], v[32:47]
    v_exp_f32 v24, v24
    ds_read_b128 a[0:3], v4 offset:10240
    ds_read_b128 a[4:7], v4 offset:11264
    v_exp_f32 v25, v25
    v_cvt_pk_bf16_f32 v82, v20, v21
    v_cvt_pk_bf16_f32 v83, v22, v23
    v_mfma_f32_16x16x32_bf16 a[68:71], v[96:99], v[88:91], a[68:71]
    s_add_u32 m0, s53, 122880
    s_nop 0
    buffer_load_dwordx4 v102, s[68:71], s48 offen lds
    v_exp_f32 v26, v26
    v_exp_f32 v27, v27
    v_mfma_f32_16x16x32_bf16 a[68:71], v[96:99], v[92:95], a[68:71]
    v_exp_f32 v28, v28
    v_exp_f32 v29, v29
    v_cvt_pk_bf16_f32 v84, v24, v25
    v_exp_f32 v30, v30
    v_exp_f32 v31, v31
    v_cvt_pk_bf16_f32 v85, v26, v27
    v_cvt_pk_bf16_f32 v86, v28, v29
    v_cvt_pk_bf16_f32 v87, v30, v31
    s_waitcnt lgkmcnt(0)
    v_mfma_f32_32x32x16_bf16 a[32:47], a[8:11], v[80:83], a[32:47]
    s_add_u32 m0, s53, 123904
    s_nop 0
    buffer_load_dwordx4 v103, s[68:71], s48 offen lds
    s_add_u32 s48, s48, 65536
    v_exp_f32 v32, v32
    v_exp_f32 v33, v33
    v_exp_f32 v34, v34
    v_mfma_f32_32x32x16_bf16 a[32:47], a[12:15], v[84:87], a[32:47]
    v_exp_f32 v35, v35
    v_exp_f32 v36, v36
    v_exp_f32 v37, v37
    v_mfma_f32_32x32x16_bf16 v[16:31], a[0:3], a[16:19], v[48:63]
    buffer_load_dwordx4 a[160:163], v100, s[64:67], s44 offen offset:0 sc1
    v_exp_f32 v38, v38
    v_exp_f32 v39, v39
    v_cvt_pk_bf16_f32 v88, v32, v33
    v_cvt_pk_bf16_f32 v89, v34, v35
    v_mfma_f32_32x32x16_bf16 v[16:31], a[4:7], a[20:23], v[16:31]
    v_exp_f32 v40, v40
    v_exp_f32 v41, v41
    v_cvt_pk_bf16_f32 v90, v36, v37
    v_cvt_pk_bf16_f32 v91, v38, v39
    v_mfma_f32_16x16x32_bf16 a[64:67], v[96:99], v[80:83], a[64:67]
    v_exp_f32 v42, v42
    v_exp_f32 v43, v43
    v_mfma_f32_16x16x32_bf16 a[64:67], v[96:99], v[84:87], a[64:67]
    v_exp_f32 v44, v44
    v_exp_f32 v45, v45
    v_cvt_pk_bf16_f32 v92, v40, v41
    v_exp_f32 v46, v46
    v_exp_f32 v47, v47
    v_cvt_pk_bf16_f32 v93, v42, v43
    v_cvt_pk_bf16_f32 v94, v44, v45
    v_cvt_pk_bf16_f32 v95, v46, v47
    v_mfma_f32_32x32x16_bf16 a[48:63], a[8:11], v[88:91], a[48:63]
    buffer_load_dwordx4 a[164:167], v100, s[64:67], s44 offen offset:256 sc1
    v_exp_f32 v16, v16
    v_exp_f32 v17, v17
    v_exp_f32 v18, v18
    v_mfma_f32_32x32x16_bf16 a[48:63], a[12:15], v[92:95], a[48:63]
    v_exp_f32 v19, v19
    ds_read_b128 a[8:11], v4 offset:26624
    ds_read_b128 a[12:15], v4 offset:27648
    v_exp_f32 v20, v20
    v_exp_f32 v21, v21
    v_mfma_f32_32x32x16_bf16 v[32:47], a[0:3], a[24:27], v[64:79]
    buffer_load_dwordx4 a[168:171], v100, s[64:67], s44 offen offset:2048 sc1
    v_exp_f32 v22, v22
    v_exp_f32 v23, v23
    v_cvt_pk_bf16_f32 v80, v16, v17
    v_cvt_pk_bf16_f32 v81, v18, v19
    v_mfma_f32_32x32x16_bf16 v[32:47], a[4:7], a[28:31], v[32:47]
    v_exp_f32 v24, v24
    ds_read_b128 a[0:3], v4 offset:12288
    ds_read_b128 a[4:7], v4 offset:13312
    v_exp_f32 v25, v25
    v_cvt_pk_bf16_f32 v82, v20, v21
    v_cvt_pk_bf16_f32 v83, v22, v23
    v_mfma_f32_16x16x32_bf16 a[68:71], v[96:99], v[88:91], a[68:71]
    buffer_load_dwordx4 a[172:175], v100, s[64:67], s44 offen offset:2304 sc1
    v_exp_f32 v26, v26
    v_exp_f32 v27, v27
    v_mfma_f32_16x16x32_bf16 a[68:71], v[96:99], v[92:95], a[68:71]
    v_exp_f32 v28, v28
    v_exp_f32 v29, v29
    v_cvt_pk_bf16_f32 v84, v24, v25
    v_exp_f32 v30, v30
    v_exp_f32 v31, v31
    v_cvt_pk_bf16_f32 v85, v26, v27
    v_cvt_pk_bf16_f32 v86, v28, v29
    v_cvt_pk_bf16_f32 v87, v30, v31
    s_waitcnt lgkmcnt(0)
    v_mfma_f32_32x32x16_bf16 a[32:47], a[8:11], v[80:83], a[32:47]
    buffer_load_dwordx4 a[176:179], v100, s[64:67], s46 offen offset:0 sc1
    v_exp_f32 v32, v32
    v_exp_f32 v33, v33
    v_exp_f32 v34, v34
    v_mfma_f32_32x32x16_bf16 a[32:47], a[12:15], v[84:87], a[32:47]
    v_exp_f32 v35, v35
    v_exp_f32 v36, v36
    v_exp_f32 v37, v37
    v_mfma_f32_32x32x16_bf16 v[16:31], a[0:3], a[16:19], v[48:63]
    buffer_load_dwordx4 a[180:183], v100, s[64:67], s46 offen offset:256 sc1
    v_exp_f32 v38, v38
    v_exp_f32 v39, v39
    v_cvt_pk_bf16_f32 v88, v32, v33
    v_cvt_pk_bf16_f32 v89, v34, v35
    v_mfma_f32_32x32x16_bf16 v[16:31], a[4:7], a[20:23], v[16:31]
    v_exp_f32 v40, v40
    v_exp_f32 v41, v41
    v_cvt_pk_bf16_f32 v90, v36, v37
    v_cvt_pk_bf16_f32 v91, v38, v39
    v_mfma_f32_16x16x32_bf16 a[64:67], v[96:99], v[80:83], a[64:67]
    v_exp_f32 v42, v42
    v_exp_f32 v43, v43
    v_mfma_f32_16x16x32_bf16 a[64:67], v[96:99], v[84:87], a[64:67]
    v_exp_f32 v44, v44
    v_exp_f32 v45, v45
    v_cvt_pk_bf16_f32 v92, v40, v41
    v_exp_f32 v46, v46
    v_exp_f32 v47, v47
    v_cvt_pk_bf16_f32 v93, v42, v43
    v_cvt_pk_bf16_f32 v94, v44, v45
    v_cvt_pk_bf16_f32 v95, v46, v47
    v_mfma_f32_32x32x16_bf16 a[48:63], a[8:11], v[88:91], a[48:63]
    buffer_load_dwordx4 a[184:187], v100, s[64:67], s46 offen offset:2048 sc1
    v_exp_f32 v16, v16
    v_exp_f32 v17, v17
    v_exp_f32 v18, v18
    v_mfma_f32_32x32x16_bf16 a[48:63], a[12:15], v[92:95], a[48:63]
    v_exp_f32 v19, v19
    ds_read_b128 a[8:11], v4 offset:28672
    ds_read_b128 a[12:15], v4 offset:29696
    v_exp_f32 v20, v20
    v_exp_f32 v21, v21
    v_mfma_f32_32x32x16_bf16 v[32:47], a[0:3], a[24:27], v[64:79]
    buffer_load_dwordx4 a[188:191], v100, s[64:67], s46 offen offset:2304 sc1
    s_add_u32 s44, s44, 8192
    s_add_u32 s46, s46, 8192
    v_exp_f32 v22, v22
    v_exp_f32 v23, v23
    v_cvt_pk_bf16_f32 v80, v16, v17
    v_cvt_pk_bf16_f32 v81, v18, v19
    v_mfma_f32_32x32x16_bf16 v[32:47], a[4:7], a[28:31], v[32:47]
    v_exp_f32 v24, v24
    ds_read_b128 a[0:3], v4 offset:14336
    ds_read_b128 a[4:7], v4 offset:15360
    v_exp_f32 v25, v25
    v_cvt_pk_bf16_f32 v82, v20, v21
    v_cvt_pk_bf16_f32 v83, v22, v23
    v_mfma_f32_16x16x32_bf16 a[68:71], v[96:99], v[88:91], a[68:71]
    s_add_u32 m0, s53, 131072
    s_nop 0
    buffer_load_dwordx4 v102, s[68:71], s48 offen lds
    v_exp_f32 v26, v26
    v_exp_f32 v27, v27
    v_mfma_f32_16x16x32_bf16 a[68:71], v[96:99], v[92:95], a[68:71]
    v_exp_f32 v28, v28
    v_exp_f32 v29, v29
    v_cvt_pk_bf16_f32 v84, v24, v25
    v_exp_f32 v30, v30
    v_exp_f32 v31, v31
    v_cvt_pk_bf16_f32 v85, v26, v27
    v_cvt_pk_bf16_f32 v86, v28, v29
    v_cvt_pk_bf16_f32 v87, v30, v31
    s_waitcnt lgkmcnt(0)
    v_mfma_f32_32x32x16_bf16 a[32:47], a[8:11], v[80:83], a[32:47]
    s_add_u32 m0, s53, 132096
    s_nop 0
    buffer_load_dwordx4 v103, s[68:71], s48 offen lds
    s_add_u32 s48, s48, 65536
    v_exp_f32 v32, v32
    v_exp_f32 v33, v33
    v_exp_f32 v34, v34
    v_mfma_f32_32x32x16_bf16 a[32:47], a[12:15], v[84:87], a[32:47]
    v_exp_f32 v35, v35
    v_exp_f32 v36, v36
    v_exp_f32 v37, v37
    v_mfma_f32_32x32x16_bf16 v[16:31], a[0:3], a[16:19], v[48:63]
    s_add_u32 m0, s53, 139264
    s_nop 0
    buffer_load_dwordx4 v102, s[68:71], s48 offen lds
    v_exp_f32 v38, v38
    v_exp_f32 v39, v39
    v_cvt_pk_bf16_f32 v88, v32, v33
    v_cvt_pk_bf16_f32 v89, v34, v35
    v_mfma_f32_32x32x16_bf16 v[16:31], a[4:7], a[20:23], v[16:31]
    v_exp_f32 v40, v40
    v_exp_f32 v41, v41
    v_cvt_pk_bf16_f32 v90, v36, v37
    v_cvt_pk_bf16_f32 v91, v38, v39
    v_mfma_f32_16x16x32_bf16 a[64:67], v[96:99], v[80:83], a[64:67]
    v_exp_f32 v42, v42
    v_exp_f32 v43, v43
    v_mfma_f32_16x16x32_bf16 a[64:67], v[96:99], v[84:87], a[64:67]
    v_exp_f32 v44, v44
    v_exp_f32 v45, v45
    v_cvt_pk_bf16_f32 v92, v40, v41
    v_exp_f32 v46, v46
    v_exp_f32 v47, v47
    v_cvt_pk_bf16_f32 v93, v42, v43
    v_cvt_pk_bf16_f32 v94, v44, v45
    v_cvt_pk_bf16_f32 v95, v46, v47
    v_mfma_f32_32x32x16_bf16 a[48:63], a[8:11], v[88:91], a[48:63]
    s_add_u32 m0, s53, 140288
    s_nop 0
    buffer_load_dwordx4 v103, s[68:71], s48 offen lds
    s_add_u32 s48, s48, 65536
    v_exp_f32 v16, v16
    v_exp_f32 v17, v17
    v_exp_f32 v18, v18
    v_mfma_f32_32x32x16_bf16 a[48:63], a[12:15], v[92:95], a[48:63]
    v_exp_f32 v19, v19
    ds_read_b128 a[8:11], v4 offset:30720
    ds_read_b128 a[12:15], v4 offset:31744
    v_exp_f32 v20, v20
    v_exp_f32 v21, v21
    v_mfma_f32_32x32x16_bf16 v[32:47], a[0:3], a[24:27], v[64:79]
    s_add_u32 m0, s53, 147456
    s_nop 0
    buffer_load_dwordx4 v102, s[68:71], s48 offen lds
    v_exp_f32 v22, v22
    v_exp_f32 v23, v23
    v_cvt_pk_bf16_f32 v80, v16, v17
    v_cvt_pk_bf16_f32 v81, v18, v19
    v_mfma_f32_32x32x16_bf16 v[32:47], a[4:7], a[28:31], v[32:47]
    v_exp_f32 v24, v24
    ds_read_b128 a[0:3], v5 offset:0
    ds_read_b128 a[4:7], v5 offset:1024
    v_exp_f32 v25, v25
    v_cvt_pk_bf16_f32 v82, v20, v21
    v_cvt_pk_bf16_f32 v83, v22, v23
    v_mfma_f32_16x16x32_bf16 a[68:71], v[96:99], v[88:91], a[68:71]
    s_add_u32 m0, s53, 148480
    s_nop 0
    buffer_load_dwordx4 v103, s[68:71], s48 offen lds
    s_add_u32 s48, s48, 65536
    v_exp_f32 v26, v26
    v_exp_f32 v27, v27
    v_mfma_f32_16x16x32_bf16 a[68:71], v[96:99], v[92:95], a[68:71]
    v_exp_f32 v28, v28
    v_exp_f32 v29, v29
    v_cvt_pk_bf16_f32 v84, v24, v25
    v_exp_f32 v30, v30
    v_exp_f32 v31, v31
    v_cvt_pk_bf16_f32 v85, v26, v27
    v_cvt_pk_bf16_f32 v86, v28, v29
    v_cvt_pk_bf16_f32 v87, v30, v31
    s_waitcnt lgkmcnt(0)
    v_mfma_f32_32x32x16_bf16 a[32:47], a[8:11], v[80:83], a[32:47]
    s_add_u32 m0, s53, 155648
    s_nop 0
    buffer_load_dwordx4 v102, s[68:71], s48 offen lds
    v_exp_f32 v32, v32
    v_exp_f32 v33, v33
    v_exp_f32 v34, v34
    v_mfma_f32_32x32x16_bf16 a[32:47], a[12:15], v[84:87], a[32:47]
    v_exp_f32 v35, v35
    v_exp_f32 v36, v36
    v_exp_f32 v37, v37
    v_mfma_f32_32x32x16_bf16 v[16:31], a[0:3], a[16:19], v[48:63]
    s_add_u32 m0, s53, 156672
    s_nop 0
    buffer_load_dwordx4 v103, s[68:71], s48 offen lds
    s_add_u32 s48, s48, 65536
    v_exp_f32 v38, v38
    v_exp_f32 v39, v39
    v_cvt_pk_bf16_f32 v88, v32, v33
    v_cvt_pk_bf16_f32 v89, v34, v35
    v_mfma_f32_32x32x16_bf16 v[16:31], a[4:7], a[20:23], v[16:31]
    v_exp_f32 v40, v40
    v_exp_f32 v41, v41
    v_cvt_pk_bf16_f32 v90, v36, v37
    v_cvt_pk_bf16_f32 v91, v38, v39
    v_mfma_f32_16x16x32_bf16 a[64:67], v[96:99], v[80:83], a[64:67]
    v_exp_f32 v42, v42
    v_exp_f32 v43, v43
    v_mfma_f32_16x16x32_bf16 a[64:67], v[96:99], v[84:87], a[64:67]
    v_exp_f32 v44, v44
    v_exp_f32 v45, v45
    v_cvt_pk_bf16_f32 v92, v40, v41
    v_exp_f32 v46, v46
    v_exp_f32 v47, v47
    v_cvt_pk_bf16_f32 v93, v42, v43
    v_cvt_pk_bf16_f32 v94, v44, v45
    v_cvt_pk_bf16_f32 v95, v46, v47
    s_nop 0
    v_mfma_f32_32x32x16_bf16 a[48:63], a[8:11], v[88:91], a[48:63]
    v_mfma_f32_32x32x16_bf16 a[48:63], a[12:15], v[92:95], a[48:63]
    v_mfma_f32_16x16x32_bf16 a[68:71], v[96:99], v[88:91], a[68:71]
    v_mfma_f32_16x16x32_bf16 a[68:71], v[96:99], v[92:95], a[68:71]
    s_add_u32 s20, s28, 33554432
    s_addc_u32 s21, s29, 0
    s_mov_b32 s22, 4194304
    s_mov_b32 s23, 0x00020000
    s_nop 15
    v_accvgpr_read_b32 v6, a64
    v_accvgpr_read_b32 v7, a68
    s_mov_b32 s38, 0x5d800000
    s_nop 0
    v_cmp_ngt_f32 vcc, s38, v6
    v_cmp_ngt_f32 s[36:37], s38, v7
    s_nop 1
    s_or_b64 vcc, vcc, s[36:37]
    s_cmp_eq_u64 vcc, 0
    s_cbranch_scc1 parallel_sum__softmax_full_mha__dense_activation_silu__prompt_kernel_attfast
    s_mov_b32 s10, 131072
    s_mov_b32 s14, 131072
    v_mov_b32 v6, 0xff800000
    v_mov_b32 v7, 0xff800000
    s_mov_b32 s38, 0
parallel_sum__softmax_full_mha__dense_activation_silu__prompt_kernel_slow1:
    buffer_load_dwordx4 a[0:3], v8, s[8:11], s38 offen sc1
    buffer_load_dwordx4 a[4:7], v8, s[8:11], s38 offen offset:1024 sc1
    s_waitcnt vmcnt(0)
    v_mfma_f32_32x32x16_bf16 v[16:31], a[0:3], a[16:19], 0
    v_mfma_f32_32x32x16_bf16 v[16:31], a[4:7], a[20:23], v[16:31]
    v_mfma_f32_32x32x16_bf16 v[32:47], a[0:3], a[24:27], 0
    v_mfma_f32_32x32x16_bf16 v[32:47], a[4:7], a[28:31], v[32:47]
    s_nop 15
    v_max3_f32 v6, v6, v16, v17
    v_max3_f32 v6, v6, v18, v19
    v_max3_f32 v6, v6, v20, v21
    v_max3_f32 v6, v6, v22, v23
    v_max3_f32 v6, v6, v24, v25
    v_max3_f32 v6, v6, v26, v27
    v_max3_f32 v6, v6, v28, v29
    v_max3_f32 v6, v6, v30, v31
    v_max3_f32 v7, v7, v32, v33
    v_max3_f32 v7, v7, v34, v35
    v_max3_f32 v7, v7, v36, v37
    v_max3_f32 v7, v7, v38, v39
    v_max3_f32 v7, v7, v40, v41
    v_max3_f32 v7, v7, v42, v43
    v_max3_f32 v7, v7, v44, v45
    v_max3_f32 v7, v7, v46, v47
    s_add_u32 s38, s38, 2048
    s_cmp_lt_u32 s38, 131072
    s_cbranch_scc1 parallel_sum__softmax_full_mha__dense_activation_silu__prompt_kernel_slow1
    v_mov_b32 v10, v6
    s_nop 1
    v_permlane32_swap_b32 v6, v10
    s_nop 1
    v_max_f32 v6, v6, v10
    v_xor_b32 v6, 0x80000000, v6
    v_mov_b32 v48, v6
    v_mov_b32 v49, v6
    v_mov_b32 v50, v6
    v_mov_b32 v51, v6
    v_mov_b32 v52, v6
    v_mov_b32 v53, v6
    v_mov_b32 v54, v6
    v_mov_b32 v55, v6
    v_mov_b32 v56, v6
    v_mov_b32 v57, v6
    v_mov_b32 v58, v6
    v_mov_b32 v59, v6
    v_mov_b32 v60, v6
    v_mov_b32 v61, v6
    v_mov_b32 v62, v6
    v_mov_b32 v63, v6
    v_mov_b32 v10, v7
    s_nop 1
    v_permlane32_swap_b32 v7, v10
    s_nop 1
    v_max_f32 v7, v7, v10
    v_xor_b32 v7, 0x80000000, v7
    v_mov_b32 v64, v7
    v_mov_b32 v65, v7
    v_mov_b32 v66, v7
    v_mov_b32 v67, v7
    v_mov_b32 v68, v7
    v_mov_b32 v69, v7
    v_mov_b32 v70, v7
    v_mov_b32 v71, v7
    v_mov_b32 v72, v7
    v_mov_b32 v73, v7
    v_mov_b32 v74, v7
    v_mov_b32 v75, v7
    v_mov_b32 v76, v7
    v_mov_b32 v77, v7
    v_mov_b32 v78, v7
    v_mov_b32 v79, v7
    v_accvgpr_write_b32 a32, 0
    v_accvgpr_write_b32 a33, 0
    v_accvgpr_write_b32 a34, 0
    v_accvgpr_write_b32 a35, 0
    v_accvgpr_write_b32 a36, 0
    v_accvgpr_write_b32 a37, 0
    v_accvgpr_write_b32 a38, 0
    v_accvgpr_write_b32 a39, 0
    v_accvgpr_write_b32 a40, 0
    v_accvgpr_write_b32 a41, 0
    v_accvgpr_write_b32 a42, 0
    v_accvgpr_write_b32 a43, 0
    v_accvgpr_write_b32 a44, 0
    v_accvgpr_write_b32 a45, 0
    v_accvgpr_write_b32 a46, 0
    v_accvgpr_write_b32 a47, 0
    v_accvgpr_write_b32 a48, 0
    v_accvgpr_write_b32 a49, 0
    v_accvgpr_write_b32 a50, 0
    v_accvgpr_write_b32 a51, 0
    v_accvgpr_write_b32 a52, 0
    v_accvgpr_write_b32 a53, 0
    v_accvgpr_write_b32 a54, 0
    v_accvgpr_write_b32 a55, 0
    v_accvgpr_write_b32 a56, 0
    v_accvgpr_write_b32 a57, 0
    v_accvgpr_write_b32 a58, 0
    v_accvgpr_write_b32 a59, 0
    v_accvgpr_write_b32 a60, 0
    v_accvgpr_write_b32 a61, 0
    v_accvgpr_write_b32 a62, 0
    v_accvgpr_write_b32 a63, 0
    v_accvgpr_write_b32 a64, 0
    v_accvgpr_write_b32 a65, 0
    v_accvgpr_write_b32 a66, 0
    v_accvgpr_write_b32 a67, 0
    v_accvgpr_write_b32 a68, 0
    v_accvgpr_write_b32 a69, 0
    v_accvgpr_write_b32 a70, 0
    v_accvgpr_write_b32 a71, 0
    s_mov_b32 s38, 0
parallel_sum__softmax_full_mha__dense_activation_silu__prompt_kernel_slow2:
    buffer_load_dwordx4 a[0:3], v8, s[8:11], s38 offen sc1
    buffer_load_dwordx4 a[4:7], v8, s[8:11], s38 offen offset:1024 sc1
    buffer_load_dwordx4 a[8:11], v8, s[12:15], s38 offen sc1
    buffer_load_dwordx4 a[12:15], v8, s[12:15], s38 offen offset:1024 sc1
    s_waitcnt vmcnt(0)
    v_mfma_f32_32x32x16_bf16 v[16:31], a[0:3], a[16:19], v[48:63]
    v_mfma_f32_32x32x16_bf16 v[16:31], a[4:7], a[20:23], v[16:31]
    v_mfma_f32_32x32x16_bf16 v[32:47], a[0:3], a[24:27], v[64:79]
    v_mfma_f32_32x32x16_bf16 v[32:47], a[4:7], a[28:31], v[32:47]
    s_nop 15
    v_exp_f32 v16, v16
    v_exp_f32 v17, v17
    v_exp_f32 v18, v18
    v_exp_f32 v19, v19
    v_exp_f32 v20, v20
    v_exp_f32 v21, v21
    v_exp_f32 v22, v22
    v_exp_f32 v23, v23
    v_exp_f32 v24, v24
    v_exp_f32 v25, v25
    v_exp_f32 v26, v26
    v_exp_f32 v27, v27
    v_exp_f32 v28, v28
    v_exp_f32 v29, v29
    v_exp_f32 v30, v30
    v_exp_f32 v31, v31
    s_nop 0
    v_cvt_pk_bf16_f32 v80, v16, v17
    v_cvt_pk_bf16_f32 v81, v18, v19
    v_cvt_pk_bf16_f32 v82, v20, v21
    v_cvt_pk_bf16_f32 v83, v22, v23
    v_cvt_pk_bf16_f32 v84, v24, v25
    v_cvt_pk_bf16_f32 v85, v26, v27
    v_cvt_pk_bf16_f32 v86, v28, v29
    v_cvt_pk_bf16_f32 v87, v30, v31
    v_exp_f32 v32, v32
    v_exp_f32 v33, v33
    v_exp_f32 v34, v34
    v_exp_f32 v35, v35
    v_exp_f32 v36, v36
    v_exp_f32 v37, v37
    v_exp_f32 v38, v38
    v_exp_f32 v39, v39
    v_exp_f32 v40, v40
    v_exp_f32 v41, v41
    v_exp_f32 v42, v42
    v_exp_f32 v43, v43
    v_exp_f32 v44, v44
    v_exp_f32 v45, v45
    v_exp_f32 v46, v46
    v_exp_f32 v47, v47
    s_nop 0
    v_cvt_pk_bf16_f32 v88, v32, v33
    v_cvt_pk_bf16_f32 v89, v34, v35
    v_cvt_pk_bf16_f32 v90, v36, v37
    v_cvt_pk_bf16_f32 v91, v38, v39
    v_cvt_pk_bf16_f32 v92, v40, v41
    v_cvt_pk_bf16_f32 v93, v42, v43
    v_cvt_pk_bf16_f32 v94, v44, v45
    v_cvt_pk_bf16_f32 v95, v46, v47
    s_nop 1
    v_mfma_f32_32x32x16_bf16 a[32:47], a[8:11], v[80:83], a[32:47]
    v_mfma_f32_32x32x16_bf16 a[32:47], a[12:15], v[84:87], a[32:47]
    v_mfma_f32_16x16x32_bf16 a[64:67], v[96:99], v[80:83], a[64:67]
    v_mfma_f32_16x16x32_bf16 a[64:67], v[96:99], v[84:87], a[64:67]
    v_mfma_f32_32x32x16_bf16 a[48:63], a[8:11], v[88:91], a[48:63]
    v_mfma_f32_32x32x16_bf16 a[48:63], a[12:15], v[92:95], a[48:63]
    v_mfma_f32_16x16x32_bf16 a[68:71], v[96:99], v[88:91], a[68:71]
    v_mfma_f32_16x16x32_bf16 a[68:71], v[96:99], v[92:95], a[68:71]
    s_add_u32 s38, s38, 2048
    s_cmp_lt_u32 s38, 131072
    s_cbranch_scc1 parallel_sum__softmax_full_mha__dense_activation_silu__prompt_kernel_slow2
    s_nop 15
parallel_sum__softmax_full_mha__dense_activation_silu__prompt_kernel_attfast:
    s_lshl_b32 s38, s31, 16
    s_lshl_b32 s3, s26, 11
    s_add_u32 s38, s38, s3
    s_add_u32 s39, s38, 65536
    v_accvgpr_read_b32 v6, a64
    s_nop 0
    v_rcp_f32 v7, v6
    v_accvgpr_read_b32 v16, a32
    v_accvgpr_read_b32 v17, a33
    v_accvgpr_read_b32 v18, a34
    v_accvgpr_read_b32 v19, a35
    v_accvgpr_read_b32 v20, a36
    v_accvgpr_read_b32 v21, a37
    v_accvgpr_read_b32 v22, a38
    v_accvgpr_read_b32 v23, a39
    v_accvgpr_read_b32 v24, a40
    v_accvgpr_read_b32 v25, a41
    v_accvgpr_read_b32 v26, a42
    v_accvgpr_read_b32 v27, a43
    v_accvgpr_read_b32 v28, a44
    v_accvgpr_read_b32 v29, a45
    v_accvgpr_read_b32 v30, a46
    v_accvgpr_read_b32 v31, a47
    v_mul_f32 v16, v16, v7
    v_mul_f32 v17, v17, v7
    v_mul_f32 v18, v18, v7
    v_mul_f32 v19, v19, v7
    v_mul_f32 v20, v20, v7
    v_mul_f32 v21, v21, v7
    v_mul_f32 v22, v22, v7
    v_mul_f32 v23, v23, v7
    v_mul_f32 v24, v24, v7
    v_mul_f32 v25, v25, v7
    v_mul_f32 v26, v26, v7
    v_mul_f32 v27, v27, v7
    v_mul_f32 v28, v28, v7
    v_mul_f32 v29, v29, v7
    v_mul_f32 v30, v30, v7
    v_mul_f32 v31, v31, v7
    v_cvt_pk_bf16_f32 v32, v16, v17
    v_cvt_pk_bf16_f32 v33, v18, v19
    v_cvt_pk_bf16_f32 v34, v20, v21
    v_cvt_pk_bf16_f32 v35, v22, v23
    v_cvt_pk_bf16_f32 v36, v24, v25
    v_cvt_pk_bf16_f32 v37, v26, v27
    v_cvt_pk_bf16_f32 v38, v28, v29
    v_cvt_pk_bf16_f32 v39, v30, v31
    buffer_store_dwordx4 v[32:35], v8, s[20:23], s38 offen offset:0 sc0 sc1
    buffer_store_dwordx4 v[36:39], v8, s[20:23], s38 offen offset:1024 sc0 sc1
    v_accvgpr_read_b32 v6, a68
    s_nop 0
    v_rcp_f32 v7, v6
    v_accvgpr_read_b32 v16, a48
    v_accvgpr_read_b32 v17, a49
    v_accvgpr_read_b32 v18, a50
    v_accvgpr_read_b32 v19, a51
    v_accvgpr_read_b32 v20, a52
    v_accvgpr_read_b32 v21, a53
    v_accvgpr_read_b32 v22, a54
    v_accvgpr_read_b32 v23, a55
    v_accvgpr_read_b32 v24, a56
    v_accvgpr_read_b32 v25, a57
    v_accvgpr_read_b32 v26, a58
    v_accvgpr_read_b32 v27, a59
    v_accvgpr_read_b32 v28, a60
    v_accvgpr_read_b32 v29, a61
    v_accvgpr_read_b32 v30, a62
    v_accvgpr_read_b32 v31, a63
    v_mul_f32 v16, v16, v7
    v_mul_f32 v17, v17, v7
    v_mul_f32 v18, v18, v7
    v_mul_f32 v19, v19, v7
    v_mul_f32 v20, v20, v7
    v_mul_f32 v21, v21, v7
    v_mul_f32 v22, v22, v7
    v_mul_f32 v23, v23, v7
    v_mul_f32 v24, v24, v7
    v_mul_f32 v25, v25, v7
    v_mul_f32 v26, v26, v7
    v_mul_f32 v27, v27, v7
    v_mul_f32 v28, v28, v7
    v_mul_f32 v29, v29, v7
    v_mul_f32 v30, v30, v7
    v_mul_f32 v31, v31, v7
    v_cvt_pk_bf16_f32 v40, v16, v17
    v_cvt_pk_bf16_f32 v41, v18, v19
    v_cvt_pk_bf16_f32 v42, v20, v21
    v_cvt_pk_bf16_f32 v43, v22, v23
    v_cvt_pk_bf16_f32 v44, v24, v25
    v_cvt_pk_bf16_f32 v45, v26, v27
    v_cvt_pk_bf16_f32 v46, v28, v29
    v_cvt_pk_bf16_f32 v47, v30, v31
    buffer_store_dwordx4 v[40:43], v8, s[20:23], s39 offen offset:0 sc0 sc1
    buffer_store_dwordx4 v[44:47], v8, s[20:23], s39 offen offset:1024 sc0 sc1
    s_add_u32 s8, s28, 33554432
    s_addc_u32 s9, s29, 0
    s_mov_b32 s10, 4194304
    s_mov_b32 s11, 0x00020000
    s_mov_b32 s12, s6
    s_mov_b32 s13, s7
    s_mov_b32 s14, 2097152
    s_mov_b32 s15, 0x00020000
    s_add_u32 s16, s28, 37748736
    s_addc_u32 s17, s29, 0
    s_mov_b32 s18, 8388608
    s_mov_b32 s19, 0x00020000
    s_lshl_b32 s36, s2, 14
    s_lshl_b32 s3, s24, 12
    s_add_u32 s36, s36, s3
    s_xor_b32 s37, s2, 1
    s_lshl_b32 s60, s37, 7
    s_add_u32 s60, s60, 98304
    s_lshl_b32 s37, s37, 14
    s_add_u32 s37, s37, s3
    s_lshl_b32 s38, s2, 7
    s_add_u32 s55, s38, 65536
    s_add_u32 s38, s38, 98304
    v_and_b32 v10, 31, v0
    s_lshr_b32 s3, s51, 1
    s_lshl_b32 s3, s3, 5
    v_add_u32 v10, s3, v10
    v_lshlrev_b32 v106, 7, v10
    s_mov_b32 s62, 65536
    v_mov_b32 v107, 0
    s_mov_b32 s56, s40
    s_mov_b32 s57, s41
    s_mov_b32 s58, 4194304
    s_mov_b32 s59, 0x00020000
    v_and_b32 v1, 15, v0
    s_lshl_b32 s3, s51, 7
    s_lshl_b32 s30, s24, 5
    s_add_u32 s3, s3, s30
    v_add_u32 v1, s3, v1
    v_lshlrev_b32 v1, 11, v1
    v_bfe_u32 v2, v0, 4, 1
    v_bfe_u32 v3, v0, 5, 1
    v_lshl_add_u32 v1, v2, 5, v1
    v_lshl_add_u32 v1, v3, 4, v1
    v_add_u32 v1, s52, v1
    s_mov_b32 s63, 32768
    s_waitcnt vmcnt(20)
    s_barrier
    ds_read_b64_tr_b16 a[72:73], v108 offset:32768
    ds_read_b64_tr_b16 a[74:75], v108 offset:36864
    ds_read_b64_tr_b16 a[76:77], v109 offset:32768
    ds_read_b64_tr_b16 a[78:79], v109 offset:36864
    ds_read_b64_tr_b16 a[80:81], v110 offset:32768
    ds_read_b64_tr_b16 a[82:83], v110 offset:36864
    ds_read_b64_tr_b16 a[84:85], v111 offset:32768
    ds_read_b64_tr_b16 a[86:87], v111 offset:36864
    ds_read_b64_tr_b16 a[88:89], v112 offset:32768
    ds_read_b64_tr_b16 a[90:91], v112 offset:36864
    ds_read_b64_tr_b16 a[92:93], v113 offset:32768
    ds_read_b64_tr_b16 a[94:95], v113 offset:36864
    ds_read_b64_tr_b16 a[96:97], v114 offset:32768
    ds_read_b64_tr_b16 a[98:99], v114 offset:36864
    ds_read_b64_tr_b16 a[100:101], v115 offset:32768
    ds_read_b64_tr_b16 a[102:103], v115 offset:36864
    s_waitcnt lgkmcnt(0)
    s_waitcnt lgkmcnt(8)
    v_mfma_f32_16x16x32_bf16 v[136:139], a[72:75], a[128:131], 0
    buffer_load_dwordx4 a[192:195], v100, s[64:67], s44 offen offset:0 sc1
    v_mfma_f32_16x16x32_bf16 v[140:143], a[72:75], a[132:135], 0
    ds_read_b64_tr_b16 a[72:73], v108 offset:40960
    v_mfma_f32_16x16x32_bf16 v[144:147], a[76:79], a[128:131], 0
    ds_read_b64_tr_b16 a[74:75], v108 offset:45056
    v_mfma_f32_16x16x32_bf16 v[148:151], a[76:79], a[132:135], 0
    ds_read_b64_tr_b16 a[76:77], v109 offset:40960
    v_mfma_f32_16x16x32_bf16 v[152:155], a[80:83], a[128:131], 0
    ds_read_b64_tr_b16 a[78:79], v109 offset:45056
    buffer_load_dwordx4 a[196:199], v100, s[64:67], s44 offen offset:256 sc1
    v_mfma_f32_16x16x32_bf16 v[156:159], a[80:83], a[132:135], 0
    ds_read_b64_tr_b16 a[80:81], v110 offset:40960
    v_mfma_f32_16x16x32_bf16 v[160:163], a[84:87], a[128:131], 0
    ds_read_b64_tr_b16 a[82:83], v110 offset:45056
    v_mfma_f32_16x16x32_bf16 v[164:167], a[84:87], a[132:135], 0
    ds_read_b64_tr_b16 a[84:85], v111 offset:40960
    s_waitcnt lgkmcnt(7)
    v_mfma_f32_16x16x32_bf16 v[168:171], a[88:91], a[128:131], 0
    ds_read_b64_tr_b16 a[86:87], v111 offset:45056
    buffer_load_dwordx4 a[200:203], v100, s[64:67], s44 offen offset:2048 sc1
    v_mfma_f32_16x16x32_bf16 v[172:175], a[88:91], a[132:135], 0
    ds_read_b64_tr_b16 a[88:89], v112 offset:40960
    v_mfma_f32_16x16x32_bf16 v[176:179], a[92:95], a[128:131], 0
    ds_read_b64_tr_b16 a[90:91], v112 offset:45056
    v_mfma_f32_16x16x32_bf16 v[180:183], a[92:95], a[132:135], 0
    ds_read_b64_tr_b16 a[92:93], v113 offset:40960
    v_mfma_f32_16x16x32_bf16 v[184:187], a[96:99], a[128:131], 0
    ds_read_b64_tr_b16 a[94:95], v113 offset:45056
    buffer_load_dwordx4 a[204:207], v100, s[64:67], s44 offen offset:2304 sc1
    v_mfma_f32_16x16x32_bf16 v[188:191], a[96:99], a[132:135], 0
    ds_read_b64_tr_b16 a[96:97], v114 offset:40960
    v_mfma_f32_16x16x32_bf16 v[192:195], a[100:103], a[128:131], 0
    ds_read_b64_tr_b16 a[98:99], v114 offset:45056
    v_mfma_f32_16x16x32_bf16 v[196:199], a[100:103], a[132:135], 0
    ds_read_b64_tr_b16 a[100:101], v115 offset:40960
    ds_read_b64_tr_b16 a[102:103], v115 offset:45056
    s_waitcnt lgkmcnt(8)
    v_mfma_f32_16x16x32_bf16 v[136:139], a[72:75], a[136:139], v[136:139]
    buffer_load_dwordx4 a[208:211], v100, s[64:67], s46 offen offset:0 sc1
    v_mfma_f32_16x16x32_bf16 v[140:143], a[72:75], a[140:143], v[140:143]
    ds_read_b64_tr_b16 a[72:73], v108 offset:49152
    v_mfma_f32_16x16x32_bf16 v[144:147], a[76:79], a[136:139], v[144:147]
    ds_read_b64_tr_b16 a[74:75], v108 offset:53248
    buffer_load_dwordx4 a[212:215], v100, s[64:67], s46 offen offset:256 sc1
    v_mfma_f32_16x16x32_bf16 v[148:151], a[76:79], a[140:143], v[148:151]
    ds_read_b64_tr_b16 a[76:77], v109 offset:49152
    v_mfma_f32_16x16x32_bf16 v[152:155], a[80:83], a[136:139], v[152:155]
    ds_read_b64_tr_b16 a[78:79], v109 offset:53248
    v_mfma_f32_16x16x32_bf16 v[156:159], a[80:83], a[140:143], v[156:159]
    ds_read_b64_tr_b16 a[80:81], v110 offset:49152
    buffer_load_dwordx4 a[216:219], v100, s[64:67], s46 offen offset:2048 sc1
    v_mfma_f32_16x16x32_bf16 v[160:163], a[84:87], a[136:139], v[160:163]
    ds_read_b64_tr_b16 a[82:83], v110 offset:53248
    v_mfma_f32_16x16x32_bf16 v[164:167], a[84:87], a[140:143], v[164:167]
    ds_read_b64_tr_b16 a[84:85], v111 offset:49152
    s_waitcnt lgkmcnt(7)
    v_mfma_f32_16x16x32_bf16 v[168:171], a[88:91], a[136:139], v[168:171]
    ds_read_b64_tr_b16 a[86:87], v111 offset:53248
    buffer_load_dwordx4 a[220:223], v100, s[64:67], s46 offen offset:2304 sc1
    v_mfma_f32_16x16x32_bf16 v[172:175], a[88:91], a[140:143], v[172:175]
    ds_read_b64_tr_b16 a[88:89], v112 offset:49152
    v_mfma_f32_16x16x32_bf16 v[176:179], a[92:95], a[136:139], v[176:179]
    ds_read_b64_tr_b16 a[90:91], v112 offset:53248
    s_add_u32 s44, s44, 8192
    v_mfma_f32_16x16x32_bf16 v[180:183], a[92:95], a[140:143], v[180:183]
    ds_read_b64_tr_b16 a[92:93], v113 offset:49152
    v_mfma_f32_16x16x32_bf16 v[184:187], a[96:99], a[136:139], v[184:187]
    ds_read_b64_tr_b16 a[94:95], v113 offset:53248
    v_mfma_f32_16x16x32_bf16 v[188:191], a[96:99], a[140:143], v[188:191]
    ds_read_b64_tr_b16 a[96:97], v114 offset:49152
    s_add_u32 s46, s46, 8192
    v_mfma_f32_16x16x32_bf16 v[192:195], a[100:103], a[136:139], v[192:195]
    ds_read_b64_tr_b16 a[98:99], v114 offset:53248
    v_mfma_f32_16x16x32_bf16 v[196:199], a[100:103], a[140:143], v[196:199]
    ds_read_b64_tr_b16 a[100:101], v115 offset:49152
    ds_read_b64_tr_b16 a[102:103], v115 offset:53248
    s_waitcnt lgkmcnt(8)
    v_mfma_f32_16x16x32_bf16 v[136:139], a[72:75], a[144:147], v[136:139]
    s_add_u32 m0, s53, 32768
    v_mfma_f32_16x16x32_bf16 v[140:143], a[72:75], a[148:151], v[140:143]
    ds_read_b64_tr_b16 a[72:73], v108 offset:57344
    buffer_load_dwordx4 v102, s[68:71], s48 offen lds
    v_mfma_f32_16x16x32_bf16 v[144:147], a[76:79], a[144:147], v[144:147]
    ds_read_b64_tr_b16 a[74:75], v108 offset:61440
    v_mfma_f32_16x16x32_bf16 v[148:151], a[76:79], a[148:151], v[148:151]
    ds_read_b64_tr_b16 a[76:77], v109 offset:57344
    s_add_u32 m0, s53, 33792
    v_mfma_f32_16x16x32_bf16 v[152:155], a[80:83], a[144:147], v[152:155]
    ds_read_b64_tr_b16 a[78:79], v109 offset:61440
    buffer_load_dwordx4 v103, s[68:71], s48 offen lds
    v_mfma_f32_16x16x32_bf16 v[156:159], a[80:83], a[148:151], v[156:159]
    ds_read_b64_tr_b16 a[80:81], v110 offset:57344
    v_mfma_f32_16x16x32_bf16 v[160:163], a[84:87], a[144:147], v[160:163]
    ds_read_b64_tr_b16 a[82:83], v110 offset:61440
    s_add_u32 s48, s48, 65536
    v_mfma_f32_16x16x32_bf16 v[164:167], a[84:87], a[148:151], v[164:167]
    ds_read_b64_tr_b16 a[84:85], v111 offset:57344
    s_waitcnt lgkmcnt(7)
    v_mfma_f32_16x16x32_bf16 v[168:171], a[88:91], a[144:147], v[168:171]
    ds_read_b64_tr_b16 a[86:87], v111 offset:61440
    s_add_u32 m0, s53, 40960
    v_mfma_f32_16x16x32_bf16 v[172:175], a[88:91], a[148:151], v[172:175]
    ds_read_b64_tr_b16 a[88:89], v112 offset:57344
    buffer_load_dwordx4 v102, s[68:71], s48 offen lds
    v_mfma_f32_16x16x32_bf16 v[176:179], a[92:95], a[144:147], v[176:179]
    ds_read_b64_tr_b16 a[90:91], v112 offset:61440
    v_mfma_f32_16x16x32_bf16 v[180:183], a[92:95], a[148:151], v[180:183]
    ds_read_b64_tr_b16 a[92:93], v113 offset:57344
    s_add_u32 m0, s53, 41984
    v_mfma_f32_16x16x32_bf16 v[184:187], a[96:99], a[144:147], v[184:187]
    ds_read_b64_tr_b16 a[94:95], v113 offset:61440
    buffer_load_dwordx4 v103, s[68:71], s48 offen lds
    v_mfma_f32_16x16x32_bf16 v[188:191], a[96:99], a[148:151], v[188:191]
    ds_read_b64_tr_b16 a[96:97], v114 offset:57344
    v_mfma_f32_16x16x32_bf16 v[192:195], a[100:103], a[144:147], v[192:195]
    ds_read_b64_tr_b16 a[98:99], v114 offset:61440
    s_add_u32 s48, s48, 65536
    v_mfma_f32_16x16x32_bf16 v[196:199], a[100:103], a[148:151], v[196:199]
    ds_read_b64_tr_b16 a[100:101], v115 offset:57344
    ds_read_b64_tr_b16 a[102:103], v115 offset:61440
    s_waitcnt lgkmcnt(8)
    v_mfma_f32_16x16x32_bf16 v[136:139], a[72:75], a[152:155], v[136:139]
    s_add_u32 m0, s53, 49152
    v_mfma_f32_16x16x32_bf16 v[140:143], a[72:75], a[156:159], v[140:143]
    ds_read_b64_tr_b16 a[72:73], v116 offset:0
    buffer_load_dwordx4 v102, s[68:71], s48 offen lds
    v_mfma_f32_16x16x32_bf16 v[144:147], a[76:79], a[152:155], v[144:147]
    ds_read_b64_tr_b16 a[74:75], v116 offset:4096
    v_mfma_f32_16x16x32_bf16 v[148:151], a[76:79], a[156:159], v[148:151]
    ds_read_b64_tr_b16 a[76:77], v117 offset:0
    s_add_u32 m0, s53, 50176
    v_mfma_f32_16x16x32_bf16 v[152:155], a[80:83], a[152:155], v[152:155]
    ds_read_b64_tr_b16 a[78:79], v117 offset:4096
    buffer_load_dwordx4 v103, s[68:71], s48 offen lds
    v_mfma_f32_16x16x32_bf16 v[156:159], a[80:83], a[156:159], v[156:159]
    ds_read_b64_tr_b16 a[80:81], v118 offset:0
    v_mfma_f32_16x16x32_bf16 v[160:163], a[84:87], a[152:155], v[160:163]
    ds_read_b64_tr_b16 a[82:83], v118 offset:4096
    s_add_u32 s48, s48, 65536
    v_mfma_f32_16x16x32_bf16 v[164:167], a[84:87], a[156:159], v[164:167]
    ds_read_b64_tr_b16 a[84:85], v119 offset:0
    s_waitcnt lgkmcnt(7)
    v_mfma_f32_16x16x32_bf16 v[168:171], a[88:91], a[152:155], v[168:171]
    ds_read_b64_tr_b16 a[86:87], v119 offset:4096
    s_add_u32 m0, s53, 57344
    v_mfma_f32_16x16x32_bf16 v[172:175], a[88:91], a[156:159], v[172:175]
    ds_read_b64_tr_b16 a[88:89], v120 offset:0
    buffer_load_dwordx4 v102, s[68:71], s48 offen lds
    v_mfma_f32_16x16x32_bf16 v[176:179], a[92:95], a[152:155], v[176:179]
    ds_read_b64_tr_b16 a[90:91], v120 offset:4096
    v_mfma_f32_16x16x32_bf16 v[180:183], a[92:95], a[156:159], v[180:183]
    ds_read_b64_tr_b16 a[92:93], v121 offset:0
    s_add_u32 m0, s53, 58368
    v_mfma_f32_16x16x32_bf16 v[184:187], a[96:99], a[152:155], v[184:187]
    ds_read_b64_tr_b16 a[94:95], v121 offset:4096
    buffer_load_dwordx4 v103, s[68:71], s48 offen lds
    v_mfma_f32_16x16x32_bf16 v[188:191], a[96:99], a[156:159], v[188:191]
    ds_read_b64_tr_b16 a[96:97], v122 offset:0
    v_mfma_f32_16x16x32_bf16 v[192:195], a[100:103], a[152:155], v[192:195]
    ds_read_b64_tr_b16 a[98:99], v122 offset:4096
    s_add_u32 s48, s48, 65536
    v_mfma_f32_16x16x32_bf16 v[196:199], a[100:103], a[156:159], v[196:199]
    ds_read_b64_tr_b16 a[100:101], v123 offset:0
    ds_read_b64_tr_b16 a[102:103], v123 offset:4096
    s_waitcnt vmcnt(20)
    s_barrier
    s_waitcnt lgkmcnt(8)
    v_mfma_f32_16x16x32_bf16 v[136:139], a[72:75], a[160:163], v[136:139]
    buffer_load_dwordx4 a[224:227], v100, s[64:67], s44 offen offset:0 sc1
    v_mfma_f32_16x16x32_bf16 v[140:143], a[72:75], a[164:167], v[140:143]
    ds_read_b64_tr_b16 a[72:73], v116 offset:8192
    v_mfma_f32_16x16x32_bf16 v[144:147], a[76:79], a[160:163], v[144:147]
    ds_read_b64_tr_b16 a[74:75], v116 offset:12288
    v_mfma_f32_16x16x32_bf16 v[148:151], a[76:79], a[164:167], v[148:151]
    ds_read_b64_tr_b16 a[76:77], v117 offset:8192
    v_mfma_f32_16x16x32_bf16 v[152:155], a[80:83], a[160:163], v[152:155]
    ds_read_b64_tr_b16 a[78:79], v117 offset:12288
    buffer_load_dwordx4 a[228:231], v100, s[64:67], s44 offen offset:256 sc1
    v_mfma_f32_16x16x32_bf16 v[156:159], a[80:83], a[164:167], v[156:159]
    ds_read_b64_tr_b16 a[80:81], v118 offset:8192
    v_mfma_f32_16x16x32_bf16 v[160:163], a[84:87], a[160:163], v[160:163]
    ds_read_b64_tr_b16 a[82:83], v118 offset:12288
    v_mfma_f32_16x16x32_bf16 v[164:167], a[84:87], a[164:167], v[164:167]
    ds_read_b64_tr_b16 a[84:85], v119 offset:8192
    s_waitcnt lgkmcnt(7)
    v_mfma_f32_16x16x32_bf16 v[168:171], a[88:91], a[160:163], v[168:171]
    ds_read_b64_tr_b16 a[86:87], v119 offset:12288
    buffer_load_dwordx4 a[232:235], v100, s[64:67], s44 offen offset:2048 sc1
    v_mfma_f32_16x16x32_bf16 v[172:175], a[88:91], a[164:167], v[172:175]
    ds_read_b64_tr_b16 a[88:89], v120 offset:8192
    v_mfma_f32_16x16x32_bf16 v[176:179], a[92:95], a[160:163], v[176:179]
    ds_read_b64_tr_b16 a[90:91], v120 offset:12288
    v_mfma_f32_16x16x32_bf16 v[180:183], a[92:95], a[164:167], v[180:183]
    ds_read_b64_tr_b16 a[92:93], v121 offset:8192
    v_mfma_f32_16x16x32_bf16 v[184:187], a[96:99], a[160:163], v[184:187]
    ds_read_b64_tr_b16 a[94:95], v121 offset:12288
    buffer_load_dwordx4 a[236:239], v100, s[64:67], s44 offen offset:2304 sc1
    v_mfma_f32_16x16x32_bf16 v[188:191], a[96:99], a[164:167], v[188:191]
    ds_read_b64_tr_b16 a[96:97], v122 offset:8192
    v_mfma_f32_16x16x32_bf16 v[192:195], a[100:103], a[160:163], v[192:195]
    ds_read_b64_tr_b16 a[98:99], v122 offset:12288
    v_mfma_f32_16x16x32_bf16 v[196:199], a[100:103], a[164:167], v[196:199]
    ds_read_b64_tr_b16 a[100:101], v123 offset:8192
    ds_read_b64_tr_b16 a[102:103], v123 offset:12288
    s_waitcnt lgkmcnt(8)
    v_mfma_f32_16x16x32_bf16 v[136:139], a[72:75], a[168:171], v[136:139]
    buffer_load_dwordx4 a[240:243], v100, s[64:67], s46 offen offset:0 sc1
    v_mfma_f32_16x16x32_bf16 v[140:143], a[72:75], a[172:175], v[140:143]
    ds_read_b64_tr_b16 a[72:73], v116 offset:16384
    v_mfma_f32_16x16x32_bf16 v[144:147], a[76:79], a[168:171], v[144:147]
    ds_read_b64_tr_b16 a[74:75], v116 offset:20480
    buffer_load_dwordx4 a[244:247], v100, s[64:67], s46 offen offset:256 sc1
    v_mfma_f32_16x16x32_bf16 v[148:151], a[76:79], a[172:175], v[148:151]
    ds_read_b64_tr_b16 a[76:77], v117 offset:16384
    v_mfma_f32_16x16x32_bf16 v[152:155], a[80:83], a[168:171], v[152:155]
    ds_read_b64_tr_b16 a[78:79], v117 offset:20480
    v_mfma_f32_16x16x32_bf16 v[156:159], a[80:83], a[172:175], v[156:159]
    ds_read_b64_tr_b16 a[80:81], v118 offset:16384
    buffer_load_dwordx4 a[248:251], v100, s[64:67], s46 offen offset:2048 sc1
    v_mfma_f32_16x16x32_bf16 v[160:163], a[84:87], a[168:171], v[160:163]
    ds_read_b64_tr_b16 a[82:83], v118 offset:20480
    v_mfma_f32_16x16x32_bf16 v[164:167], a[84:87], a[172:175], v[164:167]
    ds_read_b64_tr_b16 a[84:85], v119 offset:16384
    s_waitcnt lgkmcnt(7)
    v_mfma_f32_16x16x32_bf16 v[168:171], a[88:91], a[168:171], v[168:171]
    ds_read_b64_tr_b16 a[86:87], v119 offset:20480
    buffer_load_dwordx4 a[252:255], v100, s[64:67], s46 offen offset:2304 sc1
    v_mfma_f32_16x16x32_bf16 v[172:175], a[88:91], a[172:175], v[172:175]
    ds_read_b64_tr_b16 a[88:89], v120 offset:16384
    v_mfma_f32_16x16x32_bf16 v[176:179], a[92:95], a[168:171], v[176:179]
    ds_read_b64_tr_b16 a[90:91], v120 offset:20480
    s_add_u32 s44, s44, 8192
    v_mfma_f32_16x16x32_bf16 v[180:183], a[92:95], a[172:175], v[180:183]
    ds_read_b64_tr_b16 a[92:93], v121 offset:16384
    v_mfma_f32_16x16x32_bf16 v[184:187], a[96:99], a[168:171], v[184:187]
    ds_read_b64_tr_b16 a[94:95], v121 offset:20480
    v_mfma_f32_16x16x32_bf16 v[188:191], a[96:99], a[172:175], v[188:191]
    ds_read_b64_tr_b16 a[96:97], v122 offset:16384
    s_add_u32 s46, s46, 8192
    v_mfma_f32_16x16x32_bf16 v[192:195], a[100:103], a[168:171], v[192:195]
    ds_read_b64_tr_b16 a[98:99], v122 offset:20480
    v_mfma_f32_16x16x32_bf16 v[196:199], a[100:103], a[172:175], v[196:199]
    ds_read_b64_tr_b16 a[100:101], v123 offset:16384
    ds_read_b64_tr_b16 a[102:103], v123 offset:20480
    s_waitcnt lgkmcnt(8)
    v_mfma_f32_16x16x32_bf16 v[136:139], a[72:75], a[176:179], v[136:139]
    s_add_u32 m0, s53, 65536
    v_mfma_f32_16x16x32_bf16 v[140:143], a[72:75], a[180:183], v[140:143]
    ds_read_b64_tr_b16 a[72:73], v116 offset:24576
    buffer_load_dwordx4 v102, s[68:71], s48 offen lds
    v_mfma_f32_16x16x32_bf16 v[144:147], a[76:79], a[176:179], v[144:147]
    ds_read_b64_tr_b16 a[74:75], v116 offset:28672
    v_mfma_f32_16x16x32_bf16 v[148:151], a[76:79], a[180:183], v[148:151]
    ds_read_b64_tr_b16 a[76:77], v117 offset:24576
    s_add_u32 m0, s53, 66560
    v_mfma_f32_16x16x32_bf16 v[152:155], a[80:83], a[176:179], v[152:155]
    ds_read_b64_tr_b16 a[78:79], v117 offset:28672
    buffer_load_dwordx4 v103, s[68:71], s48 offen lds
    v_mfma_f32_16x16x32_bf16 v[156:159], a[80:83], a[180:183], v[156:159]
    ds_read_b64_tr_b16 a[80:81], v118 offset:24576
    v_mfma_f32_16x16x32_bf16 v[160:163], a[84:87], a[176:179], v[160:163]
    ds_read_b64_tr_b16 a[82:83], v118 offset:28672
    s_add_u32 s48, s48, 65536
    v_mfma_f32_16x16x32_bf16 v[164:167], a[84:87], a[180:183], v[164:167]
    ds_read_b64_tr_b16 a[84:85], v119 offset:24576
    s_waitcnt lgkmcnt(7)
    v_mfma_f32_16x16x32_bf16 v[168:171], a[88:91], a[176:179], v[168:171]
    ds_read_b64_tr_b16 a[86:87], v119 offset:28672
    s_add_u32 m0, s53, 73728
    v_mfma_f32_16x16x32_bf16 v[172:175], a[88:91], a[180:183], v[172:175]
    ds_read_b64_tr_b16 a[88:89], v120 offset:24576
    buffer_load_dwordx4 v102, s[68:71], s48 offen lds
    v_mfma_f32_16x16x32_bf16 v[176:179], a[92:95], a[176:179], v[176:179]
    ds_read_b64_tr_b16 a[90:91], v120 offset:28672
    v_mfma_f32_16x16x32_bf16 v[180:183], a[92:95], a[180:183], v[180:183]
    ds_read_b64_tr_b16 a[92:93], v121 offset:24576
    s_add_u32 m0, s53, 74752
    v_mfma_f32_16x16x32_bf16 v[184:187], a[96:99], a[176:179], v[184:187]
    ds_read_b64_tr_b16 a[94:95], v121 offset:28672
    buffer_load_dwordx4 v103, s[68:71], s48 offen lds
    v_mfma_f32_16x16x32_bf16 v[188:191], a[96:99], a[180:183], v[188:191]
    ds_read_b64_tr_b16 a[96:97], v122 offset:24576
    v_mfma_f32_16x16x32_bf16 v[192:195], a[100:103], a[176:179], v[192:195]
    ds_read_b64_tr_b16 a[98:99], v122 offset:28672
    s_add_u32 s48, s48, 65536
    v_mfma_f32_16x16x32_bf16 v[196:199], a[100:103], a[180:183], v[196:199]
    ds_read_b64_tr_b16 a[100:101], v123 offset:24576
    ds_read_b64_tr_b16 a[102:103], v123 offset:28672
    s_waitcnt lgkmcnt(8)
    v_mfma_f32_16x16x32_bf16 v[136:139], a[72:75], a[184:187], v[136:139]
    s_add_u32 m0, s53, 81920
    v_mfma_f32_16x16x32_bf16 v[140:143], a[72:75], a[188:191], v[140:143]
    ds_read_b64_tr_b16 a[72:73], v116 offset:32768
    buffer_load_dwordx4 v102, s[68:71], s48 offen lds
    v_mfma_f32_16x16x32_bf16 v[144:147], a[76:79], a[184:187], v[144:147]
    ds_read_b64_tr_b16 a[74:75], v116 offset:36864
    v_mfma_f32_16x16x32_bf16 v[148:151], a[76:79], a[188:191], v[148:151]
    ds_read_b64_tr_b16 a[76:77], v117 offset:32768
    s_add_u32 m0, s53, 82944
    v_mfma_f32_16x16x32_bf16 v[152:155], a[80:83], a[184:187], v[152:155]
    ds_read_b64_tr_b16 a[78:79], v117 offset:36864
    buffer_load_dwordx4 v103, s[68:71], s48 offen lds
    v_mfma_f32_16x16x32_bf16 v[156:159], a[80:83], a[188:191], v[156:159]
    ds_read_b64_tr_b16 a[80:81], v118 offset:32768
    v_mfma_f32_16x16x32_bf16 v[160:163], a[84:87], a[184:187], v[160:163]
    ds_read_b64_tr_b16 a[82:83], v118 offset:36864
    s_add_u32 s48, s48, 65536
    v_mfma_f32_16x16x32_bf16 v[164:167], a[84:87], a[188:191], v[164:167]
    ds_read_b64_tr_b16 a[84:85], v119 offset:32768
    s_waitcnt lgkmcnt(7)
    v_mfma_f32_16x16x32_bf16 v[168:171], a[88:91], a[184:187], v[168:171]
    ds_read_b64_tr_b16 a[86:87], v119 offset:36864
    s_add_u32 m0, s53, 90112
    v_mfma_f32_16x16x32_bf16 v[172:175], a[88:91], a[188:191], v[172:175]
    ds_read_b64_tr_b16 a[88:89], v120 offset:32768
    buffer_load_dwordx4 v102, s[68:71], s48 offen lds
    v_mfma_f32_16x16x32_bf16 v[176:179], a[92:95], a[184:187], v[176:179]
    ds_read_b64_tr_b16 a[90:91], v120 offset:36864
    v_mfma_f32_16x16x32_bf16 v[180:183], a[92:95], a[188:191], v[180:183]
    ds_read_b64_tr_b16 a[92:93], v121 offset:32768
    s_add_u32 m0, s53, 91136
    v_mfma_f32_16x16x32_bf16 v[184:187], a[96:99], a[184:187], v[184:187]
    ds_read_b64_tr_b16 a[94:95], v121 offset:36864
    buffer_load_dwordx4 v103, s[68:71], s48 offen lds
    v_mfma_f32_16x16x32_bf16 v[188:191], a[96:99], a[188:191], v[188:191]
    ds_read_b64_tr_b16 a[96:97], v122 offset:32768
    v_mfma_f32_16x16x32_bf16 v[192:195], a[100:103], a[184:187], v[192:195]
    ds_read_b64_tr_b16 a[98:99], v122 offset:36864
    s_add_u32 s48, s48, 65536
    v_mfma_f32_16x16x32_bf16 v[196:199], a[100:103], a[188:191], v[196:199]
    ds_read_b64_tr_b16 a[100:101], v123 offset:32768
    ds_read_b64_tr_b16 a[102:103], v123 offset:36864
    s_waitcnt vmcnt(16)
    s_barrier
    s_cmp_lg_u32 s24, 0
    s_cbranch_scc1 parallel_sum__softmax_full_mha__dense_activation_silu__prompt_kernel_nf_o
    v_mov_b32 v10, s94
    v_mov_b32 v11, 0
    s_mov_b64 exec, 1
    buffer_store_dword v10, v11, s[32:35], s55 offen sc0 sc1
    s_mov_b64 exec, -1
parallel_sum__softmax_full_mha__dense_activation_silu__prompt_kernel_nf_o:
    s_waitcnt lgkmcnt(8)
    v_mfma_f32_16x16x32_bf16 v[136:139], a[72:75], a[192:195], v[136:139]
    buffer_load_dwordx4 a[128:131], v100, s[64:67], s44 offen offset:0 sc1
    v_mfma_f32_16x16x32_bf16 v[140:143], a[72:75], a[196:199], v[140:143]
    ds_read_b64_tr_b16 a[72:73], v116 offset:40960
    v_mfma_f32_16x16x32_bf16 v[144:147], a[76:79], a[192:195], v[144:147]
    ds_read_b64_tr_b16 a[74:75], v116 offset:45056
    v_mfma_f32_16x16x32_bf16 v[148:151], a[76:79], a[196:199], v[148:151]
    ds_read_b64_tr_b16 a[76:77], v117 offset:40960
    v_mfma_f32_16x16x32_bf16 v[152:155], a[80:83], a[192:195], v[152:155]
    ds_read_b64_tr_b16 a[78:79], v117 offset:45056
    buffer_load_dwordx4 a[132:135], v100, s[64:67], s44 offen offset:256 sc1
    v_mfma_f32_16x16x32_bf16 v[156:159], a[80:83], a[196:199], v[156:159]
    ds_read_b64_tr_b16 a[80:81], v118 offset:40960
    v_mfma_f32_16x16x32_bf16 v[160:163], a[84:87], a[192:195], v[160:163]
    ds_read_b64_tr_b16 a[82:83], v118 offset:45056
    v_mfma_f32_16x16x32_bf16 v[164:167], a[84:87], a[196:199], v[164:167]
    ds_read_b64_tr_b16 a[84:85], v119 offset:40960
    s_waitcnt lgkmcnt(7)
    v_mfma_f32_16x16x32_bf16 v[168:171], a[88:91], a[192:195], v[168:171]
    ds_read_b64_tr_b16 a[86:87], v119 offset:45056
    buffer_load_dwordx4 a[136:139], v100, s[64:67], s44 offen offset:2048 sc1
    v_mfma_f32_16x16x32_bf16 v[172:175], a[88:91], a[196:199], v[172:175]
    ds_read_b64_tr_b16 a[88:89], v120 offset:40960
    v_mfma_f32_16x16x32_bf16 v[176:179], a[92:95], a[192:195], v[176:179]
    ds_read_b64_tr_b16 a[90:91], v120 offset:45056
    v_mfma_f32_16x16x32_bf16 v[180:183], a[92:95], a[196:199], v[180:183]
    ds_read_b64_tr_b16 a[92:93], v121 offset:40960
    v_mfma_f32_16x16x32_bf16 v[184:187], a[96:99], a[192:195], v[184:187]
    ds_read_b64_tr_b16 a[94:95], v121 offset:45056
    buffer_load_dwordx4 a[140:143], v100, s[64:67], s44 offen offset:2304 sc1
    v_mfma_f32_16x16x32_bf16 v[188:191], a[96:99], a[196:199], v[188:191]
    ds_read_b64_tr_b16 a[96:97], v122 offset:40960
    v_mfma_f32_16x16x32_bf16 v[192:195], a[100:103], a[192:195], v[192:195]
    ds_read_b64_tr_b16 a[98:99], v122 offset:45056
    v_mfma_f32_16x16x32_bf16 v[196:199], a[100:103], a[196:199], v[196:199]
    ds_read_b64_tr_b16 a[100:101], v123 offset:40960
    ds_read_b64_tr_b16 a[102:103], v123 offset:45056
    s_waitcnt lgkmcnt(8)
    v_mfma_f32_16x16x32_bf16 v[136:139], a[72:75], a[200:203], v[136:139]
    buffer_load_dwordx4 a[144:147], v100, s[64:67], s46 offen offset:0 sc1
    v_mfma_f32_16x16x32_bf16 v[140:143], a[72:75], a[204:207], v[140:143]
    ds_read_b64_tr_b16 a[72:73], v116 offset:49152
    v_mfma_f32_16x16x32_bf16 v[144:147], a[76:79], a[200:203], v[144:147]
    ds_read_b64_tr_b16 a[74:75], v116 offset:53248
    buffer_load_dwordx4 a[148:151], v100, s[64:67], s46 offen offset:256 sc1
    v_mfma_f32_16x16x32_bf16 v[148:151], a[76:79], a[204:207], v[148:151]
    ds_read_b64_tr_b16 a[76:77], v117 offset:49152
    v_mfma_f32_16x16x32_bf16 v[152:155], a[80:83], a[200:203], v[152:155]
    ds_read_b64_tr_b16 a[78:79], v117 offset:53248
    v_mfma_f32_16x16x32_bf16 v[156:159], a[80:83], a[204:207], v[156:159]
    ds_read_b64_tr_b16 a[80:81], v118 offset:49152
    buffer_load_dwordx4 a[152:155], v100, s[64:67], s46 offen offset:2048 sc1
    v_mfma_f32_16x16x32_bf16 v[160:163], a[84:87], a[200:203], v[160:163]
    ds_read_b64_tr_b16 a[82:83], v118 offset:53248
    v_mfma_f32_16x16x32_bf16 v[164:167], a[84:87], a[204:207], v[164:167]
    ds_read_b64_tr_b16 a[84:85], v119 offset:49152
    s_waitcnt lgkmcnt(7)
    v_mfma_f32_16x16x32_bf16 v[168:171], a[88:91], a[200:203], v[168:171]
    ds_read_b64_tr_b16 a[86:87], v119 offset:53248
    buffer_load_dwordx4 a[156:159], v100, s[64:67], s46 offen offset:2304 sc1
    v_mfma_f32_16x16x32_bf16 v[172:175], a[88:91], a[204:207], v[172:175]
    ds_read_b64_tr_b16 a[88:89], v120 offset:49152
    v_mfma_f32_16x16x32_bf16 v[176:179], a[92:95], a[200:203], v[176:179]
    ds_read_b64_tr_b16 a[90:91], v120 offset:53248
    s_add_u32 s44, s44, 8192
    v_mfma_f32_16x16x32_bf16 v[180:183], a[92:95], a[204:207], v[180:183]
    ds_read_b64_tr_b16 a[92:93], v121 offset:49152
    v_mfma_f32_16x16x32_bf16 v[184:187], a[96:99], a[200:203], v[184:187]
    ds_read_b64_tr_b16 a[94:95], v121 offset:53248
    v_mfma_f32_16x16x32_bf16 v[188:191], a[96:99], a[204:207], v[188:191]
    ds_read_b64_tr_b16 a[96:97], v122 offset:49152
    s_add_u32 s46, s46, 8192
    v_mfma_f32_16x16x32_bf16 v[192:195], a[100:103], a[200:203], v[192:195]
    ds_read_b64_tr_b16 a[98:99], v122 offset:53248
    v_mfma_f32_16x16x32_bf16 v[196:199], a[100:103], a[204:207], v[196:199]
    ds_read_b64_tr_b16 a[100:101], v123 offset:49152
    ds_read_b64_tr_b16 a[102:103], v123 offset:53248
    s_waitcnt lgkmcnt(8)
    v_mfma_f32_16x16x32_bf16 v[136:139], a[72:75], a[208:211], v[136:139]
    s_add_u32 m0, s53, 98304
    v_mfma_f32_16x16x32_bf16 v[140:143], a[72:75], a[212:215], v[140:143]
    ds_read_b64_tr_b16 a[72:73], v116 offset:57344
    buffer_load_dwordx4 v102, s[68:71], s48 offen lds
    v_mfma_f32_16x16x32_bf16 v[144:147], a[76:79], a[208:211], v[144:147]
    ds_read_b64_tr_b16 a[74:75], v116 offset:61440
    v_mfma_f32_16x16x32_bf16 v[148:151], a[76:79], a[212:215], v[148:151]
    ds_read_b64_tr_b16 a[76:77], v117 offset:57344
    s_add_u32 m0, s53, 99328
    v_mfma_f32_16x16x32_bf16 v[152:155], a[80:83], a[208:211], v[152:155]
    ds_read_b64_tr_b16 a[78:79], v117 offset:61440
    buffer_load_dwordx4 v103, s[68:71], s48 offen lds
    v_mfma_f32_16x16x32_bf16 v[156:159], a[80:83], a[212:215], v[156:159]
    ds_read_b64_tr_b16 a[80:81], v118 offset:57344
    v_mfma_f32_16x16x32_bf16 v[160:163], a[84:87], a[208:211], v[160:163]
    ds_read_b64_tr_b16 a[82:83], v118 offset:61440
    s_add_u32 s48, s48, 65536
    v_mfma_f32_16x16x32_bf16 v[164:167], a[84:87], a[212:215], v[164:167]
    ds_read_b64_tr_b16 a[84:85], v119 offset:57344
    s_waitcnt lgkmcnt(7)
    v_mfma_f32_16x16x32_bf16 v[168:171], a[88:91], a[208:211], v[168:171]
    ds_read_b64_tr_b16 a[86:87], v119 offset:61440
    s_add_u32 m0, s53, 106496
    v_mfma_f32_16x16x32_bf16 v[172:175], a[88:91], a[212:215], v[172:175]
    ds_read_b64_tr_b16 a[88:89], v120 offset:57344
    buffer_load_dwordx4 v102, s[68:71], s48 offen lds
    v_mfma_f32_16x16x32_bf16 v[176:179], a[92:95], a[208:211], v[176:179]
    ds_read_b64_tr_b16 a[90:91], v120 offset:61440
    v_mfma_f32_16x16x32_bf16 v[180:183], a[92:95], a[212:215], v[180:183]
    ds_read_b64_tr_b16 a[92:93], v121 offset:57344
    s_add_u32 m0, s53, 107520
    v_mfma_f32_16x16x32_bf16 v[184:187], a[96:99], a[208:211], v[184:187]
    ds_read_b64_tr_b16 a[94:95], v121 offset:61440
    buffer_load_dwordx4 v103, s[68:71], s48 offen lds
    v_mfma_f32_16x16x32_bf16 v[188:191], a[96:99], a[212:215], v[188:191]
    ds_read_b64_tr_b16 a[96:97], v122 offset:57344
    v_mfma_f32_16x16x32_bf16 v[192:195], a[100:103], a[208:211], v[192:195]
    ds_read_b64_tr_b16 a[98:99], v122 offset:61440
    s_add_u32 s48, s48, 65536
    v_mfma_f32_16x16x32_bf16 v[196:199], a[100:103], a[212:215], v[196:199]
    ds_read_b64_tr_b16 a[100:101], v123 offset:57344
    ds_read_b64_tr_b16 a[102:103], v123 offset:61440
    s_waitcnt lgkmcnt(8)
    v_mfma_f32_16x16x32_bf16 v[136:139], a[72:75], a[216:219], v[136:139]
    s_add_u32 m0, s53, 114688
    v_mfma_f32_16x16x32_bf16 v[140:143], a[72:75], a[220:223], v[140:143]
    ds_read_b64_tr_b16 a[72:73], v108 offset:0
    buffer_load_dwordx4 v102, s[68:71], s48 offen lds
    v_mfma_f32_16x16x32_bf16 v[144:147], a[76:79], a[216:219], v[144:147]
    ds_read_b64_tr_b16 a[74:75], v108 offset:4096
    v_mfma_f32_16x16x32_bf16 v[148:151], a[76:79], a[220:223], v[148:151]
    ds_read_b64_tr_b16 a[76:77], v109 offset:0
    s_add_u32 m0, s53, 115712
    v_mfma_f32_16x16x32_bf16 v[152:155], a[80:83], a[216:219], v[152:155]
    ds_read_b64_tr_b16 a[78:79], v109 offset:4096
    buffer_load_dwordx4 v103, s[68:71], s48 offen lds
    v_mfma_f32_16x16x32_bf16 v[156:159], a[80:83], a[220:223], v[156:159]
    ds_read_b64_tr_b16 a[80:81], v110 offset:0
    v_mfma_f32_16x16x32_bf16 v[160:163], a[84:87], a[216:219], v[160:163]
    ds_read_b64_tr_b16 a[82:83], v110 offset:4096
    s_add_u32 s48, s48, 65536
    v_mfma_f32_16x16x32_bf16 v[164:167], a[84:87], a[220:223], v[164:167]
    ds_read_b64_tr_b16 a[84:85], v111 offset:0
    s_waitcnt lgkmcnt(7)
    v_mfma_f32_16x16x32_bf16 v[168:171], a[88:91], a[216:219], v[168:171]
    ds_read_b64_tr_b16 a[86:87], v111 offset:4096
    s_add_u32 m0, s53, 122880
    v_mfma_f32_16x16x32_bf16 v[172:175], a[88:91], a[220:223], v[172:175]
    ds_read_b64_tr_b16 a[88:89], v112 offset:0
    buffer_load_dwordx4 v102, s[68:71], s48 offen lds
    v_mfma_f32_16x16x32_bf16 v[176:179], a[92:95], a[216:219], v[176:179]
    ds_read_b64_tr_b16 a[90:91], v112 offset:4096
    v_mfma_f32_16x16x32_bf16 v[180:183], a[92:95], a[220:223], v[180:183]
    ds_read_b64_tr_b16 a[92:93], v113 offset:0
    s_add_u32 m0, s53, 123904
    v_mfma_f32_16x16x32_bf16 v[184:187], a[96:99], a[216:219], v[184:187]
    ds_read_b64_tr_b16 a[94:95], v113 offset:4096
    buffer_load_dwordx4 v103, s[68:71], s48 offen lds
    v_mfma_f32_16x16x32_bf16 v[188:191], a[96:99], a[220:223], v[188:191]
    ds_read_b64_tr_b16 a[96:97], v114 offset:0
    v_mfma_f32_16x16x32_bf16 v[192:195], a[100:103], a[216:219], v[192:195]
    ds_read_b64_tr_b16 a[98:99], v114 offset:4096
    s_add_u32 s48, s48, 65536
    v_mfma_f32_16x16x32_bf16 v[196:199], a[100:103], a[220:223], v[196:199]
    ds_read_b64_tr_b16 a[100:101], v115 offset:0
    ds_read_b64_tr_b16 a[102:103], v115 offset:4096
    s_waitcnt vmcnt(16)
    s_barrier
    s_waitcnt lgkmcnt(8)
    v_mfma_f32_16x16x32_bf16 v[136:139], a[72:75], a[224:227], v[136:139]
    buffer_load_dwordx4 a[160:163], v100, s[64:67], s44 offen offset:0 sc1
    v_mfma_f32_16x16x32_bf16 v[140:143], a[72:75], a[228:231], v[140:143]
    ds_read_b64_tr_b16 a[72:73], v108 offset:8192
    v_mfma_f32_16x16x32_bf16 v[144:147], a[76:79], a[224:227], v[144:147]
    ds_read_b64_tr_b16 a[74:75], v108 offset:12288
    v_mfma_f32_16x16x32_bf16 v[148:151], a[76:79], a[228:231], v[148:151]
    ds_read_b64_tr_b16 a[76:77], v109 offset:8192
    v_mfma_f32_16x16x32_bf16 v[152:155], a[80:83], a[224:227], v[152:155]
    ds_read_b64_tr_b16 a[78:79], v109 offset:12288
    buffer_load_dwordx4 a[164:167], v100, s[64:67], s44 offen offset:256 sc1
    v_mfma_f32_16x16x32_bf16 v[156:159], a[80:83], a[228:231], v[156:159]
    ds_read_b64_tr_b16 a[80:81], v110 offset:8192
    v_mfma_f32_16x16x32_bf16 v[160:163], a[84:87], a[224:227], v[160:163]
    ds_read_b64_tr_b16 a[82:83], v110 offset:12288
    v_mfma_f32_16x16x32_bf16 v[164:167], a[84:87], a[228:231], v[164:167]
    ds_read_b64_tr_b16 a[84:85], v111 offset:8192
    s_waitcnt lgkmcnt(7)
    v_mfma_f32_16x16x32_bf16 v[168:171], a[88:91], a[224:227], v[168:171]
    ds_read_b64_tr_b16 a[86:87], v111 offset:12288
    buffer_load_dwordx4 a[168:171], v100, s[64:67], s44 offen offset:2048 sc1
    v_mfma_f32_16x16x32_bf16 v[172:175], a[88:91], a[228:231], v[172:175]
    ds_read_b64_tr_b16 a[88:89], v112 offset:8192
    v_mfma_f32_16x16x32_bf16 v[176:179], a[92:95], a[224:227], v[176:179]
    ds_read_b64_tr_b16 a[90:91], v112 offset:12288
    v_mfma_f32_16x16x32_bf16 v[180:183], a[92:95], a[228:231], v[180:183]
    ds_read_b64_tr_b16 a[92:93], v113 offset:8192
    v_mfma_f32_16x16x32_bf16 v[184:187], a[96:99], a[224:227], v[184:187]
    ds_read_b64_tr_b16 a[94:95], v113 offset:12288
    buffer_load_dwordx4 a[172:175], v100, s[64:67], s44 offen offset:2304 sc1
    v_mfma_f32_16x16x32_bf16 v[188:191], a[96:99], a[228:231], v[188:191]
    ds_read_b64_tr_b16 a[96:97], v114 offset:8192
    v_mfma_f32_16x16x32_bf16 v[192:195], a[100:103], a[224:227], v[192:195]
    ds_read_b64_tr_b16 a[98:99], v114 offset:12288
    v_mfma_f32_16x16x32_bf16 v[196:199], a[100:103], a[228:231], v[196:199]
    ds_read_b64_tr_b16 a[100:101], v115 offset:8192
    ds_read_b64_tr_b16 a[102:103], v115 offset:12288
    s_waitcnt lgkmcnt(8)
    v_mfma_f32_16x16x32_bf16 v[136:139], a[72:75], a[232:235], v[136:139]
    buffer_load_dwordx4 a[176:179], v100, s[64:67], s46 offen offset:0 sc1
    v_mfma_f32_16x16x32_bf16 v[140:143], a[72:75], a[236:239], v[140:143]
    ds_read_b64_tr_b16 a[72:73], v108 offset:16384
    v_mfma_f32_16x16x32_bf16 v[144:147], a[76:79], a[232:235], v[144:147]
    ds_read_b64_tr_b16 a[74:75], v108 offset:20480
    buffer_load_dwordx4 a[180:183], v100, s[64:67], s46 offen offset:256 sc1
    v_mfma_f32_16x16x32_bf16 v[148:151], a[76:79], a[236:239], v[148:151]
    ds_read_b64_tr_b16 a[76:77], v109 offset:16384
    v_mfma_f32_16x16x32_bf16 v[152:155], a[80:83], a[232:235], v[152:155]
    ds_read_b64_tr_b16 a[78:79], v109 offset:20480
    v_mfma_f32_16x16x32_bf16 v[156:159], a[80:83], a[236:239], v[156:159]
    ds_read_b64_tr_b16 a[80:81], v110 offset:16384
    buffer_load_dwordx4 a[184:187], v100, s[64:67], s46 offen offset:2048 sc1
    v_mfma_f32_16x16x32_bf16 v[160:163], a[84:87], a[232:235], v[160:163]
    ds_read_b64_tr_b16 a[82:83], v110 offset:20480
    v_mfma_f32_16x16x32_bf16 v[164:167], a[84:87], a[236:239], v[164:167]
    ds_read_b64_tr_b16 a[84:85], v111 offset:16384
    s_waitcnt lgkmcnt(7)
    v_mfma_f32_16x16x32_bf16 v[168:171], a[88:91], a[232:235], v[168:171]
    ds_read_b64_tr_b16 a[86:87], v111 offset:20480
    buffer_load_dwordx4 a[188:191], v100, s[64:67], s46 offen offset:2304 sc1
    v_mfma_f32_16x16x32_bf16 v[172:175], a[88:91], a[236:239], v[172:175]
    ds_read_b64_tr_b16 a[88:89], v112 offset:16384
    v_mfma_f32_16x16x32_bf16 v[176:179], a[92:95], a[232:235], v[176:179]
    ds_read_b64_tr_b16 a[90:91], v112 offset:20480
    s_add_u32 s44, s44, 8192
    v_mfma_f32_16x16x32_bf16 v[180:183], a[92:95], a[236:239], v[180:183]
    ds_read_b64_tr_b16 a[92:93], v113 offset:16384
    v_mfma_f32_16x16x32_bf16 v[184:187], a[96:99], a[232:235], v[184:187]
    ds_read_b64_tr_b16 a[94:95], v113 offset:20480
    v_mfma_f32_16x16x32_bf16 v[188:191], a[96:99], a[236:239], v[188:191]
    ds_read_b64_tr_b16 a[96:97], v114 offset:16384
    s_add_u32 s46, s46, 8192
    v_mfma_f32_16x16x32_bf16 v[192:195], a[100:103], a[232:235], v[192:195]
    ds_read_b64_tr_b16 a[98:99], v114 offset:20480
    v_mfma_f32_16x16x32_bf16 v[196:199], a[100:103], a[236:239], v[196:199]
    ds_read_b64_tr_b16 a[100:101], v115 offset:16384
    ds_read_b64_tr_b16 a[102:103], v115 offset:20480
    s_waitcnt lgkmcnt(8)
    v_mfma_f32_16x16x32_bf16 v[136:139], a[72:75], a[240:243], v[136:139]
    s_add_u32 m0, s53, 131072
    v_mfma_f32_16x16x32_bf16 v[140:143], a[72:75], a[244:247], v[140:143]
    ds_read_b64_tr_b16 a[72:73], v108 offset:24576
    buffer_load_dwordx4 v102, s[68:71], s48 offen lds
    v_mfma_f32_16x16x32_bf16 v[144:147], a[76:79], a[240:243], v[144:147]
    ds_read_b64_tr_b16 a[74:75], v108 offset:28672
    v_mfma_f32_16x16x32_bf16 v[148:151], a[76:79], a[244:247], v[148:151]
    ds_read_b64_tr_b16 a[76:77], v109 offset:24576
    s_add_u32 m0, s53, 132096
    v_mfma_f32_16x16x32_bf16 v[152:155], a[80:83], a[240:243], v[152:155]
    ds_read_b64_tr_b16 a[78:79], v109 offset:28672
    buffer_load_dwordx4 v103, s[68:71], s48 offen lds
    v_mfma_f32_16x16x32_bf16 v[156:159], a[80:83], a[244:247], v[156:159]
    ds_read_b64_tr_b16 a[80:81], v110 offset:24576
    v_mfma_f32_16x16x32_bf16 v[160:163], a[84:87], a[240:243], v[160:163]
    ds_read_b64_tr_b16 a[82:83], v110 offset:28672
    s_add_u32 s48, s48, 65536
    v_mfma_f32_16x16x32_bf16 v[164:167], a[84:87], a[244:247], v[164:167]
    ds_read_b64_tr_b16 a[84:85], v111 offset:24576
    s_waitcnt lgkmcnt(7)
    v_mfma_f32_16x16x32_bf16 v[168:171], a[88:91], a[240:243], v[168:171]
    ds_read_b64_tr_b16 a[86:87], v111 offset:28672
    s_add_u32 m0, s53, 139264
    v_mfma_f32_16x16x32_bf16 v[172:175], a[88:91], a[244:247], v[172:175]
    ds_read_b64_tr_b16 a[88:89], v112 offset:24576
    buffer_load_dwordx4 v102, s[68:71], s48 offen lds
    v_mfma_f32_16x16x32_bf16 v[176:179], a[92:95], a[240:243], v[176:179]
    ds_read_b64_tr_b16 a[90:91], v112 offset:28672
    v_mfma_f32_16x16x32_bf16 v[180:183], a[92:95], a[244:247], v[180:183]
    ds_read_b64_tr_b16 a[92:93], v113 offset:24576
    s_add_u32 m0, s53, 140288
    v_mfma_f32_16x16x32_bf16 v[184:187], a[96:99], a[240:243], v[184:187]
    ds_read_b64_tr_b16 a[94:95], v113 offset:28672
    buffer_load_dwordx4 v103, s[68:71], s48 offen lds
    v_mfma_f32_16x16x32_bf16 v[188:191], a[96:99], a[244:247], v[188:191]
    ds_read_b64_tr_b16 a[96:97], v114 offset:24576
    v_mfma_f32_16x16x32_bf16 v[192:195], a[100:103], a[240:243], v[192:195]
    ds_read_b64_tr_b16 a[98:99], v114 offset:28672
    s_add_u32 s48, s48, 65536
    v_mfma_f32_16x16x32_bf16 v[196:199], a[100:103], a[244:247], v[196:199]
    ds_read_b64_tr_b16 a[100:101], v115 offset:24576
    ds_read_b64_tr_b16 a[102:103], v115 offset:28672
    s_waitcnt lgkmcnt(8)
    v_mfma_f32_16x16x32_bf16 v[136:139], a[72:75], a[248:251], v[136:139]
    s_add_u32 m0, s53, 147456
    v_mfma_f32_16x16x32_bf16 v[140:143], a[72:75], a[252:255], v[140:143]
    ds_read_b64_tr_b16 a[72:73], v108 offset:32768
    buffer_load_dwordx4 v102, s[68:71], s48 offen lds
    v_mfma_f32_16x16x32_bf16 v[144:147], a[76:79], a[248:251], v[144:147]
    ds_read_b64_tr_b16 a[74:75], v108 offset:36864
    v_mfma_f32_16x16x32_bf16 v[148:151], a[76:79], a[252:255], v[148:151]
    ds_read_b64_tr_b16 a[76:77], v109 offset:32768
    s_add_u32 m0, s53, 148480
    v_mfma_f32_16x16x32_bf16 v[152:155], a[80:83], a[248:251], v[152:155]
    ds_read_b64_tr_b16 a[78:79], v109 offset:36864
    buffer_load_dwordx4 v103, s[68:71], s48 offen lds
    v_mfma_f32_16x16x32_bf16 v[156:159], a[80:83], a[252:255], v[156:159]
    ds_read_b64_tr_b16 a[80:81], v110 offset:32768
    v_mfma_f32_16x16x32_bf16 v[160:163], a[84:87], a[248:251], v[160:163]
    ds_read_b64_tr_b16 a[82:83], v110 offset:36864
    s_add_u32 s48, s48, 65536
    v_mfma_f32_16x16x32_bf16 v[164:167], a[84:87], a[252:255], v[164:167]
    ds_read_b64_tr_b16 a[84:85], v111 offset:32768
    s_waitcnt lgkmcnt(7)
    v_mfma_f32_16x16x32_bf16 v[168:171], a[88:91], a[248:251], v[168:171]
    ds_read_b64_tr_b16 a[86:87], v111 offset:36864
    s_add_u32 m0, s53, 155648
    v_mfma_f32_16x16x32_bf16 v[172:175], a[88:91], a[252:255], v[172:175]
    ds_read_b64_tr_b16 a[88:89], v112 offset:32768
    buffer_load_dwordx4 v102, s[68:71], s48 offen lds
    v_mfma_f32_16x16x32_bf16 v[176:179], a[92:95], a[248:251], v[176:179]
    ds_read_b64_tr_b16 a[90:91], v112 offset:36864
    v_mfma_f32_16x16x32_bf16 v[180:183], a[92:95], a[252:255], v[180:183]
    ds_read_b64_tr_b16 a[92:93], v113 offset:32768
    s_add_u32 m0, s53, 156672
    v_mfma_f32_16x16x32_bf16 v[184:187], a[96:99], a[248:251], v[184:187]
    ds_read_b64_tr_b16 a[94:95], v113 offset:36864
    buffer_load_dwordx4 v103, s[68:71], s48 offen lds
    v_mfma_f32_16x16x32_bf16 v[188:191], a[96:99], a[252:255], v[188:191]
    ds_read_b64_tr_b16 a[96:97], v114 offset:32768
    v_mfma_f32_16x16x32_bf16 v[192:195], a[100:103], a[248:251], v[192:195]
    ds_read_b64_tr_b16 a[98:99], v114 offset:36864
    s_add_u32 s48, s48, 65536
    v_mfma_f32_16x16x32_bf16 v[196:199], a[100:103], a[252:255], v[196:199]
    ds_read_b64_tr_b16 a[100:101], v115 offset:32768
    ds_read_b64_tr_b16 a[102:103], v115 offset:36864
    s_waitcnt vmcnt(16)
    s_barrier
    s_waitcnt lgkmcnt(8)
    v_mfma_f32_16x16x32_bf16 v[136:139], a[72:75], a[128:131], v[136:139]
    buffer_load_dwordx4 a[192:195], v100, s[64:67], s44 offen offset:0 sc1
    v_mfma_f32_16x16x32_bf16 v[140:143], a[72:75], a[132:135], v[140:143]
    ds_read_b64_tr_b16 a[72:73], v108 offset:40960
    v_mfma_f32_16x16x32_bf16 v[144:147], a[76:79], a[128:131], v[144:147]
    ds_read_b64_tr_b16 a[74:75], v108 offset:45056
    v_mfma_f32_16x16x32_bf16 v[148:151], a[76:79], a[132:135], v[148:151]
    ds_read_b64_tr_b16 a[76:77], v109 offset:40960
    buffer_load_dwordx4 a[196:199], v100, s[64:67], s44 offen offset:256 sc1
    v_mfma_f32_16x16x32_bf16 v[152:155], a[80:83], a[128:131], v[152:155]
    ds_read_b64_tr_b16 a[78:79], v109 offset:45056
    v_mfma_f32_16x16x32_bf16 v[156:159], a[80:83], a[132:135], v[156:159]
    ds_read_b64_tr_b16 a[80:81], v110 offset:40960
    v_mfma_f32_16x16x32_bf16 v[160:163], a[84:87], a[128:131], v[160:163]
    ds_read_b64_tr_b16 a[82:83], v110 offset:45056
    buffer_load_dwordx4 a[200:203], v100, s[64:67], s44 offen offset:2048 sc1
    v_mfma_f32_16x16x32_bf16 v[164:167], a[84:87], a[132:135], v[164:167]
    ds_read_b64_tr_b16 a[84:85], v111 offset:40960
    s_waitcnt lgkmcnt(7)
    v_mfma_f32_16x16x32_bf16 v[168:171], a[88:91], a[128:131], v[168:171]
    ds_read_b64_tr_b16 a[86:87], v111 offset:45056
    v_mfma_f32_16x16x32_bf16 v[172:175], a[88:91], a[132:135], v[172:175]
    ds_read_b64_tr_b16 a[88:89], v112 offset:40960
    buffer_load_dwordx4 a[204:207], v100, s[64:67], s44 offen offset:2304 sc1
    v_mfma_f32_16x16x32_bf16 v[176:179], a[92:95], a[128:131], v[176:179]
    ds_read_b64_tr_b16 a[90:91], v112 offset:45056
    v_mfma_f32_16x16x32_bf16 v[180:183], a[92:95], a[132:135], v[180:183]
    ds_read_b64_tr_b16 a[92:93], v113 offset:40960
    v_mfma_f32_16x16x32_bf16 v[184:187], a[96:99], a[128:131], v[184:187]
    ds_read_b64_tr_b16 a[94:95], v113 offset:45056
    buffer_load_dwordx4 a[208:211], v100, s[64:67], s46 offen offset:0 sc1
    v_mfma_f32_16x16x32_bf16 v[188:191], a[96:99], a[132:135], v[188:191]
    ds_read_b64_tr_b16 a[96:97], v114 offset:40960
    v_mfma_f32_16x16x32_bf16 v[192:195], a[100:103], a[128:131], v[192:195]
    ds_read_b64_tr_b16 a[98:99], v114 offset:45056
    v_mfma_f32_16x16x32_bf16 v[196:199], a[100:103], a[132:135], v[196:199]
    ds_read_b64_tr_b16 a[100:101], v115 offset:40960
    ds_read_b64_tr_b16 a[102:103], v115 offset:45056
    s_waitcnt lgkmcnt(8)
    v_mfma_f32_16x16x32_bf16 v[136:139], a[72:75], a[136:139], v[136:139]
    buffer_load_dwordx4 a[212:215], v100, s[64:67], s46 offen offset:256 sc1
    v_mfma_f32_16x16x32_bf16 v[140:143], a[72:75], a[140:143], v[140:143]
    ds_read_b64_tr_b16 a[72:73], v108 offset:49152
    buffer_load_dwordx4 a[216:219], v100, s[64:67], s46 offen offset:2048 sc1
    v_mfma_f32_16x16x32_bf16 v[144:147], a[76:79], a[136:139], v[144:147]
    ds_read_b64_tr_b16 a[74:75], v108 offset:53248
    v_mfma_f32_16x16x32_bf16 v[148:151], a[76:79], a[140:143], v[148:151]
    ds_read_b64_tr_b16 a[76:77], v109 offset:49152
    buffer_load_dwordx4 a[220:223], v100, s[64:67], s46 offen offset:2304 sc1
    v_mfma_f32_16x16x32_bf16 v[152:155], a[80:83], a[136:139], v[152:155]
    ds_read_b64_tr_b16 a[78:79], v109 offset:53248
    s_add_u32 s44, s44, 8192
    v_mfma_f32_16x16x32_bf16 v[156:159], a[80:83], a[140:143], v[156:159]
    ds_read_b64_tr_b16 a[80:81], v110 offset:49152
    v_mfma_f32_16x16x32_bf16 v[160:163], a[84:87], a[136:139], v[160:163]
    ds_read_b64_tr_b16 a[82:83], v110 offset:53248
    s_add_u32 s46, s46, 8192
    v_mfma_f32_16x16x32_bf16 v[164:167], a[84:87], a[140:143], v[164:167]
    ds_read_b64_tr_b16 a[84:85], v111 offset:49152
    s_waitcnt lgkmcnt(7)
    v_mfma_f32_16x16x32_bf16 v[168:171], a[88:91], a[136:139], v[168:171]
    ds_read_b64_tr_b16 a[86:87], v111 offset:53248
    s_add_u32 m0, s53, 32768
    v_mfma_f32_16x16x32_bf16 v[172:175], a[88:91], a[140:143], v[172:175]
    ds_read_b64_tr_b16 a[88:89], v112 offset:49152
    buffer_load_dwordx4 v102, s[68:71], s48 offen lds
    v_mfma_f32_16x16x32_bf16 v[176:179], a[92:95], a[136:139], v[176:179]
    ds_read_b64_tr_b16 a[90:91], v112 offset:53248
    v_mfma_f32_16x16x32_bf16 v[180:183], a[92:95], a[140:143], v[180:183]
    ds_read_b64_tr_b16 a[92:93], v113 offset:49152
    s_add_u32 m0, s53, 33792
    v_mfma_f32_16x16x32_bf16 v[184:187], a[96:99], a[136:139], v[184:187]
    ds_read_b64_tr_b16 a[94:95], v113 offset:53248
    buffer_load_dwordx4 v103, s[68:71], s48 offen lds
    v_mfma_f32_16x16x32_bf16 v[188:191], a[96:99], a[140:143], v[188:191]
    ds_read_b64_tr_b16 a[96:97], v114 offset:49152
    v_mfma_f32_16x16x32_bf16 v[192:195], a[100:103], a[136:139], v[192:195]
    ds_read_b64_tr_b16 a[98:99], v114 offset:53248
    s_add_u32 s48, s48, 65536
    v_mfma_f32_16x16x32_bf16 v[196:199], a[100:103], a[140:143], v[196:199]
    ds_read_b64_tr_b16 a[100:101], v115 offset:49152
    ds_read_b64_tr_b16 a[102:103], v115 offset:53248
    s_waitcnt lgkmcnt(8)
    v_mfma_f32_16x16x32_bf16 v[136:139], a[72:75], a[144:147], v[136:139]
    s_add_u32 m0, s53, 40960
    v_mfma_f32_16x16x32_bf16 v[140:143], a[72:75], a[148:151], v[140:143]
    ds_read_b64_tr_b16 a[72:73], v108 offset:57344
    buffer_load_dwordx4 v102, s[68:71], s48 offen lds
    v_mfma_f32_16x16x32_bf16 v[144:147], a[76:79], a[144:147], v[144:147]
    ds_read_b64_tr_b16 a[74:75], v108 offset:61440
    s_add_u32 m0, s53, 41984
    v_mfma_f32_16x16x32_bf16 v[148:151], a[76:79], a[148:151], v[148:151]
    ds_read_b64_tr_b16 a[76:77], v109 offset:57344
    v_mfma_f32_16x16x32_bf16 v[152:155], a[80:83], a[144:147], v[152:155]
    ds_read_b64_tr_b16 a[78:79], v109 offset:61440
    buffer_load_dwordx4 v103, s[68:71], s48 offen lds
    v_mfma_f32_16x16x32_bf16 v[156:159], a[80:83], a[148:151], v[156:159]
    ds_read_b64_tr_b16 a[80:81], v110 offset:57344
    s_add_u32 s48, s48, 65536
    v_mfma_f32_16x16x32_bf16 v[160:163], a[84:87], a[144:147], v[160:163]
    ds_read_b64_tr_b16 a[82:83], v110 offset:61440
    s_add_u32 m0, s53, 49152
    v_mfma_f32_16x16x32_bf16 v[164:167], a[84:87], a[148:151], v[164:167]
    ds_read_b64_tr_b16 a[84:85], v111 offset:57344
    s_waitcnt lgkmcnt(7)
    v_mfma_f32_16x16x32_bf16 v[168:171], a[88:91], a[144:147], v[168:171]
    ds_read_b64_tr_b16 a[86:87], v111 offset:61440
    buffer_load_dwordx4 v102, s[68:71], s48 offen lds
    v_mfma_f32_16x16x32_bf16 v[172:175], a[88:91], a[148:151], v[172:175]
    ds_read_b64_tr_b16 a[88:89], v112 offset:57344
    s_add_u32 m0, s53, 50176
    v_mfma_f32_16x16x32_bf16 v[176:179], a[92:95], a[144:147], v[176:179]
    ds_read_b64_tr_b16 a[90:91], v112 offset:61440
    buffer_load_dwordx4 v103, s[68:71], s48 offen lds
    v_mfma_f32_16x16x32_bf16 v[180:183], a[92:95], a[148:151], v[180:183]
    ds_read_b64_tr_b16 a[92:93], v113 offset:57344
    v_mfma_f32_16x16x32_bf16 v[184:187], a[96:99], a[144:147], v[184:187]
    ds_read_b64_tr_b16 a[94:95], v113 offset:61440
    s_add_u32 s48, s48, 65536
    v_mfma_f32_16x16x32_bf16 v[188:191], a[96:99], a[148:151], v[188:191]
    ds_read_b64_tr_b16 a[96:97], v114 offset:57344
    s_add_u32 m0, s53, 57344
    v_mfma_f32_16x16x32_bf16 v[192:195], a[100:103], a[144:147], v[192:195]
    ds_read_b64_tr_b16 a[98:99], v114 offset:61440
    buffer_load_dwordx4 v102, s[68:71], s48 offen lds
    v_mfma_f32_16x16x32_bf16 v[196:199], a[100:103], a[148:151], v[196:199]
    ds_read_b64_tr_b16 a[100:101], v115 offset:57344
    ds_read_b64_tr_b16 a[102:103], v115 offset:61440
    s_waitcnt lgkmcnt(8)
    v_mfma_f32_16x16x32_bf16 v[136:139], a[72:75], a[152:155], v[136:139]
    s_add_u32 m0, s53, 58368
    v_mfma_f32_16x16x32_bf16 v[140:143], a[72:75], a[156:159], v[140:143]
    ds_read_b64_tr_b16 a[72:73], v116 offset:0
    v_mfma_f32_16x16x32_bf16 v[144:147], a[76:79], a[152:155], v[144:147]
    ds_read_b64_tr_b16 a[74:75], v116 offset:4096
    buffer_load_dwordx4 v103, s[68:71], s48 offen lds
    v_mfma_f32_16x16x32_bf16 v[148:151], a[76:79], a[156:159], v[148:151]
    ds_read_b64_tr_b16 a[76:77], v117 offset:0
    v_mfma_f32_16x16x32_bf16 v[152:155], a[80:83], a[152:155], v[152:155]
    ds_read_b64_tr_b16 a[78:79], v117 offset:4096
    s_add_u32 s48, s48, 65536
    v_mfma_f32_16x16x32_bf16 v[156:159], a[80:83], a[156:159], v[156:159]
    ds_read_b64_tr_b16 a[80:81], v118 offset:0
    v_mfma_f32_16x16x32_bf16 v[160:163], a[84:87], a[152:155], v[160:163]
    ds_read_b64_tr_b16 a[82:83], v118 offset:4096
    buffer_load_dwordx4 v[200:203], v1, s[56:59], 0 offen offset:0
    v_mfma_f32_16x16x32_bf16 v[164:167], a[84:87], a[156:159], v[164:167]
    ds_read_b64_tr_b16 a[84:85], v119 offset:0
    s_waitcnt lgkmcnt(7)
    v_mfma_f32_16x16x32_bf16 v[168:171], a[88:91], a[152:155], v[168:171]
    ds_read_b64_tr_b16 a[86:87], v119 offset:4096
    v_mfma_f32_16x16x32_bf16 v[172:175], a[88:91], a[156:159], v[172:175]
    ds_read_b64_tr_b16 a[88:89], v120 offset:0
    buffer_load_dwordx4 v[204:207], v1, s[56:59], 0 offen offset:64
    v_mfma_f32_16x16x32_bf16 v[176:179], a[92:95], a[152:155], v[176:179]
    ds_read_b64_tr_b16 a[90:91], v120 offset:4096
    v_mfma_f32_16x16x32_bf16 v[180:183], a[92:95], a[156:159], v[180:183]
    ds_read_b64_tr_b16 a[92:93], v121 offset:0
    buffer_load_dwordx4 v[208:211], v1, s[56:59], s63 offen offset:0
    v_mfma_f32_16x16x32_bf16 v[184:187], a[96:99], a[152:155], v[184:187]
    ds_read_b64_tr_b16 a[94:95], v121 offset:4096
    v_mfma_f32_16x16x32_bf16 v[188:191], a[96:99], a[156:159], v[188:191]
    ds_read_b64_tr_b16 a[96:97], v122 offset:0
    buffer_load_dwordx4 v[212:215], v1, s[56:59], s63 offen offset:64
    v_mfma_f32_16x16x32_bf16 v[192:195], a[100:103], a[152:155], v[192:195]
    ds_read_b64_tr_b16 a[98:99], v122 offset:4096
    v_mfma_f32_16x16x32_bf16 v[196:199], a[100:103], a[156:159], v[196:199]
    ds_read_b64_tr_b16 a[100:101], v123 offset:0
    ds_read_b64_tr_b16 a[102:103], v123 offset:4096
    s_waitcnt vmcnt(20)
    s_barrier
    s_waitcnt lgkmcnt(8)
    v_mfma_f32_16x16x32_bf16 v[136:139], a[72:75], a[160:163], v[136:139]
    buffer_load_dwordx4 a[224:227], v100, s[64:67], s44 offen offset:0 sc1
    v_mfma_f32_16x16x32_bf16 v[140:143], a[72:75], a[164:167], v[140:143]
    ds_read_b64_tr_b16 a[72:73], v116 offset:8192
    v_mfma_f32_16x16x32_bf16 v[144:147], a[76:79], a[160:163], v[144:147]
    ds_read_b64_tr_b16 a[74:75], v116 offset:12288
    v_mfma_f32_16x16x32_bf16 v[148:151], a[76:79], a[164:167], v[148:151]
    ds_read_b64_tr_b16 a[76:77], v117 offset:8192
    v_mfma_f32_16x16x32_bf16 v[152:155], a[80:83], a[160:163], v[152:155]
    ds_read_b64_tr_b16 a[78:79], v117 offset:12288
    buffer_load_dwordx4 a[228:231], v100, s[64:67], s44 offen offset:256 sc1
    v_mfma_f32_16x16x32_bf16 v[156:159], a[80:83], a[164:167], v[156:159]
    ds_read_b64_tr_b16 a[80:81], v118 offset:8192
    v_mfma_f32_16x16x32_bf16 v[160:163], a[84:87], a[160:163], v[160:163]
    ds_read_b64_tr_b16 a[82:83], v118 offset:12288
    v_mfma_f32_16x16x32_bf16 v[164:167], a[84:87], a[164:167], v[164:167]
    ds_read_b64_tr_b16 a[84:85], v119 offset:8192
    s_waitcnt lgkmcnt(7)
    v_mfma_f32_16x16x32_bf16 v[168:171], a[88:91], a[160:163], v[168:171]
    ds_read_b64_tr_b16 a[86:87], v119 offset:12288
    buffer_load_dwordx4 a[232:235], v100, s[64:67], s44 offen offset:2048 sc1
    v_mfma_f32_16x16x32_bf16 v[172:175], a[88:91], a[164:167], v[172:175]
    ds_read_b64_tr_b16 a[88:89], v120 offset:8192
    v_mfma_f32_16x16x32_bf16 v[176:179], a[92:95], a[160:163], v[176:179]
    ds_read_b64_tr_b16 a[90:91], v120 offset:12288
    v_mfma_f32_16x16x32_bf16 v[180:183], a[92:95], a[164:167], v[180:183]
    ds_read_b64_tr_b16 a[92:93], v121 offset:8192
    v_mfma_f32_16x16x32_bf16 v[184:187], a[96:99], a[160:163], v[184:187]
    ds_read_b64_tr_b16 a[94:95], v121 offset:12288
    buffer_load_dwordx4 a[236:239], v100, s[64:67], s44 offen offset:2304 sc1
    v_mfma_f32_16x16x32_bf16 v[188:191], a[96:99], a[164:167], v[188:191]
    ds_read_b64_tr_b16 a[96:97], v122 offset:8192
    v_mfma_f32_16x16x32_bf16 v[192:195], a[100:103], a[160:163], v[192:195]
    ds_read_b64_tr_b16 a[98:99], v122 offset:12288
    v_mfma_f32_16x16x32_bf16 v[196:199], a[100:103], a[164:167], v[196:199]
    ds_read_b64_tr_b16 a[100:101], v123 offset:8192
    ds_read_b64_tr_b16 a[102:103], v123 offset:12288
    s_waitcnt lgkmcnt(8)
    v_mfma_f32_16x16x32_bf16 v[136:139], a[72:75], a[168:171], v[136:139]
    buffer_load_dwordx4 a[240:243], v100, s[64:67], s46 offen offset:0 sc1
    v_mfma_f32_16x16x32_bf16 v[140:143], a[72:75], a[172:175], v[140:143]
    ds_read_b64_tr_b16 a[72:73], v116 offset:16384
    v_mfma_f32_16x16x32_bf16 v[144:147], a[76:79], a[168:171], v[144:147]
    ds_read_b64_tr_b16 a[74:75], v116 offset:20480
    buffer_load_dwordx4 a[244:247], v100, s[64:67], s46 offen offset:256 sc1
    v_mfma_f32_16x16x32_bf16 v[148:151], a[76:79], a[172:175], v[148:151]
    ds_read_b64_tr_b16 a[76:77], v117 offset:16384
    v_mfma_f32_16x16x32_bf16 v[152:155], a[80:83], a[168:171], v[152:155]
    ds_read_b64_tr_b16 a[78:79], v117 offset:20480
    v_mfma_f32_16x16x32_bf16 v[156:159], a[80:83], a[172:175], v[156:159]
    ds_read_b64_tr_b16 a[80:81], v118 offset:16384
    buffer_load_dwordx4 a[248:251], v100, s[64:67], s46 offen offset:2048 sc1
    v_mfma_f32_16x16x32_bf16 v[160:163], a[84:87], a[168:171], v[160:163]
    ds_read_b64_tr_b16 a[82:83], v118 offset:20480
    v_mfma_f32_16x16x32_bf16 v[164:167], a[84:87], a[172:175], v[164:167]
    ds_read_b64_tr_b16 a[84:85], v119 offset:16384
    s_waitcnt lgkmcnt(7)
    v_mfma_f32_16x16x32_bf16 v[168:171], a[88:91], a[168:171], v[168:171]
    ds_read_b64_tr_b16 a[86:87], v119 offset:20480
    buffer_load_dwordx4 a[252:255], v100, s[64:67], s46 offen offset:2304 sc1
    v_mfma_f32_16x16x32_bf16 v[172:175], a[88:91], a[172:175], v[172:175]
    ds_read_b64_tr_b16 a[88:89], v120 offset:16384
    v_mfma_f32_16x16x32_bf16 v[176:179], a[92:95], a[168:171], v[176:179]
    ds_read_b64_tr_b16 a[90:91], v120 offset:20480
    s_add_u32 s44, s44, 8192
    v_mfma_f32_16x16x32_bf16 v[180:183], a[92:95], a[172:175], v[180:183]
    ds_read_b64_tr_b16 a[92:93], v121 offset:16384
    v_mfma_f32_16x16x32_bf16 v[184:187], a[96:99], a[168:171], v[184:187]
    ds_read_b64_tr_b16 a[94:95], v121 offset:20480
    v_mfma_f32_16x16x32_bf16 v[188:191], a[96:99], a[172:175], v[188:191]
    ds_read_b64_tr_b16 a[96:97], v122 offset:16384
    s_add_u32 s46, s46, 8192
    v_mfma_f32_16x16x32_bf16 v[192:195], a[100:103], a[168:171], v[192:195]
    ds_read_b64_tr_b16 a[98:99], v122 offset:20480
    v_mfma_f32_16x16x32_bf16 v[196:199], a[100:103], a[172:175], v[196:199]
    ds_read_b64_tr_b16 a[100:101], v123 offset:16384
    ds_read_b64_tr_b16 a[102:103], v123 offset:20480
    s_waitcnt lgkmcnt(8)
    v_mfma_f32_16x16x32_bf16 v[136:139], a[72:75], a[176:179], v[136:139]
    s_add_u32 m0, s53, 65536
    v_mfma_f32_16x16x32_bf16 v[140:143], a[72:75], a[180:183], v[140:143]
    ds_read_b64_tr_b16 a[72:73], v116 offset:24576
    buffer_load_dwordx4 v102, s[68:71], s48 offen lds
    v_mfma_f32_16x16x32_bf16 v[144:147], a[76:79], a[176:179], v[144:147]
    ds_read_b64_tr_b16 a[74:75], v116 offset:28672
    v_mfma_f32_16x16x32_bf16 v[148:151], a[76:79], a[180:183], v[148:151]
    ds_read_b64_tr_b16 a[76:77], v117 offset:24576
    s_add_u32 m0, s53, 66560
    v_mfma_f32_16x16x32_bf16 v[152:155], a[80:83], a[176:179], v[152:155]
    ds_read_b64_tr_b16 a[78:79], v117 offset:28672
    buffer_load_dwordx4 v103, s[68:71], s48 offen lds
    v_mfma_f32_16x16x32_bf16 v[156:159], a[80:83], a[180:183], v[156:159]
    ds_read_b64_tr_b16 a[80:81], v118 offset:24576
    v_mfma_f32_16x16x32_bf16 v[160:163], a[84:87], a[176:179], v[160:163]
    ds_read_b64_tr_b16 a[82:83], v118 offset:28672
    s_add_u32 s48, s48, 65536
    v_mfma_f32_16x16x32_bf16 v[164:167], a[84:87], a[180:183], v[164:167]
    ds_read_b64_tr_b16 a[84:85], v119 offset:24576
    s_waitcnt lgkmcnt(7)
    v_mfma_f32_16x16x32_bf16 v[168:171], a[88:91], a[176:179], v[168:171]
    ds_read_b64_tr_b16 a[86:87], v119 offset:28672
    s_add_u32 m0, s53, 73728
    v_mfma_f32_16x16x32_bf16 v[172:175], a[88:91], a[180:183], v[172:175]
    ds_read_b64_tr_b16 a[88:89], v120 offset:24576
    buffer_load_dwordx4 v102, s[68:71], s48 offen lds
    v_mfma_f32_16x16x32_bf16 v[176:179], a[92:95], a[176:179], v[176:179]
    ds_read_b64_tr_b16 a[90:91], v120 offset:28672
    v_mfma_f32_16x16x32_bf16 v[180:183], a[92:95], a[180:183], v[180:183]
    ds_read_b64_tr_b16 a[92:93], v121 offset:24576
    s_add_u32 m0, s53, 74752
    v_mfma_f32_16x16x32_bf16 v[184:187], a[96:99], a[176:179], v[184:187]
    ds_read_b64_tr_b16 a[94:95], v121 offset:28672
    buffer_load_dwordx4 v103, s[68:71], s48 offen lds
    v_mfma_f32_16x16x32_bf16 v[188:191], a[96:99], a[180:183], v[188:191]
    ds_read_b64_tr_b16 a[96:97], v122 offset:24576
    v_mfma_f32_16x16x32_bf16 v[192:195], a[100:103], a[176:179], v[192:195]
    ds_read_b64_tr_b16 a[98:99], v122 offset:28672
    s_add_u32 s48, s48, 65536
    v_mfma_f32_16x16x32_bf16 v[196:199], a[100:103], a[180:183], v[196:199]
    ds_read_b64_tr_b16 a[100:101], v123 offset:24576
    ds_read_b64_tr_b16 a[102:103], v123 offset:28672
    s_waitcnt lgkmcnt(8)
    v_mfma_f32_16x16x32_bf16 v[136:139], a[72:75], a[184:187], v[136:139]
    s_add_u32 m0, s53, 81920
    v_mfma_f32_16x16x32_bf16 v[140:143], a[72:75], a[188:191], v[140:143]
    ds_read_b64_tr_b16 a[72:73], v116 offset:32768
    buffer_load_dwordx4 v102, s[68:71], s48 offen lds
    v_mfma_f32_16x16x32_bf16 v[144:147], a[76:79], a[184:187], v[144:147]
    ds_read_b64_tr_b16 a[74:75], v116 offset:36864
    v_mfma_f32_16x16x32_bf16 v[148:151], a[76:79], a[188:191], v[148:151]
    ds_read_b64_tr_b16 a[76:77], v117 offset:32768
    s_add_u32 m0, s53, 82944
    v_mfma_f32_16x16x32_bf16 v[152:155], a[80:83], a[184:187], v[152:155]
    ds_read_b64_tr_b16 a[78:79], v117 offset:36864
    buffer_load_dwordx4 v103, s[68:71], s48 offen lds
    v_mfma_f32_16x16x32_bf16 v[156:159], a[80:83], a[188:191], v[156:159]
    ds_read_b64_tr_b16 a[80:81], v118 offset:32768
    v_mfma_f32_16x16x32_bf16 v[160:163], a[84:87], a[184:187], v[160:163]
    ds_read_b64_tr_b16 a[82:83], v118 offset:36864
    s_add_u32 s48, s48, 65536
    v_mfma_f32_16x16x32_bf16 v[164:167], a[84:87], a[188:191], v[164:167]
    ds_read_b64_tr_b16 a[84:85], v119 offset:32768
    s_waitcnt lgkmcnt(7)
    v_mfma_f32_16x16x32_bf16 v[168:171], a[88:91], a[184:187], v[168:171]
    ds_read_b64_tr_b16 a[86:87], v119 offset:36864
    s_add_u32 m0, s53, 90112
    v_mfma_f32_16x16x32_bf16 v[172:175], a[88:91], a[188:191], v[172:175]
    ds_read_b64_tr_b16 a[88:89], v120 offset:32768
    buffer_load_dwordx4 v102, s[68:71], s48 offen lds
    v_mfma_f32_16x16x32_bf16 v[176:179], a[92:95], a[184:187], v[176:179]
    ds_read_b64_tr_b16 a[90:91], v120 offset:36864
    v_mfma_f32_16x16x32_bf16 v[180:183], a[92:95], a[188:191], v[180:183]
    ds_read_b64_tr_b16 a[92:93], v121 offset:32768
    s_add_u32 m0, s53, 91136
    v_mfma_f32_16x16x32_bf16 v[184:187], a[96:99], a[184:187], v[184:187]
    ds_read_b64_tr_b16 a[94:95], v121 offset:36864
    buffer_load_dwordx4 v103, s[68:71], s48 offen lds
    v_mfma_f32_16x16x32_bf16 v[188:191], a[96:99], a[188:191], v[188:191]
    ds_read_b64_tr_b16 a[96:97], v122 offset:32768
    v_mfma_f32_16x16x32_bf16 v[192:195], a[100:103], a[184:187], v[192:195]
    ds_read_b64_tr_b16 a[98:99], v122 offset:36864
    s_add_u32 s48, s48, 65536
    v_mfma_f32_16x16x32_bf16 v[196:199], a[100:103], a[188:191], v[196:199]
    ds_read_b64_tr_b16 a[100:101], v123 offset:32768
    ds_read_b64_tr_b16 a[102:103], v123 offset:36864
    s_waitcnt vmcnt(20)
    s_barrier
    s_waitcnt lgkmcnt(8)
    v_mfma_f32_16x16x32_bf16 v[136:139], a[72:75], a[192:195], v[136:139]
    buffer_load_dwordx4 a[128:131], v100, s[64:67], s44 offen offset:0 sc1
    v_mfma_f32_16x16x32_bf16 v[140:143], a[72:75], a[196:199], v[140:143]
    ds_read_b64_tr_b16 a[72:73], v116 offset:40960
    v_mfma_f32_16x16x32_bf16 v[144:147], a[76:79], a[192:195], v[144:147]
    ds_read_b64_tr_b16 a[74:75], v116 offset:45056
    v_mfma_f32_16x16x32_bf16 v[148:151], a[76:79], a[196:199], v[148:151]
    ds_read_b64_tr_b16 a[76:77], v117 offset:40960
    v_mfma_f32_16x16x32_bf16 v[152:155], a[80:83], a[192:195], v[152:155]
    ds_read_b64_tr_b16 a[78:79], v117 offset:45056
    buffer_load_dwordx4 a[132:135], v100, s[64:67], s44 offen offset:256 sc1
    v_mfma_f32_16x16x32_bf16 v[156:159], a[80:83], a[196:199], v[156:159]
    ds_read_b64_tr_b16 a[80:81], v118 offset:40960
    v_mfma_f32_16x16x32_bf16 v[160:163], a[84:87], a[192:195], v[160:163]
    ds_read_b64_tr_b16 a[82:83], v118 offset:45056
    v_mfma_f32_16x16x32_bf16 v[164:167], a[84:87], a[196:199], v[164:167]
    ds_read_b64_tr_b16 a[84:85], v119 offset:40960
    s_waitcnt lgkmcnt(7)
    v_mfma_f32_16x16x32_bf16 v[168:171], a[88:91], a[192:195], v[168:171]
    ds_read_b64_tr_b16 a[86:87], v119 offset:45056
    buffer_load_dwordx4 a[136:139], v100, s[64:67], s44 offen offset:2048 sc1
    v_mfma_f32_16x16x32_bf16 v[172:175], a[88:91], a[196:199], v[172:175]
    ds_read_b64_tr_b16 a[88:89], v120 offset:40960
    v_mfma_f32_16x16x32_bf16 v[176:179], a[92:95], a[192:195], v[176:179]
    ds_read_b64_tr_b16 a[90:91], v120 offset:45056
    v_mfma_f32_16x16x32_bf16 v[180:183], a[92:95], a[196:199], v[180:183]
    ds_read_b64_tr_b16 a[92:93], v121 offset:40960
    v_mfma_f32_16x16x32_bf16 v[184:187], a[96:99], a[192:195], v[184:187]
    ds_read_b64_tr_b16 a[94:95], v121 offset:45056
    buffer_load_dwordx4 a[140:143], v100, s[64:67], s44 offen offset:2304 sc1
    v_mfma_f32_16x16x32_bf16 v[188:191], a[96:99], a[196:199], v[188:191]
    ds_read_b64_tr_b16 a[96:97], v122 offset:40960
    v_mfma_f32_16x16x32_bf16 v[192:195], a[100:103], a[192:195], v[192:195]
    ds_read_b64_tr_b16 a[98:99], v122 offset:45056
    v_mfma_f32_16x16x32_bf16 v[196:199], a[100:103], a[196:199], v[196:199]
    ds_read_b64_tr_b16 a[100:101], v123 offset:40960
    ds_read_b64_tr_b16 a[102:103], v123 offset:45056
    s_waitcnt lgkmcnt(8)
    v_mfma_f32_16x16x32_bf16 v[136:139], a[72:75], a[200:203], v[136:139]
    buffer_load_dwordx4 a[144:147], v100, s[64:67], s46 offen offset:0 sc1
    v_mfma_f32_16x16x32_bf16 v[140:143], a[72:75], a[204:207], v[140:143]
    ds_read_b64_tr_b16 a[72:73], v116 offset:49152
    v_mfma_f32_16x16x32_bf16 v[144:147], a[76:79], a[200:203], v[144:147]
    ds_read_b64_tr_b16 a[74:75], v116 offset:53248
    buffer_load_dwordx4 a[148:151], v100, s[64:67], s46 offen offset:256 sc1
    v_mfma_f32_16x16x32_bf16 v[148:151], a[76:79], a[204:207], v[148:151]
    ds_read_b64_tr_b16 a[76:77], v117 offset:49152
    v_mfma_f32_16x16x32_bf16 v[152:155], a[80:83], a[200:203], v[152:155]
    ds_read_b64_tr_b16 a[78:79], v117 offset:53248
    v_mfma_f32_16x16x32_bf16 v[156:159], a[80:83], a[204:207], v[156:159]
    ds_read_b64_tr_b16 a[80:81], v118 offset:49152
    buffer_load_dwordx4 a[152:155], v100, s[64:67], s46 offen offset:2048 sc1
    v_mfma_f32_16x16x32_bf16 v[160:163], a[84:87], a[200:203], v[160:163]
    ds_read_b64_tr_b16 a[82:83], v118 offset:53248
    v_mfma_f32_16x16x32_bf16 v[164:167], a[84:87], a[204:207], v[164:167]
    ds_read_b64_tr_b16 a[84:85], v119 offset:49152
    s_waitcnt lgkmcnt(7)
    v_mfma_f32_16x16x32_bf16 v[168:171], a[88:91], a[200:203], v[168:171]
    ds_read_b64_tr_b16 a[86:87], v119 offset:53248
    buffer_load_dwordx4 a[156:159], v100, s[64:67], s46 offen offset:2304 sc1
    v_mfma_f32_16x16x32_bf16 v[172:175], a[88:91], a[204:207], v[172:175]
    ds_read_b64_tr_b16 a[88:89], v120 offset:49152
    v_mfma_f32_16x16x32_bf16 v[176:179], a[92:95], a[200:203], v[176:179]
    ds_read_b64_tr_b16 a[90:91], v120 offset:53248
    s_add_u32 s44, s44, 8192
    v_mfma_f32_16x16x32_bf16 v[180:183], a[92:95], a[204:207], v[180:183]
    ds_read_b64_tr_b16 a[92:93], v121 offset:49152
    v_mfma_f32_16x16x32_bf16 v[184:187], a[96:99], a[200:203], v[184:187]
    ds_read_b64_tr_b16 a[94:95], v121 offset:53248
    v_mfma_f32_16x16x32_bf16 v[188:191], a[96:99], a[204:207], v[188:191]
    ds_read_b64_tr_b16 a[96:97], v122 offset:49152
    s_add_u32 s46, s46, 8192
    v_mfma_f32_16x16x32_bf16 v[192:195], a[100:103], a[200:203], v[192:195]
    ds_read_b64_tr_b16 a[98:99], v122 offset:53248
    v_mfma_f32_16x16x32_bf16 v[196:199], a[100:103], a[204:207], v[196:199]
    ds_read_b64_tr_b16 a[100:101], v123 offset:49152
    ds_read_b64_tr_b16 a[102:103], v123 offset:53248
    s_waitcnt lgkmcnt(8)
    v_mfma_f32_16x16x32_bf16 v[136:139], a[72:75], a[208:211], v[136:139]
    s_add_u32 m0, s53, 98304
    v_mfma_f32_16x16x32_bf16 v[140:143], a[72:75], a[212:215], v[140:143]
    ds_read_b64_tr_b16 a[72:73], v116 offset:57344
    buffer_load_dwordx4 v102, s[68:71], s48 offen lds
    v_mfma_f32_16x16x32_bf16 v[144:147], a[76:79], a[208:211], v[144:147]
    ds_read_b64_tr_b16 a[74:75], v116 offset:61440
    v_mfma_f32_16x16x32_bf16 v[148:151], a[76:79], a[212:215], v[148:151]
    ds_read_b64_tr_b16 a[76:77], v117 offset:57344
    s_add_u32 m0, s53, 99328
    v_mfma_f32_16x16x32_bf16 v[152:155], a[80:83], a[208:211], v[152:155]
    ds_read_b64_tr_b16 a[78:79], v117 offset:61440
    buffer_load_dwordx4 v103, s[68:71], s48 offen lds
    v_mfma_f32_16x16x32_bf16 v[156:159], a[80:83], a[212:215], v[156:159]
    ds_read_b64_tr_b16 a[80:81], v118 offset:57344
    v_mfma_f32_16x16x32_bf16 v[160:163], a[84:87], a[208:211], v[160:163]
    ds_read_b64_tr_b16 a[82:83], v118 offset:61440
    s_add_u32 s48, s48, 65536
    v_mfma_f32_16x16x32_bf16 v[164:167], a[84:87], a[212:215], v[164:167]
    ds_read_b64_tr_b16 a[84:85], v119 offset:57344
    s_waitcnt lgkmcnt(7)
    v_mfma_f32_16x16x32_bf16 v[168:171], a[88:91], a[208:211], v[168:171]
    ds_read_b64_tr_b16 a[86:87], v119 offset:61440
    s_add_u32 m0, s53, 106496
    v_mfma_f32_16x16x32_bf16 v[172:175], a[88:91], a[212:215], v[172:175]
    ds_read_b64_tr_b16 a[88:89], v120 offset:57344
    buffer_load_dwordx4 v102, s[68:71], s48 offen lds
    v_mfma_f32_16x16x32_bf16 v[176:179], a[92:95], a[208:211], v[176:179]
    ds_read_b64_tr_b16 a[90:91], v120 offset:61440
    v_mfma_f32_16x16x32_bf16 v[180:183], a[92:95], a[212:215], v[180:183]
    ds_read_b64_tr_b16 a[92:93], v121 offset:57344
    s_add_u32 m0, s53, 107520
    v_mfma_f32_16x16x32_bf16 v[184:187], a[96:99], a[208:211], v[184:187]
    ds_read_b64_tr_b16 a[94:95], v121 offset:61440
    buffer_load_dwordx4 v103, s[68:71], s48 offen lds
    v_mfma_f32_16x16x32_bf16 v[188:191], a[96:99], a[212:215], v[188:191]
    ds_read_b64_tr_b16 a[96:97], v122 offset:57344
    v_mfma_f32_16x16x32_bf16 v[192:195], a[100:103], a[208:211], v[192:195]
    ds_read_b64_tr_b16 a[98:99], v122 offset:61440
    s_add_u32 s48, s48, 65536
    v_mfma_f32_16x16x32_bf16 v[196:199], a[100:103], a[212:215], v[196:199]
    ds_read_b64_tr_b16 a[100:101], v123 offset:57344
    ds_read_b64_tr_b16 a[102:103], v123 offset:61440
    s_waitcnt lgkmcnt(8)
    v_mfma_f32_16x16x32_bf16 v[136:139], a[72:75], a[216:219], v[136:139]
    s_add_u32 m0, s53, 114688
    v_mfma_f32_16x16x32_bf16 v[140:143], a[72:75], a[220:223], v[140:143]
    ds_read_b64_tr_b16 a[72:73], v108 offset:0
    buffer_load_dwordx4 v102, s[68:71], s48 offen lds
    v_mfma_f32_16x16x32_bf16 v[144:147], a[76:79], a[216:219], v[144:147]
    ds_read_b64_tr_b16 a[74:75], v108 offset:4096
    v_mfma_f32_16x16x32_bf16 v[148:151], a[76:79], a[220:223], v[148:151]
    ds_read_b64_tr_b16 a[76:77], v109 offset:0
    s_add_u32 m0, s53, 115712
    v_mfma_f32_16x16x32_bf16 v[152:155], a[80:83], a[216:219], v[152:155]
    ds_read_b64_tr_b16 a[78:79], v109 offset:4096
    buffer_load_dwordx4 v103, s[68:71], s48 offen lds
    v_mfma_f32_16x16x32_bf16 v[156:159], a[80:83], a[220:223], v[156:159]
    ds_read_b64_tr_b16 a[80:81], v110 offset:0
    v_mfma_f32_16x16x32_bf16 v[160:163], a[84:87], a[216:219], v[160:163]
    ds_read_b64_tr_b16 a[82:83], v110 offset:4096
    s_add_u32 s48, s48, 65536
    v_mfma_f32_16x16x32_bf16 v[164:167], a[84:87], a[220:223], v[164:167]
    ds_read_b64_tr_b16 a[84:85], v111 offset:0
    s_waitcnt lgkmcnt(7)
    v_mfma_f32_16x16x32_bf16 v[168:171], a[88:91], a[216:219], v[168:171]
    ds_read_b64_tr_b16 a[86:87], v111 offset:4096
    s_add_u32 m0, s53, 122880
    v_mfma_f32_16x16x32_bf16 v[172:175], a[88:91], a[220:223], v[172:175]
    ds_read_b64_tr_b16 a[88:89], v112 offset:0
    buffer_load_dwordx4 v102, s[68:71], s48 offen lds
    v_mfma_f32_16x16x32_bf16 v[176:179], a[92:95], a[216:219], v[176:179]
    ds_read_b64_tr_b16 a[90:91], v112 offset:4096
    v_mfma_f32_16x16x32_bf16 v[180:183], a[92:95], a[220:223], v[180:183]
    ds_read_b64_tr_b16 a[92:93], v113 offset:0
    s_add_u32 m0, s53, 123904
    v_mfma_f32_16x16x32_bf16 v[184:187], a[96:99], a[216:219], v[184:187]
    ds_read_b64_tr_b16 a[94:95], v113 offset:4096
    buffer_load_dwordx4 v103, s[68:71], s48 offen lds
    v_mfma_f32_16x16x32_bf16 v[188:191], a[96:99], a[220:223], v[188:191]
    ds_read_b64_tr_b16 a[96:97], v114 offset:0
    v_mfma_f32_16x16x32_bf16 v[192:195], a[100:103], a[216:219], v[192:195]
    ds_read_b64_tr_b16 a[98:99], v114 offset:4096
    s_add_u32 s48, s48, 65536
    v_mfma_f32_16x16x32_bf16 v[196:199], a[100:103], a[220:223], v[196:199]
    ds_read_b64_tr_b16 a[100:101], v115 offset:0
    ds_read_b64_tr_b16 a[102:103], v115 offset:4096
    s_waitcnt vmcnt(16)
    s_barrier
    s_waitcnt lgkmcnt(8)
    v_mfma_f32_16x16x32_bf16 v[136:139], a[72:75], a[224:227], v[136:139]
    buffer_load_dwordx4 a[160:163], v100, s[64:67], s44 offen offset:0 sc1
    v_mfma_f32_16x16x32_bf16 v[140:143], a[72:75], a[228:231], v[140:143]
    ds_read_b64_tr_b16 a[72:73], v108 offset:8192
    v_mfma_f32_16x16x32_bf16 v[144:147], a[76:79], a[224:227], v[144:147]
    ds_read_b64_tr_b16 a[74:75], v108 offset:12288
    v_mfma_f32_16x16x32_bf16 v[148:151], a[76:79], a[228:231], v[148:151]
    ds_read_b64_tr_b16 a[76:77], v109 offset:8192
    v_mfma_f32_16x16x32_bf16 v[152:155], a[80:83], a[224:227], v[152:155]
    ds_read_b64_tr_b16 a[78:79], v109 offset:12288
    buffer_load_dwordx4 a[164:167], v100, s[64:67], s44 offen offset:256 sc1
    v_mfma_f32_16x16x32_bf16 v[156:159], a[80:83], a[228:231], v[156:159]
    ds_read_b64_tr_b16 a[80:81], v110 offset:8192
    v_mfma_f32_16x16x32_bf16 v[160:163], a[84:87], a[224:227], v[160:163]
    ds_read_b64_tr_b16 a[82:83], v110 offset:12288
    v_mfma_f32_16x16x32_bf16 v[164:167], a[84:87], a[228:231], v[164:167]
    ds_read_b64_tr_b16 a[84:85], v111 offset:8192
    s_waitcnt lgkmcnt(7)
    v_mfma_f32_16x16x32_bf16 v[168:171], a[88:91], a[224:227], v[168:171]
    ds_read_b64_tr_b16 a[86:87], v111 offset:12288
    buffer_load_dwordx4 a[168:171], v100, s[64:67], s44 offen offset:2048 sc1
    v_mfma_f32_16x16x32_bf16 v[172:175], a[88:91], a[228:231], v[172:175]
    ds_read_b64_tr_b16 a[88:89], v112 offset:8192
    v_mfma_f32_16x16x32_bf16 v[176:179], a[92:95], a[224:227], v[176:179]
    ds_read_b64_tr_b16 a[90:91], v112 offset:12288
    v_mfma_f32_16x16x32_bf16 v[180:183], a[92:95], a[228:231], v[180:183]
    ds_read_b64_tr_b16 a[92:93], v113 offset:8192
    v_mfma_f32_16x16x32_bf16 v[184:187], a[96:99], a[224:227], v[184:187]
    ds_read_b64_tr_b16 a[94:95], v113 offset:12288
    buffer_load_dwordx4 a[172:175], v100, s[64:67], s44 offen offset:2304 sc1
    v_mfma_f32_16x16x32_bf16 v[188:191], a[96:99], a[228:231], v[188:191]
    ds_read_b64_tr_b16 a[96:97], v114 offset:8192
    v_mfma_f32_16x16x32_bf16 v[192:195], a[100:103], a[224:227], v[192:195]
    ds_read_b64_tr_b16 a[98:99], v114 offset:12288
    v_mfma_f32_16x16x32_bf16 v[196:199], a[100:103], a[228:231], v[196:199]
    ds_read_b64_tr_b16 a[100:101], v115 offset:8192
    ds_read_b64_tr_b16 a[102:103], v115 offset:12288
    s_waitcnt lgkmcnt(8)
    v_mfma_f32_16x16x32_bf16 v[136:139], a[72:75], a[232:235], v[136:139]
    buffer_load_dwordx4 a[176:179], v100, s[64:67], s46 offen offset:0 sc1
    v_mfma_f32_16x16x32_bf16 v[140:143], a[72:75], a[236:239], v[140:143]
    ds_read_b64_tr_b16 a[72:73], v108 offset:16384
    v_mfma_f32_16x16x32_bf16 v[144:147], a[76:79], a[232:235], v[144:147]
    ds_read_b64_tr_b16 a[74:75], v108 offset:20480
    buffer_load_dwordx4 a[180:183], v100, s[64:67], s46 offen offset:256 sc1
    v_mfma_f32_16x16x32_bf16 v[148:151], a[76:79], a[236:239], v[148:151]
    ds_read_b64_tr_b16 a[76:77], v109 offset:16384
    v_mfma_f32_16x16x32_bf16 v[152:155], a[80:83], a[232:235], v[152:155]
    ds_read_b64_tr_b16 a[78:79], v109 offset:20480
    v_mfma_f32_16x16x32_bf16 v[156:159], a[80:83], a[236:239], v[156:159]
    ds_read_b64_tr_b16 a[80:81], v110 offset:16384
    buffer_load_dwordx4 a[184:187], v100, s[64:67], s46 offen offset:2048 sc1
    v_mfma_f32_16x16x32_bf16 v[160:163], a[84:87], a[232:235], v[160:163]
    ds_read_b64_tr_b16 a[82:83], v110 offset:20480
    v_mfma_f32_16x16x32_bf16 v[164:167], a[84:87], a[236:239], v[164:167]
    ds_read_b64_tr_b16 a[84:85], v111 offset:16384
    s_waitcnt lgkmcnt(7)
    v_mfma_f32_16x16x32_bf16 v[168:171], a[88:91], a[232:235], v[168:171]
    ds_read_b64_tr_b16 a[86:87], v111 offset:20480
    buffer_load_dwordx4 a[188:191], v100, s[64:67], s46 offen offset:2304 sc1
    v_mfma_f32_16x16x32_bf16 v[172:175], a[88:91], a[236:239], v[172:175]
    ds_read_b64_tr_b16 a[88:89], v112 offset:16384
    v_mfma_f32_16x16x32_bf16 v[176:179], a[92:95], a[232:235], v[176:179]
    ds_read_b64_tr_b16 a[90:91], v112 offset:20480
    s_add_u32 s44, s44, 8192
    v_mfma_f32_16x16x32_bf16 v[180:183], a[92:95], a[236:239], v[180:183]
    ds_read_b64_tr_b16 a[92:93], v113 offset:16384
    v_mfma_f32_16x16x32_bf16 v[184:187], a[96:99], a[232:235], v[184:187]
    ds_read_b64_tr_b16 a[94:95], v113 offset:20480
    v_mfma_f32_16x16x32_bf16 v[188:191], a[96:99], a[236:239], v[188:191]
    ds_read_b64_tr_b16 a[96:97], v114 offset:16384
    s_add_u32 s46, s46, 8192
    v_mfma_f32_16x16x32_bf16 v[192:195], a[100:103], a[232:235], v[192:195]
    ds_read_b64_tr_b16 a[98:99], v114 offset:20480
    v_mfma_f32_16x16x32_bf16 v[196:199], a[100:103], a[236:239], v[196:199]
    ds_read_b64_tr_b16 a[100:101], v115 offset:16384
    ds_read_b64_tr_b16 a[102:103], v115 offset:20480
    s_waitcnt lgkmcnt(8)
    v_mfma_f32_16x16x32_bf16 v[136:139], a[72:75], a[240:243], v[136:139]
    s_add_u32 m0, s53, 131072
    v_mfma_f32_16x16x32_bf16 v[140:143], a[72:75], a[244:247], v[140:143]
    ds_read_b64_tr_b16 a[72:73], v108 offset:24576
    buffer_load_dwordx4 v102, s[68:71], s48 offen lds
    v_mfma_f32_16x16x32_bf16 v[144:147], a[76:79], a[240:243], v[144:147]
    ds_read_b64_tr_b16 a[74:75], v108 offset:28672
    v_mfma_f32_16x16x32_bf16 v[148:151], a[76:79], a[244:247], v[148:151]
    ds_read_b64_tr_b16 a[76:77], v109 offset:24576
    s_add_u32 m0, s53, 132096
    v_mfma_f32_16x16x32_bf16 v[152:155], a[80:83], a[240:243], v[152:155]
    ds_read_b64_tr_b16 a[78:79], v109 offset:28672
    buffer_load_dwordx4 v103, s[68:71], s48 offen lds
    v_mfma_f32_16x16x32_bf16 v[156:159], a[80:83], a[244:247], v[156:159]
    ds_read_b64_tr_b16 a[80:81], v110 offset:24576
    v_mfma_f32_16x16x32_bf16 v[160:163], a[84:87], a[240:243], v[160:163]
    ds_read_b64_tr_b16 a[82:83], v110 offset:28672
    s_add_u32 s48, s48, 65536
    v_mfma_f32_16x16x32_bf16 v[164:167], a[84:87], a[244:247], v[164:167]
    ds_read_b64_tr_b16 a[84:85], v111 offset:24576
    s_waitcnt lgkmcnt(7)
    v_mfma_f32_16x16x32_bf16 v[168:171], a[88:91], a[240:243], v[168:171]
    ds_read_b64_tr_b16 a[86:87], v111 offset:28672
    s_add_u32 m0, s53, 139264
    v_mfma_f32_16x16x32_bf16 v[172:175], a[88:91], a[244:247], v[172:175]
    ds_read_b64_tr_b16 a[88:89], v112 offset:24576
    buffer_load_dwordx4 v102, s[68:71], s48 offen lds
    v_mfma_f32_16x16x32_bf16 v[176:179], a[92:95], a[240:243], v[176:179]
    ds_read_b64_tr_b16 a[90:91], v112 offset:28672
    v_mfma_f32_16x16x32_bf16 v[180:183], a[92:95], a[244:247], v[180:183]
    ds_read_b64_tr_b16 a[92:93], v113 offset:24576
    s_add_u32 m0, s53, 140288
    v_mfma_f32_16x16x32_bf16 v[184:187], a[96:99], a[240:243], v[184:187]
    ds_read_b64_tr_b16 a[94:95], v113 offset:28672
    buffer_load_dwordx4 v103, s[68:71], s48 offen lds
    v_mfma_f32_16x16x32_bf16 v[188:191], a[96:99], a[244:247], v[188:191]
    ds_read_b64_tr_b16 a[96:97], v114 offset:24576
    v_mfma_f32_16x16x32_bf16 v[192:195], a[100:103], a[240:243], v[192:195]
    ds_read_b64_tr_b16 a[98:99], v114 offset:28672
    s_add_u32 s48, s48, 65536
    v_mfma_f32_16x16x32_bf16 v[196:199], a[100:103], a[244:247], v[196:199]
    ds_read_b64_tr_b16 a[100:101], v115 offset:24576
    ds_read_b64_tr_b16 a[102:103], v115 offset:28672
    s_waitcnt lgkmcnt(8)
    v_mfma_f32_16x16x32_bf16 v[136:139], a[72:75], a[248:251], v[136:139]
    s_add_u32 m0, s53, 147456
    v_mfma_f32_16x16x32_bf16 v[140:143], a[72:75], a[252:255], v[140:143]
    ds_read_b64_tr_b16 a[72:73], v108 offset:32768
    buffer_load_dwordx4 v102, s[68:71], s48 offen lds
    v_mfma_f32_16x16x32_bf16 v[144:147], a[76:79], a[248:251], v[144:147]
    ds_read_b64_tr_b16 a[74:75], v108 offset:36864
    v_mfma_f32_16x16x32_bf16 v[148:151], a[76:79], a[252:255], v[148:151]
    ds_read_b64_tr_b16 a[76:77], v109 offset:32768
    s_add_u32 m0, s53, 148480
    v_mfma_f32_16x16x32_bf16 v[152:155], a[80:83], a[248:251], v[152:155]
    ds_read_b64_tr_b16 a[78:79], v109 offset:36864
    buffer_load_dwordx4 v103, s[68:71], s48 offen lds
    v_mfma_f32_16x16x32_bf16 v[156:159], a[80:83], a[252:255], v[156:159]
    ds_read_b64_tr_b16 a[80:81], v110 offset:32768
    v_mfma_f32_16x16x32_bf16 v[160:163], a[84:87], a[248:251], v[160:163]
    ds_read_b64_tr_b16 a[82:83], v110 offset:36864
    s_add_u32 s48, s48, 65536
    v_mfma_f32_16x16x32_bf16 v[164:167], a[84:87], a[252:255], v[164:167]
    ds_read_b64_tr_b16 a[84:85], v111 offset:32768
    s_waitcnt lgkmcnt(7)
    v_mfma_f32_16x16x32_bf16 v[168:171], a[88:91], a[248:251], v[168:171]
    ds_read_b64_tr_b16 a[86:87], v111 offset:36864
    s_add_u32 m0, s53, 155648
    v_mfma_f32_16x16x32_bf16 v[172:175], a[88:91], a[252:255], v[172:175]
    ds_read_b64_tr_b16 a[88:89], v112 offset:32768
    buffer_load_dwordx4 v102, s[68:71], s48 offen lds
    v_mfma_f32_16x16x32_bf16 v[176:179], a[92:95], a[248:251], v[176:179]
    ds_read_b64_tr_b16 a[90:91], v112 offset:36864
    v_mfma_f32_16x16x32_bf16 v[180:183], a[92:95], a[252:255], v[180:183]
    ds_read_b64_tr_b16 a[92:93], v113 offset:32768
    s_add_u32 m0, s53, 156672
    v_mfma_f32_16x16x32_bf16 v[184:187], a[96:99], a[248:251], v[184:187]
    ds_read_b64_tr_b16 a[94:95], v113 offset:36864
    buffer_load_dwordx4 v103, s[68:71], s48 offen lds
    v_mfma_f32_16x16x32_bf16 v[188:191], a[96:99], a[252:255], v[188:191]
    ds_read_b64_tr_b16 a[96:97], v114 offset:32768
    v_mfma_f32_16x16x32_bf16 v[192:195], a[100:103], a[248:251], v[192:195]
    ds_read_b64_tr_b16 a[98:99], v114 offset:36864
    s_add_u32 s48, s48, 65536
    v_mfma_f32_16x16x32_bf16 v[196:199], a[100:103], a[252:255], v[196:199]
    ds_read_b64_tr_b16 a[100:101], v115 offset:32768
    ds_read_b64_tr_b16 a[102:103], v115 offset:36864
    s_waitcnt vmcnt(16)
    s_barrier
    s_waitcnt lgkmcnt(8)
    v_mfma_f32_16x16x32_bf16 v[136:139], a[72:75], a[128:131], v[136:139]
    buffer_load_dwordx4 a[192:195], v100, s[64:67], s44 offen offset:0 sc1
    v_mfma_f32_16x16x32_bf16 v[140:143], a[72:75], a[132:135], v[140:143]
    ds_read_b64_tr_b16 a[72:73], v108 offset:40960
    v_mfma_f32_16x16x32_bf16 v[144:147], a[76:79], a[128:131], v[144:147]
    ds_read_b64_tr_b16 a[74:75], v108 offset:45056
    v_mfma_f32_16x16x32_bf16 v[148:151], a[76:79], a[132:135], v[148:151]
    ds_read_b64_tr_b16 a[76:77], v109 offset:40960
    v_mfma_f32_16x16x32_bf16 v[152:155], a[80:83], a[128:131], v[152:155]
    ds_read_b64_tr_b16 a[78:79], v109 offset:45056
    buffer_load_dwordx4 a[196:199], v100, s[64:67], s44 offen offset:256 sc1
    v_mfma_f32_16x16x32_bf16 v[156:159], a[80:83], a[132:135], v[156:159]
    ds_read_b64_tr_b16 a[80:81], v110 offset:40960
    v_mfma_f32_16x16x32_bf16 v[160:163], a[84:87], a[128:131], v[160:163]
    ds_read_b64_tr_b16 a[82:83], v110 offset:45056
    v_mfma_f32_16x16x32_bf16 v[164:167], a[84:87], a[132:135], v[164:167]
    ds_read_b64_tr_b16 a[84:85], v111 offset:40960
    s_waitcnt lgkmcnt(7)
    v_mfma_f32_16x16x32_bf16 v[168:171], a[88:91], a[128:131], v[168:171]
    ds_read_b64_tr_b16 a[86:87], v111 offset:45056
    buffer_load_dwordx4 a[200:203], v100, s[64:67], s44 offen offset:2048 sc1
    v_mfma_f32_16x16x32_bf16 v[172:175], a[88:91], a[132:135], v[172:175]
    ds_read_b64_tr_b16 a[88:89], v112 offset:40960
    v_mfma_f32_16x16x32_bf16 v[176:179], a[92:95], a[128:131], v[176:179]
    ds_read_b64_tr_b16 a[90:91], v112 offset:45056
    v_mfma_f32_16x16x32_bf16 v[180:183], a[92:95], a[132:135], v[180:183]
    ds_read_b64_tr_b16 a[92:93], v113 offset:40960
    v_mfma_f32_16x16x32_bf16 v[184:187], a[96:99], a[128:131], v[184:187]
    ds_read_b64_tr_b16 a[94:95], v113 offset:45056
    buffer_load_dwordx4 a[204:207], v100, s[64:67], s44 offen offset:2304 sc1
    v_mfma_f32_16x16x32_bf16 v[188:191], a[96:99], a[132:135], v[188:191]
    ds_read_b64_tr_b16 a[96:97], v114 offset:40960
    v_mfma_f32_16x16x32_bf16 v[192:195], a[100:103], a[128:131], v[192:195]
    ds_read_b64_tr_b16 a[98:99], v114 offset:45056
    v_mfma_f32_16x16x32_bf16 v[196:199], a[100:103], a[132:135], v[196:199]
    ds_read_b64_tr_b16 a[100:101], v115 offset:40960
    ds_read_b64_tr_b16 a[102:103], v115 offset:45056
    s_waitcnt lgkmcnt(8)
    v_mfma_f32_16x16x32_bf16 v[136:139], a[72:75], a[136:139], v[136:139]
    buffer_load_dwordx4 a[208:211], v100, s[64:67], s46 offen offset:0 sc1
    v_mfma_f32_16x16x32_bf16 v[140:143], a[72:75], a[140:143], v[140:143]
    ds_read_b64_tr_b16 a[72:73], v108 offset:49152
    v_mfma_f32_16x16x32_bf16 v[144:147], a[76:79], a[136:139], v[144:147]
    ds_read_b64_tr_b16 a[74:75], v108 offset:53248
    buffer_load_dwordx4 a[212:215], v100, s[64:67], s46 offen offset:256 sc1
    v_mfma_f32_16x16x32_bf16 v[148:151], a[76:79], a[140:143], v[148:151]
    ds_read_b64_tr_b16 a[76:77], v109 offset:49152
    v_mfma_f32_16x16x32_bf16 v[152:155], a[80:83], a[136:139], v[152:155]
    ds_read_b64_tr_b16 a[78:79], v109 offset:53248
    v_mfma_f32_16x16x32_bf16 v[156:159], a[80:83], a[140:143], v[156:159]
    ds_read_b64_tr_b16 a[80:81], v110 offset:49152
    buffer_load_dwordx4 a[216:219], v100, s[64:67], s46 offen offset:2048 sc1
    v_mfma_f32_16x16x32_bf16 v[160:163], a[84:87], a[136:139], v[160:163]
    ds_read_b64_tr_b16 a[82:83], v110 offset:53248
    v_mfma_f32_16x16x32_bf16 v[164:167], a[84:87], a[140:143], v[164:167]
    ds_read_b64_tr_b16 a[84:85], v111 offset:49152
    s_waitcnt lgkmcnt(7)
    v_mfma_f32_16x16x32_bf16 v[168:171], a[88:91], a[136:139], v[168:171]
    ds_read_b64_tr_b16 a[86:87], v111 offset:53248
    buffer_load_dwordx4 a[220:223], v100, s[64:67], s46 offen offset:2304 sc1
    v_mfma_f32_16x16x32_bf16 v[172:175], a[88:91], a[140:143], v[172:175]
    ds_read_b64_tr_b16 a[88:89], v112 offset:49152
    v_mfma_f32_16x16x32_bf16 v[176:179], a[92:95], a[136:139], v[176:179]
    ds_read_b64_tr_b16 a[90:91], v112 offset:53248
    s_add_u32 s44, s44, 8192
    v_mfma_f32_16x16x32_bf16 v[180:183], a[92:95], a[140:143], v[180:183]
    ds_read_b64_tr_b16 a[92:93], v113 offset:49152
    v_mfma_f32_16x16x32_bf16 v[184:187], a[96:99], a[136:139], v[184:187]
    ds_read_b64_tr_b16 a[94:95], v113 offset:53248
    v_mfma_f32_16x16x32_bf16 v[188:191], a[96:99], a[140:143], v[188:191]
    ds_read_b64_tr_b16 a[96:97], v114 offset:49152
    s_add_u32 s46, s46, 8192
    v_mfma_f32_16x16x32_bf16 v[192:195], a[100:103], a[136:139], v[192:195]
    ds_read_b64_tr_b16 a[98:99], v114 offset:53248
    v_mfma_f32_16x16x32_bf16 v[196:199], a[100:103], a[140:143], v[196:199]
    ds_read_b64_tr_b16 a[100:101], v115 offset:49152
    ds_read_b64_tr_b16 a[102:103], v115 offset:53248
    s_waitcnt lgkmcnt(8)
    v_mfma_f32_16x16x32_bf16 v[136:139], a[72:75], a[144:147], v[136:139]
    s_add_u32 m0, s53, 32768
    v_mfma_f32_16x16x32_bf16 v[140:143], a[72:75], a[148:151], v[140:143]
    ds_read_b64_tr_b16 a[72:73], v108 offset:57344
    buffer_load_dwordx4 v102, s[68:71], s48 offen lds
    v_mfma_f32_16x16x32_bf16 v[144:147], a[76:79], a[144:147], v[144:147]
    ds_read_b64_tr_b16 a[74:75], v108 offset:61440
    v_mfma_f32_16x16x32_bf16 v[148:151], a[76:79], a[148:151], v[148:151]
    ds_read_b64_tr_b16 a[76:77], v109 offset:57344
    s_add_u32 m0, s53, 33792
    v_mfma_f32_16x16x32_bf16 v[152:155], a[80:83], a[144:147], v[152:155]
    ds_read_b64_tr_b16 a[78:79], v109 offset:61440
    buffer_load_dwordx4 v103, s[68:71], s48 offen lds
    v_mfma_f32_16x16x32_bf16 v[156:159], a[80:83], a[148:151], v[156:159]
    ds_read_b64_tr_b16 a[80:81], v110 offset:57344
    v_mfma_f32_16x16x32_bf16 v[160:163], a[84:87], a[144:147], v[160:163]
    ds_read_b64_tr_b16 a[82:83], v110 offset:61440
    s_add_u32 s48, s48, 65536
    v_mfma_f32_16x16x32_bf16 v[164:167], a[84:87], a[148:151], v[164:167]
    ds_read_b64_tr_b16 a[84:85], v111 offset:57344
    s_waitcnt lgkmcnt(7)
    v_mfma_f32_16x16x32_bf16 v[168:171], a[88:91], a[144:147], v[168:171]
    ds_read_b64_tr_b16 a[86:87], v111 offset:61440
    s_add_u32 m0, s53, 40960
    v_mfma_f32_16x16x32_bf16 v[172:175], a[88:91], a[148:151], v[172:175]
    ds_read_b64_tr_b16 a[88:89], v112 offset:57344
    buffer_load_dwordx4 v102, s[68:71], s48 offen lds
    v_mfma_f32_16x16x32_bf16 v[176:179], a[92:95], a[144:147], v[176:179]
    ds_read_b64_tr_b16 a[90:91], v112 offset:61440
    v_mfma_f32_16x16x32_bf16 v[180:183], a[92:95], a[148:151], v[180:183]
    ds_read_b64_tr_b16 a[92:93], v113 offset:57344
    s_add_u32 m0, s53, 41984
    v_mfma_f32_16x16x32_bf16 v[184:187], a[96:99], a[144:147], v[184:187]
    ds_read_b64_tr_b16 a[94:95], v113 offset:61440
    buffer_load_dwordx4 v103, s[68:71], s48 offen lds
    v_mfma_f32_16x16x32_bf16 v[188:191], a[96:99], a[148:151], v[188:191]
    ds_read_b64_tr_b16 a[96:97], v114 offset:57344
    v_mfma_f32_16x16x32_bf16 v[192:195], a[100:103], a[144:147], v[192:195]
    ds_read_b64_tr_b16 a[98:99], v114 offset:61440
    s_add_u32 s48, s48, 65536
    v_mfma_f32_16x16x32_bf16 v[196:199], a[100:103], a[148:151], v[196:199]
    ds_read_b64_tr_b16 a[100:101], v115 offset:57344
    ds_read_b64_tr_b16 a[102:103], v115 offset:61440
    s_waitcnt lgkmcnt(8)
    v_mfma_f32_16x16x32_bf16 v[136:139], a[72:75], a[152:155], v[136:139]
    s_add_u32 m0, s53, 49152
    v_mfma_f32_16x16x32_bf16 v[140:143], a[72:75], a[156:159], v[140:143]
    ds_read_b64_tr_b16 a[72:73], v116 offset:0
    buffer_load_dwordx4 v102, s[68:71], s48 offen lds
    v_mfma_f32_16x16x32_bf16 v[144:147], a[76:79], a[152:155], v[144:147]
    ds_read_b64_tr_b16 a[74:75], v116 offset:4096
    v_mfma_f32_16x16x32_bf16 v[148:151], a[76:79], a[156:159], v[148:151]
    ds_read_b64_tr_b16 a[76:77], v117 offset:0
    s_add_u32 m0, s53, 50176
    v_mfma_f32_16x16x32_bf16 v[152:155], a[80:83], a[152:155], v[152:155]
    ds_read_b64_tr_b16 a[78:79], v117 offset:4096
    buffer_load_dwordx4 v103, s[68:71], s48 offen lds
    v_mfma_f32_16x16x32_bf16 v[156:159], a[80:83], a[156:159], v[156:159]
    ds_read_b64_tr_b16 a[80:81], v118 offset:0
    v_mfma_f32_16x16x32_bf16 v[160:163], a[84:87], a[152:155], v[160:163]
    ds_read_b64_tr_b16 a[82:83], v118 offset:4096
    s_add_u32 s48, s48, 65536
    v_mfma_f32_16x16x32_bf16 v[164:167], a[84:87], a[156:159], v[164:167]
    ds_read_b64_tr_b16 a[84:85], v119 offset:0
    s_waitcnt lgkmcnt(7)
    v_mfma_f32_16x16x32_bf16 v[168:171], a[88:91], a[152:155], v[168:171]
    ds_read_b64_tr_b16 a[86:87], v119 offset:4096
    s_add_u32 m0, s53, 57344
    v_mfma_f32_16x16x32_bf16 v[172:175], a[88:91], a[156:159], v[172:175]
    ds_read_b64_tr_b16 a[88:89], v120 offset:0
    buffer_load_dwordx4 v102, s[68:71], s48 offen lds
    v_mfma_f32_16x16x32_bf16 v[176:179], a[92:95], a[152:155], v[176:179]
    ds_read_b64_tr_b16 a[90:91], v120 offset:4096
    v_mfma_f32_16x16x32_bf16 v[180:183], a[92:95], a[156:159], v[180:183]
    ds_read_b64_tr_b16 a[92:93], v121 offset:0
    s_add_u32 m0, s53, 58368
    v_mfma_f32_16x16x32_bf16 v[184:187], a[96:99], a[152:155], v[184:187]
    ds_read_b64_tr_b16 a[94:95], v121 offset:4096
    buffer_load_dwordx4 v103, s[68:71], s48 offen lds
    v_mfma_f32_16x16x32_bf16 v[188:191], a[96:99], a[156:159], v[188:191]
    ds_read_b64_tr_b16 a[96:97], v122 offset:0
    v_mfma_f32_16x16x32_bf16 v[192:195], a[100:103], a[152:155], v[192:195]
    ds_read_b64_tr_b16 a[98:99], v122 offset:4096
    s_add_u32 s48, s48, 65536
    v_mfma_f32_16x16x32_bf16 v[196:199], a[100:103], a[156:159], v[196:199]
    ds_read_b64_tr_b16 a[100:101], v123 offset:0
    ds_read_b64_tr_b16 a[102:103], v123 offset:4096
    s_waitcnt vmcnt(16)
    s_barrier
    s_waitcnt lgkmcnt(8)
    v_mfma_f32_16x16x32_bf16 v[136:139], a[72:75], a[160:163], v[136:139]
    buffer_load_dwordx4 a[224:227], v100, s[64:67], s44 offen offset:0 sc1
    v_mfma_f32_16x16x32_bf16 v[140:143], a[72:75], a[164:167], v[140:143]
    ds_read_b64_tr_b16 a[72:73], v116 offset:8192
    v_mfma_f32_16x16x32_bf16 v[144:147], a[76:79], a[160:163], v[144:147]
    ds_read_b64_tr_b16 a[74:75], v116 offset:12288
    v_mfma_f32_16x16x32_bf16 v[148:151], a[76:79], a[164:167], v[148:151]
    ds_read_b64_tr_b16 a[76:77], v117 offset:8192
    buffer_load_dwordx4 a[228:231], v100, s[64:67], s44 offen offset:256 sc1
    v_mfma_f32_16x16x32_bf16 v[152:155], a[80:83], a[160:163], v[152:155]
    ds_read_b64_tr_b16 a[78:79], v117 offset:12288
    v_mfma_f32_16x16x32_bf16 v[156:159], a[80:83], a[164:167], v[156:159]
    ds_read_b64_tr_b16 a[80:81], v118 offset:8192
    v_mfma_f32_16x16x32_bf16 v[160:163], a[84:87], a[160:163], v[160:163]
    ds_read_b64_tr_b16 a[82:83], v118 offset:12288
    buffer_load_dwordx4 a[232:235], v100, s[64:67], s44 offen offset:2048 sc1
    v_mfma_f32_16x16x32_bf16 v[164:167], a[84:87], a[164:167], v[164:167]
    ds_read_b64_tr_b16 a[84:85], v119 offset:8192
    s_waitcnt lgkmcnt(7)
    v_mfma_f32_16x16x32_bf16 v[168:171], a[88:91], a[160:163], v[168:171]
    ds_read_b64_tr_b16 a[86:87], v119 offset:12288
    v_mfma_f32_16x16x32_bf16 v[172:175], a[88:91], a[164:167], v[172:175]
    ds_read_b64_tr_b16 a[88:89], v120 offset:8192
    buffer_load_dwordx4 a[236:239], v100, s[64:67], s44 offen offset:2304 sc1
    v_mfma_f32_16x16x32_bf16 v[176:179], a[92:95], a[160:163], v[176:179]
    ds_read_b64_tr_b16 a[90:91], v120 offset:12288
    v_mfma_f32_16x16x32_bf16 v[180:183], a[92:95], a[164:167], v[180:183]
    ds_read_b64_tr_b16 a[92:93], v121 offset:8192
    v_mfma_f32_16x16x32_bf16 v[184:187], a[96:99], a[160:163], v[184:187]
    ds_read_b64_tr_b16 a[94:95], v121 offset:12288
    buffer_load_dwordx4 a[240:243], v100, s[64:67], s46 offen offset:0 sc1
    v_mfma_f32_16x16x32_bf16 v[188:191], a[96:99], a[164:167], v[188:191]
    ds_read_b64_tr_b16 a[96:97], v122 offset:8192
    v_mfma_f32_16x16x32_bf16 v[192:195], a[100:103], a[160:163], v[192:195]
    ds_read_b64_tr_b16 a[98:99], v122 offset:12288
    v_mfma_f32_16x16x32_bf16 v[196:199], a[100:103], a[164:167], v[196:199]
    ds_read_b64_tr_b16 a[100:101], v123 offset:8192
    ds_read_b64_tr_b16 a[102:103], v123 offset:12288
    s_waitcnt lgkmcnt(8)
    v_mfma_f32_16x16x32_bf16 v[136:139], a[72:75], a[168:171], v[136:139]
    buffer_load_dwordx4 a[244:247], v100, s[64:67], s46 offen offset:256 sc1
    v_mfma_f32_16x16x32_bf16 v[140:143], a[72:75], a[172:175], v[140:143]
    ds_read_b64_tr_b16 a[72:73], v116 offset:16384
    v_mfma_f32_16x16x32_bf16 v[144:147], a[76:79], a[168:171], v[144:147]
    ds_read_b64_tr_b16 a[74:75], v116 offset:20480
    buffer_load_dwordx4 a[248:251], v100, s[64:67], s46 offen offset:2048 sc1
    v_mfma_f32_16x16x32_bf16 v[148:151], a[76:79], a[172:175], v[148:151]
    ds_read_b64_tr_b16 a[76:77], v117 offset:16384
    v_mfma_f32_16x16x32_bf16 v[152:155], a[80:83], a[168:171], v[152:155]
    ds_read_b64_tr_b16 a[78:79], v117 offset:20480
    buffer_load_dwordx4 a[252:255], v100, s[64:67], s46 offen offset:2304 sc1
    v_mfma_f32_16x16x32_bf16 v[156:159], a[80:83], a[172:175], v[156:159]
    ds_read_b64_tr_b16 a[80:81], v118 offset:16384
    v_mfma_f32_16x16x32_bf16 v[160:163], a[84:87], a[168:171], v[160:163]
    ds_read_b64_tr_b16 a[82:83], v118 offset:20480
    s_add_u32 s44, s44, 8192
    v_mfma_f32_16x16x32_bf16 v[164:167], a[84:87], a[172:175], v[164:167]
    ds_read_b64_tr_b16 a[84:85], v119 offset:16384
    s_waitcnt lgkmcnt(7)
    v_mfma_f32_16x16x32_bf16 v[168:171], a[88:91], a[168:171], v[168:171]
    ds_read_b64_tr_b16 a[86:87], v119 offset:20480
    v_mfma_f32_16x16x32_bf16 v[172:175], a[88:91], a[172:175], v[172:175]
    ds_read_b64_tr_b16 a[88:89], v120 offset:16384
    s_add_u32 s46, s46, 8192
    v_mfma_f32_16x16x32_bf16 v[176:179], a[92:95], a[168:171], v[176:179]
    ds_read_b64_tr_b16 a[90:91], v120 offset:20480
    v_mfma_f32_16x16x32_bf16 v[180:183], a[92:95], a[172:175], v[180:183]
    ds_read_b64_tr_b16 a[92:93], v121 offset:16384
    s_add_u32 m0, s53, 65536
    v_mfma_f32_16x16x32_bf16 v[184:187], a[96:99], a[168:171], v[184:187]
    ds_read_b64_tr_b16 a[94:95], v121 offset:20480
    v_mfma_f32_16x16x32_bf16 v[188:191], a[96:99], a[172:175], v[188:191]
    ds_read_b64_tr_b16 a[96:97], v122 offset:16384
    buffer_load_dwordx4 v102, s[68:71], s48 offen lds
    v_mfma_f32_16x16x32_bf16 v[192:195], a[100:103], a[168:171], v[192:195]
    ds_read_b64_tr_b16 a[98:99], v122 offset:20480
    v_mfma_f32_16x16x32_bf16 v[196:199], a[100:103], a[172:175], v[196:199]
    ds_read_b64_tr_b16 a[100:101], v123 offset:16384
    ds_read_b64_tr_b16 a[102:103], v123 offset:20480
    s_waitcnt lgkmcnt(8)
    v_mfma_f32_16x16x32_bf16 v[136:139], a[72:75], a[176:179], v[136:139]
    s_add_u32 m0, s53, 66560
    v_mfma_f32_16x16x32_bf16 v[140:143], a[72:75], a[180:183], v[140:143]
    ds_read_b64_tr_b16 a[72:73], v116 offset:24576
    buffer_load_dwordx4 v103, s[68:71], s48 offen lds
    v_mfma_f32_16x16x32_bf16 v[144:147], a[76:79], a[176:179], v[144:147]
    ds_read_b64_tr_b16 a[74:75], v116 offset:28672
    v_mfma_f32_16x16x32_bf16 v[148:151], a[76:79], a[180:183], v[148:151]
    ds_read_b64_tr_b16 a[76:77], v117 offset:24576
    s_add_u32 s48, s48, 65536
    v_mfma_f32_16x16x32_bf16 v[152:155], a[80:83], a[176:179], v[152:155]
    ds_read_b64_tr_b16 a[78:79], v117 offset:28672
    s_add_u32 m0, s53, 73728
    v_mfma_f32_16x16x32_bf16 v[156:159], a[80:83], a[180:183], v[156:159]
    ds_read_b64_tr_b16 a[80:81], v118 offset:24576
    v_mfma_f32_16x16x32_bf16 v[160:163], a[84:87], a[176:179], v[160:163]
    ds_read_b64_tr_b16 a[82:83], v118 offset:28672
    buffer_load_dwordx4 v102, s[68:71], s48 offen lds
    v_mfma_f32_16x16x32_bf16 v[164:167], a[84:87], a[180:183], v[164:167]
    ds_read_b64_tr_b16 a[84:85], v119 offset:24576
    s_waitcnt lgkmcnt(7)
    v_mfma_f32_16x16x32_bf16 v[168:171], a[88:91], a[176:179], v[168:171]
    ds_read_b64_tr_b16 a[86:87], v119 offset:28672
    s_add_u32 m0, s53, 74752
    v_mfma_f32_16x16x32_bf16 v[172:175], a[88:91], a[180:183], v[172:175]
    ds_read_b64_tr_b16 a[88:89], v120 offset:24576
    buffer_load_dwordx4 v103, s[68:71], s48 offen lds
    v_mfma_f32_16x16x32_bf16 v[176:179], a[92:95], a[176:179], v[176:179]
    ds_read_b64_tr_b16 a[90:91], v120 offset:28672
    v_mfma_f32_16x16x32_bf16 v[180:183], a[92:95], a[180:183], v[180:183]
    ds_read_b64_tr_b16 a[92:93], v121 offset:24576
    s_add_u32 s48, s48, 65536
    v_mfma_f32_16x16x32_bf16 v[184:187], a[96:99], a[176:179], v[184:187]
    ds_read_b64_tr_b16 a[94:95], v121 offset:28672
    s_add_u32 m0, s53, 81920
    v_mfma_f32_16x16x32_bf16 v[188:191], a[96:99], a[180:183], v[188:191]
    ds_read_b64_tr_b16 a[96:97], v122 offset:24576
    v_mfma_f32_16x16x32_bf16 v[192:195], a[100:103], a[176:179], v[192:195]
    ds_read_b64_tr_b16 a[98:99], v122 offset:28672
    buffer_load_dwordx4 v102, s[68:71], s48 offen lds
    v_mfma_f32_16x16x32_bf16 v[196:199], a[100:103], a[180:183], v[196:199]
    ds_read_b64_tr_b16 a[100:101], v123 offset:24576
    ds_read_b64_tr_b16 a[102:103], v123 offset:28672
    s_waitcnt lgkmcnt(8)
    v_mfma_f32_16x16x32_bf16 v[136:139], a[72:75], a[184:187], v[136:139]
    s_add_u32 m0, s53, 82944
    v_mfma_f32_16x16x32_bf16 v[140:143], a[72:75], a[188:191], v[140:143]
    ds_read_b64_tr_b16 a[72:73], v116 offset:32768
    buffer_load_dwordx4 v103, s[68:71], s48 offen lds
    v_mfma_f32_16x16x32_bf16 v[144:147], a[76:79], a[184:187], v[144:147]
    ds_read_b64_tr_b16 a[74:75], v116 offset:36864
    v_mfma_f32_16x16x32_bf16 v[148:151], a[76:79], a[188:191], v[148:151]
    ds_read_b64_tr_b16 a[76:77], v117 offset:32768
    s_add_u32 s48, s48, 65536
    v_mfma_f32_16x16x32_bf16 v[152:155], a[80:83], a[184:187], v[152:155]
    ds_read_b64_tr_b16 a[78:79], v117 offset:36864
    v_mfma_f32_16x16x32_bf16 v[156:159], a[80:83], a[188:191], v[156:159]
    ds_read_b64_tr_b16 a[80:81], v118 offset:32768
    s_add_u32 m0, s53, 90112
    v_mfma_f32_16x16x32_bf16 v[160:163], a[84:87], a[184:187], v[160:163]
    ds_read_b64_tr_b16 a[82:83], v118 offset:36864
    v_mfma_f32_16x16x32_bf16 v[164:167], a[84:87], a[188:191], v[164:167]
    ds_read_b64_tr_b16 a[84:85], v119 offset:32768
    buffer_load_dwordx4 v102, s[68:71], s48 offen lds
    s_waitcnt lgkmcnt(7)
    v_mfma_f32_16x16x32_bf16 v[168:171], a[88:91], a[184:187], v[168:171]
    ds_read_b64_tr_b16 a[86:87], v119 offset:36864
    s_add_u32 m0, s53, 91136
    v_mfma_f32_16x16x32_bf16 v[172:175], a[88:91], a[188:191], v[172:175]
    ds_read_b64_tr_b16 a[88:89], v120 offset:32768
    v_mfma_f32_16x16x32_bf16 v[176:179], a[92:95], a[184:187], v[176:179]
    ds_read_b64_tr_b16 a[90:91], v120 offset:36864
    buffer_load_dwordx4 v103, s[68:71], s48 offen lds
    v_mfma_f32_16x16x32_bf16 v[180:183], a[92:95], a[188:191], v[180:183]
    ds_read_b64_tr_b16 a[92:93], v121 offset:32768
    v_mfma_f32_16x16x32_bf16 v[184:187], a[96:99], a[184:187], v[184:187]
    ds_read_b64_tr_b16 a[94:95], v121 offset:36864
    s_add_u32 s48, s48, 65536
    v_mfma_f32_16x16x32_bf16 v[188:191], a[96:99], a[188:191], v[188:191]
    ds_read_b64_tr_b16 a[96:97], v122 offset:32768
    v_mfma_f32_16x16x32_bf16 v[192:195], a[100:103], a[184:187], v[192:195]
    ds_read_b64_tr_b16 a[98:99], v122 offset:36864
    buffer_load_dword v12, v106, s[32:35], s62 offen sc0 sc1
    v_mfma_f32_16x16x32_bf16 v[196:199], a[100:103], a[188:191], v[196:199]
    ds_read_b64_tr_b16 a[100:101], v123 offset:32768
    ds_read_b64_tr_b16 a[102:103], v123 offset:36864
    s_waitcnt vmcnt(17)
    s_barrier
    s_waitcnt lgkmcnt(8)
    v_mfma_f32_16x16x32_bf16 v[136:139], a[72:75], a[192:195], v[136:139]
    buffer_load_dwordx4 a[128:131], v100, s[64:67], s44 offen offset:0 sc1
    v_mfma_f32_16x16x32_bf16 v[140:143], a[72:75], a[196:199], v[140:143]
    ds_read_b64_tr_b16 a[72:73], v116 offset:40960
    v_mfma_f32_16x16x32_bf16 v[144:147], a[76:79], a[192:195], v[144:147]
    ds_read_b64_tr_b16 a[74:75], v116 offset:45056
    v_mfma_f32_16x16x32_bf16 v[148:151], a[76:79], a[196:199], v[148:151]
    ds_read_b64_tr_b16 a[76:77], v117 offset:40960
    v_mfma_f32_16x16x32_bf16 v[152:155], a[80:83], a[192:195], v[152:155]
    ds_read_b64_tr_b16 a[78:79], v117 offset:45056
    buffer_load_dwordx4 a[132:135], v100, s[64:67], s44 offen offset:256 sc1
    v_mfma_f32_16x16x32_bf16 v[156:159], a[80:83], a[196:199], v[156:159]
    ds_read_b64_tr_b16 a[80:81], v118 offset:40960
    v_mfma_f32_16x16x32_bf16 v[160:163], a[84:87], a[192:195], v[160:163]
    ds_read_b64_tr_b16 a[82:83], v118 offset:45056
    v_mfma_f32_16x16x32_bf16 v[164:167], a[84:87], a[196:199], v[164:167]
    ds_read_b64_tr_b16 a[84:85], v119 offset:40960
    s_waitcnt lgkmcnt(7)
    v_mfma_f32_16x16x32_bf16 v[168:171], a[88:91], a[192:195], v[168:171]
    ds_read_b64_tr_b16 a[86:87], v119 offset:45056
    buffer_load_dwordx4 a[136:139], v100, s[64:67], s44 offen offset:2048 sc1
    v_mfma_f32_16x16x32_bf16 v[172:175], a[88:91], a[196:199], v[172:175]
    ds_read_b64_tr_b16 a[88:89], v120 offset:40960
    v_mfma_f32_16x16x32_bf16 v[176:179], a[92:95], a[192:195], v[176:179]
    ds_read_b64_tr_b16 a[90:91], v120 offset:45056
    v_mfma_f32_16x16x32_bf16 v[180:183], a[92:95], a[196:199], v[180:183]
    ds_read_b64_tr_b16 a[92:93], v121 offset:40960
    v_mfma_f32_16x16x32_bf16 v[184:187], a[96:99], a[192:195], v[184:187]
    ds_read_b64_tr_b16 a[94:95], v121 offset:45056
    buffer_load_dwordx4 a[140:143], v100, s[64:67], s44 offen offset:2304 sc1
    v_mfma_f32_16x16x32_bf16 v[188:191], a[96:99], a[196:199], v[188:191]
    ds_read_b64_tr_b16 a[96:97], v122 offset:40960
    v_mfma_f32_16x16x32_bf16 v[192:195], a[100:103], a[192:195], v[192:195]
    ds_read_b64_tr_b16 a[98:99], v122 offset:45056
    v_mfma_f32_16x16x32_bf16 v[196:199], a[100:103], a[196:199], v[196:199]
    ds_read_b64_tr_b16 a[100:101], v123 offset:40960
    ds_read_b64_tr_b16 a[102:103], v123 offset:45056
    s_waitcnt lgkmcnt(8)
    v_mfma_f32_16x16x32_bf16 v[136:139], a[72:75], a[200:203], v[136:139]
    buffer_load_dwordx4 a[144:147], v100, s[64:67], s46 offen offset:0 sc1
    v_mfma_f32_16x16x32_bf16 v[140:143], a[72:75], a[204:207], v[140:143]
    ds_read_b64_tr_b16 a[72:73], v116 offset:49152
    v_mfma_f32_16x16x32_bf16 v[144:147], a[76:79], a[200:203], v[144:147]
    ds_read_b64_tr_b16 a[74:75], v116 offset:53248
    buffer_load_dwordx4 a[148:151], v100, s[64:67], s46 offen offset:256 sc1
    v_mfma_f32_16x16x32_bf16 v[148:151], a[76:79], a[204:207], v[148:151]
    ds_read_b64_tr_b16 a[76:77], v117 offset:49152
    v_mfma_f32_16x16x32_bf16 v[152:155], a[80:83], a[200:203], v[152:155]
    ds_read_b64_tr_b16 a[78:79], v117 offset:53248
    v_mfma_f32_16x16x32_bf16 v[156:159], a[80:83], a[204:207], v[156:159]
    ds_read_b64_tr_b16 a[80:81], v118 offset:49152
    buffer_load_dwordx4 a[152:155], v100, s[64:67], s46 offen offset:2048 sc1
    v_mfma_f32_16x16x32_bf16 v[160:163], a[84:87], a[200:203], v[160:163]
    ds_read_b64_tr_b16 a[82:83], v118 offset:53248
    v_mfma_f32_16x16x32_bf16 v[164:167], a[84:87], a[204:207], v[164:167]
    ds_read_b64_tr_b16 a[84:85], v119 offset:49152
    s_waitcnt lgkmcnt(7)
    v_mfma_f32_16x16x32_bf16 v[168:171], a[88:91], a[200:203], v[168:171]
    ds_read_b64_tr_b16 a[86:87], v119 offset:53248
    buffer_load_dwordx4 a[156:159], v100, s[64:67], s46 offen offset:2304 sc1
    v_mfma_f32_16x16x32_bf16 v[172:175], a[88:91], a[204:207], v[172:175]
    ds_read_b64_tr_b16 a[88:89], v120 offset:49152
    v_mfma_f32_16x16x32_bf16 v[176:179], a[92:95], a[200:203], v[176:179]
    ds_read_b64_tr_b16 a[90:91], v120 offset:53248
    s_add_u32 s44, s44, 8192
    v_mfma_f32_16x16x32_bf16 v[180:183], a[92:95], a[204:207], v[180:183]
    ds_read_b64_tr_b16 a[92:93], v121 offset:49152
    v_mfma_f32_16x16x32_bf16 v[184:187], a[96:99], a[200:203], v[184:187]
    ds_read_b64_tr_b16 a[94:95], v121 offset:53248
    v_mfma_f32_16x16x32_bf16 v[188:191], a[96:99], a[204:207], v[188:191]
    ds_read_b64_tr_b16 a[96:97], v122 offset:49152
    s_add_u32 s46, s46, 8192
    v_mfma_f32_16x16x32_bf16 v[192:195], a[100:103], a[200:203], v[192:195]
    ds_read_b64_tr_b16 a[98:99], v122 offset:53248
    v_mfma_f32_16x16x32_bf16 v[196:199], a[100:103], a[204:207], v[196:199]
    ds_read_b64_tr_b16 a[100:101], v123 offset:49152
    ds_read_b64_tr_b16 a[102:103], v123 offset:53248
    s_waitcnt lgkmcnt(8)
    v_mfma_f32_16x16x32_bf16 v[136:139], a[72:75], a[208:211], v[136:139]
    s_add_u32 m0, s53, 98304
    v_mfma_f32_16x16x32_bf16 v[140:143], a[72:75], a[212:215], v[140:143]
    ds_read_b64_tr_b16 a[72:73], v116 offset:57344
    buffer_load_dwordx4 v102, s[68:71], s48 offen lds
    v_mfma_f32_16x16x32_bf16 v[144:147], a[76:79], a[208:211], v[144:147]
    ds_read_b64_tr_b16 a[74:75], v116 offset:61440
    v_mfma_f32_16x16x32_bf16 v[148:151], a[76:79], a[212:215], v[148:151]
    ds_read_b64_tr_b16 a[76:77], v117 offset:57344
    s_add_u32 m0, s53, 99328
    v_mfma_f32_16x16x32_bf16 v[152:155], a[80:83], a[208:211], v[152:155]
    ds_read_b64_tr_b16 a[78:79], v117 offset:61440
    buffer_load_dwordx4 v103, s[68:71], s48 offen lds
    v_mfma_f32_16x16x32_bf16 v[156:159], a[80:83], a[212:215], v[156:159]
    ds_read_b64_tr_b16 a[80:81], v118 offset:57344
    v_mfma_f32_16x16x32_bf16 v[160:163], a[84:87], a[208:211], v[160:163]
    ds_read_b64_tr_b16 a[82:83], v118 offset:61440
    s_add_u32 s48, s48, 65536
    v_mfma_f32_16x16x32_bf16 v[164:167], a[84:87], a[212:215], v[164:167]
    ds_read_b64_tr_b16 a[84:85], v119 offset:57344
    s_waitcnt lgkmcnt(7)
    v_mfma_f32_16x16x32_bf16 v[168:171], a[88:91], a[208:211], v[168:171]
    ds_read_b64_tr_b16 a[86:87], v119 offset:61440
    s_add_u32 m0, s53, 106496
    v_mfma_f32_16x16x32_bf16 v[172:175], a[88:91], a[212:215], v[172:175]
    ds_read_b64_tr_b16 a[88:89], v120 offset:57344
    buffer_load_dwordx4 v102, s[68:71], s48 offen lds
    v_mfma_f32_16x16x32_bf16 v[176:179], a[92:95], a[208:211], v[176:179]
    ds_read_b64_tr_b16 a[90:91], v120 offset:61440
    v_mfma_f32_16x16x32_bf16 v[180:183], a[92:95], a[212:215], v[180:183]
    ds_read_b64_tr_b16 a[92:93], v121 offset:57344
    s_add_u32 m0, s53, 107520
    v_mfma_f32_16x16x32_bf16 v[184:187], a[96:99], a[208:211], v[184:187]
    ds_read_b64_tr_b16 a[94:95], v121 offset:61440
    buffer_load_dwordx4 v103, s[68:71], s48 offen lds
    v_mfma_f32_16x16x32_bf16 v[188:191], a[96:99], a[212:215], v[188:191]
    ds_read_b64_tr_b16 a[96:97], v122 offset:57344
    v_mfma_f32_16x16x32_bf16 v[192:195], a[100:103], a[208:211], v[192:195]
    ds_read_b64_tr_b16 a[98:99], v122 offset:61440
    s_add_u32 s48, s48, 65536
    v_mfma_f32_16x16x32_bf16 v[196:199], a[100:103], a[212:215], v[196:199]
    ds_read_b64_tr_b16 a[100:101], v123 offset:57344
    ds_read_b64_tr_b16 a[102:103], v123 offset:61440
    s_waitcnt lgkmcnt(8)
    v_mfma_f32_16x16x32_bf16 v[136:139], a[72:75], a[216:219], v[136:139]
    s_add_u32 m0, s53, 114688
    v_mfma_f32_16x16x32_bf16 v[140:143], a[72:75], a[220:223], v[140:143]
    ds_read_b64_tr_b16 a[72:73], v108 offset:0
    buffer_load_dwordx4 v102, s[68:71], s48 offen lds
    v_mfma_f32_16x16x32_bf16 v[144:147], a[76:79], a[216:219], v[144:147]
    ds_read_b64_tr_b16 a[74:75], v108 offset:4096
    v_mfma_f32_16x16x32_bf16 v[148:151], a[76:79], a[220:223], v[148:151]
    ds_read_b64_tr_b16 a[76:77], v109 offset:0
    s_add_u32 m0, s53, 115712
    v_mfma_f32_16x16x32_bf16 v[152:155], a[80:83], a[216:219], v[152:155]
    ds_read_b64_tr_b16 a[78:79], v109 offset:4096
    buffer_load_dwordx4 v103, s[68:71], s48 offen lds
    v_mfma_f32_16x16x32_bf16 v[156:159], a[80:83], a[220:223], v[156:159]
    ds_read_b64_tr_b16 a[80:81], v110 offset:0
    v_mfma_f32_16x16x32_bf16 v[160:163], a[84:87], a[216:219], v[160:163]
    ds_read_b64_tr_b16 a[82:83], v110 offset:4096
    s_add_u32 s48, s48, 65536
    v_mfma_f32_16x16x32_bf16 v[164:167], a[84:87], a[220:223], v[164:167]
    ds_read_b64_tr_b16 a[84:85], v111 offset:0
    s_waitcnt lgkmcnt(7)
    v_mfma_f32_16x16x32_bf16 v[168:171], a[88:91], a[216:219], v[168:171]
    ds_read_b64_tr_b16 a[86:87], v111 offset:4096
    s_add_u32 m0, s53, 122880
    v_mfma_f32_16x16x32_bf16 v[172:175], a[88:91], a[220:223], v[172:175]
    ds_read_b64_tr_b16 a[88:89], v112 offset:0
    buffer_load_dwordx4 v102, s[68:71], s48 offen lds
    v_mfma_f32_16x16x32_bf16 v[176:179], a[92:95], a[216:219], v[176:179]
    ds_read_b64_tr_b16 a[90:91], v112 offset:4096
    v_mfma_f32_16x16x32_bf16 v[180:183], a[92:95], a[220:223], v[180:183]
    ds_read_b64_tr_b16 a[92:93], v113 offset:0
    s_add_u32 m0, s53, 123904
    v_mfma_f32_16x16x32_bf16 v[184:187], a[96:99], a[216:219], v[184:187]
    ds_read_b64_tr_b16 a[94:95], v113 offset:4096
    buffer_load_dwordx4 v103, s[68:71], s48 offen lds
    v_mfma_f32_16x16x32_bf16 v[188:191], a[96:99], a[220:223], v[188:191]
    ds_read_b64_tr_b16 a[96:97], v114 offset:0
    v_mfma_f32_16x16x32_bf16 v[192:195], a[100:103], a[216:219], v[192:195]
    ds_read_b64_tr_b16 a[98:99], v114 offset:4096
    s_add_u32 s48, s48, 65536
    v_mfma_f32_16x16x32_bf16 v[196:199], a[100:103], a[220:223], v[196:199]
    ds_read_b64_tr_b16 a[100:101], v115 offset:0
    ds_read_b64_tr_b16 a[102:103], v115 offset:4096
    s_waitcnt vmcnt(16)
    v_cmp_ne_u32 vcc, s94, v12
    s_nop 1
    s_cbranch_vccz parallel_sum__softmax_full_mha__dense_activation_silu__prompt_kernel_ok_o
    s_mov_b32 s100, 0x40000
parallel_sum__softmax_full_mha__dense_activation_silu__prompt_kernel_poll_o:
    buffer_load_dword v12, v106, s[32:35], s62 offen sc0 sc1
    s_sub_u32 s100, s100, 1
    s_cmp_eq_u32 s100, 0
    s_cbranch_scc1 parallel_sum__softmax_full_mha__dense_activation_silu__prompt_kernel_pollx_o
    s_waitcnt vmcnt(0)
    v_cmp_ne_u32 vcc, s94, v12
    s_nop 1
    s_cbranch_vccnz parallel_sum__softmax_full_mha__dense_activation_silu__prompt_kernel_poll_o
parallel_sum__softmax_full_mha__dense_activation_silu__prompt_kernel_pollx_o:
parallel_sum__softmax_full_mha__dense_activation_silu__prompt_kernel_ok_o:
    s_barrier
    s_waitcnt lgkmcnt(8)
    v_mfma_f32_16x16x32_bf16 v[136:139], a[72:75], a[224:227], v[136:139]
    buffer_load_dwordx4 a[160:163], v100, s[64:67], s44 offen offset:0 sc1
    v_mfma_f32_16x16x32_bf16 v[140:143], a[72:75], a[228:231], v[140:143]
    ds_read_b64_tr_b16 a[72:73], v108 offset:8192
    v_mfma_f32_16x16x32_bf16 v[144:147], a[76:79], a[224:227], v[144:147]
    ds_read_b64_tr_b16 a[74:75], v108 offset:12288
    v_mfma_f32_16x16x32_bf16 v[148:151], a[76:79], a[228:231], v[148:151]
    ds_read_b64_tr_b16 a[76:77], v109 offset:8192
    v_mfma_f32_16x16x32_bf16 v[152:155], a[80:83], a[224:227], v[152:155]
    ds_read_b64_tr_b16 a[78:79], v109 offset:12288
    buffer_load_dwordx4 a[164:167], v100, s[64:67], s44 offen offset:256 sc1
    v_mfma_f32_16x16x32_bf16 v[156:159], a[80:83], a[228:231], v[156:159]
    ds_read_b64_tr_b16 a[80:81], v110 offset:8192
    v_mfma_f32_16x16x32_bf16 v[160:163], a[84:87], a[224:227], v[160:163]
    ds_read_b64_tr_b16 a[82:83], v110 offset:12288
    v_mfma_f32_16x16x32_bf16 v[164:167], a[84:87], a[228:231], v[164:167]
    ds_read_b64_tr_b16 a[84:85], v111 offset:8192
    s_waitcnt lgkmcnt(7)
    v_mfma_f32_16x16x32_bf16 v[168:171], a[88:91], a[224:227], v[168:171]
    ds_read_b64_tr_b16 a[86:87], v111 offset:12288
    buffer_load_dwordx4 a[168:171], v100, s[64:67], s44 offen offset:2048 sc1
    v_mfma_f32_16x16x32_bf16 v[172:175], a[88:91], a[228:231], v[172:175]
    ds_read_b64_tr_b16 a[88:89], v112 offset:8192
    v_mfma_f32_16x16x32_bf16 v[176:179], a[92:95], a[224:227], v[176:179]
    ds_read_b64_tr_b16 a[90:91], v112 offset:12288
    v_mfma_f32_16x16x32_bf16 v[180:183], a[92:95], a[228:231], v[180:183]
    ds_read_b64_tr_b16 a[92:93], v113 offset:8192
    v_mfma_f32_16x16x32_bf16 v[184:187], a[96:99], a[224:227], v[184:187]
    ds_read_b64_tr_b16 a[94:95], v113 offset:12288
    buffer_load_dwordx4 a[172:175], v100, s[64:67], s44 offen offset:2304 sc1
    v_mfma_f32_16x16x32_bf16 v[188:191], a[96:99], a[228:231], v[188:191]
    ds_read_b64_tr_b16 a[96:97], v114 offset:8192
    v_mfma_f32_16x16x32_bf16 v[192:195], a[100:103], a[224:227], v[192:195]
    ds_read_b64_tr_b16 a[98:99], v114 offset:12288
    v_mfma_f32_16x16x32_bf16 v[196:199], a[100:103], a[228:231], v[196:199]
    ds_read_b64_tr_b16 a[100:101], v115 offset:8192
    ds_read_b64_tr_b16 a[102:103], v115 offset:12288
    s_waitcnt lgkmcnt(8)
    v_mfma_f32_16x16x32_bf16 v[136:139], a[72:75], a[232:235], v[136:139]
    buffer_load_dwordx4 a[176:179], v100, s[64:67], s46 offen offset:0 sc1
    v_mfma_f32_16x16x32_bf16 v[140:143], a[72:75], a[236:239], v[140:143]
    ds_read_b64_tr_b16 a[72:73], v108 offset:16384
    v_mfma_f32_16x16x32_bf16 v[144:147], a[76:79], a[232:235], v[144:147]
    ds_read_b64_tr_b16 a[74:75], v108 offset:20480
    buffer_load_dwordx4 a[180:183], v100, s[64:67], s46 offen offset:256 sc1
    v_mfma_f32_16x16x32_bf16 v[148:151], a[76:79], a[236:239], v[148:151]
    ds_read_b64_tr_b16 a[76:77], v109 offset:16384
    v_mfma_f32_16x16x32_bf16 v[152:155], a[80:83], a[232:235], v[152:155]
    ds_read_b64_tr_b16 a[78:79], v109 offset:20480
    v_mfma_f32_16x16x32_bf16 v[156:159], a[80:83], a[236:239], v[156:159]
    ds_read_b64_tr_b16 a[80:81], v110 offset:16384
    buffer_load_dwordx4 a[184:187], v100, s[64:67], s46 offen offset:2048 sc1
    v_mfma_f32_16x16x32_bf16 v[160:163], a[84:87], a[232:235], v[160:163]
    ds_read_b64_tr_b16 a[82:83], v110 offset:20480
    v_mfma_f32_16x16x32_bf16 v[164:167], a[84:87], a[236:239], v[164:167]
    ds_read_b64_tr_b16 a[84:85], v111 offset:16384
    s_waitcnt lgkmcnt(7)
    v_mfma_f32_16x16x32_bf16 v[168:171], a[88:91], a[232:235], v[168:171]
    ds_read_b64_tr_b16 a[86:87], v111 offset:20480
    buffer_load_dwordx4 a[188:191], v100, s[64:67], s46 offen offset:2304 sc1
    v_mfma_f32_16x16x32_bf16 v[172:175], a[88:91], a[236:239], v[172:175]
    ds_read_b64_tr_b16 a[88:89], v112 offset:16384
    v_mfma_f32_16x16x32_bf16 v[176:179], a[92:95], a[232:235], v[176:179]
    ds_read_b64_tr_b16 a[90:91], v112 offset:20480
    s_add_u32 s44, s44, 8192
    v_mfma_f32_16x16x32_bf16 v[180:183], a[92:95], a[236:239], v[180:183]
    ds_read_b64_tr_b16 a[92:93], v113 offset:16384
    v_mfma_f32_16x16x32_bf16 v[184:187], a[96:99], a[232:235], v[184:187]
    ds_read_b64_tr_b16 a[94:95], v113 offset:20480
    v_mfma_f32_16x16x32_bf16 v[188:191], a[96:99], a[236:239], v[188:191]
    ds_read_b64_tr_b16 a[96:97], v114 offset:16384
    s_add_u32 s46, s46, 8192
    v_mfma_f32_16x16x32_bf16 v[192:195], a[100:103], a[232:235], v[192:195]
    ds_read_b64_tr_b16 a[98:99], v114 offset:20480
    v_mfma_f32_16x16x32_bf16 v[196:199], a[100:103], a[236:239], v[196:199]
    ds_read_b64_tr_b16 a[100:101], v115 offset:16384
    ds_read_b64_tr_b16 a[102:103], v115 offset:20480
    s_waitcnt lgkmcnt(8)
    v_mfma_f32_16x16x32_bf16 v[136:139], a[72:75], a[240:243], v[136:139]
    s_add_u32 m0, s54, 131072
    v_mfma_f32_16x16x32_bf16 v[140:143], a[72:75], a[244:247], v[140:143]
    ds_read_b64_tr_b16 a[72:73], v108 offset:24576
    buffer_load_dwordx4 v104, s[12:15], s49 offen lds
    v_mfma_f32_16x16x32_bf16 v[144:147], a[76:79], a[240:243], v[144:147]
    ds_read_b64_tr_b16 a[74:75], v108 offset:28672
    s_add_u32 s49, s49, 65536
    v_mfma_f32_16x16x32_bf16 v[148:151], a[76:79], a[244:247], v[148:151]
    ds_read_b64_tr_b16 a[76:77], v109 offset:24576
    v_mfma_f32_16x16x32_bf16 v[152:155], a[80:83], a[240:243], v[152:155]
    ds_read_b64_tr_b16 a[78:79], v109 offset:28672
    s_add_u32 m0, s54, 135168
    v_mfma_f32_16x16x32_bf16 v[156:159], a[80:83], a[244:247], v[156:159]
    ds_read_b64_tr_b16 a[80:81], v110 offset:24576
    buffer_load_dwordx4 v104, s[12:15], s49 offen lds
    v_mfma_f32_16x16x32_bf16 v[160:163], a[84:87], a[240:243], v[160:163]
    ds_read_b64_tr_b16 a[82:83], v110 offset:28672
    s_add_u32 s49, s49, 65536
    v_mfma_f32_16x16x32_bf16 v[164:167], a[84:87], a[244:247], v[164:167]
    ds_read_b64_tr_b16 a[84:85], v111 offset:24576
    s_waitcnt lgkmcnt(7)
    v_mfma_f32_16x16x32_bf16 v[168:171], a[88:91], a[240:243], v[168:171]
    ds_read_b64_tr_b16 a[86:87], v111 offset:28672
    s_add_u32 m0, s54, 139264
    v_mfma_f32_16x16x32_bf16 v[172:175], a[88:91], a[244:247], v[172:175]
    ds_read_b64_tr_b16 a[88:89], v112 offset:24576
    buffer_load_dwordx4 v104, s[12:15], s49 offen lds
    v_mfma_f32_16x16x32_bf16 v[176:179], a[92:95], a[240:243], v[176:179]
    ds_read_b64_tr_b16 a[90:91], v112 offset:28672
    s_add_u32 s49, s49, 65536
    v_mfma_f32_16x16x32_bf16 v[180:183], a[92:95], a[244:247], v[180:183]
    ds_read_b64_tr_b16 a[92:93], v113 offset:24576
    v_mfma_f32_16x16x32_bf16 v[184:187], a[96:99], a[240:243], v[184:187]
    ds_read_b64_tr_b16 a[94:95], v113 offset:28672
    s_add_u32 m0, s54, 143360
    v_mfma_f32_16x16x32_bf16 v[188:191], a[96:99], a[244:247], v[188:191]
    ds_read_b64_tr_b16 a[96:97], v114 offset:24576
    buffer_load_dwordx4 v104, s[12:15], s49 offen lds
    v_mfma_f32_16x16x32_bf16 v[192:195], a[100:103], a[240:243], v[192:195]
    ds_read_b64_tr_b16 a[98:99], v114 offset:28672
    s_add_u32 s49, s49, 65536
    v_mfma_f32_16x16x32_bf16 v[196:199], a[100:103], a[244:247], v[196:199]
    ds_read_b64_tr_b16 a[100:101], v115 offset:24576
    ds_read_b64_tr_b16 a[102:103], v115 offset:28672
    s_waitcnt lgkmcnt(8)
    v_mfma_f32_16x16x32_bf16 v[136:139], a[72:75], a[248:251], v[136:139]
    s_add_u32 m0, s54, 147456
    v_mfma_f32_16x16x32_bf16 v[140:143], a[72:75], a[252:255], v[140:143]
    ds_read_b64_tr_b16 a[72:73], v108 offset:32768
    buffer_load_dwordx4 v104, s[12:15], s49 offen lds
    v_mfma_f32_16x16x32_bf16 v[144:147], a[76:79], a[248:251], v[144:147]
    ds_read_b64_tr_b16 a[74:75], v108 offset:36864
    s_add_u32 s49, s49, 65536
    v_mfma_f32_16x16x32_bf16 v[148:151], a[76:79], a[252:255], v[148:151]
    ds_read_b64_tr_b16 a[76:77], v109 offset:32768
    v_mfma_f32_16x16x32_bf16 v[152:155], a[80:83], a[248:251], v[152:155]
    ds_read_b64_tr_b16 a[78:79], v109 offset:36864
    s_add_u32 m0, s54, 151552
    v_mfma_f32_16x16x32_bf16 v[156:159], a[80:83], a[252:255], v[156:159]
    ds_read_b64_tr_b16 a[80:81], v110 offset:32768
    buffer_load_dwordx4 v104, s[12:15], s49 offen lds
    v_mfma_f32_16x16x32_bf16 v[160:163], a[84:87], a[248:251], v[160:163]
    ds_read_b64_tr_b16 a[82:83], v110 offset:36864
    s_add_u32 s49, s49, 65536
    v_mfma_f32_16x16x32_bf16 v[164:167], a[84:87], a[252:255], v[164:167]
    ds_read_b64_tr_b16 a[84:85], v111 offset:32768
    s_waitcnt lgkmcnt(7)
    v_mfma_f32_16x16x32_bf16 v[168:171], a[88:91], a[248:251], v[168:171]
    ds_read_b64_tr_b16 a[86:87], v111 offset:36864
    s_add_u32 m0, s54, 155648
    v_mfma_f32_16x16x32_bf16 v[172:175], a[88:91], a[252:255], v[172:175]
    ds_read_b64_tr_b16 a[88:89], v112 offset:32768
    buffer_load_dwordx4 v104, s[12:15], s49 offen lds
    v_mfma_f32_16x16x32_bf16 v[176:179], a[92:95], a[248:251], v[176:179]
    ds_read_b64_tr_b16 a[90:91], v112 offset:36864
    s_add_u32 s49, s49, 65536
    v_mfma_f32_16x16x32_bf16 v[180:183], a[92:95], a[252:255], v[180:183]
    ds_read_b64_tr_b16 a[92:93], v113 offset:32768
    v_mfma_f32_16x16x32_bf16 v[184:187], a[96:99], a[248:251], v[184:187]
    ds_read_b64_tr_b16 a[94:95], v113 offset:36864
    s_add_u32 m0, s54, 159744
    v_mfma_f32_16x16x32_bf16 v[188:191], a[96:99], a[252:255], v[188:191]
    ds_read_b64_tr_b16 a[96:97], v114 offset:32768
    buffer_load_dwordx4 v104, s[12:15], s49 offen lds
    v_mfma_f32_16x16x32_bf16 v[192:195], a[100:103], a[248:251], v[192:195]
    ds_read_b64_tr_b16 a[98:99], v114 offset:36864
    s_add_u32 s49, s49, 65536
    v_mfma_f32_16x16x32_bf16 v[196:199], a[100:103], a[252:255], v[196:199]
    ds_read_b64_tr_b16 a[100:101], v115 offset:32768
    ds_read_b64_tr_b16 a[102:103], v115 offset:36864
    s_waitcnt vmcnt(16)
    s_barrier
    s_waitcnt lgkmcnt(8)
    v_mfma_f32_16x16x32_bf16 v[136:139], a[72:75], a[128:131], v[136:139]
    buffer_load_dwordx4 a[0:3], v101, s[8:11], s45 offen offset:0 sc1
    v_mfma_f32_16x16x32_bf16 v[140:143], a[72:75], a[132:135], v[140:143]
    ds_read_b64_tr_b16 a[72:73], v108 offset:40960
    v_mfma_f32_16x16x32_bf16 v[144:147], a[76:79], a[128:131], v[144:147]
    ds_read_b64_tr_b16 a[74:75], v108 offset:45056
    buffer_load_dwordx4 a[4:7], v101, s[8:11], s45 offen offset:256 sc1
    v_mfma_f32_16x16x32_bf16 v[148:151], a[76:79], a[132:135], v[148:151]
    ds_read_b64_tr_b16 a[76:77], v109 offset:40960
    v_mfma_f32_16x16x32_bf16 v[152:155], a[80:83], a[128:131], v[152:155]
    ds_read_b64_tr_b16 a[78:79], v109 offset:45056
    v_mfma_f32_16x16x32_bf16 v[156:159], a[80:83], a[132:135], v[156:159]
    ds_read_b64_tr_b16 a[80:81], v110 offset:40960
    buffer_load_dwordx4 a[8:11], v101, s[8:11], s45 offen offset:2048 sc1
    v_mfma_f32_16x16x32_bf16 v[160:163], a[84:87], a[128:131], v[160:163]
    ds_read_b64_tr_b16 a[82:83], v110 offset:45056
    v_mfma_f32_16x16x32_bf16 v[164:167], a[84:87], a[132:135], v[164:167]
    ds_read_b64_tr_b16 a[84:85], v111 offset:40960
    s_waitcnt lgkmcnt(7)
    v_mfma_f32_16x16x32_bf16 v[168:171], a[88:91], a[128:131], v[168:171]
    ds_read_b64_tr_b16 a[86:87], v111 offset:45056
    buffer_load_dwordx4 a[12:15], v101, s[8:11], s45 offen offset:2304 sc1
    v_mfma_f32_16x16x32_bf16 v[172:175], a[88:91], a[132:135], v[172:175]
    ds_read_b64_tr_b16 a[88:89], v112 offset:40960
    v_mfma_f32_16x16x32_bf16 v[176:179], a[92:95], a[128:131], v[176:179]
    ds_read_b64_tr_b16 a[90:91], v112 offset:45056
    buffer_load_dwordx4 a[16:19], v101, s[8:11], s47 offen offset:0 sc1
    v_mfma_f32_16x16x32_bf16 v[180:183], a[92:95], a[132:135], v[180:183]
    ds_read_b64_tr_b16 a[92:93], v113 offset:40960
    v_mfma_f32_16x16x32_bf16 v[184:187], a[96:99], a[128:131], v[184:187]
    ds_read_b64_tr_b16 a[94:95], v113 offset:45056
    v_mfma_f32_16x16x32_bf16 v[188:191], a[96:99], a[132:135], v[188:191]
    ds_read_b64_tr_b16 a[96:97], v114 offset:40960
    buffer_load_dwordx4 a[20:23], v101, s[8:11], s47 offen offset:256 sc1
    v_mfma_f32_16x16x32_bf16 v[192:195], a[100:103], a[128:131], v[192:195]
    ds_read_b64_tr_b16 a[98:99], v114 offset:45056
    v_mfma_f32_16x16x32_bf16 v[196:199], a[100:103], a[132:135], v[196:199]
    ds_read_b64_tr_b16 a[100:101], v115 offset:40960
    ds_read_b64_tr_b16 a[102:103], v115 offset:45056
    s_waitcnt lgkmcnt(8)
    v_mfma_f32_16x16x32_bf16 v[136:139], a[72:75], a[136:139], v[136:139]
    buffer_load_dwordx4 a[24:27], v101, s[8:11], s47 offen offset:2048 sc1
    v_mfma_f32_16x16x32_bf16 v[140:143], a[72:75], a[140:143], v[140:143]
    ds_read_b64_tr_b16 a[72:73], v108 offset:49152
    v_mfma_f32_16x16x32_bf16 v[144:147], a[76:79], a[136:139], v[144:147]
    ds_read_b64_tr_b16 a[74:75], v108 offset:53248
    buffer_load_dwordx4 a[28:31], v101, s[8:11], s47 offen offset:2304 sc1
    v_mfma_f32_16x16x32_bf16 v[148:151], a[76:79], a[140:143], v[148:151]
    ds_read_b64_tr_b16 a[76:77], v109 offset:49152
    v_mfma_f32_16x16x32_bf16 v[152:155], a[80:83], a[136:139], v[152:155]
    ds_read_b64_tr_b16 a[78:79], v109 offset:53248
    s_add_u32 s45, s45, 8192
    v_mfma_f32_16x16x32_bf16 v[156:159], a[80:83], a[140:143], v[156:159]
    ds_read_b64_tr_b16 a[80:81], v110 offset:49152
    v_mfma_f32_16x16x32_bf16 v[160:163], a[84:87], a[136:139], v[160:163]
    ds_read_b64_tr_b16 a[82:83], v110 offset:53248
    s_add_u32 s47, s47, 8192
    v_mfma_f32_16x16x32_bf16 v[164:167], a[84:87], a[140:143], v[164:167]
    ds_read_b64_tr_b16 a[84:85], v111 offset:49152
    s_waitcnt lgkmcnt(7)
    v_mfma_f32_16x16x32_bf16 v[168:171], a[88:91], a[136:139], v[168:171]
    ds_read_b64_tr_b16 a[86:87], v111 offset:53248
    buffer_load_dwordx4 a[32:35], v101, s[8:11], s45 offen offset:0 sc1
    v_mfma_f32_16x16x32_bf16 v[172:175], a[88:91], a[140:143], v[172:175]
    ds_read_b64_tr_b16 a[88:89], v112 offset:49152
    v_mfma_f32_16x16x32_bf16 v[176:179], a[92:95], a[136:139], v[176:179]
    ds_read_b64_tr_b16 a[90:91], v112 offset:53248
    buffer_load_dwordx4 a[36:39], v101, s[8:11], s45 offen offset:256 sc1
    v_mfma_f32_16x16x32_bf16 v[180:183], a[92:95], a[140:143], v[180:183]
    ds_read_b64_tr_b16 a[92:93], v113 offset:49152
    v_mfma_f32_16x16x32_bf16 v[184:187], a[96:99], a[136:139], v[184:187]
    ds_read_b64_tr_b16 a[94:95], v113 offset:53248
    buffer_load_dwordx4 a[40:43], v101, s[8:11], s45 offen offset:2048 sc1
    v_mfma_f32_16x16x32_bf16 v[188:191], a[96:99], a[140:143], v[188:191]
    ds_read_b64_tr_b16 a[96:97], v114 offset:49152
    v_mfma_f32_16x16x32_bf16 v[192:195], a[100:103], a[136:139], v[192:195]
    ds_read_b64_tr_b16 a[98:99], v114 offset:53248
    buffer_load_dwordx4 a[44:47], v101, s[8:11], s45 offen offset:2304 sc1
    v_mfma_f32_16x16x32_bf16 v[196:199], a[100:103], a[140:143], v[196:199]
    ds_read_b64_tr_b16 a[100:101], v115 offset:49152
    ds_read_b64_tr_b16 a[102:103], v115 offset:53248
    s_waitcnt lgkmcnt(8)
    v_mfma_f32_16x16x32_bf16 v[136:139], a[72:75], a[144:147], v[136:139]
    buffer_load_dwordx4 a[48:51], v101, s[8:11], s47 offen offset:0 sc1
    v_mfma_f32_16x16x32_bf16 v[140:143], a[72:75], a[148:151], v[140:143]
    ds_read_b64_tr_b16 a[72:73], v108 offset:57344
    buffer_load_dwordx4 a[52:55], v101, s[8:11], s47 offen offset:256 sc1
    v_mfma_f32_16x16x32_bf16 v[144:147], a[76:79], a[144:147], v[144:147]
    ds_read_b64_tr_b16 a[74:75], v108 offset:61440
    buffer_load_dwordx4 a[56:59], v101, s[8:11], s47 offen offset:2048 sc1
    v_mfma_f32_16x16x32_bf16 v[148:151], a[76:79], a[148:151], v[148:151]
    ds_read_b64_tr_b16 a[76:77], v109 offset:57344
    v_mfma_f32_16x16x32_bf16 v[152:155], a[80:83], a[144:147], v[152:155]
    ds_read_b64_tr_b16 a[78:79], v109 offset:61440
    buffer_load_dwordx4 a[60:63], v101, s[8:11], s47 offen offset:2304 sc1
    v_mfma_f32_16x16x32_bf16 v[156:159], a[80:83], a[148:151], v[156:159]
    ds_read_b64_tr_b16 a[80:81], v110 offset:57344
    s_add_u32 s45, s45, 8192
    v_mfma_f32_16x16x32_bf16 v[160:163], a[84:87], a[144:147], v[160:163]
    ds_read_b64_tr_b16 a[82:83], v110 offset:61440
    s_add_u32 s47, s47, 8192
    v_mfma_f32_16x16x32_bf16 v[164:167], a[84:87], a[148:151], v[164:167]
    ds_read_b64_tr_b16 a[84:85], v111 offset:57344
    s_waitcnt lgkmcnt(7)
    v_mfma_f32_16x16x32_bf16 v[168:171], a[88:91], a[144:147], v[168:171]
    ds_read_b64_tr_b16 a[86:87], v111 offset:61440
    s_add_u32 m0, s54, 32768
    v_mfma_f32_16x16x32_bf16 v[172:175], a[88:91], a[148:151], v[172:175]
    ds_read_b64_tr_b16 a[88:89], v112 offset:57344
    buffer_load_dwordx4 v104, s[12:15], s49 offen lds
    v_mfma_f32_16x16x32_bf16 v[176:179], a[92:95], a[144:147], v[176:179]
    ds_read_b64_tr_b16 a[90:91], v112 offset:61440
    s_add_u32 s49, s49, 65536
    v_mfma_f32_16x16x32_bf16 v[180:183], a[92:95], a[148:151], v[180:183]
    ds_read_b64_tr_b16 a[92:93], v113 offset:57344
    v_mfma_f32_16x16x32_bf16 v[184:187], a[96:99], a[144:147], v[184:187]
    ds_read_b64_tr_b16 a[94:95], v113 offset:61440
    s_add_u32 m0, s54, 36864
    v_mfma_f32_16x16x32_bf16 v[188:191], a[96:99], a[148:151], v[188:191]
    ds_read_b64_tr_b16 a[96:97], v114 offset:57344
    buffer_load_dwordx4 v104, s[12:15], s49 offen lds
    v_mfma_f32_16x16x32_bf16 v[192:195], a[100:103], a[144:147], v[192:195]
    ds_read_b64_tr_b16 a[98:99], v114 offset:61440
    s_add_u32 s49, s49, 65536
    v_mfma_f32_16x16x32_bf16 v[196:199], a[100:103], a[148:151], v[196:199]
    ds_read_b64_tr_b16 a[100:101], v115 offset:57344
    ds_read_b64_tr_b16 a[102:103], v115 offset:61440
    s_waitcnt lgkmcnt(8)
    v_mfma_f32_16x16x32_bf16 v[136:139], a[72:75], a[152:155], v[136:139]
    s_add_u32 m0, s54, 40960
    s_nop 0
    buffer_load_dwordx4 v104, s[12:15], s49 offen lds
    v_mfma_f32_16x16x32_bf16 v[140:143], a[72:75], a[156:159], v[140:143]
    ds_read_b64_tr_b16 a[72:73], v116 offset:0
    s_add_u32 s49, s49, 65536
    v_mfma_f32_16x16x32_bf16 v[144:147], a[76:79], a[152:155], v[144:147]
    ds_read_b64_tr_b16 a[74:75], v116 offset:4096
    s_add_u32 m0, s54, 45056
    v_mfma_f32_16x16x32_bf16 v[148:151], a[76:79], a[156:159], v[148:151]
    ds_read_b64_tr_b16 a[76:77], v117 offset:0
    buffer_load_dwordx4 v104, s[12:15], s49 offen lds
    v_mfma_f32_16x16x32_bf16 v[152:155], a[80:83], a[152:155], v[152:155]
    ds_read_b64_tr_b16 a[78:79], v117 offset:4096
    s_add_u32 s49, s49, 65536
    v_mfma_f32_16x16x32_bf16 v[156:159], a[80:83], a[156:159], v[156:159]
    ds_read_b64_tr_b16 a[80:81], v118 offset:0
    s_add_u32 m0, s54, 49152
    v_mfma_f32_16x16x32_bf16 v[160:163], a[84:87], a[152:155], v[160:163]
    ds_read_b64_tr_b16 a[82:83], v118 offset:4096
    buffer_load_dwordx4 v104, s[12:15], s49 offen lds
    v_mfma_f32_16x16x32_bf16 v[164:167], a[84:87], a[156:159], v[164:167]
    ds_read_b64_tr_b16 a[84:85], v119 offset:0
    s_add_u32 s49, s49, 65536
    s_waitcnt lgkmcnt(7)
    v_mfma_f32_16x16x32_bf16 v[168:171], a[88:91], a[152:155], v[168:171]
    ds_read_b64_tr_b16 a[86:87], v119 offset:4096
    s_add_u32 m0, s54, 53248
    s_nop 0
    buffer_load_dwordx4 v104, s[12:15], s49 offen lds
    v_mfma_f32_16x16x32_bf16 v[172:175], a[88:91], a[156:159], v[172:175]
    ds_read_b64_tr_b16 a[88:89], v120 offset:0
    s_add_u32 s49, s49, 65536
    v_mfma_f32_16x16x32_bf16 v[176:179], a[92:95], a[152:155], v[176:179]
    ds_read_b64_tr_b16 a[90:91], v120 offset:4096
    s_add_u32 m0, s54, 57344
    v_mfma_f32_16x16x32_bf16 v[180:183], a[92:95], a[156:159], v[180:183]
    ds_read_b64_tr_b16 a[92:93], v121 offset:0
    buffer_load_dwordx4 v104, s[12:15], s49 offen lds
    v_mfma_f32_16x16x32_bf16 v[184:187], a[96:99], a[152:155], v[184:187]
    ds_read_b64_tr_b16 a[94:95], v121 offset:4096
    s_add_u32 s49, s49, 65536
    v_mfma_f32_16x16x32_bf16 v[188:191], a[96:99], a[156:159], v[188:191]
    ds_read_b64_tr_b16 a[96:97], v122 offset:0
    s_add_u32 m0, s54, 61440
    v_mfma_f32_16x16x32_bf16 v[192:195], a[100:103], a[152:155], v[192:195]
    ds_read_b64_tr_b16 a[98:99], v122 offset:4096
    buffer_load_dwordx4 v104, s[12:15], s49 offen lds
    v_mfma_f32_16x16x32_bf16 v[196:199], a[100:103], a[156:159], v[196:199]
    ds_read_b64_tr_b16 a[100:101], v123 offset:0
    ds_read_b64_tr_b16 a[102:103], v123 offset:4096
    s_add_u32 s49, s49, 65536
    s_waitcnt vmcnt(24)
    s_barrier
    s_waitcnt lgkmcnt(8)
    v_mfma_f32_16x16x32_bf16 v[136:139], a[72:75], a[160:163], v[136:139]
    buffer_load_dwordx4 a[192:195], v101, s[8:11], s45 offen offset:0 sc1
    v_mfma_f32_16x16x32_bf16 v[140:143], a[72:75], a[164:167], v[140:143]
    ds_read_b64_tr_b16 a[72:73], v116 offset:8192
    v_mfma_f32_16x16x32_bf16 v[144:147], a[76:79], a[160:163], v[144:147]
    ds_read_b64_tr_b16 a[74:75], v116 offset:12288
    buffer_load_dwordx4 a[196:199], v101, s[8:11], s45 offen offset:256 sc1
    v_mfma_f32_16x16x32_bf16 v[148:151], a[76:79], a[164:167], v[148:151]
    ds_read_b64_tr_b16 a[76:77], v117 offset:8192
    v_mfma_f32_16x16x32_bf16 v[152:155], a[80:83], a[160:163], v[152:155]
    ds_read_b64_tr_b16 a[78:79], v117 offset:12288
    v_mfma_f32_16x16x32_bf16 v[156:159], a[80:83], a[164:167], v[156:159]
    ds_read_b64_tr_b16 a[80:81], v118 offset:8192
    buffer_load_dwordx4 a[200:203], v101, s[8:11], s45 offen offset:2048 sc1
    v_mfma_f32_16x16x32_bf16 v[160:163], a[84:87], a[160:163], v[160:163]
    ds_read_b64_tr_b16 a[82:83], v118 offset:12288
    v_mfma_f32_16x16x32_bf16 v[164:167], a[84:87], a[164:167], v[164:167]
    ds_read_b64_tr_b16 a[84:85], v119 offset:8192
    s_waitcnt lgkmcnt(7)
    v_mfma_f32_16x16x32_bf16 v[168:171], a[88:91], a[160:163], v[168:171]
    ds_read_b64_tr_b16 a[86:87], v119 offset:12288
    buffer_load_dwordx4 a[204:207], v101, s[8:11], s45 offen offset:2304 sc1
    v_mfma_f32_16x16x32_bf16 v[172:175], a[88:91], a[164:167], v[172:175]
    ds_read_b64_tr_b16 a[88:89], v120 offset:8192
    v_mfma_f32_16x16x32_bf16 v[176:179], a[92:95], a[160:163], v[176:179]
    ds_read_b64_tr_b16 a[90:91], v120 offset:12288
    buffer_load_dwordx4 a[208:211], v101, s[8:11], s47 offen offset:0 sc1
    v_mfma_f32_16x16x32_bf16 v[180:183], a[92:95], a[164:167], v[180:183]
    ds_read_b64_tr_b16 a[92:93], v121 offset:8192
    v_mfma_f32_16x16x32_bf16 v[184:187], a[96:99], a[160:163], v[184:187]
    ds_read_b64_tr_b16 a[94:95], v121 offset:12288
    v_mfma_f32_16x16x32_bf16 v[188:191], a[96:99], a[164:167], v[188:191]
    ds_read_b64_tr_b16 a[96:97], v122 offset:8192
    buffer_load_dwordx4 a[212:215], v101, s[8:11], s47 offen offset:256 sc1
    v_mfma_f32_16x16x32_bf16 v[192:195], a[100:103], a[160:163], v[192:195]
    ds_read_b64_tr_b16 a[98:99], v122 offset:12288
    v_mfma_f32_16x16x32_bf16 v[196:199], a[100:103], a[164:167], v[196:199]
    ds_read_b64_tr_b16 a[100:101], v123 offset:8192
    ds_read_b64_tr_b16 a[102:103], v123 offset:12288
    s_waitcnt lgkmcnt(8)
    v_mfma_f32_16x16x32_bf16 v[136:139], a[72:75], a[168:171], v[136:139]
    buffer_load_dwordx4 a[216:219], v101, s[8:11], s47 offen offset:2048 sc1
    v_mfma_f32_16x16x32_bf16 v[140:143], a[72:75], a[172:175], v[140:143]
    ds_read_b64_tr_b16 a[72:73], v116 offset:16384
    v_mfma_f32_16x16x32_bf16 v[144:147], a[76:79], a[168:171], v[144:147]
    ds_read_b64_tr_b16 a[74:75], v116 offset:20480
    buffer_load_dwordx4 a[220:223], v101, s[8:11], s47 offen offset:2304 sc1
    v_mfma_f32_16x16x32_bf16 v[148:151], a[76:79], a[172:175], v[148:151]
    ds_read_b64_tr_b16 a[76:77], v117 offset:16384
    v_mfma_f32_16x16x32_bf16 v[152:155], a[80:83], a[168:171], v[152:155]
    ds_read_b64_tr_b16 a[78:79], v117 offset:20480
    s_add_u32 s45, s45, 8192
    v_mfma_f32_16x16x32_bf16 v[156:159], a[80:83], a[172:175], v[156:159]
    ds_read_b64_tr_b16 a[80:81], v118 offset:16384
    v_mfma_f32_16x16x32_bf16 v[160:163], a[84:87], a[168:171], v[160:163]
    ds_read_b64_tr_b16 a[82:83], v118 offset:20480
    s_add_u32 s47, s47, 8192
    v_mfma_f32_16x16x32_bf16 v[164:167], a[84:87], a[172:175], v[164:167]
    ds_read_b64_tr_b16 a[84:85], v119 offset:16384
    s_waitcnt lgkmcnt(7)
    v_mfma_f32_16x16x32_bf16 v[168:171], a[88:91], a[168:171], v[168:171]
    ds_read_b64_tr_b16 a[86:87], v119 offset:20480
    buffer_load_dwordx4 a[224:227], v101, s[8:11], s45 offen offset:0 sc1
    v_mfma_f32_16x16x32_bf16 v[172:175], a[88:91], a[172:175], v[172:175]
    ds_read_b64_tr_b16 a[88:89], v120 offset:16384
    v_mfma_f32_16x16x32_bf16 v[176:179], a[92:95], a[168:171], v[176:179]
    ds_read_b64_tr_b16 a[90:91], v120 offset:20480
    buffer_load_dwordx4 a[228:231], v101, s[8:11], s45 offen offset:256 sc1
    v_mfma_f32_16x16x32_bf16 v[180:183], a[92:95], a[172:175], v[180:183]
    ds_read_b64_tr_b16 a[92:93], v121 offset:16384
    v_mfma_f32_16x16x32_bf16 v[184:187], a[96:99], a[168:171], v[184:187]
    ds_read_b64_tr_b16 a[94:95], v121 offset:20480
    buffer_load_dwordx4 a[232:235], v101, s[8:11], s45 offen offset:2048 sc1
    v_mfma_f32_16x16x32_bf16 v[188:191], a[96:99], a[172:175], v[188:191]
    ds_read_b64_tr_b16 a[96:97], v122 offset:16384
    v_mfma_f32_16x16x32_bf16 v[192:195], a[100:103], a[168:171], v[192:195]
    ds_read_b64_tr_b16 a[98:99], v122 offset:20480
    buffer_load_dwordx4 a[236:239], v101, s[8:11], s45 offen offset:2304 sc1
    v_mfma_f32_16x16x32_bf16 v[196:199], a[100:103], a[172:175], v[196:199]
    ds_read_b64_tr_b16 a[100:101], v123 offset:16384
    ds_read_b64_tr_b16 a[102:103], v123 offset:20480
    s_waitcnt lgkmcnt(8)
    v_mfma_f32_16x16x32_bf16 v[136:139], a[72:75], a[176:179], v[136:139]
    buffer_load_dwordx4 a[240:243], v101, s[8:11], s47 offen offset:0 sc1
    v_mfma_f32_16x16x32_bf16 v[140:143], a[72:75], a[180:183], v[140:143]
    ds_read_b64_tr_b16 a[72:73], v116 offset:24576
    buffer_load_dwordx4 a[244:247], v101, s[8:11], s47 offen offset:256 sc1
    v_mfma_f32_16x16x32_bf16 v[144:147], a[76:79], a[176:179], v[144:147]
    ds_read_b64_tr_b16 a[74:75], v116 offset:28672
    buffer_load_dwordx4 a[248:251], v101, s[8:11], s47 offen offset:2048 sc1
    v_mfma_f32_16x16x32_bf16 v[148:151], a[76:79], a[180:183], v[148:151]
    ds_read_b64_tr_b16 a[76:77], v117 offset:24576
    v_mfma_f32_16x16x32_bf16 v[152:155], a[80:83], a[176:179], v[152:155]
    ds_read_b64_tr_b16 a[78:79], v117 offset:28672
    buffer_load_dwordx4 a[252:255], v101, s[8:11], s47 offen offset:2304 sc1
    v_mfma_f32_16x16x32_bf16 v[156:159], a[80:83], a[180:183], v[156:159]
    ds_read_b64_tr_b16 a[80:81], v118 offset:24576
    s_add_u32 s45, s45, 8192
    v_mfma_f32_16x16x32_bf16 v[160:163], a[84:87], a[176:179], v[160:163]
    ds_read_b64_tr_b16 a[82:83], v118 offset:28672
    s_add_u32 s47, s47, 8192
    v_mfma_f32_16x16x32_bf16 v[164:167], a[84:87], a[180:183], v[164:167]
    ds_read_b64_tr_b16 a[84:85], v119 offset:24576
    s_waitcnt lgkmcnt(7)
    v_mfma_f32_16x16x32_bf16 v[168:171], a[88:91], a[176:179], v[168:171]
    ds_read_b64_tr_b16 a[86:87], v119 offset:28672
    s_add_u32 m0, s54, 65536
    v_mfma_f32_16x16x32_bf16 v[172:175], a[88:91], a[180:183], v[172:175]
    ds_read_b64_tr_b16 a[88:89], v120 offset:24576
    buffer_load_dwordx4 v104, s[12:15], s49 offen lds
    v_mfma_f32_16x16x32_bf16 v[176:179], a[92:95], a[176:179], v[176:179]
    ds_read_b64_tr_b16 a[90:91], v120 offset:28672
    s_add_u32 s49, s49, 65536
    v_mfma_f32_16x16x32_bf16 v[180:183], a[92:95], a[180:183], v[180:183]
    ds_read_b64_tr_b16 a[92:93], v121 offset:24576
    v_mfma_f32_16x16x32_bf16 v[184:187], a[96:99], a[176:179], v[184:187]
    ds_read_b64_tr_b16 a[94:95], v121 offset:28672
    s_add_u32 m0, s54, 69632
    v_mfma_f32_16x16x32_bf16 v[188:191], a[96:99], a[180:183], v[188:191]
    ds_read_b64_tr_b16 a[96:97], v122 offset:24576
    buffer_load_dwordx4 v104, s[12:15], s49 offen lds
    v_mfma_f32_16x16x32_bf16 v[192:195], a[100:103], a[176:179], v[192:195]
    ds_read_b64_tr_b16 a[98:99], v122 offset:28672
    s_add_u32 s49, s49, 65536
    v_mfma_f32_16x16x32_bf16 v[196:199], a[100:103], a[180:183], v[196:199]
    ds_read_b64_tr_b16 a[100:101], v123 offset:24576
    ds_read_b64_tr_b16 a[102:103], v123 offset:28672
    s_waitcnt lgkmcnt(8)
    v_mfma_f32_16x16x32_bf16 v[136:139], a[72:75], a[184:187], v[136:139]
    s_add_u32 m0, s54, 73728
    s_nop 0
    buffer_load_dwordx4 v104, s[12:15], s49 offen lds
    v_mfma_f32_16x16x32_bf16 v[140:143], a[72:75], a[188:191], v[140:143]
    ds_read_b64_tr_b16 a[72:73], v128 offset:32768
    s_add_u32 s49, s49, 65536
    v_mfma_f32_16x16x32_bf16 v[144:147], a[76:79], a[184:187], v[144:147]
    ds_read_b64_tr_b16 a[74:75], v128 offset:33792
    s_add_u32 m0, s54, 77824
    v_mfma_f32_16x16x32_bf16 v[148:151], a[76:79], a[188:191], v[148:151]
    ds_read_b64_tr_b16 a[76:77], v129 offset:32768
    buffer_load_dwordx4 v104, s[12:15], s49 offen lds
    v_mfma_f32_16x16x32_bf16 v[152:155], a[80:83], a[184:187], v[152:155]
    ds_read_b64_tr_b16 a[78:79], v129 offset:33792
    s_add_u32 s49, s49, 65536
    v_mfma_f32_16x16x32_bf16 v[156:159], a[80:83], a[188:191], v[156:159]
    ds_read_b64_tr_b16 a[80:81], v130 offset:32768
    s_add_u32 m0, s54, 81920
    v_mfma_f32_16x16x32_bf16 v[160:163], a[84:87], a[184:187], v[160:163]
    ds_read_b64_tr_b16 a[82:83], v130 offset:33792
    buffer_load_dwordx4 v104, s[12:15], s49 offen lds
    v_mfma_f32_16x16x32_bf16 v[164:167], a[84:87], a[188:191], v[164:167]
    ds_read_b64_tr_b16 a[84:85], v131 offset:32768
    s_add_u32 s49, s49, 65536
    s_waitcnt lgkmcnt(7)
    v_mfma_f32_16x16x32_bf16 v[168:171], a[88:91], a[184:187], v[168:171]
    ds_read_b64_tr_b16 a[86:87], v131 offset:33792
    s_add_u32 m0, s54, 86016
    s_nop 0
    buffer_load_dwordx4 v104, s[12:15], s49 offen lds
    v_mfma_f32_16x16x32_bf16 v[172:175], a[88:91], a[188:191], v[172:175]
    s_add_u32 s49, s49, 65536
    v_mfma_f32_16x16x32_bf16 v[176:179], a[92:95], a[184:187], v[176:179]
    s_add_u32 m0, s54, 90112
    v_mfma_f32_16x16x32_bf16 v[180:183], a[92:95], a[188:191], v[180:183]
    buffer_load_dwordx4 v104, s[12:15], s49 offen lds
    v_mfma_f32_16x16x32_bf16 v[184:187], a[96:99], a[184:187], v[184:187]
    s_add_u32 s49, s49, 65536
    v_mfma_f32_16x16x32_bf16 v[188:191], a[96:99], a[188:191], v[188:191]
    s_add_u32 m0, s54, 94208
    v_mfma_f32_16x16x32_bf16 v[192:195], a[100:103], a[184:187], v[192:195]
    buffer_load_dwordx4 v104, s[12:15], s49 offen lds
    v_mfma_f32_16x16x32_bf16 v[196:199], a[100:103], a[188:191], v[196:199]
    s_add_u32 s49, s49, 65536
    s_waitcnt vmcnt(24)
    s_barrier
    s_waitcnt lgkmcnt(4)
    v_mfma_f32_16x16x32_bf16 v[136:139], a[72:75], a[0:3], v[136:139]
    v_cvt_pk_bf16_f32 v168, v168, v169
    v_cvt_pk_bf16_f32 v169, v170, v171
    v_cvt_pk_bf16_f32 v170, v172, v173
    v_mfma_f32_16x16x32_bf16 v[140:143], a[72:75], a[4:7], v[140:143]
    ds_read_b64_tr_b16 a[72:73], v128 offset:36864
    v_cvt_pk_bf16_f32 v171, v174, v175
    s_nop 0
    buffer_store_dwordx4 v[168:171], v105, s[16:19], s36 offen offset:0 sc0 sc1
    v_mfma_f32_16x16x32_bf16 v[144:147], a[76:79], a[0:3], v[144:147]
    ds_read_b64_tr_b16 a[74:75], v128 offset:37888
    v_cvt_pk_bf16_f32 v176, v176, v177
    v_cvt_pk_bf16_f32 v177, v178, v179
    v_cvt_pk_bf16_f32 v178, v180, v181
    v_mfma_f32_16x16x32_bf16 v[148:151], a[76:79], a[4:7], v[148:151]
    ds_read_b64_tr_b16 a[76:77], v129 offset:36864
    v_cvt_pk_bf16_f32 v179, v182, v183
    s_nop 0
    buffer_store_dwordx4 v[176:179], v105, s[16:19], s36 offen offset:1024 sc0 sc1
    s_waitcnt lgkmcnt(3)
    v_mfma_f32_16x16x32_bf16 v[152:155], a[80:83], a[0:3], v[152:155]
    ds_read_b64_tr_b16 a[78:79], v129 offset:37888
    v_cvt_pk_bf16_f32 v184, v184, v185
    v_cvt_pk_bf16_f32 v185, v186, v187
    v_cvt_pk_bf16_f32 v186, v188, v189
    v_mfma_f32_16x16x32_bf16 v[156:159], a[80:83], a[4:7], v[156:159]
    ds_read_b64_tr_b16 a[80:81], v130 offset:36864
    v_cvt_pk_bf16_f32 v187, v190, v191
    s_nop 0
    buffer_store_dwordx4 v[184:187], v105, s[16:19], s36 offen offset:2048 sc0 sc1
    v_mfma_f32_16x16x32_bf16 v[160:163], a[84:87], a[0:3], v[160:163]
    ds_read_b64_tr_b16 a[82:83], v130 offset:37888
    v_cvt_pk_bf16_f32 v192, v192, v193
    v_cvt_pk_bf16_f32 v193, v194, v195
    v_cvt_pk_bf16_f32 v194, v196, v197
    v_mfma_f32_16x16x32_bf16 v[164:167], a[84:87], a[4:7], v[164:167]
    ds_read_b64_tr_b16 a[84:85], v131 offset:36864
    ds_read_b64_tr_b16 a[86:87], v131 offset:37888
    v_cvt_pk_bf16_f32 v195, v198, v199
    s_nop 0
    buffer_store_dwordx4 v[192:195], v105, s[16:19], s36 offen offset:3072 sc0 sc1
    s_waitcnt lgkmcnt(4)
    v_mfma_f32_16x16x32_bf16 v[136:139], a[72:75], a[8:11], v[136:139]
    buffer_load_dwordx4 a[128:131], v101, s[8:11], s45 offen offset:0 sc1
    v_mfma_f32_16x16x32_bf16 v[140:143], a[72:75], a[12:15], v[140:143]
    ds_read_b64_tr_b16 a[72:73], v128 offset:40960
    v_mfma_f32_16x16x32_bf16 v[144:147], a[76:79], a[8:11], v[144:147]
    ds_read_b64_tr_b16 a[74:75], v128 offset:41984
    buffer_load_dwordx4 a[132:135], v101, s[8:11], s45 offen offset:256 sc1
    v_mfma_f32_16x16x32_bf16 v[148:151], a[76:79], a[12:15], v[148:151]
    ds_read_b64_tr_b16 a[76:77], v129 offset:40960
    s_waitcnt lgkmcnt(3)
    v_mfma_f32_16x16x32_bf16 v[152:155], a[80:83], a[8:11], v[152:155]
    ds_read_b64_tr_b16 a[78:79], v129 offset:41984
    v_mfma_f32_16x16x32_bf16 v[156:159], a[80:83], a[12:15], v[156:159]
    ds_read_b64_tr_b16 a[80:81], v130 offset:40960
    buffer_load_dwordx4 a[136:139], v101, s[8:11], s45 offen offset:2048 sc1
    v_mfma_f32_16x16x32_bf16 v[160:163], a[84:87], a[8:11], v[160:163]
    ds_read_b64_tr_b16 a[82:83], v130 offset:41984
    v_mfma_f32_16x16x32_bf16 v[164:167], a[84:87], a[12:15], v[164:167]
    ds_read_b64_tr_b16 a[84:85], v131 offset:40960
    ds_read_b64_tr_b16 a[86:87], v131 offset:41984
    s_waitcnt lgkmcnt(4)
    v_mfma_f32_16x16x32_bf16 v[136:139], a[72:75], a[16:19], v[136:139]
    buffer_load_dwordx4 a[140:143], v101, s[8:11], s45 offen offset:2304 sc1
    v_mfma_f32_16x16x32_bf16 v[140:143], a[72:75], a[20:23], v[140:143]
    ds_read_b64_tr_b16 a[72:73], v128 offset:45056
    v_mfma_f32_16x16x32_bf16 v[144:147], a[76:79], a[16:19], v[144:147]
    ds_read_b64_tr_b16 a[74:75], v128 offset:46080
    buffer_load_dwordx4 a[144:147], v101, s[8:11], s47 offen offset:0 sc1
    v_mfma_f32_16x16x32_bf16 v[148:151], a[76:79], a[20:23], v[148:151]
    ds_read_b64_tr_b16 a[76:77], v129 offset:45056
    s_waitcnt lgkmcnt(3)
    v_mfma_f32_16x16x32_bf16 v[152:155], a[80:83], a[16:19], v[152:155]
    ds_read_b64_tr_b16 a[78:79], v129 offset:46080
    buffer_load_dwordx4 a[148:151], v101, s[8:11], s47 offen offset:256 sc1
    v_mfma_f32_16x16x32_bf16 v[156:159], a[80:83], a[20:23], v[156:159]
    ds_read_b64_tr_b16 a[80:81], v130 offset:45056
    v_mfma_f32_16x16x32_bf16 v[160:163], a[84:87], a[16:19], v[160:163]
    ds_read_b64_tr_b16 a[82:83], v130 offset:46080
    buffer_load_dwordx4 a[152:155], v101, s[8:11], s47 offen offset:2048 sc1
    v_mfma_f32_16x16x32_bf16 v[164:167], a[84:87], a[20:23], v[164:167]
    ds_read_b64_tr_b16 a[84:85], v131 offset:45056
    ds_read_b64_tr_b16 a[86:87], v131 offset:46080
    s_waitcnt lgkmcnt(4)
    v_mfma_f32_16x16x32_bf16 v[136:139], a[72:75], a[24:27], v[136:139]
    buffer_load_dwordx4 a[156:159], v101, s[8:11], s47 offen offset:2304 sc1
    v_mfma_f32_16x16x32_bf16 v[140:143], a[72:75], a[28:31], v[140:143]
    ds_read_b64_tr_b16 a[72:73], v128 offset:49152
    s_add_u32 s45, s45, 8192
    v_mfma_f32_16x16x32_bf16 v[144:147], a[76:79], a[24:27], v[144:147]
    ds_read_b64_tr_b16 a[74:75], v128 offset:50176
    v_mfma_f32_16x16x32_bf16 v[148:151], a[76:79], a[28:31], v[148:151]
    ds_read_b64_tr_b16 a[76:77], v129 offset:49152
    s_add_u32 s47, s47, 8192
    s_waitcnt lgkmcnt(3)
    v_mfma_f32_16x16x32_bf16 v[152:155], a[80:83], a[24:27], v[152:155]
    ds_read_b64_tr_b16 a[78:79], v129 offset:50176
    buffer_load_dwordx4 a[160:163], v101, s[8:11], s45 offen offset:0 sc1
    v_mfma_f32_16x16x32_bf16 v[156:159], a[80:83], a[28:31], v[156:159]
    ds_read_b64_tr_b16 a[80:81], v130 offset:49152
    v_mfma_f32_16x16x32_bf16 v[160:163], a[84:87], a[24:27], v[160:163]
    ds_read_b64_tr_b16 a[82:83], v130 offset:50176
    buffer_load_dwordx4 a[164:167], v101, s[8:11], s45 offen offset:256 sc1
    v_mfma_f32_16x16x32_bf16 v[164:167], a[84:87], a[28:31], v[164:167]
    ds_read_b64_tr_b16 a[84:85], v131 offset:49152
    ds_read_b64_tr_b16 a[86:87], v131 offset:50176
    s_waitcnt lgkmcnt(4)
    v_mfma_f32_16x16x32_bf16 v[136:139], a[72:75], a[32:35], v[136:139]
    buffer_load_dwordx4 a[168:171], v101, s[8:11], s45 offen offset:2048 sc1
    v_mfma_f32_16x16x32_bf16 v[140:143], a[72:75], a[36:39], v[140:143]
    ds_read_b64_tr_b16 a[72:73], v128 offset:53248
    v_mfma_f32_16x16x32_bf16 v[144:147], a[76:79], a[32:35], v[144:147]
    ds_read_b64_tr_b16 a[74:75], v128 offset:54272
    buffer_load_dwordx4 a[172:175], v101, s[8:11], s45 offen offset:2304 sc1
    v_mfma_f32_16x16x32_bf16 v[148:151], a[76:79], a[36:39], v[148:151]
    ds_read_b64_tr_b16 a[76:77], v129 offset:53248
    s_waitcnt lgkmcnt(3)
    v_mfma_f32_16x16x32_bf16 v[152:155], a[80:83], a[32:35], v[152:155]
    ds_read_b64_tr_b16 a[78:79], v129 offset:54272
    buffer_load_dwordx4 a[176:179], v101, s[8:11], s47 offen offset:0 sc1
    v_mfma_f32_16x16x32_bf16 v[156:159], a[80:83], a[36:39], v[156:159]
    ds_read_b64_tr_b16 a[80:81], v130 offset:53248
    v_mfma_f32_16x16x32_bf16 v[160:163], a[84:87], a[32:35], v[160:163]
    ds_read_b64_tr_b16 a[82:83], v130 offset:54272
    buffer_load_dwordx4 a[180:183], v101, s[8:11], s47 offen offset:256 sc1
    v_mfma_f32_16x16x32_bf16 v[164:167], a[84:87], a[36:39], v[164:167]
    ds_read_b64_tr_b16 a[84:85], v131 offset:53248
    ds_read_b64_tr_b16 a[86:87], v131 offset:54272
    s_waitcnt lgkmcnt(4)
    v_mfma_f32_16x16x32_bf16 v[136:139], a[72:75], a[40:43], v[136:139]
    buffer_load_dwordx4 a[184:187], v101, s[8:11], s47 offen offset:2048 sc1
    v_mfma_f32_16x16x32_bf16 v[140:143], a[72:75], a[44:47], v[140:143]
    ds_read_b64_tr_b16 a[72:73], v128 offset:57344
    buffer_load_dwordx4 a[188:191], v101, s[8:11], s47 offen offset:2304 sc1
    v_mfma_f32_16x16x32_bf16 v[144:147], a[76:79], a[40:43], v[144:147]
    ds_read_b64_tr_b16 a[74:75], v128 offset:58368
    s_add_u32 s45, s45, 8192
    v_mfma_f32_16x16x32_bf16 v[148:151], a[76:79], a[44:47], v[148:151]
    ds_read_b64_tr_b16 a[76:77], v129 offset:57344
    s_add_u32 s47, s47, 8192
    s_waitcnt lgkmcnt(3)
    v_mfma_f32_16x16x32_bf16 v[152:155], a[80:83], a[40:43], v[152:155]
    ds_read_b64_tr_b16 a[78:79], v129 offset:58368
    s_add_u32 m0, s54, 98304
    v_mfma_f32_16x16x32_bf16 v[156:159], a[80:83], a[44:47], v[156:159]
    ds_read_b64_tr_b16 a[80:81], v130 offset:57344
    buffer_load_dwordx4 v104, s[12:15], s49 offen lds
    v_mfma_f32_16x16x32_bf16 v[160:163], a[84:87], a[40:43], v[160:163]
    ds_read_b64_tr_b16 a[82:83], v130 offset:58368
    s_add_u32 s49, s49, 65536
    v_mfma_f32_16x16x32_bf16 v[164:167], a[84:87], a[44:47], v[164:167]
    ds_read_b64_tr_b16 a[84:85], v131 offset:57344
    ds_read_b64_tr_b16 a[86:87], v131 offset:58368
    s_waitcnt lgkmcnt(4)
    v_mfma_f32_16x16x32_bf16 v[136:139], a[72:75], a[48:51], v[136:139]
    s_add_u32 m0, s54, 102400
    s_nop 0
    buffer_load_dwordx4 v104, s[12:15], s49 offen lds
    v_mfma_f32_16x16x32_bf16 v[140:143], a[72:75], a[52:55], v[140:143]
    ds_read_b64_tr_b16 a[72:73], v128 offset:61440
    s_add_u32 s49, s49, 65536
    v_mfma_f32_16x16x32_bf16 v[144:147], a[76:79], a[48:51], v[144:147]
    ds_read_b64_tr_b16 a[74:75], v128 offset:62464
    s_add_u32 m0, s54, 106496
    s_nop 0
    buffer_load_dwordx4 v104, s[12:15], s49 offen lds
    v_mfma_f32_16x16x32_bf16 v[148:151], a[76:79], a[52:55], v[148:151]
    ds_read_b64_tr_b16 a[76:77], v129 offset:61440
    s_add_u32 s49, s49, 65536
    s_waitcnt lgkmcnt(3)
    v_mfma_f32_16x16x32_bf16 v[152:155], a[80:83], a[48:51], v[152:155]
    ds_read_b64_tr_b16 a[78:79], v129 offset:62464
    s_add_u32 m0, s54, 110592
    s_nop 0
    buffer_load_dwordx4 v104, s[12:15], s49 offen lds
    v_mfma_f32_16x16x32_bf16 v[156:159], a[80:83], a[52:55], v[156:159]
    ds_read_b64_tr_b16 a[80:81], v130 offset:61440
    s_add_u32 s49, s49, 65536
    v_mfma_f32_16x16x32_bf16 v[160:163], a[84:87], a[48:51], v[160:163]
    ds_read_b64_tr_b16 a[82:83], v130 offset:62464
    s_add_u32 m0, s54, 114688
    s_nop 0
    buffer_load_dwordx4 v104, s[12:15], s49 offen lds
    v_mfma_f32_16x16x32_bf16 v[164:167], a[84:87], a[52:55], v[164:167]
    ds_read_b64_tr_b16 a[84:85], v131 offset:61440
    ds_read_b64_tr_b16 a[86:87], v131 offset:62464
    s_add_u32 s49, s49, 65536
    s_waitcnt lgkmcnt(4)
    v_mfma_f32_16x16x32_bf16 v[136:139], a[72:75], a[56:59], v[136:139]
    s_add_u32 m0, s54, 118784
    s_nop 0
    buffer_load_dwordx4 v104, s[12:15], s49 offen lds
    v_mfma_f32_16x16x32_bf16 v[140:143], a[72:75], a[60:63], v[140:143]
    ds_read_b64_tr_b16 a[72:73], v124 offset:0
    s_add_u32 s49, s49, 65536
    v_mfma_f32_16x16x32_bf16 v[144:147], a[76:79], a[56:59], v[144:147]
    ds_read_b64_tr_b16 a[74:75], v124 offset:1024
    s_add_u32 m0, s54, 122880
    v_mfma_f32_16x16x32_bf16 v[148:151], a[76:79], a[60:63], v[148:151]
    ds_read_b64_tr_b16 a[76:77], v125 offset:0
    buffer_load_dwordx4 v104, s[12:15], s49 offen lds
    s_waitcnt lgkmcnt(3)
    v_mfma_f32_16x16x32_bf16 v[152:155], a[80:83], a[56:59], v[152:155]
    ds_read_b64_tr_b16 a[78:79], v125 offset:1024
    s_add_u32 s49, s49, 65536
    v_mfma_f32_16x16x32_bf16 v[156:159], a[80:83], a[60:63], v[156:159]
    ds_read_b64_tr_b16 a[80:81], v126 offset:0
    s_add_u32 m0, s54, 126976
    v_mfma_f32_16x16x32_bf16 v[160:163], a[84:87], a[56:59], v[160:163]
    ds_read_b64_tr_b16 a[82:83], v126 offset:1024
    buffer_load_dwordx4 v104, s[12:15], s49 offen lds
    v_mfma_f32_16x16x32_bf16 v[164:167], a[84:87], a[60:63], v[164:167]
    ds_read_b64_tr_b16 a[84:85], v127 offset:0
    ds_read_b64_tr_b16 a[86:87], v127 offset:1024
    s_add_u32 s49, s49, 65536
    s_waitcnt vmcnt(28)
    s_barrier
    s_waitcnt lgkmcnt(4)
    v_mfma_f32_16x16x32_bf16 v[136:139], a[72:75], a[192:195], v[136:139]
    buffer_load_dwordx4 a[0:3], v101, s[8:11], s45 offen offset:0 sc1
    v_mfma_f32_16x16x32_bf16 v[140:143], a[72:75], a[196:199], v[140:143]
    ds_read_b64_tr_b16 a[72:73], v124 offset:4096
    v_mfma_f32_16x16x32_bf16 v[144:147], a[76:79], a[192:195], v[144:147]
    ds_read_b64_tr_b16 a[74:75], v124 offset:5120
    v_mfma_f32_16x16x32_bf16 v[148:151], a[76:79], a[196:199], v[148:151]
    ds_read_b64_tr_b16 a[76:77], v125 offset:4096
    s_waitcnt lgkmcnt(3)
    v_mfma_f32_16x16x32_bf16 v[152:155], a[80:83], a[192:195], v[152:155]
    ds_read_b64_tr_b16 a[78:79], v125 offset:5120
    buffer_load_dwordx4 a[4:7], v101, s[8:11], s45 offen offset:256 sc1
    v_mfma_f32_16x16x32_bf16 v[156:159], a[80:83], a[196:199], v[156:159]
    ds_read_b64_tr_b16 a[80:81], v126 offset:4096
    v_mfma_f32_16x16x32_bf16 v[160:163], a[84:87], a[192:195], v[160:163]
    ds_read_b64_tr_b16 a[82:83], v126 offset:5120
    v_mfma_f32_16x16x32_bf16 v[164:167], a[84:87], a[196:199], v[164:167]
    ds_read_b64_tr_b16 a[84:85], v127 offset:4096
    ds_read_b64_tr_b16 a[86:87], v127 offset:5120
    s_waitcnt lgkmcnt(4)
    v_mfma_f32_16x16x32_bf16 v[136:139], a[72:75], a[200:203], v[136:139]
    buffer_load_dwordx4 a[8:11], v101, s[8:11], s45 offen offset:2048 sc1
    v_mfma_f32_16x16x32_bf16 v[140:143], a[72:75], a[204:207], v[140:143]
    ds_read_b64_tr_b16 a[72:73], v124 offset:8192
    v_mfma_f32_16x16x32_bf16 v[144:147], a[76:79], a[200:203], v[144:147]
    ds_read_b64_tr_b16 a[74:75], v124 offset:9216
    v_mfma_f32_16x16x32_bf16 v[148:151], a[76:79], a[204:207], v[148:151]
    ds_read_b64_tr_b16 a[76:77], v125 offset:8192
    s_waitcnt lgkmcnt(3)
    v_mfma_f32_16x16x32_bf16 v[152:155], a[80:83], a[200:203], v[152:155]
    ds_read_b64_tr_b16 a[78:79], v125 offset:9216
    buffer_load_dwordx4 a[12:15], v101, s[8:11], s45 offen offset:2304 sc1
    v_mfma_f32_16x16x32_bf16 v[156:159], a[80:83], a[204:207], v[156:159]
    ds_read_b64_tr_b16 a[80:81], v126 offset:8192
    v_mfma_f32_16x16x32_bf16 v[160:163], a[84:87], a[200:203], v[160:163]
    ds_read_b64_tr_b16 a[82:83], v126 offset:9216
    v_mfma_f32_16x16x32_bf16 v[164:167], a[84:87], a[204:207], v[164:167]
    ds_read_b64_tr_b16 a[84:85], v127 offset:8192
    ds_read_b64_tr_b16 a[86:87], v127 offset:9216
    s_waitcnt lgkmcnt(4)
    v_mfma_f32_16x16x32_bf16 v[136:139], a[72:75], a[208:211], v[136:139]
    buffer_load_dwordx4 a[16:19], v101, s[8:11], s47 offen offset:0 sc1
    v_mfma_f32_16x16x32_bf16 v[140:143], a[72:75], a[212:215], v[140:143]
    ds_read_b64_tr_b16 a[72:73], v124 offset:12288
    v_mfma_f32_16x16x32_bf16 v[144:147], a[76:79], a[208:211], v[144:147]
    ds_read_b64_tr_b16 a[74:75], v124 offset:13312
    v_mfma_f32_16x16x32_bf16 v[148:151], a[76:79], a[212:215], v[148:151]
    ds_read_b64_tr_b16 a[76:77], v125 offset:12288
    s_waitcnt lgkmcnt(3)
    v_mfma_f32_16x16x32_bf16 v[152:155], a[80:83], a[208:211], v[152:155]
    ds_read_b64_tr_b16 a[78:79], v125 offset:13312
    buffer_load_dwordx4 a[20:23], v101, s[8:11], s47 offen offset:256 sc1
    v_mfma_f32_16x16x32_bf16 v[156:159], a[80:83], a[212:215], v[156:159]
    ds_read_b64_tr_b16 a[80:81], v126 offset:12288
    v_mfma_f32_16x16x32_bf16 v[160:163], a[84:87], a[208:211], v[160:163]
    ds_read_b64_tr_b16 a[82:83], v126 offset:13312
    v_mfma_f32_16x16x32_bf16 v[164:167], a[84:87], a[212:215], v[164:167]
    ds_read_b64_tr_b16 a[84:85], v127 offset:12288
    ds_read_b64_tr_b16 a[86:87], v127 offset:13312
    s_waitcnt lgkmcnt(4)
    v_mfma_f32_16x16x32_bf16 v[136:139], a[72:75], a[216:219], v[136:139]
    buffer_load_dwordx4 a[24:27], v101, s[8:11], s47 offen offset:2048 sc1
    v_mfma_f32_16x16x32_bf16 v[140:143], a[72:75], a[220:223], v[140:143]
    ds_read_b64_tr_b16 a[72:73], v124 offset:16384
    v_mfma_f32_16x16x32_bf16 v[144:147], a[76:79], a[216:219], v[144:147]
    ds_read_b64_tr_b16 a[74:75], v124 offset:17408
    buffer_load_dwordx4 a[28:31], v101, s[8:11], s47 offen offset:2304 sc1
    v_mfma_f32_16x16x32_bf16 v[148:151], a[76:79], a[220:223], v[148:151]
    ds_read_b64_tr_b16 a[76:77], v125 offset:16384
    s_waitcnt lgkmcnt(3)
    v_mfma_f32_16x16x32_bf16 v[152:155], a[80:83], a[216:219], v[152:155]
    ds_read_b64_tr_b16 a[78:79], v125 offset:17408
    s_add_u32 s45, s45, 8192
    v_mfma_f32_16x16x32_bf16 v[156:159], a[80:83], a[220:223], v[156:159]
    ds_read_b64_tr_b16 a[80:81], v126 offset:16384
    v_mfma_f32_16x16x32_bf16 v[160:163], a[84:87], a[216:219], v[160:163]
    ds_read_b64_tr_b16 a[82:83], v126 offset:17408
    s_add_u32 s47, s47, 8192
    v_mfma_f32_16x16x32_bf16 v[164:167], a[84:87], a[220:223], v[164:167]
    ds_read_b64_tr_b16 a[84:85], v127 offset:16384
    ds_read_b64_tr_b16 a[86:87], v127 offset:17408
    s_waitcnt lgkmcnt(4)
    v_mfma_f32_16x16x32_bf16 v[136:139], a[72:75], a[224:227], v[136:139]
    buffer_load_dwordx4 a[32:35], v101, s[8:11], s45 offen offset:0 sc1
    v_mfma_f32_16x16x32_bf16 v[140:143], a[72:75], a[228:231], v[140:143]
    ds_read_b64_tr_b16 a[72:73], v124 offset:20480
    v_mfma_f32_16x16x32_bf16 v[144:147], a[76:79], a[224:227], v[144:147]
    ds_read_b64_tr_b16 a[74:75], v124 offset:21504
    v_mfma_f32_16x16x32_bf16 v[148:151], a[76:79], a[228:231], v[148:151]
    ds_read_b64_tr_b16 a[76:77], v125 offset:20480
    s_waitcnt lgkmcnt(3)
    v_mfma_f32_16x16x32_bf16 v[152:155], a[80:83], a[224:227], v[152:155]
    ds_read_b64_tr_b16 a[78:79], v125 offset:21504
    buffer_load_dwordx4 a[36:39], v101, s[8:11], s45 offen offset:256 sc1
    v_mfma_f32_16x16x32_bf16 v[156:159], a[80:83], a[228:231], v[156:159]
    ds_read_b64_tr_b16 a[80:81], v126 offset:20480
    v_mfma_f32_16x16x32_bf16 v[160:163], a[84:87], a[224:227], v[160:163]
    ds_read_b64_tr_b16 a[82:83], v126 offset:21504
    v_mfma_f32_16x16x32_bf16 v[164:167], a[84:87], a[228:231], v[164:167]
    ds_read_b64_tr_b16 a[84:85], v127 offset:20480
    ds_read_b64_tr_b16 a[86:87], v127 offset:21504
    s_waitcnt lgkmcnt(4)
    v_mfma_f32_16x16x32_bf16 v[136:139], a[72:75], a[232:235], v[136:139]
    buffer_load_dwordx4 a[40:43], v101, s[8:11], s45 offen offset:2048 sc1
    v_mfma_f32_16x16x32_bf16 v[140:143], a[72:75], a[236:239], v[140:143]
    ds_read_b64_tr_b16 a[72:73], v124 offset:24576
    v_mfma_f32_16x16x32_bf16 v[144:147], a[76:79], a[232:235], v[144:147]
    ds_read_b64_tr_b16 a[74:75], v124 offset:25600
    v_mfma_f32_16x16x32_bf16 v[148:151], a[76:79], a[236:239], v[148:151]
    ds_read_b64_tr_b16 a[76:77], v125 offset:24576
    s_waitcnt lgkmcnt(3)
    v_mfma_f32_16x16x32_bf16 v[152:155], a[80:83], a[232:235], v[152:155]
    ds_read_b64_tr_b16 a[78:79], v125 offset:25600
    buffer_load_dwordx4 a[44:47], v101, s[8:11], s45 offen offset:2304 sc1
    v_mfma_f32_16x16x32_bf16 v[156:159], a[80:83], a[236:239], v[156:159]
    ds_read_b64_tr_b16 a[80:81], v126 offset:24576
    v_mfma_f32_16x16x32_bf16 v[160:163], a[84:87], a[232:235], v[160:163]
    ds_read_b64_tr_b16 a[82:83], v126 offset:25600
    v_mfma_f32_16x16x32_bf16 v[164:167], a[84:87], a[236:239], v[164:167]
    ds_read_b64_tr_b16 a[84:85], v127 offset:24576
    ds_read_b64_tr_b16 a[86:87], v127 offset:25600
    s_waitcnt lgkmcnt(4)
    v_mfma_f32_16x16x32_bf16 v[136:139], a[72:75], a[240:243], v[136:139]
    buffer_load_dwordx4 a[48:51], v101, s[8:11], s47 offen offset:0 sc1
    v_mfma_f32_16x16x32_bf16 v[140:143], a[72:75], a[244:247], v[140:143]
    ds_read_b64_tr_b16 a[72:73], v124 offset:28672
    v_mfma_f32_16x16x32_bf16 v[144:147], a[76:79], a[240:243], v[144:147]
    ds_read_b64_tr_b16 a[74:75], v124 offset:29696
    v_mfma_f32_16x16x32_bf16 v[148:151], a[76:79], a[244:247], v[148:151]
    ds_read_b64_tr_b16 a[76:77], v125 offset:28672
    s_waitcnt lgkmcnt(3)
    v_mfma_f32_16x16x32_bf16 v[152:155], a[80:83], a[240:243], v[152:155]
    ds_read_b64_tr_b16 a[78:79], v125 offset:29696
    buffer_load_dwordx4 a[52:55], v101, s[8:11], s47 offen offset:256 sc1
    v_mfma_f32_16x16x32_bf16 v[156:159], a[80:83], a[244:247], v[156:159]
    ds_read_b64_tr_b16 a[80:81], v126 offset:28672
    v_mfma_f32_16x16x32_bf16 v[160:163], a[84:87], a[240:243], v[160:163]
    ds_read_b64_tr_b16 a[82:83], v126 offset:29696
    v_mfma_f32_16x16x32_bf16 v[164:167], a[84:87], a[244:247], v[164:167]
    ds_read_b64_tr_b16 a[84:85], v127 offset:28672
    ds_read_b64_tr_b16 a[86:87], v127 offset:29696
    s_waitcnt lgkmcnt(4)
    v_mfma_f32_16x16x32_bf16 v[136:139], a[72:75], a[248:251], v[136:139]
    buffer_load_dwordx4 a[56:59], v101, s[8:11], s47 offen offset:2048 sc1
    v_mfma_f32_16x16x32_bf16 v[140:143], a[72:75], a[252:255], v[140:143]
    ds_read_b64_tr_b16 a[72:73], v124 offset:32768
    v_mfma_f32_16x16x32_bf16 v[144:147], a[76:79], a[248:251], v[144:147]
    ds_read_b64_tr_b16 a[74:75], v124 offset:33792
    buffer_load_dwordx4 a[60:63], v101, s[8:11], s47 offen offset:2304 sc1
    v_mfma_f32_16x16x32_bf16 v[148:151], a[76:79], a[252:255], v[148:151]
    ds_read_b64_tr_b16 a[76:77], v125 offset:32768
    s_waitcnt lgkmcnt(3)
    v_mfma_f32_16x16x32_bf16 v[152:155], a[80:83], a[248:251], v[152:155]
    ds_read_b64_tr_b16 a[78:79], v125 offset:33792
    s_add_u32 s45, s45, 8192
    v_mfma_f32_16x16x32_bf16 v[156:159], a[80:83], a[252:255], v[156:159]
    ds_read_b64_tr_b16 a[80:81], v126 offset:32768
    v_mfma_f32_16x16x32_bf16 v[160:163], a[84:87], a[248:251], v[160:163]
    ds_read_b64_tr_b16 a[82:83], v126 offset:33792
    s_add_u32 s47, s47, 8192
    v_mfma_f32_16x16x32_bf16 v[164:167], a[84:87], a[252:255], v[164:167]
    ds_read_b64_tr_b16 a[84:85], v127 offset:32768
    ds_read_b64_tr_b16 a[86:87], v127 offset:33792
    s_waitcnt vmcnt(40)
    s_waitcnt vmcnt(16)
    s_barrier
    s_cmp_lg_u32 s24, 0
    s_cbranch_scc1 parallel_sum__softmax_full_mha__dense_activation_silu__prompt_kernel_nf_ex
    v_mov_b32 v10, s94
    v_mov_b32 v11, 0
    s_mov_b64 exec, 1
    buffer_store_dword v10, v11, s[32:35], s38 offen sc0 sc1
    s_mov_b64 exec, -1
parallel_sum__softmax_full_mha__dense_activation_silu__prompt_kernel_nf_ex:
    s_waitcnt lgkmcnt(4)
    v_mfma_f32_16x16x32_bf16 v[136:139], a[72:75], a[128:131], v[136:139]
    buffer_load_dword v12, v107, s[32:35], s60 offen sc0 sc1
    v_mfma_f32_16x16x32_bf16 v[140:143], a[72:75], a[132:135], v[140:143]
    ds_read_b64_tr_b16 a[72:73], v124 offset:36864
    v_mfma_f32_16x16x32_bf16 v[144:147], a[76:79], a[128:131], v[144:147]
    ds_read_b64_tr_b16 a[74:75], v124 offset:37888
    v_mfma_f32_16x16x32_bf16 v[148:151], a[76:79], a[132:135], v[148:151]
    ds_read_b64_tr_b16 a[76:77], v125 offset:36864
    s_waitcnt lgkmcnt(3)
    v_mfma_f32_16x16x32_bf16 v[152:155], a[80:83], a[128:131], v[152:155]
    ds_read_b64_tr_b16 a[78:79], v125 offset:37888
    v_mfma_f32_16x16x32_bf16 v[156:159], a[80:83], a[132:135], v[156:159]
    ds_read_b64_tr_b16 a[80:81], v126 offset:36864
    v_mfma_f32_16x16x32_bf16 v[160:163], a[84:87], a[128:131], v[160:163]
    ds_read_b64_tr_b16 a[82:83], v126 offset:37888
    v_mfma_f32_16x16x32_bf16 v[164:167], a[84:87], a[132:135], v[164:167]
    ds_read_b64_tr_b16 a[84:85], v127 offset:36864
    ds_read_b64_tr_b16 a[86:87], v127 offset:37888
    s_waitcnt lgkmcnt(4)
    v_mfma_f32_16x16x32_bf16 v[136:139], a[72:75], a[136:139], v[136:139]
    v_mfma_f32_16x16x32_bf16 v[140:143], a[72:75], a[140:143], v[140:143]
    ds_read_b64_tr_b16 a[72:73], v124 offset:40960
    v_mfma_f32_16x16x32_bf16 v[144:147], a[76:79], a[136:139], v[144:147]
    ds_read_b64_tr_b16 a[74:75], v124 offset:41984
    v_mfma_f32_16x16x32_bf16 v[148:151], a[76:79], a[140:143], v[148:151]
    ds_read_b64_tr_b16 a[76:77], v125 offset:40960
    s_waitcnt lgkmcnt(3)
    v_mfma_f32_16x16x32_bf16 v[152:155], a[80:83], a[136:139], v[152:155]
    ds_read_b64_tr_b16 a[78:79], v125 offset:41984
    v_mfma_f32_16x16x32_bf16 v[156:159], a[80:83], a[140:143], v[156:159]
    ds_read_b64_tr_b16 a[80:81], v126 offset:40960
    v_mfma_f32_16x16x32_bf16 v[160:163], a[84:87], a[136:139], v[160:163]
    ds_read_b64_tr_b16 a[82:83], v126 offset:41984
    v_mfma_f32_16x16x32_bf16 v[164:167], a[84:87], a[140:143], v[164:167]
    ds_read_b64_tr_b16 a[84:85], v127 offset:40960
    ds_read_b64_tr_b16 a[86:87], v127 offset:41984
    s_waitcnt lgkmcnt(4)
    v_mfma_f32_16x16x32_bf16 v[136:139], a[72:75], a[144:147], v[136:139]
    v_mfma_f32_16x16x32_bf16 v[140:143], a[72:75], a[148:151], v[140:143]
    ds_read_b64_tr_b16 a[72:73], v124 offset:45056
    v_mfma_f32_16x16x32_bf16 v[144:147], a[76:79], a[144:147], v[144:147]
    ds_read_b64_tr_b16 a[74:75], v124 offset:46080
    v_mfma_f32_16x16x32_bf16 v[148:151], a[76:79], a[148:151], v[148:151]
    ds_read_b64_tr_b16 a[76:77], v125 offset:45056
    s_waitcnt lgkmcnt(3)
    v_mfma_f32_16x16x32_bf16 v[152:155], a[80:83], a[144:147], v[152:155]
    ds_read_b64_tr_b16 a[78:79], v125 offset:46080
    v_mfma_f32_16x16x32_bf16 v[156:159], a[80:83], a[148:151], v[156:159]
    ds_read_b64_tr_b16 a[80:81], v126 offset:45056
    v_mfma_f32_16x16x32_bf16 v[160:163], a[84:87], a[144:147], v[160:163]
    ds_read_b64_tr_b16 a[82:83], v126 offset:46080
    v_mfma_f32_16x16x32_bf16 v[164:167], a[84:87], a[148:151], v[164:167]
    ds_read_b64_tr_b16 a[84:85], v127 offset:45056
    ds_read_b64_tr_b16 a[86:87], v127 offset:46080
    s_waitcnt lgkmcnt(4)
    v_mfma_f32_16x16x32_bf16 v[136:139], a[72:75], a[152:155], v[136:139]
    v_mfma_f32_16x16x32_bf16 v[140:143], a[72:75], a[156:159], v[140:143]
    ds_read_b64_tr_b16 a[72:73], v124 offset:49152
    v_mfma_f32_16x16x32_bf16 v[144:147], a[76:79], a[152:155], v[144:147]
    ds_read_b64_tr_b16 a[74:75], v124 offset:50176
    v_mfma_f32_16x16x32_bf16 v[148:151], a[76:79], a[156:159], v[148:151]
    ds_read_b64_tr_b16 a[76:77], v125 offset:49152
    s_waitcnt lgkmcnt(3)
    v_mfma_f32_16x16x32_bf16 v[152:155], a[80:83], a[152:155], v[152:155]
    ds_read_b64_tr_b16 a[78:79], v125 offset:50176
    v_mfma_f32_16x16x32_bf16 v[156:159], a[80:83], a[156:159], v[156:159]
    ds_read_b64_tr_b16 a[80:81], v126 offset:49152
    v_mfma_f32_16x16x32_bf16 v[160:163], a[84:87], a[152:155], v[160:163]
    ds_read_b64_tr_b16 a[82:83], v126 offset:50176
    v_mfma_f32_16x16x32_bf16 v[164:167], a[84:87], a[156:159], v[164:167]
    ds_read_b64_tr_b16 a[84:85], v127 offset:49152
    ds_read_b64_tr_b16 a[86:87], v127 offset:50176
    s_waitcnt lgkmcnt(4)
    v_mfma_f32_16x16x32_bf16 v[136:139], a[72:75], a[160:163], v[136:139]
    v_mfma_f32_16x16x32_bf16 v[140:143], a[72:75], a[164:167], v[140:143]
    ds_read_b64_tr_b16 a[72:73], v124 offset:53248
    v_mfma_f32_16x16x32_bf16 v[144:147], a[76:79], a[160:163], v[144:147]
    ds_read_b64_tr_b16 a[74:75], v124 offset:54272
    v_mfma_f32_16x16x32_bf16 v[148:151], a[76:79], a[164:167], v[148:151]
    ds_read_b64_tr_b16 a[76:77], v125 offset:53248
    s_waitcnt lgkmcnt(3)
    v_mfma_f32_16x16x32_bf16 v[152:155], a[80:83], a[160:163], v[152:155]
    ds_read_b64_tr_b16 a[78:79], v125 offset:54272
    v_mfma_f32_16x16x32_bf16 v[156:159], a[80:83], a[164:167], v[156:159]
    ds_read_b64_tr_b16 a[80:81], v126 offset:53248
    v_mfma_f32_16x16x32_bf16 v[160:163], a[84:87], a[160:163], v[160:163]
    ds_read_b64_tr_b16 a[82:83], v126 offset:54272
    v_mfma_f32_16x16x32_bf16 v[164:167], a[84:87], a[164:167], v[164:167]
    ds_read_b64_tr_b16 a[84:85], v127 offset:53248
    ds_read_b64_tr_b16 a[86:87], v127 offset:54272
    s_waitcnt lgkmcnt(4)
    v_mfma_f32_16x16x32_bf16 v[136:139], a[72:75], a[168:171], v[136:139]
    v_mfma_f32_16x16x32_bf16 v[140:143], a[72:75], a[172:175], v[140:143]
    ds_read_b64_tr_b16 a[72:73], v124 offset:57344
    v_mfma_f32_16x16x32_bf16 v[144:147], a[76:79], a[168:171], v[144:147]
    ds_read_b64_tr_b16 a[74:75], v124 offset:58368
    v_mfma_f32_16x16x32_bf16 v[148:151], a[76:79], a[172:175], v[148:151]
    ds_read_b64_tr_b16 a[76:77], v125 offset:57344
    s_waitcnt lgkmcnt(3)
    v_mfma_f32_16x16x32_bf16 v[152:155], a[80:83], a[168:171], v[152:155]
    ds_read_b64_tr_b16 a[78:79], v125 offset:58368
    v_mfma_f32_16x16x32_bf16 v[156:159], a[80:83], a[172:175], v[156:159]
    ds_read_b64_tr_b16 a[80:81], v126 offset:57344
    v_mfma_f32_16x16x32_bf16 v[160:163], a[84:87], a[168:171], v[160:163]
    ds_read_b64_tr_b16 a[82:83], v126 offset:58368
    v_mfma_f32_16x16x32_bf16 v[164:167], a[84:87], a[172:175], v[164:167]
    ds_read_b64_tr_b16 a[84:85], v127 offset:57344
    ds_read_b64_tr_b16 a[86:87], v127 offset:58368
    s_waitcnt lgkmcnt(4)
    v_mfma_f32_16x16x32_bf16 v[136:139], a[72:75], a[176:179], v[136:139]
    v_mfma_f32_16x16x32_bf16 v[140:143], a[72:75], a[180:183], v[140:143]
    ds_read_b64_tr_b16 a[72:73], v124 offset:61440
    v_mfma_f32_16x16x32_bf16 v[144:147], a[76:79], a[176:179], v[144:147]
    ds_read_b64_tr_b16 a[74:75], v124 offset:62464
    v_mfma_f32_16x16x32_bf16 v[148:151], a[76:79], a[180:183], v[148:151]
    ds_read_b64_tr_b16 a[76:77], v125 offset:61440
    s_waitcnt lgkmcnt(3)
    v_mfma_f32_16x16x32_bf16 v[152:155], a[80:83], a[176:179], v[152:155]
    ds_read_b64_tr_b16 a[78:79], v125 offset:62464
    v_mfma_f32_16x16x32_bf16 v[156:159], a[80:83], a[180:183], v[156:159]
    ds_read_b64_tr_b16 a[80:81], v126 offset:61440
    v_mfma_f32_16x16x32_bf16 v[160:163], a[84:87], a[176:179], v[160:163]
    ds_read_b64_tr_b16 a[82:83], v126 offset:62464
    v_mfma_f32_16x16x32_bf16 v[164:167], a[84:87], a[180:183], v[164:167]
    ds_read_b64_tr_b16 a[84:85], v127 offset:61440
    ds_read_b64_tr_b16 a[86:87], v127 offset:62464
    s_waitcnt lgkmcnt(4)
    v_mfma_f32_16x16x32_bf16 v[136:139], a[72:75], a[184:187], v[136:139]
    v_mfma_f32_16x16x32_bf16 v[140:143], a[72:75], a[188:191], v[140:143]
    ds_read_b64_tr_b16 a[72:73], v128 offset:0
    v_mfma_f32_16x16x32_bf16 v[144:147], a[76:79], a[184:187], v[144:147]
    ds_read_b64_tr_b16 a[74:75], v128 offset:1024
    v_mfma_f32_16x16x32_bf16 v[148:151], a[76:79], a[188:191], v[148:151]
    ds_read_b64_tr_b16 a[76:77], v129 offset:0
    s_waitcnt lgkmcnt(3)
    v_mfma_f32_16x16x32_bf16 v[152:155], a[80:83], a[184:187], v[152:155]
    ds_read_b64_tr_b16 a[78:79], v129 offset:1024
    v_mfma_f32_16x16x32_bf16 v[156:159], a[80:83], a[188:191], v[156:159]
    ds_read_b64_tr_b16 a[80:81], v130 offset:0
    v_mfma_f32_16x16x32_bf16 v[160:163], a[84:87], a[184:187], v[160:163]
    ds_read_b64_tr_b16 a[82:83], v130 offset:1024
    v_mfma_f32_16x16x32_bf16 v[164:167], a[84:87], a[188:191], v[164:167]
    ds_read_b64_tr_b16 a[84:85], v131 offset:0
    ds_read_b64_tr_b16 a[86:87], v131 offset:1024
    s_waitcnt vmcnt(0)
    v_cmp_ne_u32 vcc, s94, v12
    s_nop 1
    s_cbranch_vccz parallel_sum__softmax_full_mha__dense_activation_silu__prompt_kernel_ok_ex
    s_mov_b32 s100, 0x40000
parallel_sum__softmax_full_mha__dense_activation_silu__prompt_kernel_poll_ex:
    buffer_load_dword v12, v107, s[32:35], s60 offen sc0 sc1
    s_sub_u32 s100, s100, 1
    s_cmp_eq_u32 s100, 0
    s_cbranch_scc1 parallel_sum__softmax_full_mha__dense_activation_silu__prompt_kernel_pollx_ex
    s_waitcnt vmcnt(0)
    v_cmp_ne_u32 vcc, s94, v12
    s_nop 1
    s_cbranch_vccnz parallel_sum__softmax_full_mha__dense_activation_silu__prompt_kernel_poll_ex
parallel_sum__softmax_full_mha__dense_activation_silu__prompt_kernel_pollx_ex:
parallel_sum__softmax_full_mha__dense_activation_silu__prompt_kernel_ok_ex:
    s_barrier
    s_waitcnt lgkmcnt(4)
    v_mfma_f32_16x16x32_bf16 v[136:139], a[72:75], a[0:3], v[136:139]
    buffer_load_dwordx4 v[168:171], v105, s[16:19], s37 offen offset:0 sc0 sc1
    v_mfma_f32_16x16x32_bf16 v[140:143], a[72:75], a[4:7], v[140:143]
    ds_read_b64_tr_b16 a[72:73], v128 offset:4096
    v_mfma_f32_16x16x32_bf16 v[144:147], a[76:79], a[0:3], v[144:147]
    ds_read_b64_tr_b16 a[74:75], v128 offset:5120
    v_mfma_f32_16x16x32_bf16 v[148:151], a[76:79], a[4:7], v[148:151]
    ds_read_b64_tr_b16 a[76:77], v129 offset:4096
    s_waitcnt lgkmcnt(3)
    v_mfma_f32_16x16x32_bf16 v[152:155], a[80:83], a[0:3], v[152:155]
    ds_read_b64_tr_b16 a[78:79], v129 offset:5120
    buffer_load_dwordx4 v[172:175], v105, s[16:19], s37 offen offset:1024 sc0 sc1
    v_mfma_f32_16x16x32_bf16 v[156:159], a[80:83], a[4:7], v[156:159]
    ds_read_b64_tr_b16 a[80:81], v130 offset:4096
    v_mfma_f32_16x16x32_bf16 v[160:163], a[84:87], a[0:3], v[160:163]
    ds_read_b64_tr_b16 a[82:83], v130 offset:5120
    v_mfma_f32_16x16x32_bf16 v[164:167], a[84:87], a[4:7], v[164:167]
    ds_read_b64_tr_b16 a[84:85], v131 offset:4096
    ds_read_b64_tr_b16 a[86:87], v131 offset:5120
    s_waitcnt lgkmcnt(4)
    v_mfma_f32_16x16x32_bf16 v[136:139], a[72:75], a[8:11], v[136:139]
    buffer_load_dwordx4 v[176:179], v105, s[16:19], s37 offen offset:2048 sc0 sc1
    v_mfma_f32_16x16x32_bf16 v[140:143], a[72:75], a[12:15], v[140:143]
    ds_read_b64_tr_b16 a[72:73], v128 offset:8192
    v_mfma_f32_16x16x32_bf16 v[144:147], a[76:79], a[8:11], v[144:147]
    ds_read_b64_tr_b16 a[74:75], v128 offset:9216
    v_mfma_f32_16x16x32_bf16 v[148:151], a[76:79], a[12:15], v[148:151]
    ds_read_b64_tr_b16 a[76:77], v129 offset:8192
    s_waitcnt lgkmcnt(3)
    v_mfma_f32_16x16x32_bf16 v[152:155], a[80:83], a[8:11], v[152:155]
    ds_read_b64_tr_b16 a[78:79], v129 offset:9216
    buffer_load_dwordx4 v[180:183], v105, s[16:19], s37 offen offset:3072 sc0 sc1
    v_mfma_f32_16x16x32_bf16 v[156:159], a[80:83], a[12:15], v[156:159]
    ds_read_b64_tr_b16 a[80:81], v130 offset:8192
    v_mfma_f32_16x16x32_bf16 v[160:163], a[84:87], a[8:11], v[160:163]
    ds_read_b64_tr_b16 a[82:83], v130 offset:9216
    v_mfma_f32_16x16x32_bf16 v[164:167], a[84:87], a[12:15], v[164:167]
    ds_read_b64_tr_b16 a[84:85], v131 offset:8192
    ds_read_b64_tr_b16 a[86:87], v131 offset:9216
    s_waitcnt lgkmcnt(4)
    v_mfma_f32_16x16x32_bf16 v[136:139], a[72:75], a[16:19], v[136:139]
    v_mfma_f32_16x16x32_bf16 v[140:143], a[72:75], a[20:23], v[140:143]
    ds_read_b64_tr_b16 a[72:73], v128 offset:12288
    v_mfma_f32_16x16x32_bf16 v[144:147], a[76:79], a[16:19], v[144:147]
    ds_read_b64_tr_b16 a[74:75], v128 offset:13312
    v_mfma_f32_16x16x32_bf16 v[148:151], a[76:79], a[20:23], v[148:151]
    ds_read_b64_tr_b16 a[76:77], v129 offset:12288
    s_waitcnt lgkmcnt(3)
    v_mfma_f32_16x16x32_bf16 v[152:155], a[80:83], a[16:19], v[152:155]
    ds_read_b64_tr_b16 a[78:79], v129 offset:13312
    v_mfma_f32_16x16x32_bf16 v[156:159], a[80:83], a[20:23], v[156:159]
    ds_read_b64_tr_b16 a[80:81], v130 offset:12288
    v_mfma_f32_16x16x32_bf16 v[160:163], a[84:87], a[16:19], v[160:163]
    ds_read_b64_tr_b16 a[82:83], v130 offset:13312
    v_mfma_f32_16x16x32_bf16 v[164:167], a[84:87], a[20:23], v[164:167]
    ds_read_b64_tr_b16 a[84:85], v131 offset:12288
    ds_read_b64_tr_b16 a[86:87], v131 offset:13312
    s_waitcnt lgkmcnt(4)
    v_mfma_f32_16x16x32_bf16 v[136:139], a[72:75], a[24:27], v[136:139]
    v_mfma_f32_16x16x32_bf16 v[140:143], a[72:75], a[28:31], v[140:143]
    ds_read_b64_tr_b16 a[72:73], v128 offset:16384
    v_mfma_f32_16x16x32_bf16 v[144:147], a[76:79], a[24:27], v[144:147]
    ds_read_b64_tr_b16 a[74:75], v128 offset:17408
    v_mfma_f32_16x16x32_bf16 v[148:151], a[76:79], a[28:31], v[148:151]
    ds_read_b64_tr_b16 a[76:77], v129 offset:16384
    s_waitcnt lgkmcnt(3)
    v_mfma_f32_16x16x32_bf16 v[152:155], a[80:83], a[24:27], v[152:155]
    ds_read_b64_tr_b16 a[78:79], v129 offset:17408
    v_mfma_f32_16x16x32_bf16 v[156:159], a[80:83], a[28:31], v[156:159]
    ds_read_b64_tr_b16 a[80:81], v130 offset:16384
    v_mfma_f32_16x16x32_bf16 v[160:163], a[84:87], a[24:27], v[160:163]
    ds_read_b64_tr_b16 a[82:83], v130 offset:17408
    v_mfma_f32_16x16x32_bf16 v[164:167], a[84:87], a[28:31], v[164:167]
    ds_read_b64_tr_b16 a[84:85], v131 offset:16384
    ds_read_b64_tr_b16 a[86:87], v131 offset:17408
    s_waitcnt lgkmcnt(4)
    v_mfma_f32_16x16x32_bf16 v[136:139], a[72:75], a[32:35], v[136:139]
    v_mfma_f32_16x16x32_bf16 v[140:143], a[72:75], a[36:39], v[140:143]
    ds_read_b64_tr_b16 a[72:73], v128 offset:20480
    v_mfma_f32_16x16x32_bf16 v[144:147], a[76:79], a[32:35], v[144:147]
    ds_read_b64_tr_b16 a[74:75], v128 offset:21504
    v_mfma_f32_16x16x32_bf16 v[148:151], a[76:79], a[36:39], v[148:151]
    ds_read_b64_tr_b16 a[76:77], v129 offset:20480
    s_waitcnt lgkmcnt(3)
    v_mfma_f32_16x16x32_bf16 v[152:155], a[80:83], a[32:35], v[152:155]
    ds_read_b64_tr_b16 a[78:79], v129 offset:21504
    v_mfma_f32_16x16x32_bf16 v[156:159], a[80:83], a[36:39], v[156:159]
    ds_read_b64_tr_b16 a[80:81], v130 offset:20480
    v_mfma_f32_16x16x32_bf16 v[160:163], a[84:87], a[32:35], v[160:163]
    ds_read_b64_tr_b16 a[82:83], v130 offset:21504
    v_mfma_f32_16x16x32_bf16 v[164:167], a[84:87], a[36:39], v[164:167]
    ds_read_b64_tr_b16 a[84:85], v131 offset:20480
    ds_read_b64_tr_b16 a[86:87], v131 offset:21504
    s_waitcnt lgkmcnt(4)
    v_mfma_f32_16x16x32_bf16 v[136:139], a[72:75], a[40:43], v[136:139]
    v_mfma_f32_16x16x32_bf16 v[140:143], a[72:75], a[44:47], v[140:143]
    ds_read_b64_tr_b16 a[72:73], v128 offset:24576
    v_mfma_f32_16x16x32_bf16 v[144:147], a[76:79], a[40:43], v[144:147]
    ds_read_b64_tr_b16 a[74:75], v128 offset:25600
    v_mfma_f32_16x16x32_bf16 v[148:151], a[76:79], a[44:47], v[148:151]
    ds_read_b64_tr_b16 a[76:77], v129 offset:24576
    s_waitcnt lgkmcnt(3)
    v_mfma_f32_16x16x32_bf16 v[152:155], a[80:83], a[40:43], v[152:155]
    ds_read_b64_tr_b16 a[78:79], v129 offset:25600
    v_mfma_f32_16x16x32_bf16 v[156:159], a[80:83], a[44:47], v[156:159]
    ds_read_b64_tr_b16 a[80:81], v130 offset:24576
    v_mfma_f32_16x16x32_bf16 v[160:163], a[84:87], a[40:43], v[160:163]
    ds_read_b64_tr_b16 a[82:83], v130 offset:25600
    v_mfma_f32_16x16x32_bf16 v[164:167], a[84:87], a[44:47], v[164:167]
    ds_read_b64_tr_b16 a[84:85], v131 offset:24576
    ds_read_b64_tr_b16 a[86:87], v131 offset:25600
    s_waitcnt lgkmcnt(4)
    v_mfma_f32_16x16x32_bf16 v[136:139], a[72:75], a[48:51], v[136:139]
    v_mfma_f32_16x16x32_bf16 v[140:143], a[72:75], a[52:55], v[140:143]
    ds_read_b64_tr_b16 a[72:73], v128 offset:28672
    v_mfma_f32_16x16x32_bf16 v[144:147], a[76:79], a[48:51], v[144:147]
    ds_read_b64_tr_b16 a[74:75], v128 offset:29696
    v_mfma_f32_16x16x32_bf16 v[148:151], a[76:79], a[52:55], v[148:151]
    ds_read_b64_tr_b16 a[76:77], v129 offset:28672
    s_waitcnt lgkmcnt(3)
    v_mfma_f32_16x16x32_bf16 v[152:155], a[80:83], a[48:51], v[152:155]
    ds_read_b64_tr_b16 a[78:79], v129 offset:29696
    v_mfma_f32_16x16x32_bf16 v[156:159], a[80:83], a[52:55], v[156:159]
    ds_read_b64_tr_b16 a[80:81], v130 offset:28672
    v_mfma_f32_16x16x32_bf16 v[160:163], a[84:87], a[48:51], v[160:163]
    ds_read_b64_tr_b16 a[82:83], v130 offset:29696
    v_mfma_f32_16x16x32_bf16 v[164:167], a[84:87], a[52:55], v[164:167]
    ds_read_b64_tr_b16 a[84:85], v131 offset:28672
    ds_read_b64_tr_b16 a[86:87], v131 offset:29696
    s_waitcnt lgkmcnt(4)
    v_mfma_f32_16x16x32_bf16 v[136:139], a[72:75], a[56:59], v[136:139]
    v_mfma_f32_16x16x32_bf16 v[140:143], a[72:75], a[60:63], v[140:143]
    v_mfma_f32_16x16x32_bf16 v[144:147], a[76:79], a[56:59], v[144:147]
    v_mfma_f32_16x16x32_bf16 v[148:151], a[76:79], a[60:63], v[148:151]
    s_waitcnt lgkmcnt(0)
    v_mfma_f32_16x16x32_bf16 v[152:155], a[80:83], a[56:59], v[152:155]
    v_mfma_f32_16x16x32_bf16 v[156:159], a[80:83], a[60:63], v[156:159]
    v_mfma_f32_16x16x32_bf16 v[160:163], a[84:87], a[56:59], v[160:163]
    v_mfma_f32_16x16x32_bf16 v[164:167], a[84:87], a[60:63], v[164:167]
    s_mov_b32 s30, 0xffff0000
    s_mov_b32 s68, s42
    s_mov_b32 s69, s43
    s_mov_b32 s70, 4194304
    s_mov_b32 s71, 0x00020000
    s_waitcnt vmcnt(0)
    s_nop 7
    v_lshlrev_b32 v12, 16, v168
    v_and_b32 v13, s30, v168
    v_add_f32 v136, v136, v12
    v_add_f32 v137, v137, v13
    v_lshlrev_b32 v12, 16, v169
    v_and_b32 v13, s30, v169
    v_add_f32 v138, v138, v12
    v_add_f32 v139, v139, v13
    v_lshlrev_b32 v12, 16, v170
    v_and_b32 v13, s30, v170
    v_add_f32 v140, v140, v12
    v_add_f32 v141, v141, v13
    v_lshlrev_b32 v12, 16, v171
    v_and_b32 v13, s30, v171
    v_add_f32 v142, v142, v12
    v_add_f32 v143, v143, v13
    v_lshlrev_b32 v12, 16, v172
    v_and_b32 v13, s30, v172
    v_add_f32 v144, v144, v12
    v_add_f32 v145, v145, v13
    v_lshlrev_b32 v12, 16, v173
    v_and_b32 v13, s30, v173
    v_add_f32 v146, v146, v12
    v_add_f32 v147, v147, v13
    v_lshlrev_b32 v12, 16, v174
    v_and_b32 v13, s30, v174
    v_add_f32 v148, v148, v12
    v_add_f32 v149, v149, v13
    v_lshlrev_b32 v12, 16, v175
    v_and_b32 v13, s30, v175
    v_add_f32 v150, v150, v12
    v_add_f32 v151, v151, v13
    v_lshlrev_b32 v12, 16, v176
    v_and_b32 v13, s30, v176
    v_add_f32 v152, v152, v12
    v_add_f32 v153, v153, v13
    v_lshlrev_b32 v12, 16, v177
    v_and_b32 v13, s30, v177
    v_add_f32 v154, v154, v12
    v_add_f32 v155, v155, v13
    v_lshlrev_b32 v12, 16, v178
    v_and_b32 v13, s30, v178
    v_add_f32 v156, v156, v12
    v_add_f32 v157, v157, v13
    v_lshlrev_b32 v12, 16, v179
    v_and_b32 v13, s30, v179
    v_add_f32 v158, v158, v12
    v_add_f32 v159, v159, v13
    v_lshlrev_b32 v12, 16, v180
    v_and_b32 v13, s30, v180
    v_add_f32 v160, v160, v12
    v_add_f32 v161, v161, v13
    v_lshlrev_b32 v12, 16, v181
    v_and_b32 v13, s30, v181
    v_add_f32 v162, v162, v12
    v_add_f32 v163, v163, v13
    v_lshlrev_b32 v12, 16, v182
    v_and_b32 v13, s30, v182
    v_add_f32 v164, v164, v12
    v_add_f32 v165, v165, v13
    v_lshlrev_b32 v12, 16, v183
    v_and_b32 v13, s30, v183
    v_add_f32 v166, v166, v12
    v_add_f32 v167, v167, v13
    v_permlane16_swap_b32 v136, v144
    v_permlane16_swap_b32 v137, v145
    v_permlane16_swap_b32 v138, v146
    v_permlane16_swap_b32 v139, v147
    v_permlane16_swap_b32 v152, v160
    v_permlane16_swap_b32 v153, v161
    v_permlane16_swap_b32 v154, v162
    v_permlane16_swap_b32 v155, v163
    v_permlane16_swap_b32 v140, v148
    v_permlane16_swap_b32 v141, v149
    v_permlane16_swap_b32 v142, v150
    v_permlane16_swap_b32 v143, v151
    v_permlane16_swap_b32 v156, v164
    v_permlane16_swap_b32 v157, v165
    v_permlane16_swap_b32 v158, v166
    v_permlane16_swap_b32 v159, v167
    v_lshlrev_b32 v12, 16, v200
    v_and_b32 v13, s30, v200
    v_add_f32 v12, v12, v136
    v_add_f32 v13, v13, v137
    v_cvt_pk_bf16_f32 v200, v12, v13
    v_lshlrev_b32 v12, 16, v201
    v_and_b32 v13, s30, v201
    v_add_f32 v12, v12, v138
    v_add_f32 v13, v13, v139
    v_cvt_pk_bf16_f32 v201, v12, v13
    v_lshlrev_b32 v12, 16, v202
    v_and_b32 v13, s30, v202
    v_add_f32 v12, v12, v144
    v_add_f32 v13, v13, v145
    v_cvt_pk_bf16_f32 v202, v12, v13
    v_lshlrev_b32 v12, 16, v203
    v_and_b32 v13, s30, v203
    v_add_f32 v12, v12, v146
    v_add_f32 v13, v13, v147
    v_cvt_pk_bf16_f32 v203, v12, v13
    buffer_store_dwordx4 v[200:203], v1, s[68:71], 0 offen offset:0
    v_lshlrev_b32 v12, 16, v204
    v_and_b32 v13, s30, v204
    v_add_f32 v12, v12, v152
    v_add_f32 v13, v13, v153
    v_cvt_pk_bf16_f32 v204, v12, v13
    v_lshlrev_b32 v12, 16, v205
    v_and_b32 v13, s30, v205
    v_add_f32 v12, v12, v154
    v_add_f32 v13, v13, v155
    v_cvt_pk_bf16_f32 v205, v12, v13
    v_lshlrev_b32 v12, 16, v206
    v_and_b32 v13, s30, v206
    v_add_f32 v12, v12, v160
    v_add_f32 v13, v13, v161
    v_cvt_pk_bf16_f32 v206, v12, v13
    v_lshlrev_b32 v12, 16, v207
    v_and_b32 v13, s30, v207
    v_add_f32 v12, v12, v162
    v_add_f32 v13, v13, v163
    v_cvt_pk_bf16_f32 v207, v12, v13
    buffer_store_dwordx4 v[204:207], v1, s[68:71], 0 offen offset:64
    v_lshlrev_b32 v12, 16, v208
    v_and_b32 v13, s30, v208
    v_add_f32 v12, v12, v140
    v_add_f32 v13, v13, v141
    v_cvt_pk_bf16_f32 v208, v12, v13
    v_lshlrev_b32 v12, 16, v209
    v_and_b32 v13, s30, v209
    v_add_f32 v12, v12, v142
    v_add_f32 v13, v13, v143
    v_cvt_pk_bf16_f32 v209, v12, v13
    v_lshlrev_b32 v12, 16, v210
    v_and_b32 v13, s30, v210
    v_add_f32 v12, v12, v148
    v_add_f32 v13, v13, v149
    v_cvt_pk_bf16_f32 v210, v12, v13
    v_lshlrev_b32 v12, 16, v211
    v_and_b32 v13, s30, v211
    v_add_f32 v12, v12, v150
    v_add_f32 v13, v13, v151
    v_cvt_pk_bf16_f32 v211, v12, v13
    buffer_store_dwordx4 v[208:211], v1, s[68:71], s63 offen offset:0
    v_lshlrev_b32 v12, 16, v212
    v_and_b32 v13, s30, v212
    v_add_f32 v12, v12, v156
    v_add_f32 v13, v13, v157
    v_cvt_pk_bf16_f32 v212, v12, v13
    v_lshlrev_b32 v12, 16, v213
    v_and_b32 v13, s30, v213
    v_add_f32 v12, v12, v158
    v_add_f32 v13, v13, v159
    v_cvt_pk_bf16_f32 v213, v12, v13
    v_lshlrev_b32 v12, 16, v214
    v_and_b32 v13, s30, v214
    v_add_f32 v12, v12, v164
    v_add_f32 v13, v13, v165
    v_cvt_pk_bf16_f32 v214, v12, v13
    v_lshlrev_b32 v12, 16, v215
    v_and_b32 v13, s30, v215
    v_add_f32 v12, v12, v166
    v_add_f32 v13, v13, v167
    v_cvt_pk_bf16_f32 v215, v12, v13
    buffer_store_dwordx4 v[212:215], v1, s[68:71], s63 offen offset:64
    s_waitcnt vmcnt(0)
    s_waitcnt vmcnt(0)
parallel_sum__softmax_full_mha__dense_activation_silu__prompt_kernel_end:
    s_endpgm
parallel_sum__softmax_full_mha__dense_activation_silu__prompt_kernel_codeend:
.section .rodata,"a"
.p2align 6
.amdhsa_kernel parallel_sum__softmax_full_mha__dense_activation_silu__prompt_kernel
  .amdhsa_next_free_vgpr 512
  .amdhsa_next_free_sgpr 102
  .amdhsa_accum_offset 256
  .amdhsa_group_segment_fixed_size 0
  .amdhsa_kernarg_size 72
  .amdhsa_user_sgpr_count 2
  .amdhsa_user_sgpr_kernarg_segment_ptr 1
  .amdhsa_system_sgpr_workgroup_id_x 1
  .amdhsa_float_denorm_mode_32 3
.end_amdhsa_kernel
.text
```
